```python
import torch

def _softmax(x, axis=-1):
    return torch.softmax(x, dim=axis)

def _gelu(x):
    return torch.nn.functional.gelu(x, approximate='tanh')

def _silu(x):
    return torch.nn.functional.silu(x)

def _sigmoid(x):
    return torch.sigmoid(x)

def _layernorm(x, axis=-1, eps=1e-05):
    m = x.mean(dim=axis, keepdim=True)
    v = x.var(dim=axis, keepdim=True, unbiased=False)
    return (x - m) / torch.sqrt(v + eps)

def _scatter_add(tgt, idx, src, axis=0):
    return tgt.clone().index_add_(axis, idx, src)

def _segment_sum(src, seg, n):
    out = torch.zeros((n,) + src.shape[1:], dtype=src.dtype)
    return out.index_add_(0, seg, src)

def _pad(x, pw):
    flat = tuple((v for pair in reversed(pw) for v in pair))
    return torch.nn.functional.pad(x, flat)
kernel_name = 'adaLN_cond__ssm_conv_h3__glu_gated_reglu__prompt'

def setup_inputs():

    _w = lambda a: (lambda t: t.to(torch.bfloat16) if t.is_floating_point() else t)(torch.as_tensor(a))

    def _A_setup():
        B, S, D = (1, 2048, 576)
        ks = 4
        return {'q': _w((lambda *s: torch.randn(*s, dtype=torch.bfloat16) * 0.05)(B, S, D)), 'k': _w((lambda *s: torch.randn(*s, dtype=torch.bfloat16) * 0.8)(B, S, D)), 'v': _w((lambda *s: torch.randn(*s, dtype=torch.bfloat16) * 0.8)(B, S, D)), 'shift_k': _w((lambda *s: torch.randn(*s, dtype=torch.bfloat16) * 0.8)(D, ks) * 0.5), 'ssm_k': _w((lambda *s: torch.randn(*s, dtype=torch.bfloat16) * 0.8)(D, S) * (1.0 / S ** 0.5)), 'ssm_D': _w((lambda *s: torch.randn(*s, dtype=torch.bfloat16) * 0.8)(D))}
    _A_in = _A_setup()

    def _B_setup():
        B, S, D, F = (1, 2048, 576, 4608)
        return {'x': _w((lambda *s: torch.randn(*s, dtype=torch.bfloat16) * 0.05)(B, S, D)), 'W_gate': _w((lambda *s: torch.randn(*s, dtype=torch.bfloat16) * 0.8)(D, F) * (2.0 / D) ** 0.5), 'W_up': _w((lambda *s: torch.randn(*s, dtype=torch.bfloat16) * 0.8)(D, F) * (2.0 / D) ** 0.5), 'W_down': _w((lambda *s: torch.randn(*s, dtype=torch.bfloat16) * 0.8)(F, D) * (1.0 / F) ** 0.5)}
    _B_in = _B_setup()
    return {'A_q': _A_in['q'], 'A_k': _A_in['k'], 'A_v': _A_in['v'], 'A_shift_k': _A_in['shift_k'], 'A_ssm_k': _A_in['ssm_k'], 'A_ssm_D': _A_in['ssm_D'], 'B_x': _B_in['x'], 'B_W_gate': _B_in['W_gate'], 'B_W_up': _B_in['W_up'], 'B_W_down': _B_in['W_down'], 'c': _w((lambda *s: torch.randn(*s, dtype=torch.bfloat16) * 0.2)(1, 576) * 8.0), 'w_mod': _w((lambda *s: torch.randn(*s, dtype=torch.bfloat16) * 0.2)(576, 6 * 576) * 576 ** (-0.5) * 8.0)}

def reference(A_q, A_k, A_v, A_shift_k, A_ssm_k, A_ssm_D, B_x, B_W_gate, B_W_up, B_W_down, c, w_mod):

    def _A_ref(q, k, v, shift_k, ssm_k, ssm_D):
        B, S, D = q.shape
        ks = shift_k.shape[-1]
        k_pad = _pad(k, ((0, 0), (ks - 1, 0), (0, 0)))
        k_shift = torch.zeros_like(k)
        for t in range(ks):
            k_shift = k_shift + k_pad[:, t:t + S, :] * shift_k[:, ks - 1 - t][None, None, :]
        kv = k_shift * v
        L = 2 * S
        kv_pad = _pad(kv, ((0, 0), (0, S), (0, 0)))
        kf_pad = _pad(ssm_k, ((0, 0), (0, S)))
        kv_f = (lambda x, axes=(-2, -1): torch.fft.rfft2(x.float(), dim=axes))(kv_pad[:, None, :, :], axes=(1, 2))
        kf_f = (lambda x, axes=(-2, -1): torch.fft.rfft2(x.float(), dim=axes))(kf_pad[:, None, :], axes=(1, 2))
        kf_f = (lambda x, *d: x.permute(*d))(kf_f, 1, 2, 0)
        y_f = kv_f * kf_f[None, :, :, :]
        y = (lambda x, s, axes=(-2, -1): torch.fft.irfft2(x, s=s, dim=axes).to(torch.bfloat16))(y_f, (1, L), axes=(1, 2))[:, 0, :S, :]
        y = y + kv * ssm_D[None, None, :]
        return q * y

    def _B_ref(x, W_gate, W_up, W_down):
        gate = torch.einsum('bsd,df->bsf', x, W_gate)
        up = torch.einsum('bsd,df->bsf', x, W_up)
        gate = gate * (lambda x, dt: x.to(dt))(gate > 0, gate.dtype)
        h = gate * up
        return torch.einsum('bsf,fd->bsd', h, W_down)
    x = A_q
    mod = (_silu(c) @ w_mod).reshape(c.shape[0], 6, 1, -1)
    sa, ca, ga, sb, cb, gb = (mod[:, 0].clone(), mod[:, 1].clone(), mod[:, 2].clone(), mod[:, 3].clone(), mod[:, 4].clone(), mod[:, 5].clone())
    h = _layernorm(x, axis=-1) * (1 + ca) + sa
    x = x + ga * _A_ref(h, A_k, A_v, A_shift_k, A_ssm_k, A_ssm_D)
    h = _layernorm(x, axis=-1) * (1 + cb) + sb
    x = x + gb * _B_ref(h, B_W_gate, B_W_up, B_W_down)
    return x
```

```asm
; @launch kernel=k1_kernel grid=(252,1,1) block=(512,1,1) lds=103680
; @launch kernel=k34_kernel grid=(256,1,1) block=(512,1,1) lds=155712
.amdgcn_target "amdgcn-amd-amdhsa--gfx950"
.text
.globl k1_kernel
.p2align 8
.type k1_kernel,@function
k1_kernel:
    s_cmp_ge_u32 s2, 252
    s_cbranch_scc1 K1_END
    s_cmp_ge_u32 s2, 144
    s_cbranch_scc1 K1_MOD
    s_load_dwordx4 s[4:7], s[0:1], 8
    s_load_dwordx4 s[8:11], s[0:1], 24
    s_load_dwordx2 s[12:13], s[0:1], 40
    s_load_dwordx2 s[14:15], s[0:1], 112
    s_and_b32 s3, s2, 7
    s_mul_i32 s3, s3, 18
    s_lshr_b32 s16, s2, 3
    s_add_u32 s3, s3, s16
    v_lshrrev_b32 v1, 6, v0
    v_and_b32 v2, 63, v0
    s_nop 0
    v_readfirstlane_b32 s17, v1
    s_waitcnt lgkmcnt(0)
    s_mov_b32 s20, s4
    s_mov_b32 s21, s5
    s_mov_b32 s22, 2359296
    s_mov_b32 s23, 0x00020000
    s_mov_b32 s24, s6
    s_mov_b32 s25, s7
    s_mov_b32 s26, 2359296
    s_mov_b32 s27, 0x00020000
    s_mov_b32 s28, s10
    s_mov_b32 s29, s11
    s_mov_b32 s30, 2359296
    s_mov_b32 s31, 0x00020000
    s_add_u32 s32, s14, 65536
    s_addc_u32 s33, s15, 0
    s_mov_b32 s34, 2359296
    s_mov_b32 s35, 0x00020000
    s_cmp_ge_u32 s17, 4
    s_cbranch_scc1 K1_LOADER
    s_lshl_b32 s16, s3, 3
    s_add_u32 s12, s12, s16
    s_addc_u32 s13, s13, 0
    s_load_dwordx2 s[44:45], s[12:13], 0
    s_lshl_b32 s46, s3, 2
    s_add_u32 s46, s46, s17
    s_lshl_b32 s46, s46, 12
    s_mul_i32 s47, s17, 24832
    v_lshlrev_b32 v11, 4, v2
    v_add_u32 v5, s46, v11
    s_add_u32 m0, s47, 64
    s_nop 0
    buffer_load_dwordx4 v5, s[28:31], 0 offen offset:0 lds
    buffer_load_dwordx4 v5, s[28:31], 0 offen offset:1024 lds
    buffer_load_dwordx4 v5, s[28:31], 0 offen offset:2048 lds
    buffer_load_dwordx4 v5, s[28:31], 0 offen offset:3072 lds
    v_mov_b32 v56, 0
    v_mov_b32 v57, 0
    v_mov_b32 v58, 0
    v_mov_b32 v59, 0
    v_add_u32 v11, s47, v11
    ds_write_b128 v11, v[56:59] offset:21760
    ds_write_b128 v11, v[56:59] offset:22784
    ds_write_b128 v11, v[56:59] offset:23808
    v_lshrrev_b32 v54, 2, v2
    v_mul_u32_u24 v54, 4160, v54
    v_and_b32 v55, 3, v2
    v_lshlrev_b32 v55, 4, v55
    v_add3_u32 v54, v54, v55, s47
    s_mov_b64 exec, 0xffff
    ds_write_b128 v54, v[56:59]
    s_mov_b64 exec, -1
    v_and_b32 v3, 15, v2
    v_lshrrev_b32 v4, 4, v2
    v_add_u32 v5, 1, v3
    v_and_b32 v5, 3, v5
    v_lshlrev_b32 v6, 3, v4
    v_sub_u32 v6, v3, v6
    v_sub_u32 v6, v6, v5
    v_add_u32 v6, 25, v6
    v_lshlrev_b32 v6, 1, v6
    v_mul_u32_u24 v7, 4160, v5
    v_add3_u32 v6, v6, v7, s47
    v_sub_u32 v7, 15, v3
    v_mul_u32_u24 v7, 160, v7
    v_lshlrev_b32 v8, 4, v4
    v_sub_u32 v7, v7, v8
    v_add_u32 v7, 16688, v7
    v_add_u32 v7, s47, v7
    v_sub_u32 v8, 15, v3
    v_mul_u32_u24 v8, 160, v8
    v_lshlrev_b32 v9, 3, v4
    v_sub_u32 v8, v8, v9
    v_add_u32 v8, 16664, v8
    v_add_u32 v8, s47, v8
    s_mov_b32 s66, 73728
    v_mul_lo_u32 v9, v3, s66
    v_lshlrev_b32 v10, 3, v4
    s_lshr_b32 s66, s46, 7
    v_add3_u32 v9, v9, v10, s66
    v_mov_b32 v16, 0
    v_mov_b32 v17, 0
    v_mov_b32 v18, 0
    v_mov_b32 v19, 0
    v_mov_b32 v20, 0
    v_mov_b32 v21, 0
    v_mov_b32 v22, 0
    v_mov_b32 v23, 0
    v_mov_b32 v24, 0
    v_mov_b32 v25, 0
    v_mov_b32 v26, 0
    v_mov_b32 v27, 0
    v_mov_b32 v28, 0
    v_mov_b32 v29, 0
    v_mov_b32 v30, 0
    v_mov_b32 v31, 0
    v_mov_b32 v32, 0
    v_mov_b32 v33, 0
    v_mov_b32 v34, 0
    v_mov_b32 v35, 0
    v_mov_b32 v36, 0
    v_mov_b32 v37, 0
    v_mov_b32 v38, 0
    v_mov_b32 v39, 0
    v_mov_b32 v40, 0
    v_mov_b32 v41, 0
    v_mov_b32 v42, 0
    v_mov_b32 v43, 0
    v_mov_b32 v44, 0
    v_mov_b32 v45, 0
    v_mov_b32 v46, 0
    v_mov_b32 v47, 0
    s_waitcnt lgkmcnt(0)
    s_cmp_lt_u32 s17, 2
    s_cselect_b32 s64, s44, s45
    s_and_b32 s65, s17, 1
    s_cmp_eq_u32 s65, 0
    s_cselect_b32 s65, 16, 0
    s_lshl_b32 s64, s64, s65
    s_and_b32 s64, s64, 0xffff0000
    s_waitcnt vmcnt(0)
    ds_read_b128 v[48:51], v11 offset:48
    ds_read_b64 v[52:53], v11 offset:64
    ds_read_b128 v[56:59], v11 offset:1072
    ds_read_b64 v[60:61], v11 offset:1088
    ds_read_b128 v[64:67], v11 offset:2096
    ds_read_b64 v[68:69], v11 offset:2112
    ds_read_b128 v[72:75], v11 offset:3120
    ds_read_b64 v[76:77], v11 offset:3136
    ds_read_b128 v[80:83], v11 offset:3136
    ds_read_b64 v[84:85], v11 offset:3152
    s_waitcnt lgkmcnt(8)
    v_alignbit_b32 v96, v49, v48, 16
    v_mov_b32 v100, v49
    v_alignbit_b32 v104, v50, v49, 16
    v_alignbit_b32 v97, v50, v49, 16
    v_mov_b32 v101, v50
    v_alignbit_b32 v105, v51, v50, 16
    v_alignbit_b32 v98, v51, v50, 16
    v_mov_b32 v102, v51
    v_alignbit_b32 v106, v52, v51, 16
    v_alignbit_b32 v99, v52, v51, 16
    v_mov_b32 v103, v52
    v_alignbit_b32 v107, v53, v52, 16
    ds_write_b128 v11, v[96:99] offset:4208
    ds_write_b128 v11, v[100:103] offset:8368
    ds_write_b128 v11, v[104:107] offset:12528
    s_waitcnt lgkmcnt(9)
    v_alignbit_b32 v108, v57, v56, 16
    v_mov_b32 v112, v57
    v_alignbit_b32 v116, v58, v57, 16
    v_alignbit_b32 v109, v58, v57, 16
    v_mov_b32 v113, v58
    v_alignbit_b32 v117, v59, v58, 16
    v_alignbit_b32 v110, v59, v58, 16
    v_mov_b32 v114, v59
    v_alignbit_b32 v118, v60, v59, 16
    v_alignbit_b32 v111, v60, v59, 16
    v_mov_b32 v115, v60
    v_alignbit_b32 v119, v61, v60, 16
    ds_write_b128 v11, v[108:111] offset:5232
    ds_write_b128 v11, v[112:115] offset:9392
    ds_write_b128 v11, v[116:119] offset:13552
    s_waitcnt lgkmcnt(10)
    v_alignbit_b32 v96, v65, v64, 16
    v_mov_b32 v100, v65
    v_alignbit_b32 v104, v66, v65, 16
    v_alignbit_b32 v97, v66, v65, 16
    v_mov_b32 v101, v66
    v_alignbit_b32 v105, v67, v66, 16
    v_alignbit_b32 v98, v67, v66, 16
    v_mov_b32 v102, v67
    v_alignbit_b32 v106, v68, v67, 16
    v_alignbit_b32 v99, v68, v67, 16
    v_mov_b32 v103, v68
    v_alignbit_b32 v107, v69, v68, 16
    ds_write_b128 v11, v[96:99] offset:6256
    ds_write_b128 v11, v[100:103] offset:10416
    ds_write_b128 v11, v[104:107] offset:14576
    s_waitcnt lgkmcnt(11)
    v_alignbit_b32 v108, v73, v72, 16
    v_mov_b32 v112, v73
    v_alignbit_b32 v116, v74, v73, 16
    v_alignbit_b32 v109, v74, v73, 16
    v_mov_b32 v113, v74
    v_alignbit_b32 v117, v75, v74, 16
    v_alignbit_b32 v110, v75, v74, 16
    v_mov_b32 v114, v75
    v_alignbit_b32 v118, v76, v75, 16
    v_alignbit_b32 v111, v76, v75, 16
    v_mov_b32 v115, v76
    v_alignbit_b32 v119, v77, v76, 16
    ds_write_b128 v11, v[108:111] offset:7280
    ds_write_b128 v11, v[112:115] offset:11440
    ds_write_b128 v11, v[116:119] offset:15600
    s_waitcnt lgkmcnt(12)
    v_alignbit_b32 v96, v81, v80, 16
    v_mov_b32 v100, v81
    v_alignbit_b32 v104, v82, v81, 16
    v_alignbit_b32 v97, v82, v81, 16
    v_mov_b32 v101, v82
    v_alignbit_b32 v105, v83, v82, 16
    v_alignbit_b32 v98, v83, v82, 16
    v_mov_b32 v102, v83
    v_alignbit_b32 v106, v84, v83, 16
    v_alignbit_b32 v99, v84, v83, 16
    v_mov_b32 v103, v84
    v_alignbit_b32 v107, v85, v84, 16
    ds_write_b128 v11, v[96:99] offset:7296
    ds_write_b128 v11, v[100:103] offset:11456
    ds_write_b128 v11, v[104:107] offset:15616
    s_waitcnt lgkmcnt(0)
    ds_read_b64 v[48:49], v6 offset:1472
    ds_read_b64 v[50:51], v6 offset:1480
    ds_read_b64 v[52:53], v6 offset:1504
    ds_read_b64 v[54:55], v6 offset:1512
    ds_read_b64 v[56:57], v6 offset:1536
    ds_read_b64 v[58:59], v6 offset:1544
    ds_read_b64 v[60:61], v6 offset:1568
    ds_read_b64 v[62:63], v6 offset:1576
    ds_read_b64 v[64:65], v6 offset:1600
    ds_read_b64 v[66:67], v6 offset:1608
    ds_read_b64 v[68:69], v6 offset:1632
    ds_read_b64 v[70:71], v6 offset:1640
    s_barrier
    ds_read_b128 v[96:99], v7 offset:4544
    ds_read_b128 v[100:103], v7 offset:4480
    ds_read_b128 v[104:107], v7 offset:4704
    ds_read_b128 v[108:111], v7 offset:4640
    s_waitcnt lgkmcnt(2)
    v_mfma_f32_16x16x32_bf16 v[16:19], v[48:51], v[100:103], v[16:19]
    ds_read_b64 v[72:73], v6 offset:1664
    v_mfma_f32_16x16x32_bf16 v[20:23], v[52:55], v[100:103], v[20:23]
    ds_read_b64 v[74:75], v6 offset:1672
    v_mfma_f32_16x16x32_bf16 v[24:27], v[56:59], v[100:103], v[24:27]
    ds_read_b64 v[76:77], v6 offset:1696
    v_mfma_f32_16x16x32_bf16 v[28:31], v[60:63], v[100:103], v[28:31]
    ds_read_b64 v[78:79], v6 offset:1704
    v_mfma_f32_16x16x32_bf16 v[16:19], v[56:59], v[96:99], v[16:19]
    ds_read_b64 v[80:81], v6 offset:1728
    v_mfma_f32_16x16x32_bf16 v[20:23], v[60:63], v[96:99], v[20:23]
    ds_read_b64 v[82:83], v6 offset:1736
    v_mfma_f32_16x16x32_bf16 v[24:27], v[64:67], v[96:99], v[24:27]
    ds_read_b64 v[84:85], v6 offset:1760
    v_mfma_f32_16x16x32_bf16 v[28:31], v[68:71], v[96:99], v[28:31]
    ds_read_b64 v[86:87], v6 offset:1768
    ds_read_b128 v[96:99], v7 offset:4864
    ds_read_b128 v[100:103], v7 offset:4800
    s_waitcnt lgkmcnt(10)
    s_waitcnt lgkmcnt(2)
    v_mfma_f32_16x16x32_bf16 v[16:19], v[64:67], v[108:111], v[16:19]
    ds_read_b64 v[88:89], v6 offset:1792
    v_mfma_f32_16x16x32_bf16 v[20:23], v[68:71], v[108:111], v[20:23]
    ds_read_b64 v[90:91], v6 offset:1800
    v_mfma_f32_16x16x32_bf16 v[24:27], v[72:75], v[108:111], v[24:27]
    ds_read_b64 v[92:93], v6 offset:1824
    v_mfma_f32_16x16x32_bf16 v[28:31], v[76:79], v[108:111], v[28:31]
    ds_read_b64 v[94:95], v6 offset:1832
    v_mfma_f32_16x16x32_bf16 v[16:19], v[72:75], v[104:107], v[16:19]
    ds_read_b64 v[48:49], v6 offset:1856
    v_mfma_f32_16x16x32_bf16 v[20:23], v[76:79], v[104:107], v[20:23]
    ds_read_b64 v[50:51], v6 offset:1864
    v_mfma_f32_16x16x32_bf16 v[24:27], v[80:83], v[104:107], v[24:27]
    ds_read_b64 v[52:53], v6 offset:1888
    v_mfma_f32_16x16x32_bf16 v[28:31], v[84:87], v[104:107], v[28:31]
    ds_read_b64 v[54:55], v6 offset:1896
    ds_read_b128 v[104:107], v7 offset:5024
    ds_read_b128 v[108:111], v7 offset:4960
    s_waitcnt lgkmcnt(10)
    s_waitcnt lgkmcnt(2)
    v_mfma_f32_16x16x32_bf16 v[16:19], v[80:83], v[100:103], v[16:19]
    ds_read_b64 v[56:57], v6 offset:1920
    v_mfma_f32_16x16x32_bf16 v[20:23], v[84:87], v[100:103], v[20:23]
    ds_read_b64 v[58:59], v6 offset:1928
    v_mfma_f32_16x16x32_bf16 v[24:27], v[88:91], v[100:103], v[24:27]
    ds_read_b64 v[60:61], v6 offset:1952
    v_mfma_f32_16x16x32_bf16 v[28:31], v[92:95], v[100:103], v[28:31]
    ds_read_b64 v[62:63], v6 offset:1960
    v_mfma_f32_16x16x32_bf16 v[16:19], v[88:91], v[96:99], v[16:19]
    ds_read_b64 v[64:65], v6 offset:1984
    v_mfma_f32_16x16x32_bf16 v[20:23], v[92:95], v[96:99], v[20:23]
    ds_read_b64 v[66:67], v6 offset:1992
    v_mfma_f32_16x16x32_bf16 v[24:27], v[48:51], v[96:99], v[24:27]
    ds_read_b64 v[68:69], v6 offset:2016
    v_mfma_f32_16x16x32_bf16 v[28:31], v[52:55], v[96:99], v[28:31]
    ds_read_b64 v[70:71], v6 offset:2024
    ds_read_b128 v[96:99], v7 offset:4544
    ds_read_b128 v[100:103], v7 offset:4480
    s_waitcnt lgkmcnt(10)
    s_waitcnt lgkmcnt(2)
    v_mfma_f32_16x16x32_bf16 v[16:19], v[48:51], v[108:111], v[16:19]
    ds_read_b64 v[72:73], v6 offset:3520
    ds_read_b64 v[74:75], v6 offset:3528
    v_mfma_f32_16x16x32_bf16 v[20:23], v[52:55], v[108:111], v[20:23]
    ds_read_b64 v[76:77], v6 offset:3552
    v_mfma_f32_16x16x32_bf16 v[24:27], v[56:59], v[108:111], v[24:27]
    ds_read_b64 v[78:79], v6 offset:3560
    ds_read_b64 v[80:81], v6 offset:3584
    v_mfma_f32_16x16x32_bf16 v[28:31], v[60:63], v[108:111], v[28:31]
    ds_read_b64 v[82:83], v6 offset:3592
    v_mfma_f32_16x16x32_bf16 v[16:19], v[56:59], v[104:107], v[16:19]
    ds_read_b64 v[84:85], v6 offset:3616
    ds_read_b64 v[86:87], v6 offset:3624
    v_mfma_f32_16x16x32_bf16 v[20:23], v[60:63], v[104:107], v[20:23]
    ds_read_b64 v[88:89], v6 offset:3648
    v_mfma_f32_16x16x32_bf16 v[24:27], v[64:67], v[104:107], v[24:27]
    ds_read_b64 v[90:91], v6 offset:3656
    ds_read_b64 v[92:93], v6 offset:3680
    v_mfma_f32_16x16x32_bf16 v[28:31], v[68:71], v[104:107], v[28:31]
    ds_read_b64 v[94:95], v6 offset:3688
    ds_read_b128 v[104:107], v7 offset:4704
    ds_read_b128 v[108:111], v7 offset:4640
    s_waitcnt lgkmcnt(14)
    s_waitcnt lgkmcnt(2)
    v_mfma_f32_16x16x32_bf16 v[32:35], v[72:75], v[100:103], v[32:35]
    ds_read_b64 v[48:49], v6 offset:3712
    v_mfma_f32_16x16x32_bf16 v[36:39], v[76:79], v[100:103], v[36:39]
    ds_read_b64 v[50:51], v6 offset:3720
    v_mfma_f32_16x16x32_bf16 v[40:43], v[80:83], v[100:103], v[40:43]
    ds_read_b64 v[52:53], v6 offset:3744
    v_mfma_f32_16x16x32_bf16 v[44:47], v[84:87], v[100:103], v[44:47]
    ds_read_b64 v[54:55], v6 offset:3752
    v_mfma_f32_16x16x32_bf16 v[32:35], v[80:83], v[96:99], v[32:35]
    ds_read_b64 v[56:57], v6 offset:3776
    v_mfma_f32_16x16x32_bf16 v[36:39], v[84:87], v[96:99], v[36:39]
    ds_read_b64 v[58:59], v6 offset:3784
    v_mfma_f32_16x16x32_bf16 v[40:43], v[88:91], v[96:99], v[40:43]
    ds_read_b64 v[60:61], v6 offset:3808
    v_mfma_f32_16x16x32_bf16 v[44:47], v[92:95], v[96:99], v[44:47]
    ds_read_b64 v[62:63], v6 offset:3816
    ds_read_b128 v[96:99], v7 offset:4864
    ds_read_b128 v[100:103], v7 offset:4800
    s_waitcnt lgkmcnt(10)
    s_waitcnt lgkmcnt(2)
    v_mfma_f32_16x16x32_bf16 v[32:35], v[88:91], v[108:111], v[32:35]
    ds_read_b64 v[64:65], v6 offset:3840
    v_mfma_f32_16x16x32_bf16 v[36:39], v[92:95], v[108:111], v[36:39]
    ds_read_b64 v[66:67], v6 offset:3848
    v_mfma_f32_16x16x32_bf16 v[40:43], v[48:51], v[108:111], v[40:43]
    ds_read_b64 v[68:69], v6 offset:3872
    v_mfma_f32_16x16x32_bf16 v[44:47], v[52:55], v[108:111], v[44:47]
    ds_read_b64 v[70:71], v6 offset:3880
    v_mfma_f32_16x16x32_bf16 v[32:35], v[48:51], v[104:107], v[32:35]
    ds_read_b64 v[72:73], v6 offset:3904
    v_mfma_f32_16x16x32_bf16 v[36:39], v[52:55], v[104:107], v[36:39]
    ds_read_b64 v[74:75], v6 offset:3912
    v_mfma_f32_16x16x32_bf16 v[40:43], v[56:59], v[104:107], v[40:43]
    ds_read_b64 v[76:77], v6 offset:3936
    v_mfma_f32_16x16x32_bf16 v[44:47], v[60:63], v[104:107], v[44:47]
    ds_read_b64 v[78:79], v6 offset:3944
    ds_read_b128 v[104:107], v7 offset:5024
    ds_read_b128 v[108:111], v7 offset:4960
    s_waitcnt lgkmcnt(10)
    s_waitcnt lgkmcnt(2)
    v_mfma_f32_16x16x32_bf16 v[32:35], v[56:59], v[100:103], v[32:35]
    ds_read_b64 v[80:81], v6 offset:3968
    v_mfma_f32_16x16x32_bf16 v[36:39], v[60:63], v[100:103], v[36:39]
    ds_read_b64 v[82:83], v6 offset:3976
    v_mfma_f32_16x16x32_bf16 v[40:43], v[64:67], v[100:103], v[40:43]
    ds_read_b64 v[84:85], v6 offset:4000
    v_mfma_f32_16x16x32_bf16 v[44:47], v[68:71], v[100:103], v[44:47]
    ds_read_b64 v[86:87], v6 offset:4008
    v_mfma_f32_16x16x32_bf16 v[32:35], v[64:67], v[96:99], v[32:35]
    ds_read_b64 v[88:89], v6 offset:4032
    v_mfma_f32_16x16x32_bf16 v[36:39], v[68:71], v[96:99], v[36:39]
    ds_read_b64 v[90:91], v6 offset:4040
    v_mfma_f32_16x16x32_bf16 v[40:43], v[72:75], v[96:99], v[40:43]
    ds_read_b64 v[92:93], v6 offset:4064
    v_mfma_f32_16x16x32_bf16 v[44:47], v[76:79], v[96:99], v[44:47]
    ds_read_b64 v[94:95], v6 offset:4072
    s_waitcnt lgkmcnt(8)
    s_waitcnt lgkmcnt(0)
    v_mfma_f32_16x16x32_bf16 v[32:35], v[72:75], v[108:111], v[32:35]
    v_mfma_f32_16x16x32_bf16 v[36:39], v[76:79], v[108:111], v[36:39]
    v_mfma_f32_16x16x32_bf16 v[40:43], v[80:83], v[108:111], v[40:43]
    v_mfma_f32_16x16x32_bf16 v[44:47], v[84:87], v[108:111], v[44:47]
    v_mfma_f32_16x16x32_bf16 v[32:35], v[80:83], v[104:107], v[32:35]
    v_mfma_f32_16x16x32_bf16 v[36:39], v[84:87], v[104:107], v[36:39]
    v_mfma_f32_16x16x32_bf16 v[40:43], v[88:91], v[104:107], v[40:43]
    v_mfma_f32_16x16x32_bf16 v[44:47], v[92:95], v[104:107], v[44:47]
    ds_read_b64 v[48:49], v6 offset:960
    ds_read_b64 v[50:51], v6 offset:968
    ds_read_b64 v[52:53], v6 offset:992
    ds_read_b64 v[54:55], v6 offset:1000
    ds_read_b64 v[56:57], v6 offset:1024
    ds_read_b64 v[58:59], v6 offset:1032
    ds_read_b64 v[60:61], v6 offset:1056
    ds_read_b64 v[62:63], v6 offset:1064
    ds_read_b64 v[64:65], v6 offset:1088
    ds_read_b64 v[66:67], v6 offset:1096
    ds_read_b64 v[68:69], v6 offset:1120
    ds_read_b64 v[70:71], v6 offset:1128
    s_barrier
    ds_read_b128 v[96:99], v7 offset:3904
    ds_read_b128 v[100:103], v7 offset:3840
    ds_read_b128 v[104:107], v7 offset:4064
    ds_read_b128 v[108:111], v7 offset:4000
    s_waitcnt lgkmcnt(2)
    v_mfma_f32_16x16x32_bf16 v[16:19], v[48:51], v[100:103], v[16:19]
    ds_read_b64 v[72:73], v6 offset:1152
    v_mfma_f32_16x16x32_bf16 v[20:23], v[52:55], v[100:103], v[20:23]
    ds_read_b64 v[74:75], v6 offset:1160
    v_mfma_f32_16x16x32_bf16 v[24:27], v[56:59], v[100:103], v[24:27]
    ds_read_b64 v[76:77], v6 offset:1184
    v_mfma_f32_16x16x32_bf16 v[28:31], v[60:63], v[100:103], v[28:31]
    ds_read_b64 v[78:79], v6 offset:1192
    v_mfma_f32_16x16x32_bf16 v[16:19], v[56:59], v[96:99], v[16:19]
    ds_read_b64 v[80:81], v6 offset:1216
    v_mfma_f32_16x16x32_bf16 v[20:23], v[60:63], v[96:99], v[20:23]
    ds_read_b64 v[82:83], v6 offset:1224
    v_mfma_f32_16x16x32_bf16 v[24:27], v[64:67], v[96:99], v[24:27]
    ds_read_b64 v[84:85], v6 offset:1248
    v_mfma_f32_16x16x32_bf16 v[28:31], v[68:71], v[96:99], v[28:31]
    ds_read_b64 v[86:87], v6 offset:1256
    ds_read_b128 v[96:99], v7 offset:4224
    ds_read_b128 v[100:103], v7 offset:4160
    s_waitcnt lgkmcnt(10)
    s_waitcnt lgkmcnt(2)
    v_mfma_f32_16x16x32_bf16 v[16:19], v[64:67], v[108:111], v[16:19]
    ds_read_b64 v[88:89], v6 offset:1280
    v_mfma_f32_16x16x32_bf16 v[20:23], v[68:71], v[108:111], v[20:23]
    ds_read_b64 v[90:91], v6 offset:1288
    v_mfma_f32_16x16x32_bf16 v[24:27], v[72:75], v[108:111], v[24:27]
    ds_read_b64 v[92:93], v6 offset:1312
    v_mfma_f32_16x16x32_bf16 v[28:31], v[76:79], v[108:111], v[28:31]
    ds_read_b64 v[94:95], v6 offset:1320
    v_mfma_f32_16x16x32_bf16 v[16:19], v[72:75], v[104:107], v[16:19]
    ds_read_b64 v[48:49], v6 offset:1344
    v_mfma_f32_16x16x32_bf16 v[20:23], v[76:79], v[104:107], v[20:23]
    ds_read_b64 v[50:51], v6 offset:1352
    v_mfma_f32_16x16x32_bf16 v[24:27], v[80:83], v[104:107], v[24:27]
    ds_read_b64 v[52:53], v6 offset:1376
    v_mfma_f32_16x16x32_bf16 v[28:31], v[84:87], v[104:107], v[28:31]
    ds_read_b64 v[54:55], v6 offset:1384
    ds_read_b128 v[104:107], v7 offset:4384
    ds_read_b128 v[108:111], v7 offset:4320
    s_waitcnt lgkmcnt(10)
    s_waitcnt lgkmcnt(2)
    v_mfma_f32_16x16x32_bf16 v[16:19], v[80:83], v[100:103], v[16:19]
    ds_read_b64 v[56:57], v6 offset:1408
    v_mfma_f32_16x16x32_bf16 v[20:23], v[84:87], v[100:103], v[20:23]
    ds_read_b64 v[58:59], v6 offset:1416
    v_mfma_f32_16x16x32_bf16 v[24:27], v[88:91], v[100:103], v[24:27]
    ds_read_b64 v[60:61], v6 offset:1440
    v_mfma_f32_16x16x32_bf16 v[28:31], v[92:95], v[100:103], v[28:31]
    ds_read_b64 v[62:63], v6 offset:1448
    v_mfma_f32_16x16x32_bf16 v[16:19], v[88:91], v[96:99], v[16:19]
    ds_read_b64 v[64:65], v6 offset:1472
    v_mfma_f32_16x16x32_bf16 v[20:23], v[92:95], v[96:99], v[20:23]
    ds_read_b64 v[66:67], v6 offset:1480
    v_mfma_f32_16x16x32_bf16 v[24:27], v[48:51], v[96:99], v[24:27]
    ds_read_b64 v[68:69], v6 offset:1504
    v_mfma_f32_16x16x32_bf16 v[28:31], v[52:55], v[96:99], v[28:31]
    ds_read_b64 v[70:71], v6 offset:1512
    ds_read_b128 v[96:99], v7 offset:3904
    ds_read_b128 v[100:103], v7 offset:3840
    s_waitcnt lgkmcnt(10)
    s_waitcnt lgkmcnt(2)
    v_mfma_f32_16x16x32_bf16 v[16:19], v[48:51], v[108:111], v[16:19]
    ds_read_b64 v[72:73], v6 offset:3008
    ds_read_b64 v[74:75], v6 offset:3016
    v_mfma_f32_16x16x32_bf16 v[20:23], v[52:55], v[108:111], v[20:23]
    ds_read_b64 v[76:77], v6 offset:3040
    v_mfma_f32_16x16x32_bf16 v[24:27], v[56:59], v[108:111], v[24:27]
    ds_read_b64 v[78:79], v6 offset:3048
    ds_read_b64 v[80:81], v6 offset:3072
    v_mfma_f32_16x16x32_bf16 v[28:31], v[60:63], v[108:111], v[28:31]
    ds_read_b64 v[82:83], v6 offset:3080
    v_mfma_f32_16x16x32_bf16 v[16:19], v[56:59], v[104:107], v[16:19]
    ds_read_b64 v[84:85], v6 offset:3104
    ds_read_b64 v[86:87], v6 offset:3112
    v_mfma_f32_16x16x32_bf16 v[20:23], v[60:63], v[104:107], v[20:23]
    ds_read_b64 v[88:89], v6 offset:3136
    v_mfma_f32_16x16x32_bf16 v[24:27], v[64:67], v[104:107], v[24:27]
    ds_read_b64 v[90:91], v6 offset:3144
    ds_read_b64 v[92:93], v6 offset:3168
    v_mfma_f32_16x16x32_bf16 v[28:31], v[68:71], v[104:107], v[28:31]
    ds_read_b64 v[94:95], v6 offset:3176
    ds_read_b128 v[104:107], v7 offset:4064
    ds_read_b128 v[108:111], v7 offset:4000
    s_waitcnt lgkmcnt(14)
    s_waitcnt lgkmcnt(2)
    v_mfma_f32_16x16x32_bf16 v[32:35], v[72:75], v[100:103], v[32:35]
    ds_read_b64 v[48:49], v6 offset:3200
    v_mfma_f32_16x16x32_bf16 v[36:39], v[76:79], v[100:103], v[36:39]
    ds_read_b64 v[50:51], v6 offset:3208
    v_mfma_f32_16x16x32_bf16 v[40:43], v[80:83], v[100:103], v[40:43]
    ds_read_b64 v[52:53], v6 offset:3232
    v_mfma_f32_16x16x32_bf16 v[44:47], v[84:87], v[100:103], v[44:47]
    ds_read_b64 v[54:55], v6 offset:3240
    v_mfma_f32_16x16x32_bf16 v[32:35], v[80:83], v[96:99], v[32:35]
    ds_read_b64 v[56:57], v6 offset:3264
    v_mfma_f32_16x16x32_bf16 v[36:39], v[84:87], v[96:99], v[36:39]
    ds_read_b64 v[58:59], v6 offset:3272
    v_mfma_f32_16x16x32_bf16 v[40:43], v[88:91], v[96:99], v[40:43]
    ds_read_b64 v[60:61], v6 offset:3296
    v_mfma_f32_16x16x32_bf16 v[44:47], v[92:95], v[96:99], v[44:47]
    ds_read_b64 v[62:63], v6 offset:3304
    ds_read_b128 v[96:99], v7 offset:4224
    ds_read_b128 v[100:103], v7 offset:4160
    s_waitcnt lgkmcnt(10)
    s_waitcnt lgkmcnt(2)
    v_mfma_f32_16x16x32_bf16 v[32:35], v[88:91], v[108:111], v[32:35]
    ds_read_b64 v[64:65], v6 offset:3328
    v_mfma_f32_16x16x32_bf16 v[36:39], v[92:95], v[108:111], v[36:39]
    ds_read_b64 v[66:67], v6 offset:3336
    v_mfma_f32_16x16x32_bf16 v[40:43], v[48:51], v[108:111], v[40:43]
    ds_read_b64 v[68:69], v6 offset:3360
    v_mfma_f32_16x16x32_bf16 v[44:47], v[52:55], v[108:111], v[44:47]
    ds_read_b64 v[70:71], v6 offset:3368
    v_mfma_f32_16x16x32_bf16 v[32:35], v[48:51], v[104:107], v[32:35]
    ds_read_b64 v[72:73], v6 offset:3392
    v_mfma_f32_16x16x32_bf16 v[36:39], v[52:55], v[104:107], v[36:39]
    ds_read_b64 v[74:75], v6 offset:3400
    v_mfma_f32_16x16x32_bf16 v[40:43], v[56:59], v[104:107], v[40:43]
    ds_read_b64 v[76:77], v6 offset:3424
    v_mfma_f32_16x16x32_bf16 v[44:47], v[60:63], v[104:107], v[44:47]
    ds_read_b64 v[78:79], v6 offset:3432
    ds_read_b128 v[104:107], v7 offset:4384
    ds_read_b128 v[108:111], v7 offset:4320
    s_waitcnt lgkmcnt(10)
    s_waitcnt lgkmcnt(2)
    v_mfma_f32_16x16x32_bf16 v[32:35], v[56:59], v[100:103], v[32:35]
    ds_read_b64 v[80:81], v6 offset:3456
    v_mfma_f32_16x16x32_bf16 v[36:39], v[60:63], v[100:103], v[36:39]
    ds_read_b64 v[82:83], v6 offset:3464
    v_mfma_f32_16x16x32_bf16 v[40:43], v[64:67], v[100:103], v[40:43]
    ds_read_b64 v[84:85], v6 offset:3488
    v_mfma_f32_16x16x32_bf16 v[44:47], v[68:71], v[100:103], v[44:47]
    ds_read_b64 v[86:87], v6 offset:3496
    v_mfma_f32_16x16x32_bf16 v[32:35], v[64:67], v[96:99], v[32:35]
    ds_read_b64 v[88:89], v6 offset:3520
    v_mfma_f32_16x16x32_bf16 v[36:39], v[68:71], v[96:99], v[36:39]
    ds_read_b64 v[90:91], v6 offset:3528
    v_mfma_f32_16x16x32_bf16 v[40:43], v[72:75], v[96:99], v[40:43]
    ds_read_b64 v[92:93], v6 offset:3552
    v_mfma_f32_16x16x32_bf16 v[44:47], v[76:79], v[96:99], v[44:47]
    ds_read_b64 v[94:95], v6 offset:3560
    s_waitcnt lgkmcnt(8)
    s_waitcnt lgkmcnt(0)
    v_mfma_f32_16x16x32_bf16 v[32:35], v[72:75], v[108:111], v[32:35]
    v_mfma_f32_16x16x32_bf16 v[36:39], v[76:79], v[108:111], v[36:39]
    v_mfma_f32_16x16x32_bf16 v[40:43], v[80:83], v[108:111], v[40:43]
    v_mfma_f32_16x16x32_bf16 v[44:47], v[84:87], v[108:111], v[44:47]
    v_mfma_f32_16x16x32_bf16 v[32:35], v[80:83], v[104:107], v[32:35]
    v_mfma_f32_16x16x32_bf16 v[36:39], v[84:87], v[104:107], v[36:39]
    v_mfma_f32_16x16x32_bf16 v[40:43], v[88:91], v[104:107], v[40:43]
    v_mfma_f32_16x16x32_bf16 v[44:47], v[92:95], v[104:107], v[44:47]
    ds_read_b64 v[48:49], v6 offset:448
    ds_read_b64 v[50:51], v6 offset:456
    ds_read_b64 v[52:53], v6 offset:480
    ds_read_b64 v[54:55], v6 offset:488
    ds_read_b64 v[56:57], v6 offset:512
    ds_read_b64 v[58:59], v6 offset:520
    ds_read_b64 v[60:61], v6 offset:544
    ds_read_b64 v[62:63], v6 offset:552
    ds_read_b64 v[64:65], v6 offset:576
    ds_read_b64 v[66:67], v6 offset:584
    ds_read_b64 v[68:69], v6 offset:608
    ds_read_b64 v[70:71], v6 offset:616
    s_barrier
    ds_read_b128 v[96:99], v7 offset:3264
    ds_read_b128 v[100:103], v7 offset:3200
    ds_read_b128 v[104:107], v7 offset:3424
    ds_read_b128 v[108:111], v7 offset:3360
    s_waitcnt lgkmcnt(2)
    v_mfma_f32_16x16x32_bf16 v[16:19], v[48:51], v[100:103], v[16:19]
    ds_read_b64 v[72:73], v6 offset:640
    v_mfma_f32_16x16x32_bf16 v[20:23], v[52:55], v[100:103], v[20:23]
    ds_read_b64 v[74:75], v6 offset:648
    v_mfma_f32_16x16x32_bf16 v[24:27], v[56:59], v[100:103], v[24:27]
    ds_read_b64 v[76:77], v6 offset:672
    v_mfma_f32_16x16x32_bf16 v[28:31], v[60:63], v[100:103], v[28:31]
    ds_read_b64 v[78:79], v6 offset:680
    v_mfma_f32_16x16x32_bf16 v[16:19], v[56:59], v[96:99], v[16:19]
    ds_read_b64 v[80:81], v6 offset:704
    v_mfma_f32_16x16x32_bf16 v[20:23], v[60:63], v[96:99], v[20:23]
    ds_read_b64 v[82:83], v6 offset:712
    v_mfma_f32_16x16x32_bf16 v[24:27], v[64:67], v[96:99], v[24:27]
    ds_read_b64 v[84:85], v6 offset:736
    v_mfma_f32_16x16x32_bf16 v[28:31], v[68:71], v[96:99], v[28:31]
    ds_read_b64 v[86:87], v6 offset:744
    ds_read_b128 v[96:99], v7 offset:3584
    ds_read_b128 v[100:103], v7 offset:3520
    s_waitcnt lgkmcnt(10)
    s_waitcnt lgkmcnt(2)
    v_mfma_f32_16x16x32_bf16 v[16:19], v[64:67], v[108:111], v[16:19]
    ds_read_b64 v[88:89], v6 offset:768
    v_mfma_f32_16x16x32_bf16 v[20:23], v[68:71], v[108:111], v[20:23]
    ds_read_b64 v[90:91], v6 offset:776
    v_mfma_f32_16x16x32_bf16 v[24:27], v[72:75], v[108:111], v[24:27]
    ds_read_b64 v[92:93], v6 offset:800
    v_mfma_f32_16x16x32_bf16 v[28:31], v[76:79], v[108:111], v[28:31]
    ds_read_b64 v[94:95], v6 offset:808
    v_mfma_f32_16x16x32_bf16 v[16:19], v[72:75], v[104:107], v[16:19]
    ds_read_b64 v[48:49], v6 offset:832
    v_mfma_f32_16x16x32_bf16 v[20:23], v[76:79], v[104:107], v[20:23]
    ds_read_b64 v[50:51], v6 offset:840
    v_mfma_f32_16x16x32_bf16 v[24:27], v[80:83], v[104:107], v[24:27]
    ds_read_b64 v[52:53], v6 offset:864
    v_mfma_f32_16x16x32_bf16 v[28:31], v[84:87], v[104:107], v[28:31]
    ds_read_b64 v[54:55], v6 offset:872
    ds_read_b128 v[104:107], v7 offset:3744
    ds_read_b128 v[108:111], v7 offset:3680
    s_waitcnt lgkmcnt(10)
    s_waitcnt lgkmcnt(2)
    v_mfma_f32_16x16x32_bf16 v[16:19], v[80:83], v[100:103], v[16:19]
    ds_read_b64 v[56:57], v6 offset:896
    v_mfma_f32_16x16x32_bf16 v[20:23], v[84:87], v[100:103], v[20:23]
    ds_read_b64 v[58:59], v6 offset:904
    v_mfma_f32_16x16x32_bf16 v[24:27], v[88:91], v[100:103], v[24:27]
    ds_read_b64 v[60:61], v6 offset:928
    v_mfma_f32_16x16x32_bf16 v[28:31], v[92:95], v[100:103], v[28:31]
    ds_read_b64 v[62:63], v6 offset:936
    v_mfma_f32_16x16x32_bf16 v[16:19], v[88:91], v[96:99], v[16:19]
    ds_read_b64 v[64:65], v6 offset:960
    v_mfma_f32_16x16x32_bf16 v[20:23], v[92:95], v[96:99], v[20:23]
    ds_read_b64 v[66:67], v6 offset:968
    v_mfma_f32_16x16x32_bf16 v[24:27], v[48:51], v[96:99], v[24:27]
    ds_read_b64 v[68:69], v6 offset:992
    v_mfma_f32_16x16x32_bf16 v[28:31], v[52:55], v[96:99], v[28:31]
    ds_read_b64 v[70:71], v6 offset:1000
    ds_read_b128 v[96:99], v7 offset:3264
    ds_read_b128 v[100:103], v7 offset:3200
    s_waitcnt lgkmcnt(10)
    s_waitcnt lgkmcnt(2)
    v_mfma_f32_16x16x32_bf16 v[16:19], v[48:51], v[108:111], v[16:19]
    ds_read_b64 v[72:73], v6 offset:2496
    ds_read_b64 v[74:75], v6 offset:2504
    v_mfma_f32_16x16x32_bf16 v[20:23], v[52:55], v[108:111], v[20:23]
    ds_read_b64 v[76:77], v6 offset:2528
    v_mfma_f32_16x16x32_bf16 v[24:27], v[56:59], v[108:111], v[24:27]
    ds_read_b64 v[78:79], v6 offset:2536
    ds_read_b64 v[80:81], v6 offset:2560
    v_mfma_f32_16x16x32_bf16 v[28:31], v[60:63], v[108:111], v[28:31]
    ds_read_b64 v[82:83], v6 offset:2568
    v_mfma_f32_16x16x32_bf16 v[16:19], v[56:59], v[104:107], v[16:19]
    ds_read_b64 v[84:85], v6 offset:2592
    ds_read_b64 v[86:87], v6 offset:2600
    v_mfma_f32_16x16x32_bf16 v[20:23], v[60:63], v[104:107], v[20:23]
    ds_read_b64 v[88:89], v6 offset:2624
    v_mfma_f32_16x16x32_bf16 v[24:27], v[64:67], v[104:107], v[24:27]
    ds_read_b64 v[90:91], v6 offset:2632
    ds_read_b64 v[92:93], v6 offset:2656
    v_mfma_f32_16x16x32_bf16 v[28:31], v[68:71], v[104:107], v[28:31]
    ds_read_b64 v[94:95], v6 offset:2664
    ds_read_b128 v[104:107], v7 offset:3424
    ds_read_b128 v[108:111], v7 offset:3360
    s_waitcnt lgkmcnt(14)
    s_waitcnt lgkmcnt(2)
    v_mfma_f32_16x16x32_bf16 v[32:35], v[72:75], v[100:103], v[32:35]
    ds_read_b64 v[48:49], v6 offset:2688
    v_mfma_f32_16x16x32_bf16 v[36:39], v[76:79], v[100:103], v[36:39]
    ds_read_b64 v[50:51], v6 offset:2696
    v_mfma_f32_16x16x32_bf16 v[40:43], v[80:83], v[100:103], v[40:43]
    ds_read_b64 v[52:53], v6 offset:2720
    v_mfma_f32_16x16x32_bf16 v[44:47], v[84:87], v[100:103], v[44:47]
    ds_read_b64 v[54:55], v6 offset:2728
    v_mfma_f32_16x16x32_bf16 v[32:35], v[80:83], v[96:99], v[32:35]
    ds_read_b64 v[56:57], v6 offset:2752
    v_mfma_f32_16x16x32_bf16 v[36:39], v[84:87], v[96:99], v[36:39]
    ds_read_b64 v[58:59], v6 offset:2760
    v_mfma_f32_16x16x32_bf16 v[40:43], v[88:91], v[96:99], v[40:43]
    ds_read_b64 v[60:61], v6 offset:2784
    v_mfma_f32_16x16x32_bf16 v[44:47], v[92:95], v[96:99], v[44:47]
    ds_read_b64 v[62:63], v6 offset:2792
    ds_read_b128 v[96:99], v7 offset:3584
    ds_read_b128 v[100:103], v7 offset:3520
    s_waitcnt lgkmcnt(10)
    s_waitcnt lgkmcnt(2)
    v_mfma_f32_16x16x32_bf16 v[32:35], v[88:91], v[108:111], v[32:35]
    ds_read_b64 v[64:65], v6 offset:2816
    v_mfma_f32_16x16x32_bf16 v[36:39], v[92:95], v[108:111], v[36:39]
    ds_read_b64 v[66:67], v6 offset:2824
    v_mfma_f32_16x16x32_bf16 v[40:43], v[48:51], v[108:111], v[40:43]
    ds_read_b64 v[68:69], v6 offset:2848
    v_mfma_f32_16x16x32_bf16 v[44:47], v[52:55], v[108:111], v[44:47]
    ds_read_b64 v[70:71], v6 offset:2856
    v_mfma_f32_16x16x32_bf16 v[32:35], v[48:51], v[104:107], v[32:35]
    ds_read_b64 v[72:73], v6 offset:2880
    v_mfma_f32_16x16x32_bf16 v[36:39], v[52:55], v[104:107], v[36:39]
    ds_read_b64 v[74:75], v6 offset:2888
    v_mfma_f32_16x16x32_bf16 v[40:43], v[56:59], v[104:107], v[40:43]
    ds_read_b64 v[76:77], v6 offset:2912
    v_mfma_f32_16x16x32_bf16 v[44:47], v[60:63], v[104:107], v[44:47]
    ds_read_b64 v[78:79], v6 offset:2920
    ds_read_b128 v[104:107], v7 offset:3744
    ds_read_b128 v[108:111], v7 offset:3680
    s_waitcnt lgkmcnt(10)
    s_waitcnt lgkmcnt(2)
    v_mfma_f32_16x16x32_bf16 v[32:35], v[56:59], v[100:103], v[32:35]
    ds_read_b64 v[80:81], v6 offset:2944
    v_mfma_f32_16x16x32_bf16 v[36:39], v[60:63], v[100:103], v[36:39]
    ds_read_b64 v[82:83], v6 offset:2952
    v_mfma_f32_16x16x32_bf16 v[40:43], v[64:67], v[100:103], v[40:43]
    ds_read_b64 v[84:85], v6 offset:2976
    v_mfma_f32_16x16x32_bf16 v[44:47], v[68:71], v[100:103], v[44:47]
    ds_read_b64 v[86:87], v6 offset:2984
    v_mfma_f32_16x16x32_bf16 v[32:35], v[64:67], v[96:99], v[32:35]
    ds_read_b64 v[88:89], v6 offset:3008
    v_mfma_f32_16x16x32_bf16 v[36:39], v[68:71], v[96:99], v[36:39]
    ds_read_b64 v[90:91], v6 offset:3016
    v_mfma_f32_16x16x32_bf16 v[40:43], v[72:75], v[96:99], v[40:43]
    ds_read_b64 v[92:93], v6 offset:3040
    v_mfma_f32_16x16x32_bf16 v[44:47], v[76:79], v[96:99], v[44:47]
    ds_read_b64 v[94:95], v6 offset:3048
    s_waitcnt lgkmcnt(8)
    s_waitcnt lgkmcnt(0)
    v_mfma_f32_16x16x32_bf16 v[32:35], v[72:75], v[108:111], v[32:35]
    v_mfma_f32_16x16x32_bf16 v[36:39], v[76:79], v[108:111], v[36:39]
    v_mfma_f32_16x16x32_bf16 v[40:43], v[80:83], v[108:111], v[40:43]
    v_mfma_f32_16x16x32_bf16 v[44:47], v[84:87], v[108:111], v[44:47]
    v_mfma_f32_16x16x32_bf16 v[32:35], v[80:83], v[104:107], v[32:35]
    v_mfma_f32_16x16x32_bf16 v[36:39], v[84:87], v[104:107], v[36:39]
    v_mfma_f32_16x16x32_bf16 v[40:43], v[88:91], v[104:107], v[40:43]
    v_mfma_f32_16x16x32_bf16 v[44:47], v[92:95], v[104:107], v[44:47]
    ds_read_b64 v[48:49], v6 offset:0
    ds_read_b64 v[50:51], v6 offset:8
    ds_read_b64 v[52:53], v6 offset:32
    ds_read_b64 v[54:55], v6 offset:40
    ds_read_b64 v[56:57], v6 offset:64
    ds_read_b64 v[58:59], v6 offset:72
    ds_read_b64 v[60:61], v6 offset:96
    ds_read_b64 v[62:63], v6 offset:104
    s_barrier
    ds_read_b128 v[96:99], v7 offset:2624
    ds_read_b128 v[100:103], v7 offset:2560
    ds_read_b128 v[104:107], v7 offset:2784
    ds_read_b128 v[108:111], v7 offset:2720
    s_waitcnt lgkmcnt(2)
    v_mfma_f32_16x16x32_bf16 v[24:27], v[48:51], v[100:103], v[24:27]
    ds_read_b64 v[64:65], v6 offset:128
    ds_read_b64 v[66:67], v6 offset:136
    v_mfma_f32_16x16x32_bf16 v[28:31], v[52:55], v[100:103], v[28:31]
    ds_read_b64 v[68:69], v6 offset:160
    v_mfma_f32_16x16x32_bf16 v[16:19], v[48:51], v[96:99], v[16:19]
    ds_read_b64 v[70:71], v6 offset:168
    v_mfma_f32_16x16x32_bf16 v[20:23], v[52:55], v[96:99], v[20:23]
    ds_read_b64 v[72:73], v6 offset:192
    ds_read_b64 v[74:75], v6 offset:200
    v_mfma_f32_16x16x32_bf16 v[24:27], v[56:59], v[96:99], v[24:27]
    ds_read_b64 v[76:77], v6 offset:224
    v_mfma_f32_16x16x32_bf16 v[28:31], v[60:63], v[96:99], v[28:31]
    ds_read_b64 v[78:79], v6 offset:232
    ds_read_b128 v[96:99], v7 offset:2944
    ds_read_b128 v[100:103], v7 offset:2880
    s_waitcnt lgkmcnt(10)
    s_waitcnt lgkmcnt(2)
    v_mfma_f32_16x16x32_bf16 v[16:19], v[56:59], v[108:111], v[16:19]
    ds_read_b64 v[80:81], v6 offset:256
    v_mfma_f32_16x16x32_bf16 v[20:23], v[60:63], v[108:111], v[20:23]
    ds_read_b64 v[82:83], v6 offset:264
    v_mfma_f32_16x16x32_bf16 v[24:27], v[64:67], v[108:111], v[24:27]
    ds_read_b64 v[84:85], v6 offset:288
    v_mfma_f32_16x16x32_bf16 v[28:31], v[68:71], v[108:111], v[28:31]
    ds_read_b64 v[86:87], v6 offset:296
    v_mfma_f32_16x16x32_bf16 v[16:19], v[64:67], v[104:107], v[16:19]
    ds_read_b64 v[88:89], v6 offset:320
    v_mfma_f32_16x16x32_bf16 v[20:23], v[68:71], v[104:107], v[20:23]
    ds_read_b64 v[90:91], v6 offset:328
    v_mfma_f32_16x16x32_bf16 v[24:27], v[72:75], v[104:107], v[24:27]
    ds_read_b64 v[92:93], v6 offset:352
    v_mfma_f32_16x16x32_bf16 v[28:31], v[76:79], v[104:107], v[28:31]
    ds_read_b64 v[94:95], v6 offset:360
    ds_read_b128 v[104:107], v7 offset:3104
    ds_read_b128 v[108:111], v7 offset:3040
    s_waitcnt lgkmcnt(10)
    s_waitcnt lgkmcnt(2)
    v_mfma_f32_16x16x32_bf16 v[16:19], v[72:75], v[100:103], v[16:19]
    ds_read_b64 v[48:49], v6 offset:384
    v_mfma_f32_16x16x32_bf16 v[20:23], v[76:79], v[100:103], v[20:23]
    ds_read_b64 v[50:51], v6 offset:392
    v_mfma_f32_16x16x32_bf16 v[24:27], v[80:83], v[100:103], v[24:27]
    ds_read_b64 v[52:53], v6 offset:416
    v_mfma_f32_16x16x32_bf16 v[28:31], v[84:87], v[100:103], v[28:31]
    ds_read_b64 v[54:55], v6 offset:424
    v_mfma_f32_16x16x32_bf16 v[16:19], v[80:83], v[96:99], v[16:19]
    ds_read_b64 v[56:57], v6 offset:448
    v_mfma_f32_16x16x32_bf16 v[20:23], v[84:87], v[96:99], v[20:23]
    ds_read_b64 v[58:59], v6 offset:456
    v_mfma_f32_16x16x32_bf16 v[24:27], v[88:91], v[96:99], v[24:27]
    ds_read_b64 v[60:61], v6 offset:480
    v_mfma_f32_16x16x32_bf16 v[28:31], v[92:95], v[96:99], v[28:31]
    ds_read_b64 v[62:63], v6 offset:488
    ds_read_b128 v[96:99], v7 offset:2624
    ds_read_b128 v[100:103], v7 offset:2560
    s_waitcnt lgkmcnt(10)
    s_waitcnt lgkmcnt(2)
    v_mfma_f32_16x16x32_bf16 v[16:19], v[88:91], v[108:111], v[16:19]
    ds_read_b64 v[64:65], v6 offset:1984
    ds_read_b64 v[66:67], v6 offset:1992
    v_mfma_f32_16x16x32_bf16 v[20:23], v[92:95], v[108:111], v[20:23]
    ds_read_b64 v[68:69], v6 offset:2016
    v_mfma_f32_16x16x32_bf16 v[24:27], v[48:51], v[108:111], v[24:27]
    ds_read_b64 v[70:71], v6 offset:2024
    ds_read_b64 v[72:73], v6 offset:2048
    v_mfma_f32_16x16x32_bf16 v[28:31], v[52:55], v[108:111], v[28:31]
    ds_read_b64 v[74:75], v6 offset:2056
    v_mfma_f32_16x16x32_bf16 v[16:19], v[48:51], v[104:107], v[16:19]
    ds_read_b64 v[76:77], v6 offset:2080
    ds_read_b64 v[78:79], v6 offset:2088
    v_mfma_f32_16x16x32_bf16 v[20:23], v[52:55], v[104:107], v[20:23]
    ds_read_b64 v[80:81], v6 offset:2112
    v_mfma_f32_16x16x32_bf16 v[24:27], v[56:59], v[104:107], v[24:27]
    ds_read_b64 v[82:83], v6 offset:2120
    ds_read_b64 v[84:85], v6 offset:2144
    v_mfma_f32_16x16x32_bf16 v[28:31], v[60:63], v[104:107], v[28:31]
    ds_read_b64 v[86:87], v6 offset:2152
    ds_read_b128 v[104:107], v7 offset:2784
    ds_read_b128 v[108:111], v7 offset:2720
    s_waitcnt lgkmcnt(14)
    s_waitcnt lgkmcnt(2)
    v_mfma_f32_16x16x32_bf16 v[32:35], v[64:67], v[100:103], v[32:35]
    ds_read_b64 v[88:89], v6 offset:2176
    v_mfma_f32_16x16x32_bf16 v[36:39], v[68:71], v[100:103], v[36:39]
    ds_read_b64 v[90:91], v6 offset:2184
    v_mfma_f32_16x16x32_bf16 v[40:43], v[72:75], v[100:103], v[40:43]
    ds_read_b64 v[92:93], v6 offset:2208
    v_mfma_f32_16x16x32_bf16 v[44:47], v[76:79], v[100:103], v[44:47]
    ds_read_b64 v[94:95], v6 offset:2216
    v_mfma_f32_16x16x32_bf16 v[32:35], v[72:75], v[96:99], v[32:35]
    ds_read_b64 v[48:49], v6 offset:2240
    v_mfma_f32_16x16x32_bf16 v[36:39], v[76:79], v[96:99], v[36:39]
    ds_read_b64 v[50:51], v6 offset:2248
    v_mfma_f32_16x16x32_bf16 v[40:43], v[80:83], v[96:99], v[40:43]
    ds_read_b64 v[52:53], v6 offset:2272
    v_mfma_f32_16x16x32_bf16 v[44:47], v[84:87], v[96:99], v[44:47]
    ds_read_b64 v[54:55], v6 offset:2280
    ds_read_b128 v[96:99], v7 offset:2944
    ds_read_b128 v[100:103], v7 offset:2880
    s_waitcnt lgkmcnt(10)
    s_waitcnt lgkmcnt(2)
    v_mfma_f32_16x16x32_bf16 v[32:35], v[80:83], v[108:111], v[32:35]
    ds_read_b64 v[56:57], v6 offset:2304
    v_mfma_f32_16x16x32_bf16 v[36:39], v[84:87], v[108:111], v[36:39]
    ds_read_b64 v[58:59], v6 offset:2312
    v_mfma_f32_16x16x32_bf16 v[40:43], v[88:91], v[108:111], v[40:43]
    ds_read_b64 v[60:61], v6 offset:2336
    v_mfma_f32_16x16x32_bf16 v[44:47], v[92:95], v[108:111], v[44:47]
    ds_read_b64 v[62:63], v6 offset:2344
    v_mfma_f32_16x16x32_bf16 v[32:35], v[88:91], v[104:107], v[32:35]
    ds_read_b64 v[64:65], v6 offset:2368
    v_mfma_f32_16x16x32_bf16 v[36:39], v[92:95], v[104:107], v[36:39]
    ds_read_b64 v[66:67], v6 offset:2376
    v_mfma_f32_16x16x32_bf16 v[40:43], v[48:51], v[104:107], v[40:43]
    ds_read_b64 v[68:69], v6 offset:2400
    v_mfma_f32_16x16x32_bf16 v[44:47], v[52:55], v[104:107], v[44:47]
    ds_read_b64 v[70:71], v6 offset:2408
    ds_read_b128 v[104:107], v7 offset:3104
    ds_read_b128 v[108:111], v7 offset:3040
    s_waitcnt lgkmcnt(10)
    s_waitcnt lgkmcnt(2)
    v_mfma_f32_16x16x32_bf16 v[32:35], v[48:51], v[100:103], v[32:35]
    ds_read_b64 v[72:73], v6 offset:2432
    v_mfma_f32_16x16x32_bf16 v[36:39], v[52:55], v[100:103], v[36:39]
    ds_read_b64 v[74:75], v6 offset:2440
    v_mfma_f32_16x16x32_bf16 v[40:43], v[56:59], v[100:103], v[40:43]
    ds_read_b64 v[76:77], v6 offset:2464
    v_mfma_f32_16x16x32_bf16 v[44:47], v[60:63], v[100:103], v[44:47]
    ds_read_b64 v[78:79], v6 offset:2472
    v_mfma_f32_16x16x32_bf16 v[32:35], v[56:59], v[96:99], v[32:35]
    ds_read_b64 v[80:81], v6 offset:2496
    v_mfma_f32_16x16x32_bf16 v[36:39], v[60:63], v[96:99], v[36:39]
    ds_read_b64 v[82:83], v6 offset:2504
    v_mfma_f32_16x16x32_bf16 v[40:43], v[64:67], v[96:99], v[40:43]
    ds_read_b64 v[84:85], v6 offset:2528
    v_mfma_f32_16x16x32_bf16 v[44:47], v[68:71], v[96:99], v[44:47]
    ds_read_b64 v[86:87], v6 offset:2536
    s_waitcnt lgkmcnt(8)
    s_waitcnt lgkmcnt(0)
    v_mfma_f32_16x16x32_bf16 v[32:35], v[64:67], v[108:111], v[32:35]
    v_mfma_f32_16x16x32_bf16 v[36:39], v[68:71], v[108:111], v[36:39]
    v_mfma_f32_16x16x32_bf16 v[40:43], v[72:75], v[108:111], v[40:43]
    v_mfma_f32_16x16x32_bf16 v[44:47], v[76:79], v[108:111], v[44:47]
    v_mfma_f32_16x16x32_bf16 v[32:35], v[72:75], v[104:107], v[32:35]
    v_mfma_f32_16x16x32_bf16 v[36:39], v[76:79], v[104:107], v[36:39]
    v_mfma_f32_16x16x32_bf16 v[40:43], v[80:83], v[104:107], v[40:43]
    v_mfma_f32_16x16x32_bf16 v[44:47], v[84:87], v[104:107], v[44:47]
    ds_read_b64 v[88:89], v6 offset:1472
    ds_read_b64 v[90:91], v6 offset:1480
    ds_read_b64 v[92:93], v6 offset:1504
    ds_read_b64 v[94:95], v6 offset:1512
    ds_read_b64 v[48:49], v6 offset:1536
    ds_read_b64 v[50:51], v6 offset:1544
    ds_read_b64 v[52:53], v6 offset:1568
    ds_read_b64 v[54:55], v6 offset:1576
    ds_read_b64 v[56:57], v6 offset:1600
    ds_read_b64 v[58:59], v6 offset:1608
    ds_read_b64 v[60:61], v6 offset:1632
    ds_read_b64 v[62:63], v6 offset:1640
    s_barrier
    ds_read_b128 v[96:99], v7 offset:1984
    ds_read_b128 v[100:103], v7 offset:1920
    ds_read_b128 v[104:107], v7 offset:2144
    ds_read_b128 v[108:111], v7 offset:2080
    s_waitcnt lgkmcnt(2)
    v_mfma_f32_16x16x32_bf16 v[32:35], v[88:91], v[100:103], v[32:35]
    ds_read_b64 v[64:65], v6 offset:1664
    v_mfma_f32_16x16x32_bf16 v[36:39], v[92:95], v[100:103], v[36:39]
    ds_read_b64 v[66:67], v6 offset:1672
    v_mfma_f32_16x16x32_bf16 v[40:43], v[48:51], v[100:103], v[40:43]
    ds_read_b64 v[68:69], v6 offset:1696
    v_mfma_f32_16x16x32_bf16 v[44:47], v[52:55], v[100:103], v[44:47]
    ds_read_b64 v[70:71], v6 offset:1704
    v_mfma_f32_16x16x32_bf16 v[32:35], v[48:51], v[96:99], v[32:35]
    ds_read_b64 v[72:73], v6 offset:1728
    v_mfma_f32_16x16x32_bf16 v[36:39], v[52:55], v[96:99], v[36:39]
    ds_read_b64 v[74:75], v6 offset:1736
    v_mfma_f32_16x16x32_bf16 v[40:43], v[56:59], v[96:99], v[40:43]
    ds_read_b64 v[76:77], v6 offset:1760
    v_mfma_f32_16x16x32_bf16 v[44:47], v[60:63], v[96:99], v[44:47]
    ds_read_b64 v[78:79], v6 offset:1768
    ds_read_b128 v[96:99], v7 offset:2304
    ds_read_b128 v[100:103], v7 offset:2240
    s_waitcnt lgkmcnt(10)
    s_waitcnt lgkmcnt(2)
    v_mfma_f32_16x16x32_bf16 v[32:35], v[56:59], v[108:111], v[32:35]
    ds_read_b64 v[80:81], v6 offset:1792
    v_mfma_f32_16x16x32_bf16 v[36:39], v[60:63], v[108:111], v[36:39]
    ds_read_b64 v[82:83], v6 offset:1800
    v_mfma_f32_16x16x32_bf16 v[40:43], v[64:67], v[108:111], v[40:43]
    ds_read_b64 v[84:85], v6 offset:1824
    v_mfma_f32_16x16x32_bf16 v[44:47], v[68:71], v[108:111], v[44:47]
    ds_read_b64 v[86:87], v6 offset:1832
    v_mfma_f32_16x16x32_bf16 v[32:35], v[64:67], v[104:107], v[32:35]
    ds_read_b64 v[88:89], v6 offset:1856
    v_mfma_f32_16x16x32_bf16 v[36:39], v[68:71], v[104:107], v[36:39]
    ds_read_b64 v[90:91], v6 offset:1864
    v_mfma_f32_16x16x32_bf16 v[40:43], v[72:75], v[104:107], v[40:43]
    ds_read_b64 v[92:93], v6 offset:1888
    v_mfma_f32_16x16x32_bf16 v[44:47], v[76:79], v[104:107], v[44:47]
    ds_read_b64 v[94:95], v6 offset:1896
    ds_read_b128 v[104:107], v7 offset:2464
    ds_read_b128 v[108:111], v7 offset:2400
    s_waitcnt lgkmcnt(10)
    s_waitcnt lgkmcnt(2)
    v_mfma_f32_16x16x32_bf16 v[32:35], v[72:75], v[100:103], v[32:35]
    ds_read_b64 v[48:49], v6 offset:1920
    v_mfma_f32_16x16x32_bf16 v[36:39], v[76:79], v[100:103], v[36:39]
    ds_read_b64 v[50:51], v6 offset:1928
    v_mfma_f32_16x16x32_bf16 v[40:43], v[80:83], v[100:103], v[40:43]
    ds_read_b64 v[52:53], v6 offset:1952
    v_mfma_f32_16x16x32_bf16 v[44:47], v[84:87], v[100:103], v[44:47]
    ds_read_b64 v[54:55], v6 offset:1960
    v_mfma_f32_16x16x32_bf16 v[32:35], v[80:83], v[96:99], v[32:35]
    ds_read_b64 v[56:57], v6 offset:1984
    v_mfma_f32_16x16x32_bf16 v[36:39], v[84:87], v[96:99], v[36:39]
    ds_read_b64 v[58:59], v6 offset:1992
    v_mfma_f32_16x16x32_bf16 v[40:43], v[88:91], v[96:99], v[40:43]
    ds_read_b64 v[60:61], v6 offset:2016
    v_mfma_f32_16x16x32_bf16 v[44:47], v[92:95], v[96:99], v[44:47]
    ds_read_b64 v[62:63], v6 offset:2024
    s_waitcnt lgkmcnt(8)
    s_waitcnt lgkmcnt(0)
    v_mfma_f32_16x16x32_bf16 v[32:35], v[88:91], v[108:111], v[32:35]
    v_mfma_f32_16x16x32_bf16 v[36:39], v[92:95], v[108:111], v[36:39]
    v_mfma_f32_16x16x32_bf16 v[40:43], v[48:51], v[108:111], v[40:43]
    v_mfma_f32_16x16x32_bf16 v[44:47], v[52:55], v[108:111], v[44:47]
    v_mfma_f32_16x16x32_bf16 v[32:35], v[48:51], v[104:107], v[32:35]
    v_mfma_f32_16x16x32_bf16 v[36:39], v[52:55], v[104:107], v[36:39]
    v_mfma_f32_16x16x32_bf16 v[40:43], v[56:59], v[104:107], v[40:43]
    v_mfma_f32_16x16x32_bf16 v[44:47], v[60:63], v[104:107], v[44:47]
    ds_read_b64 v[64:65], v6 offset:960
    ds_read_b64 v[66:67], v6 offset:968
    ds_read_b64 v[68:69], v6 offset:992
    ds_read_b64 v[70:71], v6 offset:1000
    ds_read_b64 v[72:73], v6 offset:1024
    ds_read_b64 v[74:75], v6 offset:1032
    ds_read_b64 v[76:77], v6 offset:1056
    ds_read_b64 v[78:79], v6 offset:1064
    ds_read_b64 v[80:81], v6 offset:1088
    ds_read_b64 v[82:83], v6 offset:1096
    ds_read_b64 v[84:85], v6 offset:1120
    ds_read_b64 v[86:87], v6 offset:1128
    s_barrier
    ds_read_b128 v[96:99], v7 offset:1344
    ds_read_b128 v[100:103], v7 offset:1280
    ds_read_b128 v[104:107], v7 offset:1504
    ds_read_b128 v[108:111], v7 offset:1440
    s_waitcnt lgkmcnt(2)
    v_mfma_f32_16x16x32_bf16 v[32:35], v[64:67], v[100:103], v[32:35]
    ds_read_b64 v[88:89], v6 offset:1152
    v_mfma_f32_16x16x32_bf16 v[36:39], v[68:71], v[100:103], v[36:39]
    ds_read_b64 v[90:91], v6 offset:1160
    v_mfma_f32_16x16x32_bf16 v[40:43], v[72:75], v[100:103], v[40:43]
    ds_read_b64 v[92:93], v6 offset:1184
    v_mfma_f32_16x16x32_bf16 v[44:47], v[76:79], v[100:103], v[44:47]
    ds_read_b64 v[94:95], v6 offset:1192
    v_mfma_f32_16x16x32_bf16 v[32:35], v[72:75], v[96:99], v[32:35]
    ds_read_b64 v[48:49], v6 offset:1216
    v_mfma_f32_16x16x32_bf16 v[36:39], v[76:79], v[96:99], v[36:39]
    ds_read_b64 v[50:51], v6 offset:1224
    v_mfma_f32_16x16x32_bf16 v[40:43], v[80:83], v[96:99], v[40:43]
    ds_read_b64 v[52:53], v6 offset:1248
    v_mfma_f32_16x16x32_bf16 v[44:47], v[84:87], v[96:99], v[44:47]
    ds_read_b64 v[54:55], v6 offset:1256
    ds_read_b128 v[96:99], v7 offset:1664
    ds_read_b128 v[100:103], v7 offset:1600
    s_waitcnt lgkmcnt(10)
    s_waitcnt lgkmcnt(2)
    v_mfma_f32_16x16x32_bf16 v[32:35], v[80:83], v[108:111], v[32:35]
    ds_read_b64 v[56:57], v6 offset:1280
    v_mfma_f32_16x16x32_bf16 v[36:39], v[84:87], v[108:111], v[36:39]
    ds_read_b64 v[58:59], v6 offset:1288
    v_mfma_f32_16x16x32_bf16 v[40:43], v[88:91], v[108:111], v[40:43]
    ds_read_b64 v[60:61], v6 offset:1312
    v_mfma_f32_16x16x32_bf16 v[44:47], v[92:95], v[108:111], v[44:47]
    ds_read_b64 v[62:63], v6 offset:1320
    v_mfma_f32_16x16x32_bf16 v[32:35], v[88:91], v[104:107], v[32:35]
    ds_read_b64 v[64:65], v6 offset:1344
    v_mfma_f32_16x16x32_bf16 v[36:39], v[92:95], v[104:107], v[36:39]
    ds_read_b64 v[66:67], v6 offset:1352
    v_mfma_f32_16x16x32_bf16 v[40:43], v[48:51], v[104:107], v[40:43]
    ds_read_b64 v[68:69], v6 offset:1376
    v_mfma_f32_16x16x32_bf16 v[44:47], v[52:55], v[104:107], v[44:47]
    ds_read_b64 v[70:71], v6 offset:1384
    ds_read_b128 v[104:107], v7 offset:1824
    ds_read_b128 v[108:111], v7 offset:1760
    s_waitcnt lgkmcnt(10)
    s_waitcnt lgkmcnt(2)
    v_mfma_f32_16x16x32_bf16 v[32:35], v[48:51], v[100:103], v[32:35]
    ds_read_b64 v[72:73], v6 offset:1408
    v_mfma_f32_16x16x32_bf16 v[36:39], v[52:55], v[100:103], v[36:39]
    ds_read_b64 v[74:75], v6 offset:1416
    v_mfma_f32_16x16x32_bf16 v[40:43], v[56:59], v[100:103], v[40:43]
    ds_read_b64 v[76:77], v6 offset:1440
    v_mfma_f32_16x16x32_bf16 v[44:47], v[60:63], v[100:103], v[44:47]
    ds_read_b64 v[78:79], v6 offset:1448
    v_mfma_f32_16x16x32_bf16 v[32:35], v[56:59], v[96:99], v[32:35]
    ds_read_b64 v[80:81], v6 offset:1472
    v_mfma_f32_16x16x32_bf16 v[36:39], v[60:63], v[96:99], v[36:39]
    ds_read_b64 v[82:83], v6 offset:1480
    v_mfma_f32_16x16x32_bf16 v[40:43], v[64:67], v[96:99], v[40:43]
    ds_read_b64 v[84:85], v6 offset:1504
    v_mfma_f32_16x16x32_bf16 v[44:47], v[68:71], v[96:99], v[44:47]
    ds_read_b64 v[86:87], v6 offset:1512
    s_waitcnt lgkmcnt(8)
    s_waitcnt lgkmcnt(0)
    v_mfma_f32_16x16x32_bf16 v[32:35], v[64:67], v[108:111], v[32:35]
    v_mfma_f32_16x16x32_bf16 v[36:39], v[68:71], v[108:111], v[36:39]
    v_mfma_f32_16x16x32_bf16 v[40:43], v[72:75], v[108:111], v[40:43]
    v_mfma_f32_16x16x32_bf16 v[44:47], v[76:79], v[108:111], v[44:47]
    v_mfma_f32_16x16x32_bf16 v[32:35], v[72:75], v[104:107], v[32:35]
    v_mfma_f32_16x16x32_bf16 v[36:39], v[76:79], v[104:107], v[36:39]
    v_mfma_f32_16x16x32_bf16 v[40:43], v[80:83], v[104:107], v[40:43]
    v_mfma_f32_16x16x32_bf16 v[44:47], v[84:87], v[104:107], v[44:47]
    ds_read_b64 v[88:89], v6 offset:448
    ds_read_b64 v[90:91], v6 offset:456
    ds_read_b64 v[92:93], v6 offset:480
    ds_read_b64 v[94:95], v6 offset:488
    ds_read_b64 v[48:49], v6 offset:512
    ds_read_b64 v[50:51], v6 offset:520
    ds_read_b64 v[52:53], v6 offset:544
    ds_read_b64 v[54:55], v6 offset:552
    ds_read_b64 v[56:57], v6 offset:576
    ds_read_b64 v[58:59], v6 offset:584
    ds_read_b64 v[60:61], v6 offset:608
    ds_read_b64 v[62:63], v6 offset:616
    s_barrier
    ds_read_b128 v[96:99], v7 offset:704
    ds_read_b128 v[100:103], v7 offset:640
    ds_read_b128 v[104:107], v7 offset:864
    ds_read_b128 v[108:111], v7 offset:800
    s_waitcnt lgkmcnt(2)
    v_mfma_f32_16x16x32_bf16 v[32:35], v[88:91], v[100:103], v[32:35]
    ds_read_b64 v[64:65], v6 offset:640
    v_mfma_f32_16x16x32_bf16 v[36:39], v[92:95], v[100:103], v[36:39]
    ds_read_b64 v[66:67], v6 offset:648
    v_mfma_f32_16x16x32_bf16 v[40:43], v[48:51], v[100:103], v[40:43]
    ds_read_b64 v[68:69], v6 offset:672
    v_mfma_f32_16x16x32_bf16 v[44:47], v[52:55], v[100:103], v[44:47]
    ds_read_b64 v[70:71], v6 offset:680
    v_mfma_f32_16x16x32_bf16 v[32:35], v[48:51], v[96:99], v[32:35]
    ds_read_b64 v[72:73], v6 offset:704
    v_mfma_f32_16x16x32_bf16 v[36:39], v[52:55], v[96:99], v[36:39]
    ds_read_b64 v[74:75], v6 offset:712
    v_mfma_f32_16x16x32_bf16 v[40:43], v[56:59], v[96:99], v[40:43]
    ds_read_b64 v[76:77], v6 offset:736
    v_mfma_f32_16x16x32_bf16 v[44:47], v[60:63], v[96:99], v[44:47]
    ds_read_b64 v[78:79], v6 offset:744
    ds_read_b128 v[96:99], v7 offset:1024
    ds_read_b128 v[100:103], v7 offset:960
    s_waitcnt lgkmcnt(10)
    s_waitcnt lgkmcnt(2)
    v_mfma_f32_16x16x32_bf16 v[32:35], v[56:59], v[108:111], v[32:35]
    ds_read_b64 v[80:81], v6 offset:768
    v_mfma_f32_16x16x32_bf16 v[36:39], v[60:63], v[108:111], v[36:39]
    ds_read_b64 v[82:83], v6 offset:776
    v_mfma_f32_16x16x32_bf16 v[40:43], v[64:67], v[108:111], v[40:43]
    ds_read_b64 v[84:85], v6 offset:800
    v_mfma_f32_16x16x32_bf16 v[44:47], v[68:71], v[108:111], v[44:47]
    ds_read_b64 v[86:87], v6 offset:808
    v_mfma_f32_16x16x32_bf16 v[32:35], v[64:67], v[104:107], v[32:35]
    ds_read_b64 v[88:89], v6 offset:832
    v_mfma_f32_16x16x32_bf16 v[36:39], v[68:71], v[104:107], v[36:39]
    ds_read_b64 v[90:91], v6 offset:840
    v_mfma_f32_16x16x32_bf16 v[40:43], v[72:75], v[104:107], v[40:43]
    ds_read_b64 v[92:93], v6 offset:864
    v_mfma_f32_16x16x32_bf16 v[44:47], v[76:79], v[104:107], v[44:47]
    ds_read_b64 v[94:95], v6 offset:872
    ds_read_b128 v[104:107], v7 offset:1184
    ds_read_b128 v[108:111], v7 offset:1120
    s_waitcnt lgkmcnt(10)
    s_waitcnt lgkmcnt(2)
    v_mfma_f32_16x16x32_bf16 v[32:35], v[72:75], v[100:103], v[32:35]
    ds_read_b64 v[48:49], v6 offset:896
    v_mfma_f32_16x16x32_bf16 v[36:39], v[76:79], v[100:103], v[36:39]
    ds_read_b64 v[50:51], v6 offset:904
    v_mfma_f32_16x16x32_bf16 v[40:43], v[80:83], v[100:103], v[40:43]
    ds_read_b64 v[52:53], v6 offset:928
    v_mfma_f32_16x16x32_bf16 v[44:47], v[84:87], v[100:103], v[44:47]
    ds_read_b64 v[54:55], v6 offset:936
    v_mfma_f32_16x16x32_bf16 v[32:35], v[80:83], v[96:99], v[32:35]
    ds_read_b64 v[56:57], v6 offset:960
    v_mfma_f32_16x16x32_bf16 v[36:39], v[84:87], v[96:99], v[36:39]
    ds_read_b64 v[58:59], v6 offset:968
    v_mfma_f32_16x16x32_bf16 v[40:43], v[88:91], v[96:99], v[40:43]
    ds_read_b64 v[60:61], v6 offset:992
    v_mfma_f32_16x16x32_bf16 v[44:47], v[92:95], v[96:99], v[44:47]
    ds_read_b64 v[62:63], v6 offset:1000
    s_waitcnt lgkmcnt(8)
    s_waitcnt lgkmcnt(0)
    v_mfma_f32_16x16x32_bf16 v[32:35], v[88:91], v[108:111], v[32:35]
    v_mfma_f32_16x16x32_bf16 v[36:39], v[92:95], v[108:111], v[36:39]
    v_mfma_f32_16x16x32_bf16 v[40:43], v[48:51], v[108:111], v[40:43]
    v_mfma_f32_16x16x32_bf16 v[44:47], v[52:55], v[108:111], v[44:47]
    v_mfma_f32_16x16x32_bf16 v[32:35], v[48:51], v[104:107], v[32:35]
    v_mfma_f32_16x16x32_bf16 v[36:39], v[52:55], v[104:107], v[36:39]
    v_mfma_f32_16x16x32_bf16 v[40:43], v[56:59], v[104:107], v[40:43]
    v_mfma_f32_16x16x32_bf16 v[44:47], v[60:63], v[104:107], v[44:47]
    ds_read_b64 v[64:65], v6 offset:0
    ds_read_b64 v[66:67], v6 offset:8
    ds_read_b64 v[68:69], v6 offset:32
    ds_read_b64 v[70:71], v6 offset:40
    ds_read_b64 v[72:73], v6 offset:64
    ds_read_b64 v[74:75], v6 offset:72
    ds_read_b64 v[76:77], v6 offset:96
    ds_read_b64 v[78:79], v6 offset:104
    s_barrier
    ds_read_b128 v[96:99], v7 offset:64
    ds_read_b128 v[100:103], v7 offset:0
    ds_read_b128 v[104:107], v7 offset:224
    ds_read_b128 v[108:111], v7 offset:160
    s_waitcnt lgkmcnt(2)
    v_mfma_f32_16x16x32_bf16 v[40:43], v[64:67], v[100:103], v[40:43]
    ds_read_b64 v[80:81], v6 offset:128
    ds_read_b64 v[82:83], v6 offset:136
    v_mfma_f32_16x16x32_bf16 v[44:47], v[68:71], v[100:103], v[44:47]
    ds_read_b64 v[84:85], v6 offset:160
    v_mfma_f32_16x16x32_bf16 v[32:35], v[64:67], v[96:99], v[32:35]
    ds_read_b64 v[86:87], v6 offset:168
    v_mfma_f32_16x16x32_bf16 v[36:39], v[68:71], v[96:99], v[36:39]
    ds_read_b64 v[88:89], v6 offset:192
    ds_read_b64 v[90:91], v6 offset:200
    v_mfma_f32_16x16x32_bf16 v[40:43], v[72:75], v[96:99], v[40:43]
    ds_read_b64 v[92:93], v6 offset:224
    v_mfma_f32_16x16x32_bf16 v[44:47], v[76:79], v[96:99], v[44:47]
    ds_read_b64 v[94:95], v6 offset:232
    ds_read_b128 v[96:99], v7 offset:384
    ds_read_b128 v[100:103], v7 offset:320
    s_waitcnt lgkmcnt(10)
    s_waitcnt lgkmcnt(2)
    v_mfma_f32_16x16x32_bf16 v[32:35], v[72:75], v[108:111], v[32:35]
    ds_read_b64 v[48:49], v6 offset:256
    v_mfma_f32_16x16x32_bf16 v[36:39], v[76:79], v[108:111], v[36:39]
    ds_read_b64 v[50:51], v6 offset:264
    v_mfma_f32_16x16x32_bf16 v[40:43], v[80:83], v[108:111], v[40:43]
    ds_read_b64 v[52:53], v6 offset:288
    v_mfma_f32_16x16x32_bf16 v[44:47], v[84:87], v[108:111], v[44:47]
    ds_read_b64 v[54:55], v6 offset:296
    v_mfma_f32_16x16x32_bf16 v[32:35], v[80:83], v[104:107], v[32:35]
    ds_read_b64 v[56:57], v6 offset:320
    v_mfma_f32_16x16x32_bf16 v[36:39], v[84:87], v[104:107], v[36:39]
    ds_read_b64 v[58:59], v6 offset:328
    v_mfma_f32_16x16x32_bf16 v[40:43], v[88:91], v[104:107], v[40:43]
    ds_read_b64 v[60:61], v6 offset:352
    v_mfma_f32_16x16x32_bf16 v[44:47], v[92:95], v[104:107], v[44:47]
    ds_read_b64 v[62:63], v6 offset:360
    ds_read_b128 v[104:107], v7 offset:544
    ds_read_b128 v[108:111], v7 offset:480
    s_waitcnt lgkmcnt(10)
    s_waitcnt lgkmcnt(2)
    v_mfma_f32_16x16x32_bf16 v[32:35], v[88:91], v[100:103], v[32:35]
    ds_read_b64 v[64:65], v6 offset:384
    v_mfma_f32_16x16x32_bf16 v[36:39], v[92:95], v[100:103], v[36:39]
    ds_read_b64 v[66:67], v6 offset:392
    v_mfma_f32_16x16x32_bf16 v[40:43], v[48:51], v[100:103], v[40:43]
    ds_read_b64 v[68:69], v6 offset:416
    v_mfma_f32_16x16x32_bf16 v[44:47], v[52:55], v[100:103], v[44:47]
    ds_read_b64 v[70:71], v6 offset:424
    v_mfma_f32_16x16x32_bf16 v[32:35], v[48:51], v[96:99], v[32:35]
    ds_read_b64 v[72:73], v6 offset:448
    v_mfma_f32_16x16x32_bf16 v[36:39], v[52:55], v[96:99], v[36:39]
    ds_read_b64 v[74:75], v6 offset:456
    v_mfma_f32_16x16x32_bf16 v[40:43], v[56:59], v[96:99], v[40:43]
    ds_read_b64 v[76:77], v6 offset:480
    v_mfma_f32_16x16x32_bf16 v[44:47], v[60:63], v[96:99], v[44:47]
    ds_read_b64 v[78:79], v6 offset:488
    s_waitcnt lgkmcnt(8)
    s_waitcnt lgkmcnt(0)
    v_mfma_f32_16x16x32_bf16 v[32:35], v[56:59], v[108:111], v[32:35]
    v_mfma_f32_16x16x32_bf16 v[36:39], v[60:63], v[108:111], v[36:39]
    v_mfma_f32_16x16x32_bf16 v[40:43], v[64:67], v[108:111], v[40:43]
    v_mfma_f32_16x16x32_bf16 v[44:47], v[68:71], v[108:111], v[44:47]
    v_mfma_f32_16x16x32_bf16 v[32:35], v[64:67], v[104:107], v[32:35]
    v_mfma_f32_16x16x32_bf16 v[36:39], v[68:71], v[104:107], v[36:39]
    v_mfma_f32_16x16x32_bf16 v[40:43], v[72:75], v[104:107], v[40:43]
    v_mfma_f32_16x16x32_bf16 v[44:47], v[76:79], v[104:107], v[44:47]
    ds_read_b64 v[48:49], v8 offset:2656
    ds_read_b64 v[50:51], v8 offset:2624
    ds_read_b64 v[52:53], v8 offset:2592
    ds_read_b64 v[54:55], v8 offset:2560
    ds_read_b64 v[56:57], v8 offset:96
    ds_read_b64 v[58:59], v8 offset:64
    ds_read_b64 v[60:61], v8 offset:32
    ds_read_b64 v[62:63], v8 offset:0
    s_nop 7
    s_waitcnt lgkmcnt(0)
    v_and_b32 v64, 0xffff0000, v49
    v_lshlrev_b32 v65, 16, v49
    v_and_b32 v66, 0xffff0000, v48
    v_lshlrev_b32 v67, 16, v48
    v_fmac_f32 v16, s64, v64
    v_fmac_f32 v17, s64, v65
    v_fmac_f32 v18, s64, v66
    v_fmac_f32 v19, s64, v67
    v_cvt_pk_bf16_f32 v48, v16, v17
    v_cvt_pk_bf16_f32 v49, v18, v19
    s_mov_b32 s66, 0
    buffer_store_dwordx2 v[48:49], v9, s[32:35], s66 offen
    v_and_b32 v64, 0xffff0000, v51
    v_lshlrev_b32 v65, 16, v51
    v_and_b32 v66, 0xffff0000, v50
    v_lshlrev_b32 v67, 16, v50
    v_fmac_f32 v20, s64, v64
    v_fmac_f32 v21, s64, v65
    v_fmac_f32 v22, s64, v66
    v_fmac_f32 v23, s64, v67
    v_cvt_pk_bf16_f32 v50, v20, v21
    v_cvt_pk_bf16_f32 v51, v22, v23
    s_mov_b32 s66, 18432
    buffer_store_dwordx2 v[50:51], v9, s[32:35], s66 offen
    v_and_b32 v64, 0xffff0000, v53
    v_lshlrev_b32 v65, 16, v53
    v_and_b32 v66, 0xffff0000, v52
    v_lshlrev_b32 v67, 16, v52
    v_fmac_f32 v24, s64, v64
    v_fmac_f32 v25, s64, v65
    v_fmac_f32 v26, s64, v66
    v_fmac_f32 v27, s64, v67
    v_cvt_pk_bf16_f32 v52, v24, v25
    v_cvt_pk_bf16_f32 v53, v26, v27
    s_mov_b32 s66, 36864
    buffer_store_dwordx2 v[52:53], v9, s[32:35], s66 offen
    v_and_b32 v64, 0xffff0000, v55
    v_lshlrev_b32 v65, 16, v55
    v_and_b32 v66, 0xffff0000, v54
    v_lshlrev_b32 v67, 16, v54
    v_fmac_f32 v28, s64, v64
    v_fmac_f32 v29, s64, v65
    v_fmac_f32 v30, s64, v66
    v_fmac_f32 v31, s64, v67
    v_cvt_pk_bf16_f32 v54, v28, v29
    v_cvt_pk_bf16_f32 v55, v30, v31
    s_mov_b32 s66, 55296
    buffer_store_dwordx2 v[54:55], v9, s[32:35], s66 offen
    v_and_b32 v64, 0xffff0000, v57
    v_lshlrev_b32 v65, 16, v57
    v_and_b32 v66, 0xffff0000, v56
    v_lshlrev_b32 v67, 16, v56
    v_fmac_f32 v32, s64, v64
    v_fmac_f32 v33, s64, v65
    v_fmac_f32 v34, s64, v66
    v_fmac_f32 v35, s64, v67
    v_cvt_pk_bf16_f32 v56, v32, v33
    v_cvt_pk_bf16_f32 v57, v34, v35
    s_mov_b32 s66, 1179648
    buffer_store_dwordx2 v[56:57], v9, s[32:35], s66 offen
    v_and_b32 v64, 0xffff0000, v59
    v_lshlrev_b32 v65, 16, v59
    v_and_b32 v66, 0xffff0000, v58
    v_lshlrev_b32 v67, 16, v58
    v_fmac_f32 v36, s64, v64
    v_fmac_f32 v37, s64, v65
    v_fmac_f32 v38, s64, v66
    v_fmac_f32 v39, s64, v67
    v_cvt_pk_bf16_f32 v58, v36, v37
    v_cvt_pk_bf16_f32 v59, v38, v39
    s_mov_b32 s66, 1198080
    buffer_store_dwordx2 v[58:59], v9, s[32:35], s66 offen
    v_and_b32 v64, 0xffff0000, v61
    v_lshlrev_b32 v65, 16, v61
    v_and_b32 v66, 0xffff0000, v60
    v_lshlrev_b32 v67, 16, v60
    v_fmac_f32 v40, s64, v64
    v_fmac_f32 v41, s64, v65
    v_fmac_f32 v42, s64, v66
    v_fmac_f32 v43, s64, v67
    v_cvt_pk_bf16_f32 v60, v40, v41
    v_cvt_pk_bf16_f32 v61, v42, v43
    s_mov_b32 s66, 1216512
    buffer_store_dwordx2 v[60:61], v9, s[32:35], s66 offen
    v_and_b32 v64, 0xffff0000, v63
    v_lshlrev_b32 v65, 16, v63
    v_and_b32 v66, 0xffff0000, v62
    v_lshlrev_b32 v67, 16, v62
    v_fmac_f32 v44, s64, v64
    v_fmac_f32 v45, s64, v65
    v_fmac_f32 v46, s64, v66
    v_fmac_f32 v47, s64, v67
    v_cvt_pk_bf16_f32 v62, v44, v45
    v_cvt_pk_bf16_f32 v63, v46, v47
    s_mov_b32 s66, 1234944
    buffer_store_dwordx2 v[62:63], v9, s[32:35], s66 offen
    s_endpgm
K1_LOADER:
    s_sub_u32 s17, s17, 4
    s_lshl_b32 s16, s3, 3
    s_mul_i32 s18, s17, 73728
    s_add_u32 s18, s18, s16
    s_add_u32 s42, s4, s18
    s_addc_u32 s43, s5, 0
    s_mov_b32 s48, 0
    s_mov_b32 s49, 0
    s_mov_b32 s50, 0
    s_mov_b32 s51, 0
    s_mov_b32 s52, 0
    s_mov_b32 s53, 0
    s_cmp_eq_u32 s17, 0
    s_cbranch_scc1 K1_NOHALO
    s_sub_u32 s44, s42, 3456
    s_subb_u32 s45, s43, 0
    s_load_dwordx2 s[48:49], s[44:45], 0
    s_load_dwordx2 s[50:51], s[44:45], 1152
    s_load_dwordx2 s[52:53], s[44:45], 2304
K1_NOHALO:
    s_mov_b32 s36, s8
    s_mov_b32 s37, s9
    s_mov_b32 s38, 4608
    s_mov_b32 s39, 0x00020000
    s_lshl_b32 s18, s17, 6
    v_add_u32 v8, s18, v2
    s_movk_i32 s18, 1152
    v_mul_lo_u32 v8, v8, s18
    v_add_u32 v8, s16, v8
    s_mov_b32 s40, 0
    buffer_load_dwordx2 v[96:97], v8, s[20:23], s40 offen
    buffer_load_dwordx2 v[98:99], v8, s[24:27], s40 offen
    v_and_b32 v3, 7, v2
    v_bfe_u32 v4, v2, 3, 2
    s_lshl_b32 s18, s3, 5
    v_lshl_add_u32 v5, v4, 3, s18
    buffer_load_dwordx2 v[6:7], v5, s[36:39], 0 offen
    s_add_u32 s44, s42, 291456
    s_addc_u32 s45, s43, 0
    s_load_dwordx2 s[54:55], s[44:45], 0
    s_load_dwordx2 s[56:57], s[44:45], 1152
    s_load_dwordx2 s[58:59], s[44:45], 2304
    s_add_u32 s44, s42, 586368
    s_addc_u32 s45, s43, 0
    s_load_dwordx2 s[60:61], s[44:45], 0
    s_load_dwordx2 s[62:63], s[44:45], 1152
    s_load_dwordx2 s[64:65], s[44:45], 2304
    s_add_u32 s44, s42, 881280
    s_addc_u32 s45, s43, 0
    s_load_dwordx2 s[66:67], s[44:45], 0
    s_load_dwordx2 s[68:69], s[44:45], 1152
    s_load_dwordx2 s[70:71], s[44:45], 2304
    s_add_u32 s44, s42, 1176192
    s_addc_u32 s45, s43, 0
    s_load_dwordx2 s[72:73], s[44:45], 0
    s_load_dwordx2 s[74:75], s[44:45], 1152
    s_load_dwordx2 s[76:77], s[44:45], 2304
    s_add_u32 s44, s42, 1471104
    s_addc_u32 s45, s43, 0
    s_load_dwordx2 s[78:79], s[44:45], 0
    s_load_dwordx2 s[80:81], s[44:45], 1152
    s_load_dwordx2 s[82:83], s[44:45], 2304
    s_add_u32 s44, s42, 1766016
    s_addc_u32 s45, s43, 0
    s_load_dwordx2 s[84:85], s[44:45], 0
    s_load_dwordx2 s[86:87], s[44:45], 1152
    s_load_dwordx2 s[88:89], s[44:45], 2304
    s_add_u32 s44, s42, 2060928
    s_addc_u32 s45, s43, 0
    s_load_dwordx2 s[90:91], s[44:45], 0
    s_load_dwordx2 s[92:93], s[44:45], 1152
    s_load_dwordx2 s[94:95], s[44:45], 2304
    s_mul_i32 s46, s17, 1088
    s_add_u32 s46, s46, 99328
    v_lshlrev_b32 v9, 2, v2
    v_add_u32 v9, s46, v9
    v_and_b32 v10, 1, v2
    v_mul_u32_u24 v10, 272, v10
    v_lshrrev_b32 v11, 1, v2
    v_lshl_add_u32 v10, v11, 2, v10
    v_add_u32 v10, 4, v10
    v_add_u32 v10, s46, v10
    v_lshrrev_b32 v11, 1, v4
    v_mul_u32_u24 v12, 272, v11
    v_lshl_add_u32 v12, v3, 5, v12
    v_add_u32 v12, s46, v12
    v_lshlrev_b32 v13, 8, v11
    v_lshl_add_u32 v13, v3, 5, v13
    v_add_u32 v13, s46, v13
    v_and_b32 v14, 1, v4
    v_mul_u32_u24 v14, 0x0202, v14
    v_lshlrev_b32 v14, 16, v14
    v_add_u32 v14, 0x01000c0c, v14
    s_sub_u32 s18, 3, s17
    s_mul_i32 s18, s18, 160
    s_add_u32 s18, s18, 16752
    s_mov_b32 s19, 24832
    v_mul_lo_u32 v60, v4, s19
    v_lshlrev_b32 v61, 4, v3
    v_sub_u32 v60, v60, v61
    v_add_u32 v60, s18, v60
    s_mov_b32 s40, 294912
    buffer_load_dwordx2 v[100:101], v8, s[20:23], s40 offen
    buffer_load_dwordx2 v[102:103], v8, s[24:27], s40 offen
    s_waitcnt vmcnt(2)
    v_lshlrev_b32 v56, 16, v6
    v_and_b32 v57, 0xffff0000, v6
    v_lshlrev_b32 v58, 16, v7
    v_and_b32 v59, 0xffff0000, v7
    s_waitcnt lgkmcnt(0)
    v_writelane_b32 v62, s48, 0
    v_writelane_b32 v62, s49, 1
    v_writelane_b32 v62, s50, 2
    v_writelane_b32 v62, s51, 3
    v_writelane_b32 v62, s52, 4
    v_writelane_b32 v62, s53, 5
    ds_write2_b32 v9, v96, v97 offset0:4 offset1:72
    ds_write2_b32 v9, v98, v99 offset0:136 offset1:200
    s_mov_b64 exec, 0x3f
    ds_write_b32 v10, v62
    s_mov_b64 exec, -1
    s_waitcnt lgkmcnt(0)
    ds_read_b128 v[32:35], v12 offset:0
    ds_read_b128 v[36:39], v12 offset:16
    ds_read_b128 v[40:43], v12 offset:32
    ds_read_b128 v[44:47], v13 offset:544
    ds_read_b128 v[48:51], v13 offset:560
    s_waitcnt lgkmcnt(2)
    v_perm_b32 v64, v33, v33, v14
    v_perm_b32 v65, v34, v34, v14
    v_perm_b32 v66, v35, v35, v14
    v_perm_b32 v67, v36, v36, v14
    v_perm_b32 v68, v37, v37, v14
    v_perm_b32 v69, v38, v38, v14
    v_perm_b32 v70, v39, v39, v14
    v_perm_b32 v71, v40, v40, v14
    v_perm_b32 v72, v41, v41, v14
    v_perm_b32 v73, v42, v42, v14
    v_perm_b32 v74, v43, v43, v14
    s_waitcnt lgkmcnt(0)
    v_perm_b32 v76, v44, v44, v14
    v_perm_b32 v77, v45, v45, v14
    v_perm_b32 v78, v46, v46, v14
    v_perm_b32 v79, v47, v47, v14
    v_perm_b32 v80, v48, v48, v14
    v_perm_b32 v81, v49, v49, v14
    v_perm_b32 v82, v50, v50, v14
    v_perm_b32 v83, v51, v51, v14
    v_mul_f32 v84, v59, v64
    v_fmac_f32 v84, v58, v65
    v_fmac_f32 v84, v57, v66
    v_fmac_f32 v84, v56, v67
    v_mul_f32 v84, v84, v76
    v_mul_f32 v85, v59, v65
    v_fmac_f32 v85, v58, v66
    v_fmac_f32 v85, v57, v67
    v_fmac_f32 v85, v56, v68
    v_mul_f32 v85, v85, v77
    v_mul_f32 v86, v59, v66
    v_fmac_f32 v86, v58, v67
    v_fmac_f32 v86, v57, v68
    v_fmac_f32 v86, v56, v69
    v_mul_f32 v86, v86, v78
    v_mul_f32 v87, v59, v67
    v_fmac_f32 v87, v58, v68
    v_fmac_f32 v87, v57, v69
    v_fmac_f32 v87, v56, v70
    v_mul_f32 v87, v87, v79
    v_mul_f32 v88, v59, v68
    v_fmac_f32 v88, v58, v69
    v_fmac_f32 v88, v57, v70
    v_fmac_f32 v88, v56, v71
    v_mul_f32 v88, v88, v80
    v_mul_f32 v89, v59, v69
    v_fmac_f32 v89, v58, v70
    v_fmac_f32 v89, v57, v71
    v_fmac_f32 v89, v56, v72
    v_mul_f32 v89, v89, v81
    v_mul_f32 v90, v59, v70
    v_fmac_f32 v90, v58, v71
    v_fmac_f32 v90, v57, v72
    v_fmac_f32 v90, v56, v73
    v_mul_f32 v90, v90, v82
    v_mul_f32 v91, v59, v71
    v_fmac_f32 v91, v58, v72
    v_fmac_f32 v91, v57, v73
    v_fmac_f32 v91, v56, v74
    v_mul_f32 v91, v91, v83
    v_cvt_pk_bf16_f32 v92, v91, v90
    v_cvt_pk_bf16_f32 v93, v89, v88
    v_cvt_pk_bf16_f32 v94, v87, v86
    v_cvt_pk_bf16_f32 v95, v85, v84
    ds_write_b128 v60, v[92:95] offset:4480
    s_waitcnt lgkmcnt(0)
    s_barrier
    s_mov_b32 s40, 589824
    buffer_load_dwordx2 v[104:105], v8, s[20:23], s40 offen
    buffer_load_dwordx2 v[106:107], v8, s[24:27], s40 offen
    v_writelane_b32 v62, s54, 0
    v_writelane_b32 v62, s55, 1
    v_writelane_b32 v62, s56, 2
    v_writelane_b32 v62, s57, 3
    v_writelane_b32 v62, s58, 4
    v_writelane_b32 v62, s59, 5
    s_waitcnt vmcnt(2)
    ds_write2_b32 v9, v100, v101 offset0:4 offset1:72
    ds_write2_b32 v9, v102, v103 offset0:136 offset1:200
    s_mov_b64 exec, 0x3f
    ds_write_b32 v10, v62
    s_mov_b64 exec, -1
    s_waitcnt lgkmcnt(0)
    ds_read_b128 v[32:35], v12 offset:0
    ds_read_b128 v[36:39], v12 offset:16
    ds_read_b128 v[40:43], v12 offset:32
    ds_read_b128 v[44:47], v13 offset:544
    ds_read_b128 v[48:51], v13 offset:560
    s_waitcnt lgkmcnt(2)
    v_perm_b32 v64, v33, v33, v14
    v_perm_b32 v65, v34, v34, v14
    v_perm_b32 v66, v35, v35, v14
    v_perm_b32 v67, v36, v36, v14
    v_perm_b32 v68, v37, v37, v14
    v_perm_b32 v69, v38, v38, v14
    v_perm_b32 v70, v39, v39, v14
    v_perm_b32 v71, v40, v40, v14
    v_perm_b32 v72, v41, v41, v14
    v_perm_b32 v73, v42, v42, v14
    v_perm_b32 v74, v43, v43, v14
    s_waitcnt lgkmcnt(0)
    v_perm_b32 v76, v44, v44, v14
    v_perm_b32 v77, v45, v45, v14
    v_perm_b32 v78, v46, v46, v14
    v_perm_b32 v79, v47, v47, v14
    v_perm_b32 v80, v48, v48, v14
    v_perm_b32 v81, v49, v49, v14
    v_perm_b32 v82, v50, v50, v14
    v_perm_b32 v83, v51, v51, v14
    v_mul_f32 v84, v59, v64
    v_fmac_f32 v84, v58, v65
    v_fmac_f32 v84, v57, v66
    v_fmac_f32 v84, v56, v67
    v_mul_f32 v84, v84, v76
    v_mul_f32 v85, v59, v65
    v_fmac_f32 v85, v58, v66
    v_fmac_f32 v85, v57, v67
    v_fmac_f32 v85, v56, v68
    v_mul_f32 v85, v85, v77
    v_mul_f32 v86, v59, v66
    v_fmac_f32 v86, v58, v67
    v_fmac_f32 v86, v57, v68
    v_fmac_f32 v86, v56, v69
    v_mul_f32 v86, v86, v78
    v_mul_f32 v87, v59, v67
    v_fmac_f32 v87, v58, v68
    v_fmac_f32 v87, v57, v69
    v_fmac_f32 v87, v56, v70
    v_mul_f32 v87, v87, v79
    v_mul_f32 v88, v59, v68
    v_fmac_f32 v88, v58, v69
    v_fmac_f32 v88, v57, v70
    v_fmac_f32 v88, v56, v71
    v_mul_f32 v88, v88, v80
    v_mul_f32 v89, v59, v69
    v_fmac_f32 v89, v58, v70
    v_fmac_f32 v89, v57, v71
    v_fmac_f32 v89, v56, v72
    v_mul_f32 v89, v89, v81
    v_mul_f32 v90, v59, v70
    v_fmac_f32 v90, v58, v71
    v_fmac_f32 v90, v57, v72
    v_fmac_f32 v90, v56, v73
    v_mul_f32 v90, v90, v82
    v_mul_f32 v91, v59, v71
    v_fmac_f32 v91, v58, v72
    v_fmac_f32 v91, v57, v73
    v_fmac_f32 v91, v56, v74
    v_mul_f32 v91, v91, v83
    v_cvt_pk_bf16_f32 v92, v91, v90
    v_cvt_pk_bf16_f32 v93, v89, v88
    v_cvt_pk_bf16_f32 v94, v87, v86
    v_cvt_pk_bf16_f32 v95, v85, v84
    ds_write_b128 v60, v[92:95] offset:3840
    s_waitcnt lgkmcnt(0)
    s_barrier
    s_mov_b32 s40, 884736
    buffer_load_dwordx2 v[108:109], v8, s[20:23], s40 offen
    buffer_load_dwordx2 v[110:111], v8, s[24:27], s40 offen
    v_writelane_b32 v62, s60, 0
    v_writelane_b32 v62, s61, 1
    v_writelane_b32 v62, s62, 2
    v_writelane_b32 v62, s63, 3
    v_writelane_b32 v62, s64, 4
    v_writelane_b32 v62, s65, 5
    s_waitcnt vmcnt(2)
    ds_write2_b32 v9, v104, v105 offset0:4 offset1:72
    ds_write2_b32 v9, v106, v107 offset0:136 offset1:200
    s_mov_b64 exec, 0x3f
    ds_write_b32 v10, v62
    s_mov_b64 exec, -1
    s_waitcnt lgkmcnt(0)
    ds_read_b128 v[32:35], v12 offset:0
    ds_read_b128 v[36:39], v12 offset:16
    ds_read_b128 v[40:43], v12 offset:32
    ds_read_b128 v[44:47], v13 offset:544
    ds_read_b128 v[48:51], v13 offset:560
    s_waitcnt lgkmcnt(2)
    v_perm_b32 v64, v33, v33, v14
    v_perm_b32 v65, v34, v34, v14
    v_perm_b32 v66, v35, v35, v14
    v_perm_b32 v67, v36, v36, v14
    v_perm_b32 v68, v37, v37, v14
    v_perm_b32 v69, v38, v38, v14
    v_perm_b32 v70, v39, v39, v14
    v_perm_b32 v71, v40, v40, v14
    v_perm_b32 v72, v41, v41, v14
    v_perm_b32 v73, v42, v42, v14
    v_perm_b32 v74, v43, v43, v14
    s_waitcnt lgkmcnt(0)
    v_perm_b32 v76, v44, v44, v14
    v_perm_b32 v77, v45, v45, v14
    v_perm_b32 v78, v46, v46, v14
    v_perm_b32 v79, v47, v47, v14
    v_perm_b32 v80, v48, v48, v14
    v_perm_b32 v81, v49, v49, v14
    v_perm_b32 v82, v50, v50, v14
    v_perm_b32 v83, v51, v51, v14
    v_mul_f32 v84, v59, v64
    v_fmac_f32 v84, v58, v65
    v_fmac_f32 v84, v57, v66
    v_fmac_f32 v84, v56, v67
    v_mul_f32 v84, v84, v76
    v_mul_f32 v85, v59, v65
    v_fmac_f32 v85, v58, v66
    v_fmac_f32 v85, v57, v67
    v_fmac_f32 v85, v56, v68
    v_mul_f32 v85, v85, v77
    v_mul_f32 v86, v59, v66
    v_fmac_f32 v86, v58, v67
    v_fmac_f32 v86, v57, v68
    v_fmac_f32 v86, v56, v69
    v_mul_f32 v86, v86, v78
    v_mul_f32 v87, v59, v67
    v_fmac_f32 v87, v58, v68
    v_fmac_f32 v87, v57, v69
    v_fmac_f32 v87, v56, v70
    v_mul_f32 v87, v87, v79
    v_mul_f32 v88, v59, v68
    v_fmac_f32 v88, v58, v69
    v_fmac_f32 v88, v57, v70
    v_fmac_f32 v88, v56, v71
    v_mul_f32 v88, v88, v80
    v_mul_f32 v89, v59, v69
    v_fmac_f32 v89, v58, v70
    v_fmac_f32 v89, v57, v71
    v_fmac_f32 v89, v56, v72
    v_mul_f32 v89, v89, v81
    v_mul_f32 v90, v59, v70
    v_fmac_f32 v90, v58, v71
    v_fmac_f32 v90, v57, v72
    v_fmac_f32 v90, v56, v73
    v_mul_f32 v90, v90, v82
    v_mul_f32 v91, v59, v71
    v_fmac_f32 v91, v58, v72
    v_fmac_f32 v91, v57, v73
    v_fmac_f32 v91, v56, v74
    v_mul_f32 v91, v91, v83
    v_cvt_pk_bf16_f32 v92, v91, v90
    v_cvt_pk_bf16_f32 v93, v89, v88
    v_cvt_pk_bf16_f32 v94, v87, v86
    v_cvt_pk_bf16_f32 v95, v85, v84
    ds_write_b128 v60, v[92:95] offset:3200
    s_waitcnt lgkmcnt(0)
    s_barrier
    s_mov_b32 s40, 1179648
    buffer_load_dwordx2 v[112:113], v8, s[20:23], s40 offen
    buffer_load_dwordx2 v[114:115], v8, s[24:27], s40 offen
    v_writelane_b32 v62, s66, 0
    v_writelane_b32 v62, s67, 1
    v_writelane_b32 v62, s68, 2
    v_writelane_b32 v62, s69, 3
    v_writelane_b32 v62, s70, 4
    v_writelane_b32 v62, s71, 5
    s_waitcnt vmcnt(2)
    ds_write2_b32 v9, v108, v109 offset0:4 offset1:72
    ds_write2_b32 v9, v110, v111 offset0:136 offset1:200
    s_mov_b64 exec, 0x3f
    ds_write_b32 v10, v62
    s_mov_b64 exec, -1
    s_waitcnt lgkmcnt(0)
    ds_read_b128 v[32:35], v12 offset:0
    ds_read_b128 v[36:39], v12 offset:16
    ds_read_b128 v[40:43], v12 offset:32
    ds_read_b128 v[44:47], v13 offset:544
    ds_read_b128 v[48:51], v13 offset:560
    s_waitcnt lgkmcnt(2)
    v_perm_b32 v64, v33, v33, v14
    v_perm_b32 v65, v34, v34, v14
    v_perm_b32 v66, v35, v35, v14
    v_perm_b32 v67, v36, v36, v14
    v_perm_b32 v68, v37, v37, v14
    v_perm_b32 v69, v38, v38, v14
    v_perm_b32 v70, v39, v39, v14
    v_perm_b32 v71, v40, v40, v14
    v_perm_b32 v72, v41, v41, v14
    v_perm_b32 v73, v42, v42, v14
    v_perm_b32 v74, v43, v43, v14
    s_waitcnt lgkmcnt(0)
    v_perm_b32 v76, v44, v44, v14
    v_perm_b32 v77, v45, v45, v14
    v_perm_b32 v78, v46, v46, v14
    v_perm_b32 v79, v47, v47, v14
    v_perm_b32 v80, v48, v48, v14
    v_perm_b32 v81, v49, v49, v14
    v_perm_b32 v82, v50, v50, v14
    v_perm_b32 v83, v51, v51, v14
    v_mul_f32 v84, v59, v64
    v_fmac_f32 v84, v58, v65
    v_fmac_f32 v84, v57, v66
    v_fmac_f32 v84, v56, v67
    v_mul_f32 v84, v84, v76
    v_mul_f32 v85, v59, v65
    v_fmac_f32 v85, v58, v66
    v_fmac_f32 v85, v57, v67
    v_fmac_f32 v85, v56, v68
    v_mul_f32 v85, v85, v77
    v_mul_f32 v86, v59, v66
    v_fmac_f32 v86, v58, v67
    v_fmac_f32 v86, v57, v68
    v_fmac_f32 v86, v56, v69
    v_mul_f32 v86, v86, v78
    v_mul_f32 v87, v59, v67
    v_fmac_f32 v87, v58, v68
    v_fmac_f32 v87, v57, v69
    v_fmac_f32 v87, v56, v70
    v_mul_f32 v87, v87, v79
    v_mul_f32 v88, v59, v68
    v_fmac_f32 v88, v58, v69
    v_fmac_f32 v88, v57, v70
    v_fmac_f32 v88, v56, v71
    v_mul_f32 v88, v88, v80
    v_mul_f32 v89, v59, v69
    v_fmac_f32 v89, v58, v70
    v_fmac_f32 v89, v57, v71
    v_fmac_f32 v89, v56, v72
    v_mul_f32 v89, v89, v81
    v_mul_f32 v90, v59, v70
    v_fmac_f32 v90, v58, v71
    v_fmac_f32 v90, v57, v72
    v_fmac_f32 v90, v56, v73
    v_mul_f32 v90, v90, v82
    v_mul_f32 v91, v59, v71
    v_fmac_f32 v91, v58, v72
    v_fmac_f32 v91, v57, v73
    v_fmac_f32 v91, v56, v74
    v_mul_f32 v91, v91, v83
    v_cvt_pk_bf16_f32 v92, v91, v90
    v_cvt_pk_bf16_f32 v93, v89, v88
    v_cvt_pk_bf16_f32 v94, v87, v86
    v_cvt_pk_bf16_f32 v95, v85, v84
    ds_write_b128 v60, v[92:95] offset:2560
    s_waitcnt lgkmcnt(0)
    s_barrier
    s_mov_b32 s40, 1474560
    buffer_load_dwordx2 v[116:117], v8, s[20:23], s40 offen
    buffer_load_dwordx2 v[118:119], v8, s[24:27], s40 offen
    v_writelane_b32 v62, s72, 0
    v_writelane_b32 v62, s73, 1
    v_writelane_b32 v62, s74, 2
    v_writelane_b32 v62, s75, 3
    v_writelane_b32 v62, s76, 4
    v_writelane_b32 v62, s77, 5
    s_waitcnt vmcnt(2)
    ds_write2_b32 v9, v112, v113 offset0:4 offset1:72
    ds_write2_b32 v9, v114, v115 offset0:136 offset1:200
    s_mov_b64 exec, 0x3f
    ds_write_b32 v10, v62
    s_mov_b64 exec, -1
    s_waitcnt lgkmcnt(0)
    ds_read_b128 v[32:35], v12 offset:0
    ds_read_b128 v[36:39], v12 offset:16
    ds_read_b128 v[40:43], v12 offset:32
    ds_read_b128 v[44:47], v13 offset:544
    ds_read_b128 v[48:51], v13 offset:560
    s_waitcnt lgkmcnt(2)
    v_perm_b32 v64, v33, v33, v14
    v_perm_b32 v65, v34, v34, v14
    v_perm_b32 v66, v35, v35, v14
    v_perm_b32 v67, v36, v36, v14
    v_perm_b32 v68, v37, v37, v14
    v_perm_b32 v69, v38, v38, v14
    v_perm_b32 v70, v39, v39, v14
    v_perm_b32 v71, v40, v40, v14
    v_perm_b32 v72, v41, v41, v14
    v_perm_b32 v73, v42, v42, v14
    v_perm_b32 v74, v43, v43, v14
    s_waitcnt lgkmcnt(0)
    v_perm_b32 v76, v44, v44, v14
    v_perm_b32 v77, v45, v45, v14
    v_perm_b32 v78, v46, v46, v14
    v_perm_b32 v79, v47, v47, v14
    v_perm_b32 v80, v48, v48, v14
    v_perm_b32 v81, v49, v49, v14
    v_perm_b32 v82, v50, v50, v14
    v_perm_b32 v83, v51, v51, v14
    v_mul_f32 v84, v59, v64
    v_fmac_f32 v84, v58, v65
    v_fmac_f32 v84, v57, v66
    v_fmac_f32 v84, v56, v67
    v_mul_f32 v84, v84, v76
    v_mul_f32 v85, v59, v65
    v_fmac_f32 v85, v58, v66
    v_fmac_f32 v85, v57, v67
    v_fmac_f32 v85, v56, v68
    v_mul_f32 v85, v85, v77
    v_mul_f32 v86, v59, v66
    v_fmac_f32 v86, v58, v67
    v_fmac_f32 v86, v57, v68
    v_fmac_f32 v86, v56, v69
    v_mul_f32 v86, v86, v78
    v_mul_f32 v87, v59, v67
    v_fmac_f32 v87, v58, v68
    v_fmac_f32 v87, v57, v69
    v_fmac_f32 v87, v56, v70
    v_mul_f32 v87, v87, v79
    v_mul_f32 v88, v59, v68
    v_fmac_f32 v88, v58, v69
    v_fmac_f32 v88, v57, v70
    v_fmac_f32 v88, v56, v71
    v_mul_f32 v88, v88, v80
    v_mul_f32 v89, v59, v69
    v_fmac_f32 v89, v58, v70
    v_fmac_f32 v89, v57, v71
    v_fmac_f32 v89, v56, v72
    v_mul_f32 v89, v89, v81
    v_mul_f32 v90, v59, v70
    v_fmac_f32 v90, v58, v71
    v_fmac_f32 v90, v57, v72
    v_fmac_f32 v90, v56, v73
    v_mul_f32 v90, v90, v82
    v_mul_f32 v91, v59, v71
    v_fmac_f32 v91, v58, v72
    v_fmac_f32 v91, v57, v73
    v_fmac_f32 v91, v56, v74
    v_mul_f32 v91, v91, v83
    v_cvt_pk_bf16_f32 v92, v91, v90
    v_cvt_pk_bf16_f32 v93, v89, v88
    v_cvt_pk_bf16_f32 v94, v87, v86
    v_cvt_pk_bf16_f32 v95, v85, v84
    ds_write_b128 v60, v[92:95] offset:1920
    s_waitcnt lgkmcnt(0)
    s_barrier
    s_mov_b32 s40, 1769472
    buffer_load_dwordx2 v[96:97], v8, s[20:23], s40 offen
    buffer_load_dwordx2 v[98:99], v8, s[24:27], s40 offen
    v_writelane_b32 v62, s78, 0
    v_writelane_b32 v62, s79, 1
    v_writelane_b32 v62, s80, 2
    v_writelane_b32 v62, s81, 3
    v_writelane_b32 v62, s82, 4
    v_writelane_b32 v62, s83, 5
    s_waitcnt vmcnt(2)
    ds_write2_b32 v9, v116, v117 offset0:4 offset1:72
    ds_write2_b32 v9, v118, v119 offset0:136 offset1:200
    s_mov_b64 exec, 0x3f
    ds_write_b32 v10, v62
    s_mov_b64 exec, -1
    s_waitcnt lgkmcnt(0)
    ds_read_b128 v[32:35], v12 offset:0
    ds_read_b128 v[36:39], v12 offset:16
    ds_read_b128 v[40:43], v12 offset:32
    ds_read_b128 v[44:47], v13 offset:544
    ds_read_b128 v[48:51], v13 offset:560
    s_waitcnt lgkmcnt(2)
    v_perm_b32 v64, v33, v33, v14
    v_perm_b32 v65, v34, v34, v14
    v_perm_b32 v66, v35, v35, v14
    v_perm_b32 v67, v36, v36, v14
    v_perm_b32 v68, v37, v37, v14
    v_perm_b32 v69, v38, v38, v14
    v_perm_b32 v70, v39, v39, v14
    v_perm_b32 v71, v40, v40, v14
    v_perm_b32 v72, v41, v41, v14
    v_perm_b32 v73, v42, v42, v14
    v_perm_b32 v74, v43, v43, v14
    s_waitcnt lgkmcnt(0)
    v_perm_b32 v76, v44, v44, v14
    v_perm_b32 v77, v45, v45, v14
    v_perm_b32 v78, v46, v46, v14
    v_perm_b32 v79, v47, v47, v14
    v_perm_b32 v80, v48, v48, v14
    v_perm_b32 v81, v49, v49, v14
    v_perm_b32 v82, v50, v50, v14
    v_perm_b32 v83, v51, v51, v14
    v_mul_f32 v84, v59, v64
    v_fmac_f32 v84, v58, v65
    v_fmac_f32 v84, v57, v66
    v_fmac_f32 v84, v56, v67
    v_mul_f32 v84, v84, v76
    v_mul_f32 v85, v59, v65
    v_fmac_f32 v85, v58, v66
    v_fmac_f32 v85, v57, v67
    v_fmac_f32 v85, v56, v68
    v_mul_f32 v85, v85, v77
    v_mul_f32 v86, v59, v66
    v_fmac_f32 v86, v58, v67
    v_fmac_f32 v86, v57, v68
    v_fmac_f32 v86, v56, v69
    v_mul_f32 v86, v86, v78
    v_mul_f32 v87, v59, v67
    v_fmac_f32 v87, v58, v68
    v_fmac_f32 v87, v57, v69
    v_fmac_f32 v87, v56, v70
    v_mul_f32 v87, v87, v79
    v_mul_f32 v88, v59, v68
    v_fmac_f32 v88, v58, v69
    v_fmac_f32 v88, v57, v70
    v_fmac_f32 v88, v56, v71
    v_mul_f32 v88, v88, v80
    v_mul_f32 v89, v59, v69
    v_fmac_f32 v89, v58, v70
    v_fmac_f32 v89, v57, v71
    v_fmac_f32 v89, v56, v72
    v_mul_f32 v89, v89, v81
    v_mul_f32 v90, v59, v70
    v_fmac_f32 v90, v58, v71
    v_fmac_f32 v90, v57, v72
    v_fmac_f32 v90, v56, v73
    v_mul_f32 v90, v90, v82
    v_mul_f32 v91, v59, v71
    v_fmac_f32 v91, v58, v72
    v_fmac_f32 v91, v57, v73
    v_fmac_f32 v91, v56, v74
    v_mul_f32 v91, v91, v83
    v_cvt_pk_bf16_f32 v92, v91, v90
    v_cvt_pk_bf16_f32 v93, v89, v88
    v_cvt_pk_bf16_f32 v94, v87, v86
    v_cvt_pk_bf16_f32 v95, v85, v84
    ds_write_b128 v60, v[92:95] offset:1280
    s_waitcnt lgkmcnt(0)
    s_barrier
    s_mov_b32 s40, 2064384
    buffer_load_dwordx2 v[100:101], v8, s[20:23], s40 offen
    buffer_load_dwordx2 v[102:103], v8, s[24:27], s40 offen
    v_writelane_b32 v62, s84, 0
    v_writelane_b32 v62, s85, 1
    v_writelane_b32 v62, s86, 2
    v_writelane_b32 v62, s87, 3
    v_writelane_b32 v62, s88, 4
    v_writelane_b32 v62, s89, 5
    s_waitcnt vmcnt(2)
    ds_write2_b32 v9, v96, v97 offset0:4 offset1:72
    ds_write2_b32 v9, v98, v99 offset0:136 offset1:200
    s_mov_b64 exec, 0x3f
    ds_write_b32 v10, v62
    s_mov_b64 exec, -1
    s_waitcnt lgkmcnt(0)
    ds_read_b128 v[32:35], v12 offset:0
    ds_read_b128 v[36:39], v12 offset:16
    ds_read_b128 v[40:43], v12 offset:32
    ds_read_b128 v[44:47], v13 offset:544
    ds_read_b128 v[48:51], v13 offset:560
    s_waitcnt lgkmcnt(2)
    v_perm_b32 v64, v33, v33, v14
    v_perm_b32 v65, v34, v34, v14
    v_perm_b32 v66, v35, v35, v14
    v_perm_b32 v67, v36, v36, v14
    v_perm_b32 v68, v37, v37, v14
    v_perm_b32 v69, v38, v38, v14
    v_perm_b32 v70, v39, v39, v14
    v_perm_b32 v71, v40, v40, v14
    v_perm_b32 v72, v41, v41, v14
    v_perm_b32 v73, v42, v42, v14
    v_perm_b32 v74, v43, v43, v14
    s_waitcnt lgkmcnt(0)
    v_perm_b32 v76, v44, v44, v14
    v_perm_b32 v77, v45, v45, v14
    v_perm_b32 v78, v46, v46, v14
    v_perm_b32 v79, v47, v47, v14
    v_perm_b32 v80, v48, v48, v14
    v_perm_b32 v81, v49, v49, v14
    v_perm_b32 v82, v50, v50, v14
    v_perm_b32 v83, v51, v51, v14
    v_mul_f32 v84, v59, v64
    v_fmac_f32 v84, v58, v65
    v_fmac_f32 v84, v57, v66
    v_fmac_f32 v84, v56, v67
    v_mul_f32 v84, v84, v76
    v_mul_f32 v85, v59, v65
    v_fmac_f32 v85, v58, v66
    v_fmac_f32 v85, v57, v67
    v_fmac_f32 v85, v56, v68
    v_mul_f32 v85, v85, v77
    v_mul_f32 v86, v59, v66
    v_fmac_f32 v86, v58, v67
    v_fmac_f32 v86, v57, v68
    v_fmac_f32 v86, v56, v69
    v_mul_f32 v86, v86, v78
    v_mul_f32 v87, v59, v67
    v_fmac_f32 v87, v58, v68
    v_fmac_f32 v87, v57, v69
    v_fmac_f32 v87, v56, v70
    v_mul_f32 v87, v87, v79
    v_mul_f32 v88, v59, v68
    v_fmac_f32 v88, v58, v69
    v_fmac_f32 v88, v57, v70
    v_fmac_f32 v88, v56, v71
    v_mul_f32 v88, v88, v80
    v_mul_f32 v89, v59, v69
    v_fmac_f32 v89, v58, v70
    v_fmac_f32 v89, v57, v71
    v_fmac_f32 v89, v56, v72
    v_mul_f32 v89, v89, v81
    v_mul_f32 v90, v59, v70
    v_fmac_f32 v90, v58, v71
    v_fmac_f32 v90, v57, v72
    v_fmac_f32 v90, v56, v73
    v_mul_f32 v90, v90, v82
    v_mul_f32 v91, v59, v71
    v_fmac_f32 v91, v58, v72
    v_fmac_f32 v91, v57, v73
    v_fmac_f32 v91, v56, v74
    v_mul_f32 v91, v91, v83
    v_cvt_pk_bf16_f32 v92, v91, v90
    v_cvt_pk_bf16_f32 v93, v89, v88
    v_cvt_pk_bf16_f32 v94, v87, v86
    v_cvt_pk_bf16_f32 v95, v85, v84
    ds_write_b128 v60, v[92:95] offset:640
    s_waitcnt lgkmcnt(0)
    s_barrier
    v_writelane_b32 v62, s90, 0
    v_writelane_b32 v62, s91, 1
    v_writelane_b32 v62, s92, 2
    v_writelane_b32 v62, s93, 3
    v_writelane_b32 v62, s94, 4
    v_writelane_b32 v62, s95, 5
    s_waitcnt vmcnt(0)
    ds_write2_b32 v9, v100, v101 offset0:4 offset1:72
    ds_write2_b32 v9, v102, v103 offset0:136 offset1:200
    s_mov_b64 exec, 0x3f
    ds_write_b32 v10, v62
    s_mov_b64 exec, -1
    s_waitcnt lgkmcnt(0)
    ds_read_b128 v[32:35], v12 offset:0
    ds_read_b128 v[36:39], v12 offset:16
    ds_read_b128 v[40:43], v12 offset:32
    ds_read_b128 v[44:47], v13 offset:544
    ds_read_b128 v[48:51], v13 offset:560
    s_waitcnt lgkmcnt(2)
    v_perm_b32 v64, v33, v33, v14
    v_perm_b32 v65, v34, v34, v14
    v_perm_b32 v66, v35, v35, v14
    v_perm_b32 v67, v36, v36, v14
    v_perm_b32 v68, v37, v37, v14
    v_perm_b32 v69, v38, v38, v14
    v_perm_b32 v70, v39, v39, v14
    v_perm_b32 v71, v40, v40, v14
    v_perm_b32 v72, v41, v41, v14
    v_perm_b32 v73, v42, v42, v14
    v_perm_b32 v74, v43, v43, v14
    s_waitcnt lgkmcnt(0)
    v_perm_b32 v76, v44, v44, v14
    v_perm_b32 v77, v45, v45, v14
    v_perm_b32 v78, v46, v46, v14
    v_perm_b32 v79, v47, v47, v14
    v_perm_b32 v80, v48, v48, v14
    v_perm_b32 v81, v49, v49, v14
    v_perm_b32 v82, v50, v50, v14
    v_perm_b32 v83, v51, v51, v14
    v_mul_f32 v84, v59, v64
    v_fmac_f32 v84, v58, v65
    v_fmac_f32 v84, v57, v66
    v_fmac_f32 v84, v56, v67
    v_mul_f32 v84, v84, v76
    v_mul_f32 v85, v59, v65
    v_fmac_f32 v85, v58, v66
    v_fmac_f32 v85, v57, v67
    v_fmac_f32 v85, v56, v68
    v_mul_f32 v85, v85, v77
    v_mul_f32 v86, v59, v66
    v_fmac_f32 v86, v58, v67
    v_fmac_f32 v86, v57, v68
    v_fmac_f32 v86, v56, v69
    v_mul_f32 v86, v86, v78
    v_mul_f32 v87, v59, v67
    v_fmac_f32 v87, v58, v68
    v_fmac_f32 v87, v57, v69
    v_fmac_f32 v87, v56, v70
    v_mul_f32 v87, v87, v79
    v_mul_f32 v88, v59, v68
    v_fmac_f32 v88, v58, v69
    v_fmac_f32 v88, v57, v70
    v_fmac_f32 v88, v56, v71
    v_mul_f32 v88, v88, v80
    v_mul_f32 v89, v59, v69
    v_fmac_f32 v89, v58, v70
    v_fmac_f32 v89, v57, v71
    v_fmac_f32 v89, v56, v72
    v_mul_f32 v89, v89, v81
    v_mul_f32 v90, v59, v70
    v_fmac_f32 v90, v58, v71
    v_fmac_f32 v90, v57, v72
    v_fmac_f32 v90, v56, v73
    v_mul_f32 v90, v90, v82
    v_mul_f32 v91, v59, v71
    v_fmac_f32 v91, v58, v72
    v_fmac_f32 v91, v57, v73
    v_fmac_f32 v91, v56, v74
    v_mul_f32 v91, v91, v83
    v_cvt_pk_bf16_f32 v92, v91, v90
    v_cvt_pk_bf16_f32 v93, v89, v88
    v_cvt_pk_bf16_f32 v94, v87, v86
    v_cvt_pk_bf16_f32 v95, v85, v84
    ds_write_b128 v60, v[92:95] offset:0
    s_waitcnt lgkmcnt(0)
    s_barrier
    s_endpgm
K1_MOD:
    s_load_dwordx4 s[4:7], s[0:1], 80
    s_load_dwordx2 s[8:9], s[0:1], 112
    s_load_dwordx4 s[40:43], s[0:1], 56
    s_load_dwordx2 s[44:45], s[0:1], 72
    s_load_dwordx2 s[46:47], s[0:1], 0
    s_load_dwordx4 s[48:51], s[0:1], 8
    s_sub_u32 s3, s2, 144
    v_lshrrev_b32 v1, 6, v0
    s_nop 0
    v_readfirstlane_b32 s17, v1
    s_cmp_ge_u32 s17, 4
    s_cbranch_scc1 K1_PF
    v_and_b32 v2, 63, v0
    v_mul_u32_u24 v3, 18, v2
    s_mov_b32 s16, 62208
    v_mul_lo_u32 v4, v2, s16
    s_lshl_b32 s16, s3, 6
    s_lshl_b32 s17, s17, 4
    s_add_u32 s17, s17, s16
    v_add_u32 v4, s17, v4
    s_waitcnt lgkmcnt(0)
    s_mov_b32 s20, s4
    s_mov_b32 s21, s5
    s_mov_b32 s22, 1152
    s_mov_b32 s23, 0x00020000
    s_mov_b32 s24, s6
    s_mov_b32 s25, s7
    s_mov_b32 s26, 3981312
    s_mov_b32 s27, 0x00020000
    s_add_u32 s28, s8, 8192
    s_addc_u32 s29, s9, 0
    s_mov_b32 s30, 13824
    s_mov_b32 s31, 0x00020000
    buffer_load_ushort v10, v3, s[20:23], 0 offen offset:0
    buffer_load_ushort v11, v3, s[20:23], 0 offen offset:2
    buffer_load_ushort v12, v3, s[20:23], 0 offen offset:4
    buffer_load_ushort v13, v3, s[20:23], 0 offen offset:6
    buffer_load_ushort v14, v3, s[20:23], 0 offen offset:8
    buffer_load_ushort v15, v3, s[20:23], 0 offen offset:10
    buffer_load_ushort v16, v3, s[20:23], 0 offen offset:12
    buffer_load_ushort v17, v3, s[20:23], 0 offen offset:14
    buffer_load_ushort v18, v3, s[20:23], 0 offen offset:16
    s_mov_b32 s18, 0
    buffer_load_dwordx4 v[20:23], v4, s[24:27], s18 offen
    s_mov_b32 s18, 6912
    buffer_load_dwordx4 v[24:27], v4, s[24:27], s18 offen
    s_mov_b32 s18, 13824
    buffer_load_dwordx4 v[28:31], v4, s[24:27], s18 offen
    s_mov_b32 s18, 20736
    buffer_load_dwordx4 v[32:35], v4, s[24:27], s18 offen
    s_mov_b32 s18, 27648
    buffer_load_dwordx4 v[36:39], v4, s[24:27], s18 offen
    s_mov_b32 s18, 34560
    buffer_load_dwordx4 v[40:43], v4, s[24:27], s18 offen
    s_mov_b32 s18, 41472
    buffer_load_dwordx4 v[44:47], v4, s[24:27], s18 offen
    s_mov_b32 s18, 48384
    buffer_load_dwordx4 v[48:51], v4, s[24:27], s18 offen
    s_mov_b32 s18, 55296
    buffer_load_dwordx4 v[52:55], v4, s[24:27], s18 offen
    v_mov_b32 v60, 0
    v_mov_b32 v61, 0
    v_mov_b32 v62, 0
    v_mov_b32 v63, 0
    v_mov_b32 v64, 0
    v_mov_b32 v65, 0
    v_mov_b32 v66, 0
    v_mov_b32 v67, 0
    s_waitcnt vmcnt(9)
    s_mov_b32 s19, 0xbfb8aa3b
    v_lshlrev_b32 v10, 16, v10
    v_mul_f32 v70, s19, v10
    v_exp_f32 v70, v70
    s_nop 0
    v_add_f32 v70, 1.0, v70
    v_rcp_f32 v70, v70
    s_nop 0
    v_mul_f32 v70, v70, v10
    v_cvt_pk_bf16_f32 v70, v70, v70
    v_lshlrev_b32 v10, 16, v70
    v_lshlrev_b32 v11, 16, v11
    v_mul_f32 v70, s19, v11
    v_exp_f32 v70, v70
    s_nop 0
    v_add_f32 v70, 1.0, v70
    v_rcp_f32 v70, v70
    s_nop 0
    v_mul_f32 v70, v70, v11
    v_cvt_pk_bf16_f32 v70, v70, v70
    v_lshlrev_b32 v11, 16, v70
    v_lshlrev_b32 v12, 16, v12
    v_mul_f32 v70, s19, v12
    v_exp_f32 v70, v70
    s_nop 0
    v_add_f32 v70, 1.0, v70
    v_rcp_f32 v70, v70
    s_nop 0
    v_mul_f32 v70, v70, v12
    v_cvt_pk_bf16_f32 v70, v70, v70
    v_lshlrev_b32 v12, 16, v70
    v_lshlrev_b32 v13, 16, v13
    v_mul_f32 v70, s19, v13
    v_exp_f32 v70, v70
    s_nop 0
    v_add_f32 v70, 1.0, v70
    v_rcp_f32 v70, v70
    s_nop 0
    v_mul_f32 v70, v70, v13
    v_cvt_pk_bf16_f32 v70, v70, v70
    v_lshlrev_b32 v13, 16, v70
    v_lshlrev_b32 v14, 16, v14
    v_mul_f32 v70, s19, v14
    v_exp_f32 v70, v70
    s_nop 0
    v_add_f32 v70, 1.0, v70
    v_rcp_f32 v70, v70
    s_nop 0
    v_mul_f32 v70, v70, v14
    v_cvt_pk_bf16_f32 v70, v70, v70
    v_lshlrev_b32 v14, 16, v70
    v_lshlrev_b32 v15, 16, v15
    v_mul_f32 v70, s19, v15
    v_exp_f32 v70, v70
    s_nop 0
    v_add_f32 v70, 1.0, v70
    v_rcp_f32 v70, v70
    s_nop 0
    v_mul_f32 v70, v70, v15
    v_cvt_pk_bf16_f32 v70, v70, v70
    v_lshlrev_b32 v15, 16, v70
    v_lshlrev_b32 v16, 16, v16
    v_mul_f32 v70, s19, v16
    v_exp_f32 v70, v70
    s_nop 0
    v_add_f32 v70, 1.0, v70
    v_rcp_f32 v70, v70
    s_nop 0
    v_mul_f32 v70, v70, v16
    v_cvt_pk_bf16_f32 v70, v70, v70
    v_lshlrev_b32 v16, 16, v70
    v_lshlrev_b32 v17, 16, v17
    v_mul_f32 v70, s19, v17
    v_exp_f32 v70, v70
    s_nop 0
    v_add_f32 v70, 1.0, v70
    v_rcp_f32 v70, v70
    s_nop 0
    v_mul_f32 v70, v70, v17
    v_cvt_pk_bf16_f32 v70, v70, v70
    v_lshlrev_b32 v17, 16, v70
    v_lshlrev_b32 v18, 16, v18
    v_mul_f32 v70, s19, v18
    v_exp_f32 v70, v70
    s_nop 0
    v_add_f32 v70, 1.0, v70
    v_rcp_f32 v70, v70
    s_nop 0
    v_mul_f32 v70, v70, v18
    v_cvt_pk_bf16_f32 v70, v70, v70
    v_lshlrev_b32 v18, 16, v70
    s_waitcnt vmcnt(8)
    v_lshlrev_b32 v70, 16, v20
    v_and_b32 v71, 0xffff0000, v20
    v_fmac_f32 v60, v70, v10
    v_fmac_f32 v61, v71, v10
    v_lshlrev_b32 v70, 16, v21
    v_and_b32 v71, 0xffff0000, v21
    v_fmac_f32 v62, v70, v10
    v_fmac_f32 v63, v71, v10
    v_lshlrev_b32 v70, 16, v22
    v_and_b32 v71, 0xffff0000, v22
    v_fmac_f32 v64, v70, v10
    v_fmac_f32 v65, v71, v10
    v_lshlrev_b32 v70, 16, v23
    v_and_b32 v71, 0xffff0000, v23
    v_fmac_f32 v66, v70, v10
    v_fmac_f32 v67, v71, v10
    s_waitcnt vmcnt(7)
    v_lshlrev_b32 v70, 16, v24
    v_and_b32 v71, 0xffff0000, v24
    v_fmac_f32 v60, v70, v11
    v_fmac_f32 v61, v71, v11
    v_lshlrev_b32 v70, 16, v25
    v_and_b32 v71, 0xffff0000, v25
    v_fmac_f32 v62, v70, v11
    v_fmac_f32 v63, v71, v11
    v_lshlrev_b32 v70, 16, v26
    v_and_b32 v71, 0xffff0000, v26
    v_fmac_f32 v64, v70, v11
    v_fmac_f32 v65, v71, v11
    v_lshlrev_b32 v70, 16, v27
    v_and_b32 v71, 0xffff0000, v27
    v_fmac_f32 v66, v70, v11
    v_fmac_f32 v67, v71, v11
    s_waitcnt vmcnt(6)
    v_lshlrev_b32 v70, 16, v28
    v_and_b32 v71, 0xffff0000, v28
    v_fmac_f32 v60, v70, v12
    v_fmac_f32 v61, v71, v12
    v_lshlrev_b32 v70, 16, v29
    v_and_b32 v71, 0xffff0000, v29
    v_fmac_f32 v62, v70, v12
    v_fmac_f32 v63, v71, v12
    v_lshlrev_b32 v70, 16, v30
    v_and_b32 v71, 0xffff0000, v30
    v_fmac_f32 v64, v70, v12
    v_fmac_f32 v65, v71, v12
    v_lshlrev_b32 v70, 16, v31
    v_and_b32 v71, 0xffff0000, v31
    v_fmac_f32 v66, v70, v12
    v_fmac_f32 v67, v71, v12
    s_waitcnt vmcnt(5)
    v_lshlrev_b32 v70, 16, v32
    v_and_b32 v71, 0xffff0000, v32
    v_fmac_f32 v60, v70, v13
    v_fmac_f32 v61, v71, v13
    v_lshlrev_b32 v70, 16, v33
    v_and_b32 v71, 0xffff0000, v33
    v_fmac_f32 v62, v70, v13
    v_fmac_f32 v63, v71, v13
    v_lshlrev_b32 v70, 16, v34
    v_and_b32 v71, 0xffff0000, v34
    v_fmac_f32 v64, v70, v13
    v_fmac_f32 v65, v71, v13
    v_lshlrev_b32 v70, 16, v35
    v_and_b32 v71, 0xffff0000, v35
    v_fmac_f32 v66, v70, v13
    v_fmac_f32 v67, v71, v13
    s_waitcnt vmcnt(4)
    v_lshlrev_b32 v70, 16, v36
    v_and_b32 v71, 0xffff0000, v36
    v_fmac_f32 v60, v70, v14
    v_fmac_f32 v61, v71, v14
    v_lshlrev_b32 v70, 16, v37
    v_and_b32 v71, 0xffff0000, v37
    v_fmac_f32 v62, v70, v14
    v_fmac_f32 v63, v71, v14
    v_lshlrev_b32 v70, 16, v38
    v_and_b32 v71, 0xffff0000, v38
    v_fmac_f32 v64, v70, v14
    v_fmac_f32 v65, v71, v14
    v_lshlrev_b32 v70, 16, v39
    v_and_b32 v71, 0xffff0000, v39
    v_fmac_f32 v66, v70, v14
    v_fmac_f32 v67, v71, v14
    s_waitcnt vmcnt(3)
    v_lshlrev_b32 v70, 16, v40
    v_and_b32 v71, 0xffff0000, v40
    v_fmac_f32 v60, v70, v15
    v_fmac_f32 v61, v71, v15
    v_lshlrev_b32 v70, 16, v41
    v_and_b32 v71, 0xffff0000, v41
    v_fmac_f32 v62, v70, v15
    v_fmac_f32 v63, v71, v15
    v_lshlrev_b32 v70, 16, v42
    v_and_b32 v71, 0xffff0000, v42
    v_fmac_f32 v64, v70, v15
    v_fmac_f32 v65, v71, v15
    v_lshlrev_b32 v70, 16, v43
    v_and_b32 v71, 0xffff0000, v43
    v_fmac_f32 v66, v70, v15
    v_fmac_f32 v67, v71, v15
    s_waitcnt vmcnt(2)
    v_lshlrev_b32 v70, 16, v44
    v_and_b32 v71, 0xffff0000, v44
    v_fmac_f32 v60, v70, v16
    v_fmac_f32 v61, v71, v16
    v_lshlrev_b32 v70, 16, v45
    v_and_b32 v71, 0xffff0000, v45
    v_fmac_f32 v62, v70, v16
    v_fmac_f32 v63, v71, v16
    v_lshlrev_b32 v70, 16, v46
    v_and_b32 v71, 0xffff0000, v46
    v_fmac_f32 v64, v70, v16
    v_fmac_f32 v65, v71, v16
    v_lshlrev_b32 v70, 16, v47
    v_and_b32 v71, 0xffff0000, v47
    v_fmac_f32 v66, v70, v16
    v_fmac_f32 v67, v71, v16
    s_waitcnt vmcnt(1)
    v_lshlrev_b32 v70, 16, v48
    v_and_b32 v71, 0xffff0000, v48
    v_fmac_f32 v60, v70, v17
    v_fmac_f32 v61, v71, v17
    v_lshlrev_b32 v70, 16, v49
    v_and_b32 v71, 0xffff0000, v49
    v_fmac_f32 v62, v70, v17
    v_fmac_f32 v63, v71, v17
    v_lshlrev_b32 v70, 16, v50
    v_and_b32 v71, 0xffff0000, v50
    v_fmac_f32 v64, v70, v17
    v_fmac_f32 v65, v71, v17
    v_lshlrev_b32 v70, 16, v51
    v_and_b32 v71, 0xffff0000, v51
    v_fmac_f32 v66, v70, v17
    v_fmac_f32 v67, v71, v17
    s_waitcnt vmcnt(0)
    v_lshlrev_b32 v70, 16, v52
    v_and_b32 v71, 0xffff0000, v52
    v_fmac_f32 v60, v70, v18
    v_fmac_f32 v61, v71, v18
    v_lshlrev_b32 v70, 16, v53
    v_and_b32 v71, 0xffff0000, v53
    v_fmac_f32 v62, v70, v18
    v_fmac_f32 v63, v71, v18
    v_lshlrev_b32 v70, 16, v54
    v_and_b32 v71, 0xffff0000, v54
    v_fmac_f32 v64, v70, v18
    v_fmac_f32 v65, v71, v18
    v_lshlrev_b32 v70, 16, v55
    v_and_b32 v71, 0xffff0000, v55
    v_fmac_f32 v66, v70, v18
    v_fmac_f32 v67, v71, v18
    s_nop 1
    v_add_f32_dpp v60, v60, v60 row_ror:1 row_mask:0xf bank_mask:0xf
    v_add_f32_dpp v61, v61, v61 row_ror:1 row_mask:0xf bank_mask:0xf
    v_add_f32_dpp v62, v62, v62 row_ror:1 row_mask:0xf bank_mask:0xf
    v_add_f32_dpp v63, v63, v63 row_ror:1 row_mask:0xf bank_mask:0xf
    v_add_f32_dpp v64, v64, v64 row_ror:1 row_mask:0xf bank_mask:0xf
    v_add_f32_dpp v65, v65, v65 row_ror:1 row_mask:0xf bank_mask:0xf
    v_add_f32_dpp v66, v66, v66 row_ror:1 row_mask:0xf bank_mask:0xf
    v_add_f32_dpp v67, v67, v67 row_ror:1 row_mask:0xf bank_mask:0xf
    s_nop 1
    v_add_f32_dpp v60, v60, v60 row_ror:2 row_mask:0xf bank_mask:0xf
    v_add_f32_dpp v61, v61, v61 row_ror:2 row_mask:0xf bank_mask:0xf
    v_add_f32_dpp v62, v62, v62 row_ror:2 row_mask:0xf bank_mask:0xf
    v_add_f32_dpp v63, v63, v63 row_ror:2 row_mask:0xf bank_mask:0xf
    v_add_f32_dpp v64, v64, v64 row_ror:2 row_mask:0xf bank_mask:0xf
    v_add_f32_dpp v65, v65, v65 row_ror:2 row_mask:0xf bank_mask:0xf
    v_add_f32_dpp v66, v66, v66 row_ror:2 row_mask:0xf bank_mask:0xf
    v_add_f32_dpp v67, v67, v67 row_ror:2 row_mask:0xf bank_mask:0xf
    s_nop 1
    v_add_f32_dpp v60, v60, v60 row_ror:4 row_mask:0xf bank_mask:0xf
    v_add_f32_dpp v61, v61, v61 row_ror:4 row_mask:0xf bank_mask:0xf
    v_add_f32_dpp v62, v62, v62 row_ror:4 row_mask:0xf bank_mask:0xf
    v_add_f32_dpp v63, v63, v63 row_ror:4 row_mask:0xf bank_mask:0xf
    v_add_f32_dpp v64, v64, v64 row_ror:4 row_mask:0xf bank_mask:0xf
    v_add_f32_dpp v65, v65, v65 row_ror:4 row_mask:0xf bank_mask:0xf
    v_add_f32_dpp v66, v66, v66 row_ror:4 row_mask:0xf bank_mask:0xf
    v_add_f32_dpp v67, v67, v67 row_ror:4 row_mask:0xf bank_mask:0xf
    s_nop 1
    v_add_f32_dpp v60, v60, v60 row_ror:8 row_mask:0xf bank_mask:0xf
    v_add_f32_dpp v61, v61, v61 row_ror:8 row_mask:0xf bank_mask:0xf
    v_add_f32_dpp v62, v62, v62 row_ror:8 row_mask:0xf bank_mask:0xf
    v_add_f32_dpp v63, v63, v63 row_ror:8 row_mask:0xf bank_mask:0xf
    v_add_f32_dpp v64, v64, v64 row_ror:8 row_mask:0xf bank_mask:0xf
    v_add_f32_dpp v65, v65, v65 row_ror:8 row_mask:0xf bank_mask:0xf
    v_add_f32_dpp v66, v66, v66 row_ror:8 row_mask:0xf bank_mask:0xf
    v_add_f32_dpp v67, v67, v67 row_ror:8 row_mask:0xf bank_mask:0xf
    v_mov_b32 v70, v60
    v_mov_b32 v71, v61
    v_mov_b32 v72, v62
    v_mov_b32 v73, v63
    v_mov_b32 v74, v64
    v_mov_b32 v75, v65
    v_mov_b32 v76, v66
    v_mov_b32 v77, v67
    s_nop 1
    v_permlane16_swap_b32 v60, v70
    v_permlane16_swap_b32 v61, v71
    v_permlane16_swap_b32 v62, v72
    v_permlane16_swap_b32 v63, v73
    v_permlane16_swap_b32 v64, v74
    v_permlane16_swap_b32 v65, v75
    v_permlane16_swap_b32 v66, v76
    v_permlane16_swap_b32 v67, v77
    s_nop 1
    v_add_f32 v60, v60, v70
    v_add_f32 v61, v61, v71
    v_add_f32 v62, v62, v72
    v_add_f32 v63, v63, v73
    v_add_f32 v64, v64, v74
    v_add_f32 v65, v65, v75
    v_add_f32 v66, v66, v76
    v_add_f32 v67, v67, v77
    v_mov_b32 v70, v60
    v_mov_b32 v71, v61
    v_mov_b32 v72, v62
    v_mov_b32 v73, v63
    v_mov_b32 v74, v64
    v_mov_b32 v75, v65
    v_mov_b32 v76, v66
    v_mov_b32 v77, v67
    s_nop 1
    v_permlane32_swap_b32 v60, v70
    v_permlane32_swap_b32 v61, v71
    v_permlane32_swap_b32 v62, v72
    v_permlane32_swap_b32 v63, v73
    v_permlane32_swap_b32 v64, v74
    v_permlane32_swap_b32 v65, v75
    v_permlane32_swap_b32 v66, v76
    v_permlane32_swap_b32 v67, v77
    s_nop 1
    v_add_f32 v60, v60, v70
    v_add_f32 v61, v61, v71
    v_add_f32 v62, v62, v72
    v_add_f32 v63, v63, v73
    v_add_f32 v64, v64, v74
    v_add_f32 v65, v65, v75
    v_add_f32 v66, v66, v76
    v_add_f32 v67, v67, v77
    s_mul_i32 s16, s3, 3641
    s_lshr_b32 s16, s16, 16
    s_cmp_eq_u32 s16, 1
    s_cselect_b32 s18, 1.0, 0
    s_cmp_eq_u32 s16, 4
    s_cselect_b32 s18, 1.0, s18
    v_cvt_pk_bf16_f32 v60, v60, v60
    v_lshlrev_b32 v60, 16, v60
    v_add_f32 v60, s18, v60
    v_cvt_pk_bf16_f32 v60, v60, v60
    v_lshlrev_b32 v60, 16, v60
    v_cvt_pk_bf16_f32 v61, v61, v61
    v_lshlrev_b32 v61, 16, v61
    v_add_f32 v61, s18, v61
    v_cvt_pk_bf16_f32 v61, v61, v61
    v_lshlrev_b32 v61, 16, v61
    v_cvt_pk_bf16_f32 v62, v62, v62
    v_lshlrev_b32 v62, 16, v62
    v_add_f32 v62, s18, v62
    v_cvt_pk_bf16_f32 v62, v62, v62
    v_lshlrev_b32 v62, 16, v62
    v_cvt_pk_bf16_f32 v63, v63, v63
    v_lshlrev_b32 v63, 16, v63
    v_add_f32 v63, s18, v63
    v_cvt_pk_bf16_f32 v63, v63, v63
    v_lshlrev_b32 v63, 16, v63
    v_cvt_pk_bf16_f32 v64, v64, v64
    v_lshlrev_b32 v64, 16, v64
    v_add_f32 v64, s18, v64
    v_cvt_pk_bf16_f32 v64, v64, v64
    v_lshlrev_b32 v64, 16, v64
    v_cvt_pk_bf16_f32 v65, v65, v65
    v_lshlrev_b32 v65, 16, v65
    v_add_f32 v65, s18, v65
    v_cvt_pk_bf16_f32 v65, v65, v65
    v_lshlrev_b32 v65, 16, v65
    v_cvt_pk_bf16_f32 v66, v66, v66
    v_lshlrev_b32 v66, 16, v66
    v_add_f32 v66, s18, v66
    v_cvt_pk_bf16_f32 v66, v66, v66
    v_lshlrev_b32 v66, 16, v66
    v_cvt_pk_bf16_f32 v67, v67, v67
    v_lshlrev_b32 v67, 16, v67
    v_add_f32 v67, s18, v67
    v_cvt_pk_bf16_f32 v67, v67, v67
    v_lshlrev_b32 v67, 16, v67
    s_lshl_b32 s17, s17, 1
    v_mov_b32 v9, 0
    s_mov_b64 exec, 1
    buffer_store_dwordx4 v[60:63], v9, s[28:31], s17 offen
    buffer_store_dwordx4 v[64:67], v9, s[28:31], s17 offen offset:16
    s_endpgm
K1_PF:
    v_subrev_u32 v1, 256, v0
    s_lshl_b32 s16, s3, 8
    v_add_u32 v1, s16, v1
    v_lshlrev_b32 v1, 4, v1
    s_waitcnt lgkmcnt(0)
    s_mov_b32 s20, s46
    s_mov_b32 s21, s47
    s_mov_b32 s22, 2359296
    s_mov_b32 s23, 0x00020000
    s_mov_b32 s24, s40
    s_mov_b32 s25, s41
    s_mov_b32 s26, 5308416
    s_mov_b32 s27, 0x00020000
    s_mov_b32 s28, s42
    s_mov_b32 s29, s43
    s_mov_b32 s30, 5308416
    s_mov_b32 s31, 0x00020000
    s_mov_b32 s32, s44
    s_mov_b32 s33, s45
    s_mov_b32 s34, 5308416
    s_mov_b32 s35, 0x00020000
    s_mov_b32 s52, s48
    s_mov_b32 s53, s49
    s_mov_b32 s54, 2359296
    s_mov_b32 s55, 0x00020000
    s_mov_b32 s56, s50
    s_mov_b32 s57, s51
    s_mov_b32 s58, 2359296
    s_mov_b32 s59, 0x00020000
    s_add_u32 s64, s8, 36864
    s_addc_u32 s65, s9, 0
    s_mov_b32 s66, 26624
    s_mov_b32 s67, 0x00020000
    s_cmp_lg_u32 s3, 0
    s_cbranch_scc1 K1_NOZ
    v_subrev_u32 v2, 256, v0
    v_lshlrev_b32 v2, 8, v2
    v_mov_b32 v3, 0
    buffer_store_dword v3, v2, s[64:67], 0 offen
K1_NOZ:
    v_subrev_u32 v2, 256, v0
    s_lshr_b32 s16, s3, 3
    s_lshl_b32 s16, s16, 8
    v_add_u32 v2, s16, v2
    v_lshrrev_b32 v3, 1, v2
    s_movk_i32 s16, 1152
    v_mul_lo_u32 v3, v3, s16
    v_and_b32 v2, 1, v2
    v_mul_u32_u24 v2, 140, v2
    s_and_b32 s16, s3, 7
    s_mul_i32 s16, s16, 144
    v_add3_u32 v3, v3, v2, s16
    s_mov_b32 s18, 1916928
    buffer_load_dword v70, v3, s[52:55], 0 offen
    buffer_load_dword v71, v3, s[56:59], 0 offen
    buffer_load_dword v72, v3, s[52:55], s18 offen
    buffer_load_dword v73, v3, s[56:59], s18 offen
    s_getpc_b64 s[60:61]
K1_PC:
    s_sub_u32 s60, s60, K1_PC-k1_kernel
    s_subb_u32 s61, s61, 0
    s_mov_b32 s62, CODE_END-k1_kernel
    s_mov_b32 s63, 0x00020000
    v_subrev_u32 v2, 256, v0
    s_lshr_b32 s16, s3, 3
    s_lshl_b32 s16, s16, 8
    v_add_u32 v2, s16, v2
    v_lshlrev_b32 v3, 4, v2
    buffer_load_dwordx4 v[76:79], v3, s[60:63], 0 offen
    s_mov_b32 s18, 53248
    buffer_load_dwordx4 v[80:83], v3, s[60:63], s18 offen
    s_add_u32 s72, s8, 45088768
    s_addc_u32 s73, s9, 0
    s_mov_b32 s74, 16384
    s_mov_b32 s75, 0x00020000
    s_lshl_b32 s16, s3, 2
    s_add_u32 s16, s16, s17
    s_sub_u32 s16, s16, 4
    v_and_b32 v100, 63, v0
    v_lshlrev_b32 v101, 4, v100
    s_mul_i32 s19, s16, 1152
    v_mov_b32 v28, 0
    v_mov_b32 v29, 0
    v_mov_b32 v30, 0
    v_mov_b32 v31, 0
    v_mov_b32 v36, 0
    v_mov_b32 v37, 0
    v_mov_b32 v38, 0
    v_mov_b32 v39, 0
    v_mov_b32 v44, 0
    v_mov_b32 v45, 0
    v_mov_b32 v46, 0
    v_mov_b32 v47, 0
    v_mov_b32 v52, 0
    v_mov_b32 v53, 0
    v_mov_b32 v54, 0
    v_mov_b32 v55, 0
    v_mov_b32 v60, 0
    v_mov_b32 v61, 0
    v_mov_b32 v62, 0
    v_mov_b32 v63, 0
    s_add_u32 s18, s19, 0
    buffer_load_dwordx4 v[24:27], v101, s[20:23], s18 offen
    s_mov_b64 exec, 0xff
    buffer_load_dwordx4 v[28:31], v101, s[20:23], s18 offen offset:1024
    s_mov_b64 exec, -1
    s_add_u32 s18, s19, 497664
    buffer_load_dwordx4 v[32:35], v101, s[20:23], s18 offen
    s_mov_b64 exec, 0xff
    buffer_load_dwordx4 v[36:39], v101, s[20:23], s18 offen offset:1024
    s_mov_b64 exec, -1
    s_add_u32 s18, s19, 995328
    buffer_load_dwordx4 v[40:43], v101, s[20:23], s18 offen
    s_mov_b64 exec, 0xff
    buffer_load_dwordx4 v[44:47], v101, s[20:23], s18 offen offset:1024
    s_mov_b64 exec, -1
    s_add_u32 s18, s19, 1492992
    buffer_load_dwordx4 v[48:51], v101, s[20:23], s18 offen
    s_mov_b64 exec, 0xff
    buffer_load_dwordx4 v[52:55], v101, s[20:23], s18 offen offset:1024
    s_mov_b64 exec, -1
    s_add_u32 s18, s19, 1990656
    buffer_load_dwordx4 v[56:59], v101, s[20:23], s18 offen
    s_mov_b64 exec, 0xff
    buffer_load_dwordx4 v[60:63], v101, s[20:23], s18 offen offset:1024
    s_mov_b64 exec, -1
    s_mov_b32 s18, 0
    buffer_load_dwordx4 v[4:7], v1, s[32:35], s18 offen
    s_mov_b32 s18, 442368
    buffer_load_dwordx4 v[8:11], v1, s[32:35], s18 offen
    s_mov_b32 s18, 884736
    buffer_load_dwordx4 v[12:15], v1, s[32:35], s18 offen
    s_mov_b32 s18, 1327104
    buffer_load_dwordx4 v[16:19], v1, s[32:35], s18 offen
    s_mov_b32 s18, 1769472
    buffer_load_dwordx4 v[4:7], v1, s[32:35], s18 offen
    s_mov_b32 s18, 2211840
    buffer_load_dwordx4 v[8:11], v1, s[32:35], s18 offen
    s_mov_b32 s18, 2654208
    buffer_load_dwordx4 v[12:15], v1, s[32:35], s18 offen
    s_mov_b32 s18, 3096576
    buffer_load_dwordx4 v[16:19], v1, s[32:35], s18 offen
    s_mov_b32 s18, 3538944
    buffer_load_dwordx4 v[4:7], v1, s[32:35], s18 offen
    s_mov_b32 s18, 3981312
    buffer_load_dwordx4 v[8:11], v1, s[32:35], s18 offen
    s_mov_b32 s18, 4423680
    buffer_load_dwordx4 v[12:15], v1, s[32:35], s18 offen
    s_mov_b32 s18, 4866048
    buffer_load_dwordx4 v[16:19], v1, s[32:35], s18 offen
    s_mov_b32 s18, 0
    buffer_load_dwordx4 v[4:7], v1, s[24:27], s18 offen
    s_mov_b32 s18, 442368
    buffer_load_dwordx4 v[8:11], v1, s[24:27], s18 offen
    s_mov_b32 s18, 884736
    buffer_load_dwordx4 v[12:15], v1, s[24:27], s18 offen
    s_mov_b32 s18, 1327104
    buffer_load_dwordx4 v[16:19], v1, s[24:27], s18 offen
    s_mov_b32 s18, 1769472
    buffer_load_dwordx4 v[4:7], v1, s[24:27], s18 offen
    s_mov_b32 s18, 2211840
    buffer_load_dwordx4 v[8:11], v1, s[24:27], s18 offen
    s_mov_b32 s18, 2654208
    buffer_load_dwordx4 v[12:15], v1, s[24:27], s18 offen
    s_mov_b32 s18, 3096576
    buffer_load_dwordx4 v[16:19], v1, s[24:27], s18 offen
    s_mov_b32 s18, 3538944
    buffer_load_dwordx4 v[4:7], v1, s[24:27], s18 offen
    s_mov_b32 s18, 3981312
    buffer_load_dwordx4 v[8:11], v1, s[24:27], s18 offen
    s_mov_b32 s18, 4423680
    buffer_load_dwordx4 v[12:15], v1, s[24:27], s18 offen
    s_mov_b32 s18, 4866048
    buffer_load_dwordx4 v[16:19], v1, s[24:27], s18 offen
    s_mov_b32 s18, 0
    buffer_load_dwordx4 v[4:7], v1, s[28:31], s18 offen
    s_mov_b32 s18, 442368
    buffer_load_dwordx4 v[8:11], v1, s[28:31], s18 offen
    s_mov_b32 s18, 884736
    buffer_load_dwordx4 v[12:15], v1, s[28:31], s18 offen
    s_mov_b32 s18, 1327104
    buffer_load_dwordx4 v[16:19], v1, s[28:31], s18 offen
    s_mov_b32 s18, 1769472
    buffer_load_dwordx4 v[4:7], v1, s[28:31], s18 offen
    s_mov_b32 s18, 2211840
    buffer_load_dwordx4 v[8:11], v1, s[28:31], s18 offen
    s_mov_b32 s18, 2654208
    buffer_load_dwordx4 v[12:15], v1, s[28:31], s18 offen
    s_mov_b32 s18, 3096576
    buffer_load_dwordx4 v[16:19], v1, s[28:31], s18 offen
    s_mov_b32 s18, 3538944
    buffer_load_dwordx4 v[4:7], v1, s[28:31], s18 offen
    s_mov_b32 s18, 3981312
    buffer_load_dwordx4 v[8:11], v1, s[28:31], s18 offen
    s_mov_b32 s18, 4423680
    buffer_load_dwordx4 v[12:15], v1, s[28:31], s18 offen
    s_mov_b32 s18, 4866048
    buffer_load_dwordx4 v[16:19], v1, s[28:31], s18 offen
    s_waitcnt vmcnt(44)
    v_lshlrev_b32 v102, 16, v24
    v_and_b32 v103, 0xffff0000, v24
    v_add_f32 v104, v102, v103
    v_mul_f32 v105, v102, v102
    v_fmac_f32 v105, v103, v103
    v_lshlrev_b32 v102, 16, v25
    v_and_b32 v103, 0xffff0000, v25
    v_add_f32 v104, v104, v102
    v_fmac_f32 v105, v102, v102
    v_add_f32 v104, v104, v103
    v_fmac_f32 v105, v103, v103
    v_lshlrev_b32 v102, 16, v26
    v_and_b32 v103, 0xffff0000, v26
    v_add_f32 v104, v104, v102
    v_fmac_f32 v105, v102, v102
    v_add_f32 v104, v104, v103
    v_fmac_f32 v105, v103, v103
    v_lshlrev_b32 v102, 16, v27
    v_and_b32 v103, 0xffff0000, v27
    v_add_f32 v104, v104, v102
    v_fmac_f32 v105, v102, v102
    v_add_f32 v104, v104, v103
    v_fmac_f32 v105, v103, v103
    v_lshlrev_b32 v102, 16, v28
    v_and_b32 v103, 0xffff0000, v28
    v_add_f32 v104, v104, v102
    v_fmac_f32 v105, v102, v102
    v_add_f32 v104, v104, v103
    v_fmac_f32 v105, v103, v103
    v_lshlrev_b32 v102, 16, v29
    v_and_b32 v103, 0xffff0000, v29
    v_add_f32 v104, v104, v102
    v_fmac_f32 v105, v102, v102
    v_add_f32 v104, v104, v103
    v_fmac_f32 v105, v103, v103
    v_lshlrev_b32 v102, 16, v30
    v_and_b32 v103, 0xffff0000, v30
    v_add_f32 v104, v104, v102
    v_fmac_f32 v105, v102, v102
    v_add_f32 v104, v104, v103
    v_fmac_f32 v105, v103, v103
    v_lshlrev_b32 v102, 16, v31
    v_and_b32 v103, 0xffff0000, v31
    v_add_f32 v104, v104, v102
    v_fmac_f32 v105, v102, v102
    v_add_f32 v104, v104, v103
    v_fmac_f32 v105, v103, v103
    s_nop 1
    v_add_f32_dpp v104, v104, v104 row_ror:1 row_mask:0xf bank_mask:0xf
    v_add_f32_dpp v105, v105, v105 row_ror:1 row_mask:0xf bank_mask:0xf
    s_nop 1
    v_add_f32_dpp v104, v104, v104 row_ror:2 row_mask:0xf bank_mask:0xf
    v_add_f32_dpp v105, v105, v105 row_ror:2 row_mask:0xf bank_mask:0xf
    s_nop 1
    v_add_f32_dpp v104, v104, v104 row_ror:4 row_mask:0xf bank_mask:0xf
    v_add_f32_dpp v105, v105, v105 row_ror:4 row_mask:0xf bank_mask:0xf
    s_nop 1
    v_add_f32_dpp v104, v104, v104 row_ror:8 row_mask:0xf bank_mask:0xf
    v_add_f32_dpp v105, v105, v105 row_ror:8 row_mask:0xf bank_mask:0xf
    v_mov_b32 v106, v104
    v_mov_b32 v107, v105
    s_nop 1
    v_permlane16_swap_b32 v104, v106
    v_permlane16_swap_b32 v105, v107
    s_nop 1
    v_add_f32 v104, v104, v106
    v_add_f32 v105, v105, v107
    v_mov_b32 v106, v104
    v_mov_b32 v107, v105
    s_nop 1
    v_permlane32_swap_b32 v104, v106
    v_permlane32_swap_b32 v105, v107
    s_nop 1
    v_add_f32 v104, v104, v106
    v_add_f32 v105, v105, v107
    s_mov_b32 s18, 0x3ae38e39
    v_mul_f32 v104, s18, v104
    v_mul_f32 v105, s18, v105
    v_fma_f32 v105, -v104, v104, v105
    v_max_f32 v105, 0, v105
    v_cvt_pk_bf16_f32 v104, v104, v104
    v_lshlrev_b32 v104, 16, v104
    v_cvt_pk_bf16_f32 v105, v105, v105
    v_lshlrev_b32 v105, 16, v105
    v_add_f32 v105, 0x3727c5ac, v105
    v_cvt_pk_bf16_f32 v105, v105, v105
    v_lshlrev_b32 v105, 16, v105
    v_sqrt_f32 v105, v105
    s_nop 0
    v_cvt_pk_bf16_f32 v105, v105, v105
    v_lshlrev_b32 v105, 16, v105
    v_rcp_f32 v105, v105
    s_nop 0
    v_mul_f32 v109, v104, v105
    v_sub_f32 v109, 0, v109
    v_mov_b32 v108, v105
    s_waitcnt vmcnt(42)
    v_lshlrev_b32 v102, 16, v32
    v_and_b32 v103, 0xffff0000, v32
    v_add_f32 v104, v102, v103
    v_mul_f32 v105, v102, v102
    v_fmac_f32 v105, v103, v103
    v_lshlrev_b32 v102, 16, v33
    v_and_b32 v103, 0xffff0000, v33
    v_add_f32 v104, v104, v102
    v_fmac_f32 v105, v102, v102
    v_add_f32 v104, v104, v103
    v_fmac_f32 v105, v103, v103
    v_lshlrev_b32 v102, 16, v34
    v_and_b32 v103, 0xffff0000, v34
    v_add_f32 v104, v104, v102
    v_fmac_f32 v105, v102, v102
    v_add_f32 v104, v104, v103
    v_fmac_f32 v105, v103, v103
    v_lshlrev_b32 v102, 16, v35
    v_and_b32 v103, 0xffff0000, v35
    v_add_f32 v104, v104, v102
    v_fmac_f32 v105, v102, v102
    v_add_f32 v104, v104, v103
    v_fmac_f32 v105, v103, v103
    v_lshlrev_b32 v102, 16, v36
    v_and_b32 v103, 0xffff0000, v36
    v_add_f32 v104, v104, v102
    v_fmac_f32 v105, v102, v102
    v_add_f32 v104, v104, v103
    v_fmac_f32 v105, v103, v103
    v_lshlrev_b32 v102, 16, v37
    v_and_b32 v103, 0xffff0000, v37
    v_add_f32 v104, v104, v102
    v_fmac_f32 v105, v102, v102
    v_add_f32 v104, v104, v103
    v_fmac_f32 v105, v103, v103
    v_lshlrev_b32 v102, 16, v38
    v_and_b32 v103, 0xffff0000, v38
    v_add_f32 v104, v104, v102
    v_fmac_f32 v105, v102, v102
    v_add_f32 v104, v104, v103
    v_fmac_f32 v105, v103, v103
    v_lshlrev_b32 v102, 16, v39
    v_and_b32 v103, 0xffff0000, v39
    v_add_f32 v104, v104, v102
    v_fmac_f32 v105, v102, v102
    v_add_f32 v104, v104, v103
    v_fmac_f32 v105, v103, v103
    s_nop 1
    v_add_f32_dpp v104, v104, v104 row_ror:1 row_mask:0xf bank_mask:0xf
    v_add_f32_dpp v105, v105, v105 row_ror:1 row_mask:0xf bank_mask:0xf
    s_nop 1
    v_add_f32_dpp v104, v104, v104 row_ror:2 row_mask:0xf bank_mask:0xf
    v_add_f32_dpp v105, v105, v105 row_ror:2 row_mask:0xf bank_mask:0xf
    s_nop 1
    v_add_f32_dpp v104, v104, v104 row_ror:4 row_mask:0xf bank_mask:0xf
    v_add_f32_dpp v105, v105, v105 row_ror:4 row_mask:0xf bank_mask:0xf
    s_nop 1
    v_add_f32_dpp v104, v104, v104 row_ror:8 row_mask:0xf bank_mask:0xf
    v_add_f32_dpp v105, v105, v105 row_ror:8 row_mask:0xf bank_mask:0xf
    v_mov_b32 v106, v104
    v_mov_b32 v107, v105
    s_nop 1
    v_permlane16_swap_b32 v104, v106
    v_permlane16_swap_b32 v105, v107
    s_nop 1
    v_add_f32 v104, v104, v106
    v_add_f32 v105, v105, v107
    v_mov_b32 v106, v104
    v_mov_b32 v107, v105
    s_nop 1
    v_permlane32_swap_b32 v104, v106
    v_permlane32_swap_b32 v105, v107
    s_nop 1
    v_add_f32 v104, v104, v106
    v_add_f32 v105, v105, v107
    s_mov_b32 s18, 0x3ae38e39
    v_mul_f32 v104, s18, v104
    v_mul_f32 v105, s18, v105
    v_fma_f32 v105, -v104, v104, v105
    v_max_f32 v105, 0, v105
    v_cvt_pk_bf16_f32 v104, v104, v104
    v_lshlrev_b32 v104, 16, v104
    v_cvt_pk_bf16_f32 v105, v105, v105
    v_lshlrev_b32 v105, 16, v105
    v_add_f32 v105, 0x3727c5ac, v105
    v_cvt_pk_bf16_f32 v105, v105, v105
    v_lshlrev_b32 v105, 16, v105
    v_sqrt_f32 v105, v105
    s_nop 0
    v_cvt_pk_bf16_f32 v105, v105, v105
    v_lshlrev_b32 v105, 16, v105
    v_rcp_f32 v105, v105
    s_nop 0
    v_mul_f32 v111, v104, v105
    v_sub_f32 v111, 0, v111
    v_mov_b32 v110, v105
    s_waitcnt vmcnt(40)
    v_lshlrev_b32 v102, 16, v40
    v_and_b32 v103, 0xffff0000, v40
    v_add_f32 v104, v102, v103
    v_mul_f32 v105, v102, v102
    v_fmac_f32 v105, v103, v103
    v_lshlrev_b32 v102, 16, v41
    v_and_b32 v103, 0xffff0000, v41
    v_add_f32 v104, v104, v102
    v_fmac_f32 v105, v102, v102
    v_add_f32 v104, v104, v103
    v_fmac_f32 v105, v103, v103
    v_lshlrev_b32 v102, 16, v42
    v_and_b32 v103, 0xffff0000, v42
    v_add_f32 v104, v104, v102
    v_fmac_f32 v105, v102, v102
    v_add_f32 v104, v104, v103
    v_fmac_f32 v105, v103, v103
    v_lshlrev_b32 v102, 16, v43
    v_and_b32 v103, 0xffff0000, v43
    v_add_f32 v104, v104, v102
    v_fmac_f32 v105, v102, v102
    v_add_f32 v104, v104, v103
    v_fmac_f32 v105, v103, v103
    v_lshlrev_b32 v102, 16, v44
    v_and_b32 v103, 0xffff0000, v44
    v_add_f32 v104, v104, v102
    v_fmac_f32 v105, v102, v102
    v_add_f32 v104, v104, v103
    v_fmac_f32 v105, v103, v103
    v_lshlrev_b32 v102, 16, v45
    v_and_b32 v103, 0xffff0000, v45
    v_add_f32 v104, v104, v102
    v_fmac_f32 v105, v102, v102
    v_add_f32 v104, v104, v103
    v_fmac_f32 v105, v103, v103
    v_lshlrev_b32 v102, 16, v46
    v_and_b32 v103, 0xffff0000, v46
    v_add_f32 v104, v104, v102
    v_fmac_f32 v105, v102, v102
    v_add_f32 v104, v104, v103
    v_fmac_f32 v105, v103, v103
    v_lshlrev_b32 v102, 16, v47
    v_and_b32 v103, 0xffff0000, v47
    v_add_f32 v104, v104, v102
    v_fmac_f32 v105, v102, v102
    v_add_f32 v104, v104, v103
    v_fmac_f32 v105, v103, v103
    s_nop 1
    v_add_f32_dpp v104, v104, v104 row_ror:1 row_mask:0xf bank_mask:0xf
    v_add_f32_dpp v105, v105, v105 row_ror:1 row_mask:0xf bank_mask:0xf
    s_nop 1
    v_add_f32_dpp v104, v104, v104 row_ror:2 row_mask:0xf bank_mask:0xf
    v_add_f32_dpp v105, v105, v105 row_ror:2 row_mask:0xf bank_mask:0xf
    s_nop 1
    v_add_f32_dpp v104, v104, v104 row_ror:4 row_mask:0xf bank_mask:0xf
    v_add_f32_dpp v105, v105, v105 row_ror:4 row_mask:0xf bank_mask:0xf
    s_nop 1
    v_add_f32_dpp v104, v104, v104 row_ror:8 row_mask:0xf bank_mask:0xf
    v_add_f32_dpp v105, v105, v105 row_ror:8 row_mask:0xf bank_mask:0xf
    v_mov_b32 v106, v104
    v_mov_b32 v107, v105
    s_nop 1
    v_permlane16_swap_b32 v104, v106
    v_permlane16_swap_b32 v105, v107
    s_nop 1
    v_add_f32 v104, v104, v106
    v_add_f32 v105, v105, v107
    v_mov_b32 v106, v104
    v_mov_b32 v107, v105
    s_nop 1
    v_permlane32_swap_b32 v104, v106
    v_permlane32_swap_b32 v105, v107
    s_nop 1
    v_add_f32 v104, v104, v106
    v_add_f32 v105, v105, v107
    s_mov_b32 s18, 0x3ae38e39
    v_mul_f32 v104, s18, v104
    v_mul_f32 v105, s18, v105
    v_fma_f32 v105, -v104, v104, v105
    v_max_f32 v105, 0, v105
    v_cvt_pk_bf16_f32 v104, v104, v104
    v_lshlrev_b32 v104, 16, v104
    v_cvt_pk_bf16_f32 v105, v105, v105
    v_lshlrev_b32 v105, 16, v105
    v_add_f32 v105, 0x3727c5ac, v105
    v_cvt_pk_bf16_f32 v105, v105, v105
    v_lshlrev_b32 v105, 16, v105
    v_sqrt_f32 v105, v105
    s_nop 0
    v_cvt_pk_bf16_f32 v105, v105, v105
    v_lshlrev_b32 v105, 16, v105
    v_rcp_f32 v105, v105
    s_nop 0
    v_mul_f32 v113, v104, v105
    v_sub_f32 v113, 0, v113
    v_mov_b32 v112, v105
    s_waitcnt vmcnt(38)
    v_lshlrev_b32 v102, 16, v48
    v_and_b32 v103, 0xffff0000, v48
    v_add_f32 v104, v102, v103
    v_mul_f32 v105, v102, v102
    v_fmac_f32 v105, v103, v103
    v_lshlrev_b32 v102, 16, v49
    v_and_b32 v103, 0xffff0000, v49
    v_add_f32 v104, v104, v102
    v_fmac_f32 v105, v102, v102
    v_add_f32 v104, v104, v103
    v_fmac_f32 v105, v103, v103
    v_lshlrev_b32 v102, 16, v50
    v_and_b32 v103, 0xffff0000, v50
    v_add_f32 v104, v104, v102
    v_fmac_f32 v105, v102, v102
    v_add_f32 v104, v104, v103
    v_fmac_f32 v105, v103, v103
    v_lshlrev_b32 v102, 16, v51
    v_and_b32 v103, 0xffff0000, v51
    v_add_f32 v104, v104, v102
    v_fmac_f32 v105, v102, v102
    v_add_f32 v104, v104, v103
    v_fmac_f32 v105, v103, v103
    v_lshlrev_b32 v102, 16, v52
    v_and_b32 v103, 0xffff0000, v52
    v_add_f32 v104, v104, v102
    v_fmac_f32 v105, v102, v102
    v_add_f32 v104, v104, v103
    v_fmac_f32 v105, v103, v103
    v_lshlrev_b32 v102, 16, v53
    v_and_b32 v103, 0xffff0000, v53
    v_add_f32 v104, v104, v102
    v_fmac_f32 v105, v102, v102
    v_add_f32 v104, v104, v103
    v_fmac_f32 v105, v103, v103
    v_lshlrev_b32 v102, 16, v54
    v_and_b32 v103, 0xffff0000, v54
    v_add_f32 v104, v104, v102
    v_fmac_f32 v105, v102, v102
    v_add_f32 v104, v104, v103
    v_fmac_f32 v105, v103, v103
    v_lshlrev_b32 v102, 16, v55
    v_and_b32 v103, 0xffff0000, v55
    v_add_f32 v104, v104, v102
    v_fmac_f32 v105, v102, v102
    v_add_f32 v104, v104, v103
    v_fmac_f32 v105, v103, v103
    s_nop 1
    v_add_f32_dpp v104, v104, v104 row_ror:1 row_mask:0xf bank_mask:0xf
    v_add_f32_dpp v105, v105, v105 row_ror:1 row_mask:0xf bank_mask:0xf
    s_nop 1
    v_add_f32_dpp v104, v104, v104 row_ror:2 row_mask:0xf bank_mask:0xf
    v_add_f32_dpp v105, v105, v105 row_ror:2 row_mask:0xf bank_mask:0xf
    s_nop 1
    v_add_f32_dpp v104, v104, v104 row_ror:4 row_mask:0xf bank_mask:0xf
    v_add_f32_dpp v105, v105, v105 row_ror:4 row_mask:0xf bank_mask:0xf
    s_nop 1
    v_add_f32_dpp v104, v104, v104 row_ror:8 row_mask:0xf bank_mask:0xf
    v_add_f32_dpp v105, v105, v105 row_ror:8 row_mask:0xf bank_mask:0xf
    v_mov_b32 v106, v104
    v_mov_b32 v107, v105
    s_nop 1
    v_permlane16_swap_b32 v104, v106
    v_permlane16_swap_b32 v105, v107
    s_nop 1
    v_add_f32 v104, v104, v106
    v_add_f32 v105, v105, v107
    v_mov_b32 v106, v104
    v_mov_b32 v107, v105
    s_nop 1
    v_permlane32_swap_b32 v104, v106
    v_permlane32_swap_b32 v105, v107
    s_nop 1
    v_add_f32 v104, v104, v106
    v_add_f32 v105, v105, v107
    s_mov_b32 s18, 0x3ae38e39
    v_mul_f32 v104, s18, v104
    v_mul_f32 v105, s18, v105
    v_fma_f32 v105, -v104, v104, v105
    v_max_f32 v105, 0, v105
    v_cvt_pk_bf16_f32 v104, v104, v104
    v_lshlrev_b32 v104, 16, v104
    v_cvt_pk_bf16_f32 v105, v105, v105
    v_lshlrev_b32 v105, 16, v105
    v_add_f32 v105, 0x3727c5ac, v105
    v_cvt_pk_bf16_f32 v105, v105, v105
    v_lshlrev_b32 v105, 16, v105
    v_sqrt_f32 v105, v105
    s_nop 0
    v_cvt_pk_bf16_f32 v105, v105, v105
    v_lshlrev_b32 v105, 16, v105
    v_rcp_f32 v105, v105
    s_nop 0
    v_mul_f32 v115, v104, v105
    v_sub_f32 v115, 0, v115
    v_mov_b32 v114, v105
    s_waitcnt vmcnt(36)
    v_lshlrev_b32 v102, 16, v56
    v_and_b32 v103, 0xffff0000, v56
    v_add_f32 v104, v102, v103
    v_mul_f32 v105, v102, v102
    v_fmac_f32 v105, v103, v103
    v_lshlrev_b32 v102, 16, v57
    v_and_b32 v103, 0xffff0000, v57
    v_add_f32 v104, v104, v102
    v_fmac_f32 v105, v102, v102
    v_add_f32 v104, v104, v103
    v_fmac_f32 v105, v103, v103
    v_lshlrev_b32 v102, 16, v58
    v_and_b32 v103, 0xffff0000, v58
    v_add_f32 v104, v104, v102
    v_fmac_f32 v105, v102, v102
    v_add_f32 v104, v104, v103
    v_fmac_f32 v105, v103, v103
    v_lshlrev_b32 v102, 16, v59
    v_and_b32 v103, 0xffff0000, v59
    v_add_f32 v104, v104, v102
    v_fmac_f32 v105, v102, v102
    v_add_f32 v104, v104, v103
    v_fmac_f32 v105, v103, v103
    v_lshlrev_b32 v102, 16, v60
    v_and_b32 v103, 0xffff0000, v60
    v_add_f32 v104, v104, v102
    v_fmac_f32 v105, v102, v102
    v_add_f32 v104, v104, v103
    v_fmac_f32 v105, v103, v103
    v_lshlrev_b32 v102, 16, v61
    v_and_b32 v103, 0xffff0000, v61
    v_add_f32 v104, v104, v102
    v_fmac_f32 v105, v102, v102
    v_add_f32 v104, v104, v103
    v_fmac_f32 v105, v103, v103
    v_lshlrev_b32 v102, 16, v62
    v_and_b32 v103, 0xffff0000, v62
    v_add_f32 v104, v104, v102
    v_fmac_f32 v105, v102, v102
    v_add_f32 v104, v104, v103
    v_fmac_f32 v105, v103, v103
    v_lshlrev_b32 v102, 16, v63
    v_and_b32 v103, 0xffff0000, v63
    v_add_f32 v104, v104, v102
    v_fmac_f32 v105, v102, v102
    v_add_f32 v104, v104, v103
    v_fmac_f32 v105, v103, v103
    s_nop 1
    v_add_f32_dpp v104, v104, v104 row_ror:1 row_mask:0xf bank_mask:0xf
    v_add_f32_dpp v105, v105, v105 row_ror:1 row_mask:0xf bank_mask:0xf
    s_nop 1
    v_add_f32_dpp v104, v104, v104 row_ror:2 row_mask:0xf bank_mask:0xf
    v_add_f32_dpp v105, v105, v105 row_ror:2 row_mask:0xf bank_mask:0xf
    s_nop 1
    v_add_f32_dpp v104, v104, v104 row_ror:4 row_mask:0xf bank_mask:0xf
    v_add_f32_dpp v105, v105, v105 row_ror:4 row_mask:0xf bank_mask:0xf
    s_nop 1
    v_add_f32_dpp v104, v104, v104 row_ror:8 row_mask:0xf bank_mask:0xf
    v_add_f32_dpp v105, v105, v105 row_ror:8 row_mask:0xf bank_mask:0xf
    v_mov_b32 v106, v104
    v_mov_b32 v107, v105
    s_nop 1
    v_permlane16_swap_b32 v104, v106
    v_permlane16_swap_b32 v105, v107
    s_nop 1
    v_add_f32 v104, v104, v106
    v_add_f32 v105, v105, v107
    v_mov_b32 v106, v104
    v_mov_b32 v107, v105
    s_nop 1
    v_permlane32_swap_b32 v104, v106
    v_permlane32_swap_b32 v105, v107
    s_nop 1
    v_add_f32 v104, v104, v106
    v_add_f32 v105, v105, v107
    s_mov_b32 s18, 0x3ae38e39
    v_mul_f32 v104, s18, v104
    v_mul_f32 v105, s18, v105
    v_fma_f32 v105, -v104, v104, v105
    v_max_f32 v105, 0, v105
    v_cvt_pk_bf16_f32 v104, v104, v104
    v_lshlrev_b32 v104, 16, v104
    v_cvt_pk_bf16_f32 v105, v105, v105
    v_lshlrev_b32 v105, 16, v105
    v_add_f32 v105, 0x3727c5ac, v105
    v_cvt_pk_bf16_f32 v105, v105, v105
    v_lshlrev_b32 v105, 16, v105
    v_sqrt_f32 v105, v105
    s_nop 0
    v_cvt_pk_bf16_f32 v105, v105, v105
    v_lshlrev_b32 v105, 16, v105
    v_rcp_f32 v105, v105
    s_nop 0
    v_mul_f32 v117, v104, v105
    v_sub_f32 v117, 0, v117
    v_mov_b32 v116, v105
    s_lshl_b32 s19, s16, 3
    v_mov_b32 v102, 0
    s_mov_b64 exec, 1
    s_add_u32 s18, s19, 0
    buffer_store_dwordx2 v[108:109], v102, s[72:75], s18 offen
    s_add_u32 s18, s19, 3456
    buffer_store_dwordx2 v[110:111], v102, s[72:75], s18 offen
    s_add_u32 s18, s19, 6912
    buffer_store_dwordx2 v[112:113], v102, s[72:75], s18 offen
    s_add_u32 s18, s19, 10368
    buffer_store_dwordx2 v[114:115], v102, s[72:75], s18 offen
    s_add_u32 s18, s19, 13824
    buffer_store_dwordx2 v[116:117], v102, s[72:75], s18 offen
    s_mov_b64 exec, -1
    s_waitcnt vmcnt(0)
K1_END:
    s_endpgm
.globl k34_kernel
.p2align 8
.type k34_kernel,@function
k34_kernel:
    s_cmp_ge_u32 s2, 256
    s_cbranch_scc1 K34_END
    s_load_dwordx4 s[4:7], s[0:1], 56
    s_load_dwordx2 s[8:9], s[0:1], 72
    s_load_dwordx4 s[48:51], s[0:1], 104
    s_load_dwordx2 s[78:79], s[0:1], 0
    s_load_dwordx2 s[80:81], s[0:1], 96
    v_lshrrev_b32 v1, 6, v0
    v_and_b32 v2, 63, v0
    s_nop 0
    v_readfirstlane_b32 s17, v1
    s_and_b32 s10, s2, 7
    s_lshr_b32 s11, s2, 3
    s_and_b32 s18, s10, 1
    s_lshr_b32 s10, s10, 1
    s_lshl_b32 s12, s18, 2
    s_and_b32 s14, s11, 3
    s_add_u32 s12, s12, s14
    s_lshl_b32 s13, s10, 3
    s_lshr_b32 s14, s11, 2
    s_add_u32 s13, s13, s14
    s_lshl_b32 s52, s18, 3
    s_and_b32 s14, s11, 7
    s_add_u32 s52, s52, s14
    s_lshr_b32 s14, s11, 3
    s_and_b32 s15, s17, 3
    s_and_b32 s16, s13, 1
    v_lshlrev_b32 v3, 4, v2
    s_waitcnt lgkmcnt(0)
    s_add_u32 s84, s50, 4784128
    s_addc_u32 s85, s51, 0
    s_mov_b32 s86, 2359296
    s_mov_b32 s87, 0x00020000
    s_add_u32 s88, s50, 8192
    s_addc_u32 s89, s51, 0
    s_mov_b32 s90, 45096960
    s_mov_b32 s91, 0x00020000
    s_add_u32 s60, s50, 36864
    s_addc_u32 s61, s51, 0
    s_mov_b32 s62, 26624
    s_mov_b32 s63, 0x00020000
    v_mov_b32 v7, 155648
    v_mov_b32 v23, 0
    ds_write_b32 v7, v23
    s_add_u32 s18, s12, 32
    s_lshl_b32 s18, s18, 8
    v_mov_b32 v19, s18
    v_mov_b32 v22, 1
    s_mov_b32 s92, s78
    s_mov_b32 s93, s79
    s_mov_b32 s94, 2359296
    s_mov_b32 s95, 0x00020000
    s_add_u32 s96, s50, 65536
    s_addc_u32 s97, s51, 0
    s_mov_b32 s98, 2359296
    s_mov_b32 s99, 0x00020000
    s_lshl_b32 s18, s12, 4
    s_lshr_b32 s19, s13, 1
    s_add_u32 s82, s18, s19
    s_lshl_b32 s18, s12, 8
    s_lshl_b32 s19, s13, 3
    s_add_u32 s83, s18, s19
    v_and_b32 v24, 7, v2
    v_lshrrev_b32 v25, 3, v2
    v_lshlrev_b32 v26, 5, v2
    s_mul_i32 s18, s82, 18432
    s_lshl_b32 s19, s16, 4
    s_add_u32 s18, s18, s19
    s_lshl_b32 s19, s17, 11
    s_add_u32 s19, s19, s18
    s_lshl_b32 s77, s17, 10
    s_add_u32 m0, s77, 49152
    v_add_u32 v27, s83, v24
    buffer_load_dwordx4 v26, s[96:99], s19 offen lds
    v_lshlrev_b32 v29, 3, v27
    s_movk_i32 s19, 1152
    v_mul_lo_u32 v27, v27, s19
    v_lshlrev_b32 v28, 4, v25
    s_lshl_b32 s19, s17, 7
    v_add_u32 v28, s19, v28
    v_add_u32 v27, v27, v28
    v_lshlrev_b32 v28, 1, v28
    s_mov_b32 s76, 45080576
    buffer_load_dwordx2 v[104:105], v29, s[88:91], s76 offen
    buffer_load_dwordx4 v[32:35], v27, s[92:95], 0 offen
    s_movk_i32 s19, 0
    buffer_load_dwordx4 v[36:39], v28, s[88:91], s19 offen
    buffer_load_dwordx4 v[40:43], v28, s[88:91], s19 offen offset:16
    s_movk_i32 s19, 2304
    buffer_load_dwordx4 v[44:47], v28, s[88:91], s19 offen
    buffer_load_dwordx4 v[48:51], v28, s[88:91], s19 offen offset:16
    s_movk_i32 s19, 4608
    buffer_load_dwordx4 v[52:55], v28, s[88:91], s19 offen
    buffer_load_dwordx4 v[56:59], v28, s[88:91], s19 offen offset:16
    s_movk_i32 s19, 6912
    buffer_load_dwordx4 v[60:63], v28, s[88:91], s19 offen
    buffer_load_dwordx4 v[64:67], v28, s[88:91], s19 offen offset:16
    s_movk_i32 s19, 9216
    buffer_load_dwordx4 v[68:71], v28, s[88:91], s19 offen
    buffer_load_dwordx4 v[72:75], v28, s[88:91], s19 offen offset:16
    s_cmp_lg_u32 s17, 0
    s_cbranch_scc1 LN_L1_S
    s_add_u32 s19, s18, 16384
    s_mov_b32 m0, 57344
    s_nop 0
    buffer_load_dwordx4 v26, s[96:99], s19 offen lds
    buffer_load_dwordx4 v[112:115], v27, s[92:95], 0 offen offset:1024
    s_movk_i32 s19, 2048
    buffer_load_dwordx4 v[116:119], v28, s[88:91], s19 offen
    buffer_load_dwordx4 v[120:123], v28, s[88:91], s19 offen offset:16
    s_movk_i32 s19, 4352
    buffer_load_dwordx4 v[124:127], v28, s[88:91], s19 offen
    buffer_load_dwordx4 v[128:131], v28, s[88:91], s19 offen offset:16
    s_movk_i32 s19, 6656
    buffer_load_dwordx4 v[132:135], v28, s[88:91], s19 offen
    buffer_load_dwordx4 v[136:139], v28, s[88:91], s19 offen offset:16
    s_movk_i32 s19, 8960
    buffer_load_dwordx4 v[140:143], v28, s[88:91], s19 offen
    buffer_load_dwordx4 v[144:147], v28, s[88:91], s19 offen offset:16
    s_movk_i32 s19, 11264
    buffer_load_dwordx4 v[148:151], v28, s[88:91], s19 offen
    buffer_load_dwordx4 v[152:155], v28, s[88:91], s19 offen offset:16
LN_L1_S:
    v_lshrrev_b32 v29, 4, v2
    v_lshlrev_b32 v29, 8, v29
    v_bfe_u32 v30, v2, 1, 1
    v_lshl_add_u32 v29, v30, 7, v29
    v_bfe_u32 v30, v2, 2, 2
    v_lshl_add_u32 v29, v30, 4, v29
    v_and_b32 v30, 1, v2
    v_lshl_add_u32 v29, v30, 3, v29
    s_add_u32 s19, s77, 49152
    v_add_u32 v29, s19, v29
    v_lshlrev_b32 v31, 3, v24
    v_add_u32 v31, 59392, v31
    s_lshl_b32 s19, s17, 6
    v_add_u32 v30, s19, v31
    v_lshrrev_b32 v26, 2, v25
    v_lshlrev_b32 v26, 10, v26
    v_and_b32 v28, 3, v25
    v_lshl_add_u32 v26, v28, 8, v26
    v_lshl_add_u32 v26, v24, 4, v26
    s_waitcnt vmcnt(0)
    s_add_u32 s92, s50, 2424832
    s_addc_u32 s93, s51, 0
    s_mov_b32 s94, 2359296
    s_mov_b32 s95, 0x00020000
    ds_read_b64_tr_b16 v[96:97], v29
    ds_read_b64_tr_b16 v[98:99], v29 offset:64
    v_mov_b32 v106, v105
    v_mov_b32 v107, v105
    v_mov_b32 v105, v104
    v_lshlrev_b32 v80, 16, v32
    v_and_b32 v81, 0xffff0000, v32
    v_lshlrev_b32 v82, 16, v33
    v_and_b32 v83, 0xffff0000, v33
    v_lshlrev_b32 v84, 16, v34
    v_and_b32 v85, 0xffff0000, v34
    v_lshlrev_b32 v86, 16, v35
    v_and_b32 v87, 0xffff0000, v35
    s_waitcnt lgkmcnt(0)
    v_lshlrev_b32 v160, 16, v96
    v_and_b32 v161, 0xffff0000, v96
    v_lshlrev_b32 v162, 16, v97
    v_and_b32 v163, 0xffff0000, v97
    v_lshlrev_b32 v164, 16, v98
    v_and_b32 v165, 0xffff0000, v98
    v_lshlrev_b32 v166, 16, v99
    v_and_b32 v167, 0xffff0000, v99
    v_pk_fma_f32 v[108:109], v[80:81], v[104:105], v[106:107]
    v_pk_fma_f32 v[108:109], v[108:109], v[44:45], v[36:37]
    v_pk_mul_f32 v[108:109], v[108:109], v[160:161]
    v_pk_fma_f32 v[80:81], v[108:109], v[52:53], v[80:81]
    v_pk_fma_f32 v[108:109], v[82:83], v[104:105], v[106:107]
    v_pk_fma_f32 v[108:109], v[108:109], v[46:47], v[38:39]
    v_pk_mul_f32 v[108:109], v[108:109], v[162:163]
    v_pk_fma_f32 v[82:83], v[108:109], v[54:55], v[82:83]
    v_pk_fma_f32 v[108:109], v[84:85], v[104:105], v[106:107]
    v_pk_fma_f32 v[108:109], v[108:109], v[48:49], v[40:41]
    v_pk_mul_f32 v[108:109], v[108:109], v[164:165]
    v_pk_fma_f32 v[84:85], v[108:109], v[56:57], v[84:85]
    v_pk_fma_f32 v[108:109], v[86:87], v[104:105], v[106:107]
    v_pk_fma_f32 v[108:109], v[108:109], v[50:51], v[42:43]
    v_pk_mul_f32 v[108:109], v[108:109], v[166:167]
    v_pk_fma_f32 v[86:87], v[108:109], v[58:59], v[86:87]
    v_cvt_pk_bf16_f32 v32, v80, v81
    v_cvt_pk_bf16_f32 v33, v82, v83
    v_cvt_pk_bf16_f32 v34, v84, v85
    v_cvt_pk_bf16_f32 v35, v86, v87
    v_lshlrev_b32 v80, 16, v32
    v_and_b32 v81, 0xffff0000, v32
    v_lshlrev_b32 v82, 16, v33
    v_and_b32 v83, 0xffff0000, v33
    v_lshlrev_b32 v84, 16, v34
    v_and_b32 v85, 0xffff0000, v34
    v_lshlrev_b32 v86, 16, v35
    v_and_b32 v87, 0xffff0000, v35
    buffer_store_dwordx4 v[32:35], v27, s[84:87], 0 offen sc1
    v_pk_mul_f32 v[78:79], v[80:81], v[80:81]
    v_mov_b32 v76, v80
    v_mov_b32 v77, v81
    v_pk_fma_f32 v[78:79], v[82:83], v[82:83], v[78:79]
    v_pk_add_f32 v[76:77], v[76:77], v[82:83]
    v_pk_fma_f32 v[78:79], v[84:85], v[84:85], v[78:79]
    v_pk_add_f32 v[76:77], v[76:77], v[84:85]
    v_pk_fma_f32 v[78:79], v[86:87], v[86:87], v[78:79]
    v_pk_add_f32 v[76:77], v[76:77], v[86:87]
    s_cmp_lg_u32 s17, 0
    s_cbranch_scc1 LN_B_S
    ds_read_b64_tr_b16 v[100:101], v29 offset:8192
    ds_read_b64_tr_b16 v[102:103], v29 offset:8256
    v_lshlrev_b32 v88, 16, v112
    v_and_b32 v89, 0xffff0000, v112
    v_lshlrev_b32 v90, 16, v113
    v_and_b32 v91, 0xffff0000, v113
    v_lshlrev_b32 v92, 16, v114
    v_and_b32 v93, 0xffff0000, v114
    v_lshlrev_b32 v94, 16, v115
    v_and_b32 v95, 0xffff0000, v115
    s_waitcnt lgkmcnt(0)
    v_lshlrev_b32 v160, 16, v100
    v_and_b32 v161, 0xffff0000, v100
    v_lshlrev_b32 v162, 16, v101
    v_and_b32 v163, 0xffff0000, v101
    v_lshlrev_b32 v164, 16, v102
    v_and_b32 v165, 0xffff0000, v102
    v_lshlrev_b32 v166, 16, v103
    v_and_b32 v167, 0xffff0000, v103
    v_pk_fma_f32 v[108:109], v[88:89], v[104:105], v[106:107]
    v_pk_fma_f32 v[108:109], v[108:109], v[124:125], v[116:117]
    v_pk_mul_f32 v[108:109], v[108:109], v[160:161]
    v_pk_fma_f32 v[88:89], v[108:109], v[132:133], v[88:89]
    v_pk_fma_f32 v[108:109], v[90:91], v[104:105], v[106:107]
    v_pk_fma_f32 v[108:109], v[108:109], v[126:127], v[118:119]
    v_pk_mul_f32 v[108:109], v[108:109], v[162:163]
    v_pk_fma_f32 v[90:91], v[108:109], v[134:135], v[90:91]
    v_pk_fma_f32 v[108:109], v[92:93], v[104:105], v[106:107]
    v_pk_fma_f32 v[108:109], v[108:109], v[128:129], v[120:121]
    v_pk_mul_f32 v[108:109], v[108:109], v[164:165]
    v_pk_fma_f32 v[92:93], v[108:109], v[136:137], v[92:93]
    v_pk_fma_f32 v[108:109], v[94:95], v[104:105], v[106:107]
    v_pk_fma_f32 v[108:109], v[108:109], v[130:131], v[122:123]
    v_pk_mul_f32 v[108:109], v[108:109], v[166:167]
    v_pk_fma_f32 v[94:95], v[108:109], v[138:139], v[94:95]
    v_cvt_pk_bf16_f32 v112, v88, v89
    v_cvt_pk_bf16_f32 v113, v90, v91
    v_cvt_pk_bf16_f32 v114, v92, v93
    v_cvt_pk_bf16_f32 v115, v94, v95
    v_lshlrev_b32 v88, 16, v112
    v_and_b32 v89, 0xffff0000, v112
    v_lshlrev_b32 v90, 16, v113
    v_and_b32 v91, 0xffff0000, v113
    v_lshlrev_b32 v92, 16, v114
    v_and_b32 v93, 0xffff0000, v114
    v_lshlrev_b32 v94, 16, v115
    v_and_b32 v95, 0xffff0000, v115
    buffer_store_dwordx4 v[112:115], v27, s[84:87], 0 offen offset:1024 sc1
    v_pk_fma_f32 v[78:79], v[88:89], v[88:89], v[78:79]
    v_pk_add_f32 v[76:77], v[76:77], v[88:89]
    v_pk_fma_f32 v[78:79], v[90:91], v[90:91], v[78:79]
    v_pk_add_f32 v[76:77], v[76:77], v[90:91]
    v_pk_fma_f32 v[78:79], v[92:93], v[92:93], v[78:79]
    v_pk_add_f32 v[76:77], v[76:77], v[92:93]
    v_pk_fma_f32 v[78:79], v[94:95], v[94:95], v[78:79]
    v_pk_add_f32 v[76:77], v[76:77], v[94:95]
LN_B_S:
    v_add_f32 v104, v76, v77
    v_add_f32 v105, v78, v79
    s_nop 1
    v_add_f32_dpp v104, v104, v104 row_ror:8 row_mask:0xf bank_mask:0xf
    v_add_f32_dpp v105, v105, v105 row_ror:8 row_mask:0xf bank_mask:0xf
    v_mov_b32 v106, v104
    v_mov_b32 v107, v105
    s_nop 1
    v_permlane16_swap_b32 v104, v106
    v_permlane16_swap_b32 v105, v107
    s_nop 1
    v_add_f32 v104, v104, v106
    v_add_f32 v105, v105, v107
    v_mov_b32 v106, v104
    v_mov_b32 v107, v105
    s_nop 1
    v_permlane32_swap_b32 v104, v106
    v_permlane32_swap_b32 v105, v107
    s_nop 1
    v_add_f32 v104, v104, v106
    v_add_f32 v105, v105, v107
    ds_write_b64 v30, v[104:105]
    s_waitcnt lgkmcnt(0)
    s_barrier
    ds_read_b64 v[36:37], v31 offset:0
    ds_read_b64 v[38:39], v31 offset:64
    ds_read_b64 v[40:41], v31 offset:128
    ds_read_b64 v[42:43], v31 offset:192
    ds_read_b64 v[44:45], v31 offset:256
    ds_read_b64 v[46:47], v31 offset:320
    ds_read_b64 v[48:49], v31 offset:384
    ds_read_b64 v[50:51], v31 offset:448
    s_mul_i32 s18, s82, 18432
    s_lshl_b32 s19, s16, 7
    s_add_u32 s83, s18, s19
    s_lshl_b32 s19, s17, 11
    s_add_u32 s19, s19, s83
    s_waitcnt lgkmcnt(0)
    v_pk_add_f32 v[36:37], v[36:37], v[38:39]
    v_pk_add_f32 v[40:41], v[40:41], v[42:43]
    v_pk_add_f32 v[44:45], v[44:45], v[46:47]
    v_pk_add_f32 v[48:49], v[48:49], v[50:51]
    v_pk_add_f32 v[36:37], v[36:37], v[40:41]
    v_pk_add_f32 v[44:45], v[44:45], v[48:49]
    v_pk_add_f32 v[36:37], v[36:37], v[44:45]
    s_mov_b32 s18, 0x3ae38e39
    v_mul_f32 v106, s18, v36
    v_mul_f32 v104, s18, v37
    v_fma_f32 v104, -v106, v106, v104
    v_max_f32 v104, 0, v104
    v_cvt_pk_bf16_f32 v106, v106, v106
    v_lshlrev_b32 v106, 16, v106
    v_cvt_pk_bf16_f32 v104, v104, v104
    v_lshlrev_b32 v104, 16, v104
    v_add_f32 v104, 0x3727c5ac, v104
    v_cvt_pk_bf16_f32 v104, v104, v104
    v_lshlrev_b32 v104, 16, v104
    v_sqrt_f32 v104, v104
    s_nop 0
    v_cvt_pk_bf16_f32 v104, v104, v104
    v_lshlrev_b32 v104, 16, v104
    v_rcp_f32 v104, v104
    s_nop 0
    v_mul_f32 v106, v106, v104
    v_sub_f32 v106, 0, v106
    v_mov_b32 v105, v104
    v_mov_b32 v107, v106
    v_pk_fma_f32 v[80:81], v[80:81], v[104:105], v[106:107]
    v_pk_fma_f32 v[80:81], v[80:81], v[68:69], v[60:61]
    v_pk_fma_f32 v[82:83], v[82:83], v[104:105], v[106:107]
    v_pk_fma_f32 v[82:83], v[82:83], v[70:71], v[62:63]
    v_pk_fma_f32 v[84:85], v[84:85], v[104:105], v[106:107]
    v_pk_fma_f32 v[84:85], v[84:85], v[72:73], v[64:65]
    v_pk_fma_f32 v[86:87], v[86:87], v[104:105], v[106:107]
    v_pk_fma_f32 v[86:87], v[86:87], v[74:75], v[66:67]
    v_cvt_pk_bf16_f32 v96, v80, v81
    v_cvt_pk_bf16_f32 v97, v82, v83
    v_cvt_pk_bf16_f32 v98, v84, v85
    v_cvt_pk_bf16_f32 v99, v86, v87
    buffer_store_dwordx4 v[96:99], v26, s[92:95], s19 offen sc1
    s_cmp_lg_u32 s17, 0
    s_cbranch_scc1 LN_D_S
    v_pk_fma_f32 v[88:89], v[88:89], v[104:105], v[106:107]
    v_pk_fma_f32 v[88:89], v[88:89], v[148:149], v[140:141]
    v_pk_fma_f32 v[90:91], v[90:91], v[104:105], v[106:107]
    v_pk_fma_f32 v[90:91], v[90:91], v[150:151], v[142:143]
    v_pk_fma_f32 v[92:93], v[92:93], v[104:105], v[106:107]
    v_pk_fma_f32 v[92:93], v[92:93], v[152:153], v[144:145]
    v_pk_fma_f32 v[94:95], v[94:95], v[104:105], v[106:107]
    v_pk_fma_f32 v[94:95], v[94:95], v[154:155], v[146:147]
    v_cvt_pk_bf16_f32 v100, v88, v89
    v_cvt_pk_bf16_f32 v101, v90, v91
    v_cvt_pk_bf16_f32 v102, v92, v93
    v_cvt_pk_bf16_f32 v103, v94, v95
    s_add_u32 s19, s83, 16384
    buffer_store_dwordx4 v[100:103], v26, s[92:95], s19 offen sc1
LN_D_S:
    s_waitcnt vmcnt(0)
    s_barrier
    s_cmp_lg_u32 s17, 4
    s_cbranch_scc1 K34_SIGLN
    s_mov_b64 exec, 1
    buffer_atomic_add v22, v19, s[60:63], 0 offen sc1
    s_mov_b64 exec, -1
K34_SIGLN:
    s_cmp_ge_u32 s17, 4
    s_cbranch_scc1 K34_LOADER
    s_add_u32 s32, s50, 7340032
    s_addc_u32 s33, s51, 0
    s_mov_b32 s34, 18874368
    s_mov_b32 s35, 0x00020000
    s_add_u32 s36, s50, 26214400
    s_addc_u32 s37, s51, 0
    s_mov_b32 s38, 9437184
    s_mov_b32 s39, 0x00020000
    s_lshl_b32 s18, s15, 12
    v_add_u32 v4, s18, v3
    s_lshl_b32 s18, s15, 11
    v_add_u32 v6, s18, v3
    v_add_u32 v5, 0x8000, v4
    v_add_u32 v7, 0x8000, v6
    v_lshrrev_b32 v14, 2, v2
    v_and_b32 v15, 3, v2
    v_mul_u32_u24 v8, 160, v14
    v_lshl_add_u32 v8, v15, 3, v8
    v_add_u32 v8, 81920, v8
    s_lshl_b32 s18, s16, 7
    s_xor_b32 s18, s18, 128
    v_add_u32 v10, s18, v8
    v_add_u32 v11, 0x8000, v10
    s_lshl_b32 s18, s16, 5
    v_add_u32 v8, s18, v8
    v_add_u32 v9, 0x8000, v8
    v_mul_u32_u24 v12, 288, v14
    v_lshl_add_u32 v12, v15, 3, v12
    v_add_u32 v12, 81920, v12
    v_add_u32 v13, 0x8000, v12
    s_lshl_b32 s19, s12, 4
    s_lshl_b32 s18, s15, 2
    s_add_u32 s19, s19, s18
    s_mul_i32 s19, s19, 144
    s_mul_i32 s18, s13, 9
    s_cmp_eq_u32 s16, 0
    s_cselect_b32 s40, 4, 1
    s_cselect_b32 s41, 0, 5
    s_cselect_b32 s42, 8, 0
    s_add_u32 s40, s40, s18
    s_lshr_b32 s40, s40, 1
    s_add_u32 s40, s40, s19
    s_lshl_b32 s40, s40, 10
    s_add_u32 s41, s41, s18
    s_lshr_b32 s41, s41, 1
    s_add_u32 s41, s41, s19
    s_lshl_b32 s41, s41, 10
    s_add_u32 s42, s42, s18
    s_lshr_b32 s42, s42, 1
    s_add_u32 s42, s42, s19
    s_lshl_b32 s42, s42, 10
    s_lshl_b32 s18, s16, 3
    s_add_u32 s42, s42, s18
    s_barrier
    ds_read_b128 v[16:19], v4 offset:0
    ds_read_b128 v[20:23], v4 offset:1024
    ds_read_b128 v[24:27], v4 offset:2048
    ds_read_b128 v[28:31], v4 offset:3072
    ds_read_b64_tr_b16 v[48:49], v11 offset:28672
    ds_read_b64_tr_b16 v[50:51], v11 offset:31232
    ds_read_b64_tr_b16 v[52:53], v11 offset:33792
    ds_read_b64_tr_b16 v[54:55], v11 offset:36352
    ds_read_b64_tr_b16 v[56:57], v9 offset:28672
    ds_read_b64_tr_b16 v[58:59], v9 offset:31232
    ds_read_b64_tr_b16 v[60:61], v9 offset:33792
    ds_read_b64_tr_b16 v[62:63], v9 offset:36352
    ds_read_b64_tr_b16 v[224:225], v9 offset:28704
    ds_read_b64_tr_b16 v[226:227], v9 offset:31264
    s_waitcnt lgkmcnt(8)
    v_mfma_f32_16x16x32_bf16 v[64:67], v[48:51], v[16:19], 0
    ds_read_b64_tr_b16 v[228:229], v9 offset:33824
    v_mfma_f32_16x16x32_bf16 v[68:71], v[48:51], v[20:23], 0
    v_mfma_f32_16x16x32_bf16 v[72:75], v[48:51], v[24:27], 0
    ds_read_b64_tr_b16 v[230:231], v9 offset:36384
    v_mfma_f32_16x16x32_bf16 v[76:79], v[48:51], v[28:31], 0
    s_waitcnt lgkmcnt(8)
    v_mfma_f32_16x16x32_bf16 v[80:83], v[52:55], v[16:19], 0
    ds_read_b64_tr_b16 v[48:49], v9 offset:28736
    v_mfma_f32_16x16x32_bf16 v[84:87], v[52:55], v[20:23], 0
    v_mfma_f32_16x16x32_bf16 v[88:91], v[52:55], v[24:27], 0
    ds_read_b64_tr_b16 v[50:51], v9 offset:31296
    v_mfma_f32_16x16x32_bf16 v[92:95], v[52:55], v[28:31], 0
    s_waitcnt lgkmcnt(8)
    v_mfma_f32_16x16x32_bf16 v[96:99], v[56:59], v[16:19], 0
    ds_read_b64_tr_b16 v[52:53], v9 offset:33856
    v_mfma_f32_16x16x32_bf16 v[100:103], v[56:59], v[20:23], 0
    v_mfma_f32_16x16x32_bf16 v[104:107], v[56:59], v[24:27], 0
    ds_read_b64_tr_b16 v[54:55], v9 offset:36416
    v_mfma_f32_16x16x32_bf16 v[108:111], v[56:59], v[28:31], 0
    s_waitcnt lgkmcnt(8)
    v_mfma_f32_16x16x32_bf16 v[112:115], v[60:63], v[16:19], 0
    ds_read_b64_tr_b16 v[56:57], v9 offset:28768
    v_mfma_f32_16x16x32_bf16 v[116:119], v[60:63], v[20:23], 0
    v_mfma_f32_16x16x32_bf16 v[120:123], v[60:63], v[24:27], 0
    ds_read_b64_tr_b16 v[58:59], v9 offset:31328
    v_mfma_f32_16x16x32_bf16 v[124:127], v[60:63], v[28:31], 0
    s_barrier
    s_waitcnt lgkmcnt(8)
    v_mfma_f32_16x16x32_bf16 v[128:131], v[224:227], v[16:19], 0
    ds_read_b64_tr_b16 v[60:61], v9 offset:33888
    v_mfma_f32_16x16x32_bf16 v[132:135], v[224:227], v[20:23], 0
    v_mfma_f32_16x16x32_bf16 v[136:139], v[224:227], v[24:27], 0
    ds_read_b64_tr_b16 v[62:63], v9 offset:36448
    v_mfma_f32_16x16x32_bf16 v[140:143], v[224:227], v[28:31], 0
    s_waitcnt lgkmcnt(8)
    v_mfma_f32_16x16x32_bf16 v[144:147], v[228:231], v[16:19], 0
    ds_read_b64_tr_b16 v[224:225], v10 offset:0
    v_mfma_f32_16x16x32_bf16 v[148:151], v[228:231], v[20:23], 0
    v_mfma_f32_16x16x32_bf16 v[152:155], v[228:231], v[24:27], 0
    ds_read_b64_tr_b16 v[226:227], v10 offset:2560
    v_mfma_f32_16x16x32_bf16 v[156:159], v[228:231], v[28:31], 0
    s_waitcnt lgkmcnt(8)
    v_mfma_f32_16x16x32_bf16 v[160:163], v[48:51], v[16:19], 0
    ds_read_b64_tr_b16 v[228:229], v10 offset:5120
    v_mfma_f32_16x16x32_bf16 v[164:167], v[48:51], v[20:23], 0
    ds_read_b64_tr_b16 v[230:231], v10 offset:7680
    v_mfma_f32_16x16x32_bf16 v[168:171], v[48:51], v[24:27], 0
    ds_read_b128 v[32:35], v4 offset:16384
    v_mfma_f32_16x16x32_bf16 v[172:175], v[48:51], v[28:31], 0
    s_waitcnt lgkmcnt(9)
    v_mfma_f32_16x16x32_bf16 v[176:179], v[52:55], v[16:19], 0
    ds_read_b64_tr_b16 v[48:49], v8 offset:0
    v_mfma_f32_16x16x32_bf16 v[180:183], v[52:55], v[20:23], 0
    ds_read_b64_tr_b16 v[50:51], v8 offset:2560
    v_mfma_f32_16x16x32_bf16 v[184:187], v[52:55], v[24:27], 0
    ds_read_b128 v[36:39], v4 offset:17408
    v_mfma_f32_16x16x32_bf16 v[188:191], v[52:55], v[28:31], 0
    s_waitcnt lgkmcnt(10)
    v_mfma_f32_16x16x32_bf16 v[192:195], v[56:59], v[16:19], 0
    ds_read_b64_tr_b16 v[52:53], v8 offset:5120
    v_mfma_f32_16x16x32_bf16 v[196:199], v[56:59], v[20:23], 0
    ds_read_b64_tr_b16 v[54:55], v8 offset:7680
    v_mfma_f32_16x16x32_bf16 v[200:203], v[56:59], v[24:27], 0
    ds_read_b128 v[40:43], v4 offset:18432
    v_mfma_f32_16x16x32_bf16 v[204:207], v[56:59], v[28:31], 0
    s_waitcnt lgkmcnt(11)
    v_mfma_f32_16x16x32_bf16 v[208:211], v[60:63], v[16:19], 0
    ds_read_b64_tr_b16 v[56:57], v8 offset:32
    v_mfma_f32_16x16x32_bf16 v[212:215], v[60:63], v[20:23], 0
    ds_read_b64_tr_b16 v[58:59], v8 offset:2592
    v_mfma_f32_16x16x32_bf16 v[216:219], v[60:63], v[24:27], 0
    ds_read_b128 v[44:47], v4 offset:19456
    v_mfma_f32_16x16x32_bf16 v[220:223], v[60:63], v[28:31], 0
    s_waitcnt lgkmcnt(12)
    s_waitcnt lgkmcnt(0)
    v_mfma_f32_16x16x32_bf16 v[64:67], v[224:227], v[32:35], v[64:67]
    ds_read_b64_tr_b16 v[60:61], v8 offset:5152
    v_mfma_f32_16x16x32_bf16 v[68:71], v[224:227], v[36:39], v[68:71]
    v_mfma_f32_16x16x32_bf16 v[72:75], v[224:227], v[40:43], v[72:75]
    ds_read_b64_tr_b16 v[62:63], v8 offset:7712
    v_mfma_f32_16x16x32_bf16 v[76:79], v[224:227], v[44:47], v[76:79]
    v_mfma_f32_16x16x32_bf16 v[80:83], v[228:231], v[32:35], v[80:83]
    ds_read_b64_tr_b16 v[224:225], v8 offset:64
    v_mfma_f32_16x16x32_bf16 v[84:87], v[228:231], v[36:39], v[84:87]
    v_mfma_f32_16x16x32_bf16 v[88:91], v[228:231], v[40:43], v[88:91]
    ds_read_b64_tr_b16 v[226:227], v8 offset:2624
    v_mfma_f32_16x16x32_bf16 v[92:95], v[228:231], v[44:47], v[92:95]
    v_mfma_f32_16x16x32_bf16 v[96:99], v[48:51], v[32:35], v[96:99]
    ds_read_b64_tr_b16 v[228:229], v8 offset:5184
    v_mfma_f32_16x16x32_bf16 v[100:103], v[48:51], v[36:39], v[100:103]
    v_mfma_f32_16x16x32_bf16 v[104:107], v[48:51], v[40:43], v[104:107]
    ds_read_b64_tr_b16 v[230:231], v8 offset:7744
    v_mfma_f32_16x16x32_bf16 v[108:111], v[48:51], v[44:47], v[108:111]
    v_mfma_f32_16x16x32_bf16 v[112:115], v[52:55], v[32:35], v[112:115]
    ds_read_b64_tr_b16 v[48:49], v8 offset:96
    v_mfma_f32_16x16x32_bf16 v[116:119], v[52:55], v[36:39], v[116:119]
    v_mfma_f32_16x16x32_bf16 v[120:123], v[52:55], v[40:43], v[120:123]
    ds_read_b64_tr_b16 v[50:51], v8 offset:2656
    v_mfma_f32_16x16x32_bf16 v[124:127], v[52:55], v[44:47], v[124:127]
    s_barrier
    v_mfma_f32_16x16x32_bf16 v[128:131], v[56:59], v[32:35], v[128:131]
    ds_read_b64_tr_b16 v[52:53], v8 offset:5216
    v_mfma_f32_16x16x32_bf16 v[132:135], v[56:59], v[36:39], v[132:135]
    v_mfma_f32_16x16x32_bf16 v[136:139], v[56:59], v[40:43], v[136:139]
    ds_read_b64_tr_b16 v[54:55], v8 offset:7776
    v_mfma_f32_16x16x32_bf16 v[140:143], v[56:59], v[44:47], v[140:143]
    s_waitcnt lgkmcnt(8)
    v_mfma_f32_16x16x32_bf16 v[144:147], v[60:63], v[32:35], v[144:147]
    ds_read_b64_tr_b16 v[56:57], v10 offset:10240
    v_mfma_f32_16x16x32_bf16 v[148:151], v[60:63], v[36:39], v[148:151]
    v_mfma_f32_16x16x32_bf16 v[152:155], v[60:63], v[40:43], v[152:155]
    ds_read_b64_tr_b16 v[58:59], v10 offset:12800
    v_mfma_f32_16x16x32_bf16 v[156:159], v[60:63], v[44:47], v[156:159]
    s_waitcnt lgkmcnt(8)
    v_mfma_f32_16x16x32_bf16 v[160:163], v[224:227], v[32:35], v[160:163]
    ds_read_b64_tr_b16 v[60:61], v10 offset:15360
    v_mfma_f32_16x16x32_bf16 v[164:167], v[224:227], v[36:39], v[164:167]
    ds_read_b64_tr_b16 v[62:63], v10 offset:17920
    v_mfma_f32_16x16x32_bf16 v[168:171], v[224:227], v[40:43], v[168:171]
    ds_read_b128 v[16:19], v5 offset:0
    v_mfma_f32_16x16x32_bf16 v[172:175], v[224:227], v[44:47], v[172:175]
    s_waitcnt lgkmcnt(9)
    v_mfma_f32_16x16x32_bf16 v[176:179], v[228:231], v[32:35], v[176:179]
    ds_read_b64_tr_b16 v[224:225], v8 offset:10240
    v_mfma_f32_16x16x32_bf16 v[180:183], v[228:231], v[36:39], v[180:183]
    ds_read_b64_tr_b16 v[226:227], v8 offset:12800
    v_mfma_f32_16x16x32_bf16 v[184:187], v[228:231], v[40:43], v[184:187]
    ds_read_b128 v[20:23], v5 offset:1024
    v_mfma_f32_16x16x32_bf16 v[188:191], v[228:231], v[44:47], v[188:191]
    s_waitcnt lgkmcnt(10)
    v_mfma_f32_16x16x32_bf16 v[192:195], v[48:51], v[32:35], v[192:195]
    ds_read_b64_tr_b16 v[228:229], v8 offset:15360
    v_mfma_f32_16x16x32_bf16 v[196:199], v[48:51], v[36:39], v[196:199]
    ds_read_b64_tr_b16 v[230:231], v8 offset:17920
    v_mfma_f32_16x16x32_bf16 v[200:203], v[48:51], v[40:43], v[200:203]
    ds_read_b128 v[24:27], v5 offset:2048
    v_mfma_f32_16x16x32_bf16 v[204:207], v[48:51], v[44:47], v[204:207]
    s_waitcnt lgkmcnt(11)
    v_mfma_f32_16x16x32_bf16 v[208:211], v[52:55], v[32:35], v[208:211]
    ds_read_b64_tr_b16 v[48:49], v8 offset:10272
    v_mfma_f32_16x16x32_bf16 v[212:215], v[52:55], v[36:39], v[212:215]
    ds_read_b64_tr_b16 v[50:51], v8 offset:12832
    v_mfma_f32_16x16x32_bf16 v[216:219], v[52:55], v[40:43], v[216:219]
    ds_read_b128 v[28:31], v5 offset:3072
    v_mfma_f32_16x16x32_bf16 v[220:223], v[52:55], v[44:47], v[220:223]
    s_waitcnt lgkmcnt(12)
    s_waitcnt lgkmcnt(0)
    v_mfma_f32_16x16x32_bf16 v[64:67], v[56:59], v[16:19], v[64:67]
    ds_read_b64_tr_b16 v[52:53], v8 offset:15392
    v_mfma_f32_16x16x32_bf16 v[68:71], v[56:59], v[20:23], v[68:71]
    v_mfma_f32_16x16x32_bf16 v[72:75], v[56:59], v[24:27], v[72:75]
    ds_read_b64_tr_b16 v[54:55], v8 offset:17952
    v_mfma_f32_16x16x32_bf16 v[76:79], v[56:59], v[28:31], v[76:79]
    v_mfma_f32_16x16x32_bf16 v[80:83], v[60:63], v[16:19], v[80:83]
    ds_read_b64_tr_b16 v[56:57], v8 offset:10304
    v_mfma_f32_16x16x32_bf16 v[84:87], v[60:63], v[20:23], v[84:87]
    v_mfma_f32_16x16x32_bf16 v[88:91], v[60:63], v[24:27], v[88:91]
    ds_read_b64_tr_b16 v[58:59], v8 offset:12864
    v_mfma_f32_16x16x32_bf16 v[92:95], v[60:63], v[28:31], v[92:95]
    v_mfma_f32_16x16x32_bf16 v[96:99], v[224:227], v[16:19], v[96:99]
    ds_read_b64_tr_b16 v[60:61], v8 offset:15424
    v_mfma_f32_16x16x32_bf16 v[100:103], v[224:227], v[20:23], v[100:103]
    v_mfma_f32_16x16x32_bf16 v[104:107], v[224:227], v[24:27], v[104:107]
    ds_read_b64_tr_b16 v[62:63], v8 offset:17984
    v_mfma_f32_16x16x32_bf16 v[108:111], v[224:227], v[28:31], v[108:111]
    v_mfma_f32_16x16x32_bf16 v[112:115], v[228:231], v[16:19], v[112:115]
    ds_read_b64_tr_b16 v[224:225], v8 offset:10336
    v_mfma_f32_16x16x32_bf16 v[116:119], v[228:231], v[20:23], v[116:119]
    v_mfma_f32_16x16x32_bf16 v[120:123], v[228:231], v[24:27], v[120:123]
    ds_read_b64_tr_b16 v[226:227], v8 offset:12896
    v_mfma_f32_16x16x32_bf16 v[124:127], v[228:231], v[28:31], v[124:127]
    s_barrier
    v_mfma_f32_16x16x32_bf16 v[128:131], v[48:51], v[16:19], v[128:131]
    ds_read_b64_tr_b16 v[228:229], v8 offset:15456
    v_mfma_f32_16x16x32_bf16 v[132:135], v[48:51], v[20:23], v[132:135]
    v_mfma_f32_16x16x32_bf16 v[136:139], v[48:51], v[24:27], v[136:139]
    ds_read_b64_tr_b16 v[230:231], v8 offset:18016
    v_mfma_f32_16x16x32_bf16 v[140:143], v[48:51], v[28:31], v[140:143]
    s_waitcnt lgkmcnt(8)
    v_mfma_f32_16x16x32_bf16 v[144:147], v[52:55], v[16:19], v[144:147]
    ds_read_b64_tr_b16 v[48:49], v10 offset:20480
    v_mfma_f32_16x16x32_bf16 v[148:151], v[52:55], v[20:23], v[148:151]
    v_mfma_f32_16x16x32_bf16 v[152:155], v[52:55], v[24:27], v[152:155]
    ds_read_b64_tr_b16 v[50:51], v10 offset:23040
    v_mfma_f32_16x16x32_bf16 v[156:159], v[52:55], v[28:31], v[156:159]
    s_waitcnt lgkmcnt(8)
    v_mfma_f32_16x16x32_bf16 v[160:163], v[56:59], v[16:19], v[160:163]
    ds_read_b64_tr_b16 v[52:53], v10 offset:25600
    v_mfma_f32_16x16x32_bf16 v[164:167], v[56:59], v[20:23], v[164:167]
    ds_read_b64_tr_b16 v[54:55], v10 offset:28160
    v_mfma_f32_16x16x32_bf16 v[168:171], v[56:59], v[24:27], v[168:171]
    ds_read_b128 v[32:35], v5 offset:16384
    v_mfma_f32_16x16x32_bf16 v[172:175], v[56:59], v[28:31], v[172:175]
    s_waitcnt lgkmcnt(9)
    v_mfma_f32_16x16x32_bf16 v[176:179], v[60:63], v[16:19], v[176:179]
    ds_read_b64_tr_b16 v[56:57], v8 offset:20480
    v_mfma_f32_16x16x32_bf16 v[180:183], v[60:63], v[20:23], v[180:183]
    ds_read_b64_tr_b16 v[58:59], v8 offset:23040
    v_mfma_f32_16x16x32_bf16 v[184:187], v[60:63], v[24:27], v[184:187]
    ds_read_b128 v[36:39], v5 offset:17408
    v_mfma_f32_16x16x32_bf16 v[188:191], v[60:63], v[28:31], v[188:191]
    s_waitcnt lgkmcnt(10)
    v_mfma_f32_16x16x32_bf16 v[192:195], v[224:227], v[16:19], v[192:195]
    ds_read_b64_tr_b16 v[60:61], v8 offset:25600
    v_mfma_f32_16x16x32_bf16 v[196:199], v[224:227], v[20:23], v[196:199]
    ds_read_b64_tr_b16 v[62:63], v8 offset:28160
    v_mfma_f32_16x16x32_bf16 v[200:203], v[224:227], v[24:27], v[200:203]
    ds_read_b128 v[40:43], v5 offset:18432
    v_mfma_f32_16x16x32_bf16 v[204:207], v[224:227], v[28:31], v[204:207]
    s_waitcnt lgkmcnt(11)
    v_mfma_f32_16x16x32_bf16 v[208:211], v[228:231], v[16:19], v[208:211]
    ds_read_b64_tr_b16 v[224:225], v8 offset:20512
    v_mfma_f32_16x16x32_bf16 v[212:215], v[228:231], v[20:23], v[212:215]
    ds_read_b64_tr_b16 v[226:227], v8 offset:23072
    v_mfma_f32_16x16x32_bf16 v[216:219], v[228:231], v[24:27], v[216:219]
    ds_read_b128 v[44:47], v5 offset:19456
    v_mfma_f32_16x16x32_bf16 v[220:223], v[228:231], v[28:31], v[220:223]
    s_waitcnt lgkmcnt(12)
    s_waitcnt lgkmcnt(0)
    v_mfma_f32_16x16x32_bf16 v[64:67], v[48:51], v[32:35], v[64:67]
    ds_read_b64_tr_b16 v[228:229], v8 offset:25632
    v_mfma_f32_16x16x32_bf16 v[68:71], v[48:51], v[36:39], v[68:71]
    v_mfma_f32_16x16x32_bf16 v[72:75], v[48:51], v[40:43], v[72:75]
    ds_read_b64_tr_b16 v[230:231], v8 offset:28192
    v_mfma_f32_16x16x32_bf16 v[76:79], v[48:51], v[44:47], v[76:79]
    v_mfma_f32_16x16x32_bf16 v[80:83], v[52:55], v[32:35], v[80:83]
    ds_read_b64_tr_b16 v[48:49], v8 offset:20544
    v_mfma_f32_16x16x32_bf16 v[84:87], v[52:55], v[36:39], v[84:87]
    v_mfma_f32_16x16x32_bf16 v[88:91], v[52:55], v[40:43], v[88:91]
    ds_read_b64_tr_b16 v[50:51], v8 offset:23104
    v_mfma_f32_16x16x32_bf16 v[92:95], v[52:55], v[44:47], v[92:95]
    v_mfma_f32_16x16x32_bf16 v[96:99], v[56:59], v[32:35], v[96:99]
    ds_read_b64_tr_b16 v[52:53], v8 offset:25664
    v_mfma_f32_16x16x32_bf16 v[100:103], v[56:59], v[36:39], v[100:103]
    v_mfma_f32_16x16x32_bf16 v[104:107], v[56:59], v[40:43], v[104:107]
    ds_read_b64_tr_b16 v[54:55], v8 offset:28224
    v_mfma_f32_16x16x32_bf16 v[108:111], v[56:59], v[44:47], v[108:111]
    v_mfma_f32_16x16x32_bf16 v[112:115], v[60:63], v[32:35], v[112:115]
    ds_read_b64_tr_b16 v[56:57], v8 offset:20576
    v_mfma_f32_16x16x32_bf16 v[116:119], v[60:63], v[36:39], v[116:119]
    v_mfma_f32_16x16x32_bf16 v[120:123], v[60:63], v[40:43], v[120:123]
    ds_read_b64_tr_b16 v[58:59], v8 offset:23136
    v_mfma_f32_16x16x32_bf16 v[124:127], v[60:63], v[44:47], v[124:127]
    s_barrier
    v_mfma_f32_16x16x32_bf16 v[128:131], v[224:227], v[32:35], v[128:131]
    ds_read_b64_tr_b16 v[60:61], v8 offset:25696
    v_mfma_f32_16x16x32_bf16 v[132:135], v[224:227], v[36:39], v[132:135]
    v_mfma_f32_16x16x32_bf16 v[136:139], v[224:227], v[40:43], v[136:139]
    ds_read_b64_tr_b16 v[62:63], v8 offset:28256
    v_mfma_f32_16x16x32_bf16 v[140:143], v[224:227], v[44:47], v[140:143]
    s_waitcnt lgkmcnt(8)
    v_mfma_f32_16x16x32_bf16 v[144:147], v[228:231], v[32:35], v[144:147]
    ds_read_b64_tr_b16 v[224:225], v10 offset:30720
    v_mfma_f32_16x16x32_bf16 v[148:151], v[228:231], v[36:39], v[148:151]
    v_mfma_f32_16x16x32_bf16 v[152:155], v[228:231], v[40:43], v[152:155]
    ds_read_b64_tr_b16 v[226:227], v10 offset:33280
    v_mfma_f32_16x16x32_bf16 v[156:159], v[228:231], v[44:47], v[156:159]
    s_waitcnt lgkmcnt(8)
    v_mfma_f32_16x16x32_bf16 v[160:163], v[48:51], v[32:35], v[160:163]
    ds_read_b64_tr_b16 v[228:229], v11 offset:3072
    v_mfma_f32_16x16x32_bf16 v[164:167], v[48:51], v[36:39], v[164:167]
    ds_read_b64_tr_b16 v[230:231], v11 offset:5632
    v_mfma_f32_16x16x32_bf16 v[168:171], v[48:51], v[40:43], v[168:171]
    ds_read_b128 v[16:19], v5 offset:32768
    v_mfma_f32_16x16x32_bf16 v[172:175], v[48:51], v[44:47], v[172:175]
    s_waitcnt lgkmcnt(9)
    v_mfma_f32_16x16x32_bf16 v[176:179], v[52:55], v[32:35], v[176:179]
    ds_read_b64_tr_b16 v[48:49], v8 offset:30720
    v_mfma_f32_16x16x32_bf16 v[180:183], v[52:55], v[36:39], v[180:183]
    ds_read_b64_tr_b16 v[50:51], v8 offset:33280
    v_mfma_f32_16x16x32_bf16 v[184:187], v[52:55], v[40:43], v[184:187]
    ds_read_b128 v[20:23], v5 offset:33792
    v_mfma_f32_16x16x32_bf16 v[188:191], v[52:55], v[44:47], v[188:191]
    s_waitcnt lgkmcnt(10)
    v_mfma_f32_16x16x32_bf16 v[192:195], v[56:59], v[32:35], v[192:195]
    ds_read_b64_tr_b16 v[52:53], v9 offset:3072
    v_mfma_f32_16x16x32_bf16 v[196:199], v[56:59], v[36:39], v[196:199]
    ds_read_b64_tr_b16 v[54:55], v9 offset:5632
    v_mfma_f32_16x16x32_bf16 v[200:203], v[56:59], v[40:43], v[200:203]
    ds_read_b128 v[24:27], v5 offset:34816
    v_mfma_f32_16x16x32_bf16 v[204:207], v[56:59], v[44:47], v[204:207]
    s_waitcnt lgkmcnt(11)
    v_mfma_f32_16x16x32_bf16 v[208:211], v[60:63], v[32:35], v[208:211]
    ds_read_b64_tr_b16 v[56:57], v8 offset:30752
    v_mfma_f32_16x16x32_bf16 v[212:215], v[60:63], v[36:39], v[212:215]
    ds_read_b64_tr_b16 v[58:59], v8 offset:33312
    v_mfma_f32_16x16x32_bf16 v[216:219], v[60:63], v[40:43], v[216:219]
    ds_read_b128 v[28:31], v5 offset:35840
    v_mfma_f32_16x16x32_bf16 v[220:223], v[60:63], v[44:47], v[220:223]
    s_waitcnt lgkmcnt(12)
    s_waitcnt lgkmcnt(0)
    v_mfma_f32_16x16x32_bf16 v[64:67], v[224:227], v[16:19], v[64:67]
    ds_read_b64_tr_b16 v[60:61], v9 offset:3104
    v_mfma_f32_16x16x32_bf16 v[68:71], v[224:227], v[20:23], v[68:71]
    v_mfma_f32_16x16x32_bf16 v[72:75], v[224:227], v[24:27], v[72:75]
    ds_read_b64_tr_b16 v[62:63], v9 offset:5664
    v_mfma_f32_16x16x32_bf16 v[76:79], v[224:227], v[28:31], v[76:79]
    v_mfma_f32_16x16x32_bf16 v[80:83], v[228:231], v[16:19], v[80:83]
    ds_read_b64_tr_b16 v[224:225], v8 offset:30784
    v_mfma_f32_16x16x32_bf16 v[84:87], v[228:231], v[20:23], v[84:87]
    v_mfma_f32_16x16x32_bf16 v[88:91], v[228:231], v[24:27], v[88:91]
    ds_read_b64_tr_b16 v[226:227], v8 offset:33344
    v_mfma_f32_16x16x32_bf16 v[92:95], v[228:231], v[28:31], v[92:95]
    v_mfma_f32_16x16x32_bf16 v[96:99], v[48:51], v[16:19], v[96:99]
    ds_read_b64_tr_b16 v[228:229], v9 offset:3136
    v_mfma_f32_16x16x32_bf16 v[100:103], v[48:51], v[20:23], v[100:103]
    v_mfma_f32_16x16x32_bf16 v[104:107], v[48:51], v[24:27], v[104:107]
    ds_read_b64_tr_b16 v[230:231], v9 offset:5696
    v_mfma_f32_16x16x32_bf16 v[108:111], v[48:51], v[28:31], v[108:111]
    v_mfma_f32_16x16x32_bf16 v[112:115], v[52:55], v[16:19], v[112:115]
    ds_read_b64_tr_b16 v[48:49], v8 offset:30816
    v_mfma_f32_16x16x32_bf16 v[116:119], v[52:55], v[20:23], v[116:119]
    v_mfma_f32_16x16x32_bf16 v[120:123], v[52:55], v[24:27], v[120:123]
    ds_read_b64_tr_b16 v[50:51], v8 offset:33376
    v_mfma_f32_16x16x32_bf16 v[124:127], v[52:55], v[28:31], v[124:127]
    s_barrier
    v_mfma_f32_16x16x32_bf16 v[128:131], v[56:59], v[16:19], v[128:131]
    ds_read_b64_tr_b16 v[52:53], v9 offset:3168
    v_mfma_f32_16x16x32_bf16 v[132:135], v[56:59], v[20:23], v[132:135]
    v_mfma_f32_16x16x32_bf16 v[136:139], v[56:59], v[24:27], v[136:139]
    ds_read_b64_tr_b16 v[54:55], v9 offset:5728
    v_mfma_f32_16x16x32_bf16 v[140:143], v[56:59], v[28:31], v[140:143]
    s_waitcnt lgkmcnt(8)
    v_mfma_f32_16x16x32_bf16 v[144:147], v[60:63], v[16:19], v[144:147]
    ds_read_b64_tr_b16 v[56:57], v11 offset:8192
    v_mfma_f32_16x16x32_bf16 v[148:151], v[60:63], v[20:23], v[148:151]
    v_mfma_f32_16x16x32_bf16 v[152:155], v[60:63], v[24:27], v[152:155]
    ds_read_b64_tr_b16 v[58:59], v11 offset:10752
    v_mfma_f32_16x16x32_bf16 v[156:159], v[60:63], v[28:31], v[156:159]
    s_waitcnt lgkmcnt(8)
    v_mfma_f32_16x16x32_bf16 v[160:163], v[224:227], v[16:19], v[160:163]
    ds_read_b64_tr_b16 v[60:61], v11 offset:13312
    v_mfma_f32_16x16x32_bf16 v[164:167], v[224:227], v[20:23], v[164:167]
    ds_read_b64_tr_b16 v[62:63], v11 offset:15872
    v_mfma_f32_16x16x32_bf16 v[168:171], v[224:227], v[24:27], v[168:171]
    ds_read_b128 v[32:35], v4 offset:0
    v_mfma_f32_16x16x32_bf16 v[172:175], v[224:227], v[28:31], v[172:175]
    s_waitcnt lgkmcnt(9)
    v_mfma_f32_16x16x32_bf16 v[176:179], v[228:231], v[16:19], v[176:179]
    ds_read_b64_tr_b16 v[224:225], v9 offset:8192
    v_mfma_f32_16x16x32_bf16 v[180:183], v[228:231], v[20:23], v[180:183]
    ds_read_b64_tr_b16 v[226:227], v9 offset:10752
    v_mfma_f32_16x16x32_bf16 v[184:187], v[228:231], v[24:27], v[184:187]
    ds_read_b128 v[36:39], v4 offset:1024
    v_mfma_f32_16x16x32_bf16 v[188:191], v[228:231], v[28:31], v[188:191]
    s_waitcnt lgkmcnt(10)
    v_mfma_f32_16x16x32_bf16 v[192:195], v[48:51], v[16:19], v[192:195]
    ds_read_b64_tr_b16 v[228:229], v9 offset:13312
    v_mfma_f32_16x16x32_bf16 v[196:199], v[48:51], v[20:23], v[196:199]
    ds_read_b64_tr_b16 v[230:231], v9 offset:15872
    v_mfma_f32_16x16x32_bf16 v[200:203], v[48:51], v[24:27], v[200:203]
    ds_read_b128 v[40:43], v4 offset:2048
    v_mfma_f32_16x16x32_bf16 v[204:207], v[48:51], v[28:31], v[204:207]
    s_waitcnt lgkmcnt(11)
    v_mfma_f32_16x16x32_bf16 v[208:211], v[52:55], v[16:19], v[208:211]
    ds_read_b64_tr_b16 v[48:49], v9 offset:8224
    v_mfma_f32_16x16x32_bf16 v[212:215], v[52:55], v[20:23], v[212:215]
    ds_read_b64_tr_b16 v[50:51], v9 offset:10784
    v_mfma_f32_16x16x32_bf16 v[216:219], v[52:55], v[24:27], v[216:219]
    ds_read_b128 v[44:47], v4 offset:3072
    v_mfma_f32_16x16x32_bf16 v[220:223], v[52:55], v[28:31], v[220:223]
    s_waitcnt lgkmcnt(12)
    s_waitcnt lgkmcnt(0)
    v_mfma_f32_16x16x32_bf16 v[64:67], v[56:59], v[32:35], v[64:67]
    ds_read_b64_tr_b16 v[52:53], v9 offset:13344
    v_mfma_f32_16x16x32_bf16 v[68:71], v[56:59], v[36:39], v[68:71]
    v_mfma_f32_16x16x32_bf16 v[72:75], v[56:59], v[40:43], v[72:75]
    ds_read_b64_tr_b16 v[54:55], v9 offset:15904
    v_mfma_f32_16x16x32_bf16 v[76:79], v[56:59], v[44:47], v[76:79]
    v_mfma_f32_16x16x32_bf16 v[80:83], v[60:63], v[32:35], v[80:83]
    ds_read_b64_tr_b16 v[56:57], v9 offset:8256
    v_mfma_f32_16x16x32_bf16 v[84:87], v[60:63], v[36:39], v[84:87]
    v_mfma_f32_16x16x32_bf16 v[88:91], v[60:63], v[40:43], v[88:91]
    ds_read_b64_tr_b16 v[58:59], v9 offset:10816
    v_mfma_f32_16x16x32_bf16 v[92:95], v[60:63], v[44:47], v[92:95]
    v_mfma_f32_16x16x32_bf16 v[96:99], v[224:227], v[32:35], v[96:99]
    ds_read_b64_tr_b16 v[60:61], v9 offset:13376
    v_mfma_f32_16x16x32_bf16 v[100:103], v[224:227], v[36:39], v[100:103]
    v_mfma_f32_16x16x32_bf16 v[104:107], v[224:227], v[40:43], v[104:107]
    ds_read_b64_tr_b16 v[62:63], v9 offset:15936
    v_mfma_f32_16x16x32_bf16 v[108:111], v[224:227], v[44:47], v[108:111]
    v_mfma_f32_16x16x32_bf16 v[112:115], v[228:231], v[32:35], v[112:115]
    ds_read_b64_tr_b16 v[224:225], v9 offset:8288
    v_mfma_f32_16x16x32_bf16 v[116:119], v[228:231], v[36:39], v[116:119]
    v_mfma_f32_16x16x32_bf16 v[120:123], v[228:231], v[40:43], v[120:123]
    ds_read_b64_tr_b16 v[226:227], v9 offset:10848
    v_mfma_f32_16x16x32_bf16 v[124:127], v[228:231], v[44:47], v[124:127]
    s_barrier
    v_mfma_f32_16x16x32_bf16 v[128:131], v[48:51], v[32:35], v[128:131]
    ds_read_b64_tr_b16 v[228:229], v9 offset:13408
    v_mfma_f32_16x16x32_bf16 v[132:135], v[48:51], v[36:39], v[132:135]
    v_mfma_f32_16x16x32_bf16 v[136:139], v[48:51], v[40:43], v[136:139]
    ds_read_b64_tr_b16 v[230:231], v9 offset:15968
    v_mfma_f32_16x16x32_bf16 v[140:143], v[48:51], v[44:47], v[140:143]
    s_waitcnt lgkmcnt(8)
    v_mfma_f32_16x16x32_bf16 v[144:147], v[52:55], v[32:35], v[144:147]
    ds_read_b64_tr_b16 v[48:49], v11 offset:18432
    v_mfma_f32_16x16x32_bf16 v[148:151], v[52:55], v[36:39], v[148:151]
    v_mfma_f32_16x16x32_bf16 v[152:155], v[52:55], v[40:43], v[152:155]
    ds_read_b64_tr_b16 v[50:51], v11 offset:20992
    v_mfma_f32_16x16x32_bf16 v[156:159], v[52:55], v[44:47], v[156:159]
    s_waitcnt lgkmcnt(8)
    v_mfma_f32_16x16x32_bf16 v[160:163], v[56:59], v[32:35], v[160:163]
    ds_read_b64_tr_b16 v[52:53], v11 offset:23552
    v_mfma_f32_16x16x32_bf16 v[164:167], v[56:59], v[36:39], v[164:167]
    ds_read_b64_tr_b16 v[54:55], v11 offset:26112
    v_mfma_f32_16x16x32_bf16 v[168:171], v[56:59], v[40:43], v[168:171]
    ds_read_b128 v[16:19], v4 offset:16384
    v_mfma_f32_16x16x32_bf16 v[172:175], v[56:59], v[44:47], v[172:175]
    s_waitcnt lgkmcnt(9)
    v_mfma_f32_16x16x32_bf16 v[176:179], v[60:63], v[32:35], v[176:179]
    ds_read_b64_tr_b16 v[56:57], v9 offset:18432
    v_mfma_f32_16x16x32_bf16 v[180:183], v[60:63], v[36:39], v[180:183]
    ds_read_b64_tr_b16 v[58:59], v9 offset:20992
    v_mfma_f32_16x16x32_bf16 v[184:187], v[60:63], v[40:43], v[184:187]
    ds_read_b128 v[20:23], v4 offset:17408
    v_mfma_f32_16x16x32_bf16 v[188:191], v[60:63], v[44:47], v[188:191]
    s_waitcnt lgkmcnt(10)
    v_mfma_f32_16x16x32_bf16 v[192:195], v[224:227], v[32:35], v[192:195]
    ds_read_b64_tr_b16 v[60:61], v9 offset:23552
    v_mfma_f32_16x16x32_bf16 v[196:199], v[224:227], v[36:39], v[196:199]
    ds_read_b64_tr_b16 v[62:63], v9 offset:26112
    v_mfma_f32_16x16x32_bf16 v[200:203], v[224:227], v[40:43], v[200:203]
    ds_read_b128 v[24:27], v4 offset:18432
    v_mfma_f32_16x16x32_bf16 v[204:207], v[224:227], v[44:47], v[204:207]
    s_waitcnt lgkmcnt(11)
    v_mfma_f32_16x16x32_bf16 v[208:211], v[228:231], v[32:35], v[208:211]
    ds_read_b64_tr_b16 v[224:225], v9 offset:18464
    v_mfma_f32_16x16x32_bf16 v[212:215], v[228:231], v[36:39], v[212:215]
    ds_read_b64_tr_b16 v[226:227], v9 offset:21024
    v_mfma_f32_16x16x32_bf16 v[216:219], v[228:231], v[40:43], v[216:219]
    ds_read_b128 v[28:31], v4 offset:19456
    v_mfma_f32_16x16x32_bf16 v[220:223], v[228:231], v[44:47], v[220:223]
    s_waitcnt lgkmcnt(12)
    s_waitcnt lgkmcnt(0)
    v_mfma_f32_16x16x32_bf16 v[64:67], v[48:51], v[16:19], v[64:67]
    ds_read_b64_tr_b16 v[228:229], v9 offset:23584
    v_mfma_f32_16x16x32_bf16 v[68:71], v[48:51], v[20:23], v[68:71]
    v_mfma_f32_16x16x32_bf16 v[72:75], v[48:51], v[24:27], v[72:75]
    ds_read_b64_tr_b16 v[230:231], v9 offset:26144
    v_mfma_f32_16x16x32_bf16 v[76:79], v[48:51], v[28:31], v[76:79]
    v_mfma_f32_16x16x32_bf16 v[80:83], v[52:55], v[16:19], v[80:83]
    ds_read_b64_tr_b16 v[48:49], v9 offset:18496
    v_mfma_f32_16x16x32_bf16 v[84:87], v[52:55], v[20:23], v[84:87]
    v_mfma_f32_16x16x32_bf16 v[88:91], v[52:55], v[24:27], v[88:91]
    ds_read_b64_tr_b16 v[50:51], v9 offset:21056
    v_mfma_f32_16x16x32_bf16 v[92:95], v[52:55], v[28:31], v[92:95]
    v_mfma_f32_16x16x32_bf16 v[96:99], v[56:59], v[16:19], v[96:99]
    ds_read_b64_tr_b16 v[52:53], v9 offset:23616
    v_mfma_f32_16x16x32_bf16 v[100:103], v[56:59], v[20:23], v[100:103]
    v_mfma_f32_16x16x32_bf16 v[104:107], v[56:59], v[24:27], v[104:107]
    ds_read_b64_tr_b16 v[54:55], v9 offset:26176
    v_mfma_f32_16x16x32_bf16 v[108:111], v[56:59], v[28:31], v[108:111]
    v_mfma_f32_16x16x32_bf16 v[112:115], v[60:63], v[16:19], v[112:115]
    ds_read_b64_tr_b16 v[56:57], v9 offset:18528
    v_mfma_f32_16x16x32_bf16 v[116:119], v[60:63], v[20:23], v[116:119]
    v_mfma_f32_16x16x32_bf16 v[120:123], v[60:63], v[24:27], v[120:123]
    ds_read_b64_tr_b16 v[58:59], v9 offset:21088
    v_mfma_f32_16x16x32_bf16 v[124:127], v[60:63], v[28:31], v[124:127]
    s_barrier
    v_mfma_f32_16x16x32_bf16 v[128:131], v[224:227], v[16:19], v[128:131]
    ds_read_b64_tr_b16 v[60:61], v9 offset:23648
    v_mfma_f32_16x16x32_bf16 v[132:135], v[224:227], v[20:23], v[132:135]
    v_mfma_f32_16x16x32_bf16 v[136:139], v[224:227], v[24:27], v[136:139]
    ds_read_b64_tr_b16 v[62:63], v9 offset:26208
    v_mfma_f32_16x16x32_bf16 v[140:143], v[224:227], v[28:31], v[140:143]
    s_waitcnt lgkmcnt(8)
    v_mfma_f32_16x16x32_bf16 v[144:147], v[228:231], v[16:19], v[144:147]
    ds_read_b64_tr_b16 v[224:225], v11 offset:28672
    v_mfma_f32_16x16x32_bf16 v[148:151], v[228:231], v[20:23], v[148:151]
    v_mfma_f32_16x16x32_bf16 v[152:155], v[228:231], v[24:27], v[152:155]
    ds_read_b64_tr_b16 v[226:227], v11 offset:31232
    v_mfma_f32_16x16x32_bf16 v[156:159], v[228:231], v[28:31], v[156:159]
    s_waitcnt lgkmcnt(8)
    v_mfma_f32_16x16x32_bf16 v[160:163], v[48:51], v[16:19], v[160:163]
    ds_read_b64_tr_b16 v[228:229], v11 offset:33792
    v_mfma_f32_16x16x32_bf16 v[164:167], v[48:51], v[20:23], v[164:167]
    ds_read_b64_tr_b16 v[230:231], v11 offset:36352
    v_mfma_f32_16x16x32_bf16 v[168:171], v[48:51], v[24:27], v[168:171]
    ds_read_b128 v[32:35], v5 offset:0
    v_mfma_f32_16x16x32_bf16 v[172:175], v[48:51], v[28:31], v[172:175]
    s_waitcnt lgkmcnt(9)
    v_mfma_f32_16x16x32_bf16 v[176:179], v[52:55], v[16:19], v[176:179]
    ds_read_b64_tr_b16 v[48:49], v9 offset:28672
    v_mfma_f32_16x16x32_bf16 v[180:183], v[52:55], v[20:23], v[180:183]
    ds_read_b64_tr_b16 v[50:51], v9 offset:31232
    v_mfma_f32_16x16x32_bf16 v[184:187], v[52:55], v[24:27], v[184:187]
    ds_read_b128 v[36:39], v5 offset:1024
    v_mfma_f32_16x16x32_bf16 v[188:191], v[52:55], v[28:31], v[188:191]
    s_waitcnt lgkmcnt(10)
    v_mfma_f32_16x16x32_bf16 v[192:195], v[56:59], v[16:19], v[192:195]
    ds_read_b64_tr_b16 v[52:53], v9 offset:33792
    v_mfma_f32_16x16x32_bf16 v[196:199], v[56:59], v[20:23], v[196:199]
    ds_read_b64_tr_b16 v[54:55], v9 offset:36352
    v_mfma_f32_16x16x32_bf16 v[200:203], v[56:59], v[24:27], v[200:203]
    ds_read_b128 v[40:43], v5 offset:2048
    v_mfma_f32_16x16x32_bf16 v[204:207], v[56:59], v[28:31], v[204:207]
    s_waitcnt lgkmcnt(11)
    v_mfma_f32_16x16x32_bf16 v[208:211], v[60:63], v[16:19], v[208:211]
    ds_read_b64_tr_b16 v[56:57], v9 offset:28704
    v_mfma_f32_16x16x32_bf16 v[212:215], v[60:63], v[20:23], v[212:215]
    ds_read_b64_tr_b16 v[58:59], v9 offset:31264
    v_mfma_f32_16x16x32_bf16 v[216:219], v[60:63], v[24:27], v[216:219]
    ds_read_b128 v[44:47], v5 offset:3072
    v_mfma_f32_16x16x32_bf16 v[220:223], v[60:63], v[28:31], v[220:223]
    s_waitcnt lgkmcnt(12)
    s_waitcnt lgkmcnt(0)
    v_mfma_f32_16x16x32_bf16 v[64:67], v[224:227], v[32:35], v[64:67]
    ds_read_b64_tr_b16 v[60:61], v9 offset:33824
    v_mfma_f32_16x16x32_bf16 v[68:71], v[224:227], v[36:39], v[68:71]
    v_mfma_f32_16x16x32_bf16 v[72:75], v[224:227], v[40:43], v[72:75]
    ds_read_b64_tr_b16 v[62:63], v9 offset:36384
    v_mfma_f32_16x16x32_bf16 v[76:79], v[224:227], v[44:47], v[76:79]
    v_mfma_f32_16x16x32_bf16 v[80:83], v[228:231], v[32:35], v[80:83]
    ds_read_b64_tr_b16 v[224:225], v9 offset:28736
    v_mfma_f32_16x16x32_bf16 v[84:87], v[228:231], v[36:39], v[84:87]
    v_mfma_f32_16x16x32_bf16 v[88:91], v[228:231], v[40:43], v[88:91]
    ds_read_b64_tr_b16 v[226:227], v9 offset:31296
    v_mfma_f32_16x16x32_bf16 v[92:95], v[228:231], v[44:47], v[92:95]
    v_mfma_f32_16x16x32_bf16 v[96:99], v[48:51], v[32:35], v[96:99]
    ds_read_b64_tr_b16 v[228:229], v9 offset:33856
    v_mfma_f32_16x16x32_bf16 v[100:103], v[48:51], v[36:39], v[100:103]
    v_mfma_f32_16x16x32_bf16 v[104:107], v[48:51], v[40:43], v[104:107]
    ds_read_b64_tr_b16 v[230:231], v9 offset:36416
    v_mfma_f32_16x16x32_bf16 v[108:111], v[48:51], v[44:47], v[108:111]
    v_mfma_f32_16x16x32_bf16 v[112:115], v[52:55], v[32:35], v[112:115]
    ds_read_b64_tr_b16 v[48:49], v9 offset:28768
    v_mfma_f32_16x16x32_bf16 v[116:119], v[52:55], v[36:39], v[116:119]
    v_mfma_f32_16x16x32_bf16 v[120:123], v[52:55], v[40:43], v[120:123]
    ds_read_b64_tr_b16 v[50:51], v9 offset:31328
    v_mfma_f32_16x16x32_bf16 v[124:127], v[52:55], v[44:47], v[124:127]
    s_barrier
    v_mfma_f32_16x16x32_bf16 v[128:131], v[56:59], v[32:35], v[128:131]
    ds_read_b64_tr_b16 v[52:53], v9 offset:33888
    v_mfma_f32_16x16x32_bf16 v[132:135], v[56:59], v[36:39], v[132:135]
    v_mfma_f32_16x16x32_bf16 v[136:139], v[56:59], v[40:43], v[136:139]
    ds_read_b64_tr_b16 v[54:55], v9 offset:36448
    v_mfma_f32_16x16x32_bf16 v[140:143], v[56:59], v[44:47], v[140:143]
    s_waitcnt lgkmcnt(8)
    v_mfma_f32_16x16x32_bf16 v[144:147], v[60:63], v[32:35], v[144:147]
    ds_read_b64_tr_b16 v[56:57], v10 offset:0
    v_mfma_f32_16x16x32_bf16 v[148:151], v[60:63], v[36:39], v[148:151]
    v_mfma_f32_16x16x32_bf16 v[152:155], v[60:63], v[40:43], v[152:155]
    ds_read_b64_tr_b16 v[58:59], v10 offset:2560
    v_mfma_f32_16x16x32_bf16 v[156:159], v[60:63], v[44:47], v[156:159]
    s_waitcnt lgkmcnt(8)
    v_mfma_f32_16x16x32_bf16 v[160:163], v[224:227], v[32:35], v[160:163]
    ds_read_b64_tr_b16 v[60:61], v10 offset:5120
    v_mfma_f32_16x16x32_bf16 v[164:167], v[224:227], v[36:39], v[164:167]
    ds_read_b64_tr_b16 v[62:63], v10 offset:7680
    v_mfma_f32_16x16x32_bf16 v[168:171], v[224:227], v[40:43], v[168:171]
    ds_read_b128 v[16:19], v5 offset:16384
    v_mfma_f32_16x16x32_bf16 v[172:175], v[224:227], v[44:47], v[172:175]
    s_waitcnt lgkmcnt(9)
    v_mfma_f32_16x16x32_bf16 v[176:179], v[228:231], v[32:35], v[176:179]
    ds_read_b64_tr_b16 v[224:225], v8 offset:0
    v_mfma_f32_16x16x32_bf16 v[180:183], v[228:231], v[36:39], v[180:183]
    ds_read_b64_tr_b16 v[226:227], v8 offset:2560
    v_mfma_f32_16x16x32_bf16 v[184:187], v[228:231], v[40:43], v[184:187]
    ds_read_b128 v[20:23], v5 offset:17408
    v_mfma_f32_16x16x32_bf16 v[188:191], v[228:231], v[44:47], v[188:191]
    s_waitcnt lgkmcnt(10)
    v_mfma_f32_16x16x32_bf16 v[192:195], v[48:51], v[32:35], v[192:195]
    ds_read_b64_tr_b16 v[228:229], v8 offset:5120
    v_mfma_f32_16x16x32_bf16 v[196:199], v[48:51], v[36:39], v[196:199]
    ds_read_b64_tr_b16 v[230:231], v8 offset:7680
    v_mfma_f32_16x16x32_bf16 v[200:203], v[48:51], v[40:43], v[200:203]
    ds_read_b128 v[24:27], v5 offset:18432
    v_mfma_f32_16x16x32_bf16 v[204:207], v[48:51], v[44:47], v[204:207]
    s_waitcnt lgkmcnt(11)
    v_mfma_f32_16x16x32_bf16 v[208:211], v[52:55], v[32:35], v[208:211]
    ds_read_b64_tr_b16 v[48:49], v8 offset:32
    v_mfma_f32_16x16x32_bf16 v[212:215], v[52:55], v[36:39], v[212:215]
    ds_read_b64_tr_b16 v[50:51], v8 offset:2592
    v_mfma_f32_16x16x32_bf16 v[216:219], v[52:55], v[40:43], v[216:219]
    ds_read_b128 v[28:31], v5 offset:19456
    v_mfma_f32_16x16x32_bf16 v[220:223], v[52:55], v[44:47], v[220:223]
    s_waitcnt lgkmcnt(12)
    s_waitcnt lgkmcnt(0)
    v_mfma_f32_16x16x32_bf16 v[64:67], v[56:59], v[16:19], v[64:67]
    ds_read_b64_tr_b16 v[52:53], v8 offset:5152
    v_mfma_f32_16x16x32_bf16 v[68:71], v[56:59], v[20:23], v[68:71]
    v_mfma_f32_16x16x32_bf16 v[72:75], v[56:59], v[24:27], v[72:75]
    ds_read_b64_tr_b16 v[54:55], v8 offset:7712
    v_mfma_f32_16x16x32_bf16 v[76:79], v[56:59], v[28:31], v[76:79]
    v_mfma_f32_16x16x32_bf16 v[80:83], v[60:63], v[16:19], v[80:83]
    ds_read_b64_tr_b16 v[56:57], v8 offset:64
    v_mfma_f32_16x16x32_bf16 v[84:87], v[60:63], v[20:23], v[84:87]
    v_mfma_f32_16x16x32_bf16 v[88:91], v[60:63], v[24:27], v[88:91]
    ds_read_b64_tr_b16 v[58:59], v8 offset:2624
    v_mfma_f32_16x16x32_bf16 v[92:95], v[60:63], v[28:31], v[92:95]
    v_mfma_f32_16x16x32_bf16 v[96:99], v[224:227], v[16:19], v[96:99]
    ds_read_b64_tr_b16 v[60:61], v8 offset:5184
    v_mfma_f32_16x16x32_bf16 v[100:103], v[224:227], v[20:23], v[100:103]
    v_mfma_f32_16x16x32_bf16 v[104:107], v[224:227], v[24:27], v[104:107]
    ds_read_b64_tr_b16 v[62:63], v8 offset:7744
    v_mfma_f32_16x16x32_bf16 v[108:111], v[224:227], v[28:31], v[108:111]
    v_mfma_f32_16x16x32_bf16 v[112:115], v[228:231], v[16:19], v[112:115]
    ds_read_b64_tr_b16 v[224:225], v8 offset:96
    v_mfma_f32_16x16x32_bf16 v[116:119], v[228:231], v[20:23], v[116:119]
    v_mfma_f32_16x16x32_bf16 v[120:123], v[228:231], v[24:27], v[120:123]
    ds_read_b64_tr_b16 v[226:227], v8 offset:2656
    v_mfma_f32_16x16x32_bf16 v[124:127], v[228:231], v[28:31], v[124:127]
    s_barrier
    v_mfma_f32_16x16x32_bf16 v[128:131], v[48:51], v[16:19], v[128:131]
    ds_read_b64_tr_b16 v[228:229], v8 offset:5216
    v_mfma_f32_16x16x32_bf16 v[132:135], v[48:51], v[20:23], v[132:135]
    v_mfma_f32_16x16x32_bf16 v[136:139], v[48:51], v[24:27], v[136:139]
    ds_read_b64_tr_b16 v[230:231], v8 offset:7776
    v_mfma_f32_16x16x32_bf16 v[140:143], v[48:51], v[28:31], v[140:143]
    s_waitcnt lgkmcnt(8)
    v_mfma_f32_16x16x32_bf16 v[144:147], v[52:55], v[16:19], v[144:147]
    ds_read_b64_tr_b16 v[48:49], v10 offset:10240
    v_mfma_f32_16x16x32_bf16 v[148:151], v[52:55], v[20:23], v[148:151]
    v_mfma_f32_16x16x32_bf16 v[152:155], v[52:55], v[24:27], v[152:155]
    ds_read_b64_tr_b16 v[50:51], v10 offset:12800
    v_mfma_f32_16x16x32_bf16 v[156:159], v[52:55], v[28:31], v[156:159]
    s_waitcnt lgkmcnt(8)
    v_mfma_f32_16x16x32_bf16 v[160:163], v[56:59], v[16:19], v[160:163]
    ds_read_b64_tr_b16 v[52:53], v10 offset:15360
    v_mfma_f32_16x16x32_bf16 v[164:167], v[56:59], v[20:23], v[164:167]
    ds_read_b64_tr_b16 v[54:55], v10 offset:17920
    v_mfma_f32_16x16x32_bf16 v[168:171], v[56:59], v[24:27], v[168:171]
    ds_read_b128 v[32:35], v5 offset:32768
    v_mfma_f32_16x16x32_bf16 v[172:175], v[56:59], v[28:31], v[172:175]
    s_waitcnt lgkmcnt(9)
    v_mfma_f32_16x16x32_bf16 v[176:179], v[60:63], v[16:19], v[176:179]
    ds_read_b64_tr_b16 v[56:57], v8 offset:10240
    v_mfma_f32_16x16x32_bf16 v[180:183], v[60:63], v[20:23], v[180:183]
    ds_read_b64_tr_b16 v[58:59], v8 offset:12800
    v_mfma_f32_16x16x32_bf16 v[184:187], v[60:63], v[24:27], v[184:187]
    ds_read_b128 v[36:39], v5 offset:33792
    v_mfma_f32_16x16x32_bf16 v[188:191], v[60:63], v[28:31], v[188:191]
    s_waitcnt lgkmcnt(10)
    v_mfma_f32_16x16x32_bf16 v[192:195], v[224:227], v[16:19], v[192:195]
    ds_read_b64_tr_b16 v[60:61], v8 offset:15360
    v_mfma_f32_16x16x32_bf16 v[196:199], v[224:227], v[20:23], v[196:199]
    ds_read_b64_tr_b16 v[62:63], v8 offset:17920
    v_mfma_f32_16x16x32_bf16 v[200:203], v[224:227], v[24:27], v[200:203]
    ds_read_b128 v[40:43], v5 offset:34816
    v_mfma_f32_16x16x32_bf16 v[204:207], v[224:227], v[28:31], v[204:207]
    s_waitcnt lgkmcnt(11)
    v_mfma_f32_16x16x32_bf16 v[208:211], v[228:231], v[16:19], v[208:211]
    ds_read_b64_tr_b16 v[224:225], v8 offset:10272
    v_mfma_f32_16x16x32_bf16 v[212:215], v[228:231], v[20:23], v[212:215]
    ds_read_b64_tr_b16 v[226:227], v8 offset:12832
    v_mfma_f32_16x16x32_bf16 v[216:219], v[228:231], v[24:27], v[216:219]
    ds_read_b128 v[44:47], v5 offset:35840
    v_mfma_f32_16x16x32_bf16 v[220:223], v[228:231], v[28:31], v[220:223]
    s_waitcnt lgkmcnt(12)
    s_waitcnt lgkmcnt(0)
    v_mfma_f32_16x16x32_bf16 v[64:67], v[48:51], v[32:35], v[64:67]
    ds_read_b64_tr_b16 v[228:229], v8 offset:15392
    v_mfma_f32_16x16x32_bf16 v[68:71], v[48:51], v[36:39], v[68:71]
    v_mfma_f32_16x16x32_bf16 v[72:75], v[48:51], v[40:43], v[72:75]
    ds_read_b64_tr_b16 v[230:231], v8 offset:17952
    v_mfma_f32_16x16x32_bf16 v[76:79], v[48:51], v[44:47], v[76:79]
    v_mfma_f32_16x16x32_bf16 v[80:83], v[52:55], v[32:35], v[80:83]
    ds_read_b64_tr_b16 v[48:49], v8 offset:10304
    v_mfma_f32_16x16x32_bf16 v[84:87], v[52:55], v[36:39], v[84:87]
    v_mfma_f32_16x16x32_bf16 v[88:91], v[52:55], v[40:43], v[88:91]
    ds_read_b64_tr_b16 v[50:51], v8 offset:12864
    v_mfma_f32_16x16x32_bf16 v[92:95], v[52:55], v[44:47], v[92:95]
    v_mfma_f32_16x16x32_bf16 v[96:99], v[56:59], v[32:35], v[96:99]
    ds_read_b64_tr_b16 v[52:53], v8 offset:15424
    v_mfma_f32_16x16x32_bf16 v[100:103], v[56:59], v[36:39], v[100:103]
    v_mfma_f32_16x16x32_bf16 v[104:107], v[56:59], v[40:43], v[104:107]
    ds_read_b64_tr_b16 v[54:55], v8 offset:17984
    v_mfma_f32_16x16x32_bf16 v[108:111], v[56:59], v[44:47], v[108:111]
    v_mfma_f32_16x16x32_bf16 v[112:115], v[60:63], v[32:35], v[112:115]
    ds_read_b64_tr_b16 v[56:57], v8 offset:10336
    v_mfma_f32_16x16x32_bf16 v[116:119], v[60:63], v[36:39], v[116:119]
    v_mfma_f32_16x16x32_bf16 v[120:123], v[60:63], v[40:43], v[120:123]
    ds_read_b64_tr_b16 v[58:59], v8 offset:12896
    v_mfma_f32_16x16x32_bf16 v[124:127], v[60:63], v[44:47], v[124:127]
    s_barrier
    v_mfma_f32_16x16x32_bf16 v[128:131], v[224:227], v[32:35], v[128:131]
    ds_read_b64_tr_b16 v[60:61], v8 offset:15456
    v_mfma_f32_16x16x32_bf16 v[132:135], v[224:227], v[36:39], v[132:135]
    v_mfma_f32_16x16x32_bf16 v[136:139], v[224:227], v[40:43], v[136:139]
    ds_read_b64_tr_b16 v[62:63], v8 offset:18016
    v_mfma_f32_16x16x32_bf16 v[140:143], v[224:227], v[44:47], v[140:143]
    s_waitcnt lgkmcnt(8)
    v_mfma_f32_16x16x32_bf16 v[144:147], v[228:231], v[32:35], v[144:147]
    ds_read_b64_tr_b16 v[224:225], v10 offset:20480
    v_mfma_f32_16x16x32_bf16 v[148:151], v[228:231], v[36:39], v[148:151]
    v_mfma_f32_16x16x32_bf16 v[152:155], v[228:231], v[40:43], v[152:155]
    ds_read_b64_tr_b16 v[226:227], v10 offset:23040
    v_mfma_f32_16x16x32_bf16 v[156:159], v[228:231], v[44:47], v[156:159]
    s_waitcnt lgkmcnt(8)
    v_mfma_f32_16x16x32_bf16 v[160:163], v[48:51], v[32:35], v[160:163]
    ds_read_b64_tr_b16 v[228:229], v10 offset:25600
    v_mfma_f32_16x16x32_bf16 v[164:167], v[48:51], v[36:39], v[164:167]
    ds_read_b64_tr_b16 v[230:231], v10 offset:28160
    v_mfma_f32_16x16x32_bf16 v[168:171], v[48:51], v[40:43], v[168:171]
    ds_read_b128 v[16:19], v4 offset:0
    v_mfma_f32_16x16x32_bf16 v[172:175], v[48:51], v[44:47], v[172:175]
    s_waitcnt lgkmcnt(9)
    v_mfma_f32_16x16x32_bf16 v[176:179], v[52:55], v[32:35], v[176:179]
    ds_read_b64_tr_b16 v[48:49], v8 offset:20480
    v_mfma_f32_16x16x32_bf16 v[180:183], v[52:55], v[36:39], v[180:183]
    ds_read_b64_tr_b16 v[50:51], v8 offset:23040
    v_mfma_f32_16x16x32_bf16 v[184:187], v[52:55], v[40:43], v[184:187]
    ds_read_b128 v[20:23], v4 offset:1024
    v_mfma_f32_16x16x32_bf16 v[188:191], v[52:55], v[44:47], v[188:191]
    s_waitcnt lgkmcnt(10)
    v_mfma_f32_16x16x32_bf16 v[192:195], v[56:59], v[32:35], v[192:195]
    ds_read_b64_tr_b16 v[52:53], v8 offset:25600
    v_mfma_f32_16x16x32_bf16 v[196:199], v[56:59], v[36:39], v[196:199]
    ds_read_b64_tr_b16 v[54:55], v8 offset:28160
    v_mfma_f32_16x16x32_bf16 v[200:203], v[56:59], v[40:43], v[200:203]
    ds_read_b128 v[24:27], v4 offset:2048
    v_mfma_f32_16x16x32_bf16 v[204:207], v[56:59], v[44:47], v[204:207]
    s_waitcnt lgkmcnt(11)
    v_mfma_f32_16x16x32_bf16 v[208:211], v[60:63], v[32:35], v[208:211]
    ds_read_b64_tr_b16 v[56:57], v8 offset:20512
    v_mfma_f32_16x16x32_bf16 v[212:215], v[60:63], v[36:39], v[212:215]
    ds_read_b64_tr_b16 v[58:59], v8 offset:23072
    v_mfma_f32_16x16x32_bf16 v[216:219], v[60:63], v[40:43], v[216:219]
    ds_read_b128 v[28:31], v4 offset:3072
    v_mfma_f32_16x16x32_bf16 v[220:223], v[60:63], v[44:47], v[220:223]
    s_waitcnt lgkmcnt(12)
    s_waitcnt lgkmcnt(0)
    v_mfma_f32_16x16x32_bf16 v[64:67], v[224:227], v[16:19], v[64:67]
    ds_read_b64_tr_b16 v[60:61], v8 offset:25632
    v_mfma_f32_16x16x32_bf16 v[68:71], v[224:227], v[20:23], v[68:71]
    v_mfma_f32_16x16x32_bf16 v[72:75], v[224:227], v[24:27], v[72:75]
    ds_read_b64_tr_b16 v[62:63], v8 offset:28192
    v_mfma_f32_16x16x32_bf16 v[76:79], v[224:227], v[28:31], v[76:79]
    v_mfma_f32_16x16x32_bf16 v[80:83], v[228:231], v[16:19], v[80:83]
    ds_read_b64_tr_b16 v[224:225], v8 offset:20544
    v_mfma_f32_16x16x32_bf16 v[84:87], v[228:231], v[20:23], v[84:87]
    v_mfma_f32_16x16x32_bf16 v[88:91], v[228:231], v[24:27], v[88:91]
    ds_read_b64_tr_b16 v[226:227], v8 offset:23104
    v_mfma_f32_16x16x32_bf16 v[92:95], v[228:231], v[28:31], v[92:95]
    v_mfma_f32_16x16x32_bf16 v[96:99], v[48:51], v[16:19], v[96:99]
    ds_read_b64_tr_b16 v[228:229], v8 offset:25664
    v_mfma_f32_16x16x32_bf16 v[100:103], v[48:51], v[20:23], v[100:103]
    v_mfma_f32_16x16x32_bf16 v[104:107], v[48:51], v[24:27], v[104:107]
    ds_read_b64_tr_b16 v[230:231], v8 offset:28224
    v_mfma_f32_16x16x32_bf16 v[108:111], v[48:51], v[28:31], v[108:111]
    v_mfma_f32_16x16x32_bf16 v[112:115], v[52:55], v[16:19], v[112:115]
    ds_read_b64_tr_b16 v[48:49], v8 offset:20576
    v_mfma_f32_16x16x32_bf16 v[116:119], v[52:55], v[20:23], v[116:119]
    v_mfma_f32_16x16x32_bf16 v[120:123], v[52:55], v[24:27], v[120:123]
    ds_read_b64_tr_b16 v[50:51], v8 offset:23136
    v_mfma_f32_16x16x32_bf16 v[124:127], v[52:55], v[28:31], v[124:127]
    s_barrier
    v_mfma_f32_16x16x32_bf16 v[128:131], v[56:59], v[16:19], v[128:131]
    ds_read_b64_tr_b16 v[52:53], v8 offset:25696
    v_mfma_f32_16x16x32_bf16 v[132:135], v[56:59], v[20:23], v[132:135]
    v_mfma_f32_16x16x32_bf16 v[136:139], v[56:59], v[24:27], v[136:139]
    ds_read_b64_tr_b16 v[54:55], v8 offset:28256
    v_mfma_f32_16x16x32_bf16 v[140:143], v[56:59], v[28:31], v[140:143]
    s_waitcnt lgkmcnt(8)
    v_mfma_f32_16x16x32_bf16 v[144:147], v[60:63], v[16:19], v[144:147]
    ds_read_b64_tr_b16 v[56:57], v10 offset:30720
    v_mfma_f32_16x16x32_bf16 v[148:151], v[60:63], v[20:23], v[148:151]
    v_mfma_f32_16x16x32_bf16 v[152:155], v[60:63], v[24:27], v[152:155]
    ds_read_b64_tr_b16 v[58:59], v10 offset:33280
    v_mfma_f32_16x16x32_bf16 v[156:159], v[60:63], v[28:31], v[156:159]
    s_waitcnt lgkmcnt(8)
    v_mfma_f32_16x16x32_bf16 v[160:163], v[224:227], v[16:19], v[160:163]
    ds_read_b64_tr_b16 v[60:61], v11 offset:3072
    v_mfma_f32_16x16x32_bf16 v[164:167], v[224:227], v[20:23], v[164:167]
    ds_read_b64_tr_b16 v[62:63], v11 offset:5632
    v_mfma_f32_16x16x32_bf16 v[168:171], v[224:227], v[24:27], v[168:171]
    ds_read_b128 v[32:35], v4 offset:16384
    v_mfma_f32_16x16x32_bf16 v[172:175], v[224:227], v[28:31], v[172:175]
    s_waitcnt lgkmcnt(9)
    v_mfma_f32_16x16x32_bf16 v[176:179], v[228:231], v[16:19], v[176:179]
    ds_read_b64_tr_b16 v[224:225], v8 offset:30720
    v_mfma_f32_16x16x32_bf16 v[180:183], v[228:231], v[20:23], v[180:183]
    ds_read_b64_tr_b16 v[226:227], v8 offset:33280
    v_mfma_f32_16x16x32_bf16 v[184:187], v[228:231], v[24:27], v[184:187]
    ds_read_b128 v[36:39], v4 offset:17408
    v_mfma_f32_16x16x32_bf16 v[188:191], v[228:231], v[28:31], v[188:191]
    s_waitcnt lgkmcnt(10)
    v_mfma_f32_16x16x32_bf16 v[192:195], v[48:51], v[16:19], v[192:195]
    ds_read_b64_tr_b16 v[228:229], v9 offset:3072
    v_mfma_f32_16x16x32_bf16 v[196:199], v[48:51], v[20:23], v[196:199]
    ds_read_b64_tr_b16 v[230:231], v9 offset:5632
    v_mfma_f32_16x16x32_bf16 v[200:203], v[48:51], v[24:27], v[200:203]
    ds_read_b128 v[40:43], v4 offset:18432
    v_mfma_f32_16x16x32_bf16 v[204:207], v[48:51], v[28:31], v[204:207]
    s_waitcnt lgkmcnt(11)
    v_mfma_f32_16x16x32_bf16 v[208:211], v[52:55], v[16:19], v[208:211]
    ds_read_b64_tr_b16 v[48:49], v8 offset:30752
    v_mfma_f32_16x16x32_bf16 v[212:215], v[52:55], v[20:23], v[212:215]
    ds_read_b64_tr_b16 v[50:51], v8 offset:33312
    v_mfma_f32_16x16x32_bf16 v[216:219], v[52:55], v[24:27], v[216:219]
    ds_read_b128 v[44:47], v4 offset:19456
    v_mfma_f32_16x16x32_bf16 v[220:223], v[52:55], v[28:31], v[220:223]
    s_waitcnt lgkmcnt(12)
    s_waitcnt lgkmcnt(0)
    v_mfma_f32_16x16x32_bf16 v[64:67], v[56:59], v[32:35], v[64:67]
    ds_read_b64_tr_b16 v[52:53], v9 offset:3104
    v_mfma_f32_16x16x32_bf16 v[68:71], v[56:59], v[36:39], v[68:71]
    v_mfma_f32_16x16x32_bf16 v[72:75], v[56:59], v[40:43], v[72:75]
    ds_read_b64_tr_b16 v[54:55], v9 offset:5664
    v_mfma_f32_16x16x32_bf16 v[76:79], v[56:59], v[44:47], v[76:79]
    v_mfma_f32_16x16x32_bf16 v[80:83], v[60:63], v[32:35], v[80:83]
    ds_read_b64_tr_b16 v[56:57], v8 offset:30784
    v_mfma_f32_16x16x32_bf16 v[84:87], v[60:63], v[36:39], v[84:87]
    v_mfma_f32_16x16x32_bf16 v[88:91], v[60:63], v[40:43], v[88:91]
    ds_read_b64_tr_b16 v[58:59], v8 offset:33344
    v_mfma_f32_16x16x32_bf16 v[92:95], v[60:63], v[44:47], v[92:95]
    v_mfma_f32_16x16x32_bf16 v[96:99], v[224:227], v[32:35], v[96:99]
    ds_read_b64_tr_b16 v[60:61], v9 offset:3136
    v_mfma_f32_16x16x32_bf16 v[100:103], v[224:227], v[36:39], v[100:103]
    v_mfma_f32_16x16x32_bf16 v[104:107], v[224:227], v[40:43], v[104:107]
    ds_read_b64_tr_b16 v[62:63], v9 offset:5696
    v_mfma_f32_16x16x32_bf16 v[108:111], v[224:227], v[44:47], v[108:111]
    v_mfma_f32_16x16x32_bf16 v[112:115], v[228:231], v[32:35], v[112:115]
    ds_read_b64_tr_b16 v[224:225], v8 offset:30816
    v_mfma_f32_16x16x32_bf16 v[116:119], v[228:231], v[36:39], v[116:119]
    v_mfma_f32_16x16x32_bf16 v[120:123], v[228:231], v[40:43], v[120:123]
    ds_read_b64_tr_b16 v[226:227], v8 offset:33376
    v_mfma_f32_16x16x32_bf16 v[124:127], v[228:231], v[44:47], v[124:127]
    s_barrier
    v_mfma_f32_16x16x32_bf16 v[128:131], v[48:51], v[32:35], v[128:131]
    ds_read_b64_tr_b16 v[228:229], v9 offset:3168
    v_mfma_f32_16x16x32_bf16 v[132:135], v[48:51], v[36:39], v[132:135]
    v_mfma_f32_16x16x32_bf16 v[136:139], v[48:51], v[40:43], v[136:139]
    ds_read_b64_tr_b16 v[230:231], v9 offset:5728
    v_mfma_f32_16x16x32_bf16 v[140:143], v[48:51], v[44:47], v[140:143]
    s_waitcnt lgkmcnt(8)
    v_mfma_f32_16x16x32_bf16 v[144:147], v[52:55], v[32:35], v[144:147]
    ds_read_b64_tr_b16 v[48:49], v11 offset:8192
    v_mfma_f32_16x16x32_bf16 v[148:151], v[52:55], v[36:39], v[148:151]
    v_mfma_f32_16x16x32_bf16 v[152:155], v[52:55], v[40:43], v[152:155]
    ds_read_b64_tr_b16 v[50:51], v11 offset:10752
    v_mfma_f32_16x16x32_bf16 v[156:159], v[52:55], v[44:47], v[156:159]
    s_waitcnt lgkmcnt(8)
    v_mfma_f32_16x16x32_bf16 v[160:163], v[56:59], v[32:35], v[160:163]
    ds_read_b64_tr_b16 v[52:53], v11 offset:13312
    v_mfma_f32_16x16x32_bf16 v[164:167], v[56:59], v[36:39], v[164:167]
    ds_read_b64_tr_b16 v[54:55], v11 offset:15872
    v_mfma_f32_16x16x32_bf16 v[168:171], v[56:59], v[40:43], v[168:171]
    ds_read_b128 v[16:19], v5 offset:0
    v_mfma_f32_16x16x32_bf16 v[172:175], v[56:59], v[44:47], v[172:175]
    s_waitcnt lgkmcnt(9)
    v_mfma_f32_16x16x32_bf16 v[176:179], v[60:63], v[32:35], v[176:179]
    ds_read_b64_tr_b16 v[56:57], v9 offset:8192
    v_mfma_f32_16x16x32_bf16 v[180:183], v[60:63], v[36:39], v[180:183]
    ds_read_b64_tr_b16 v[58:59], v9 offset:10752
    v_mfma_f32_16x16x32_bf16 v[184:187], v[60:63], v[40:43], v[184:187]
    ds_read_b128 v[20:23], v5 offset:1024
    v_mfma_f32_16x16x32_bf16 v[188:191], v[60:63], v[44:47], v[188:191]
    s_waitcnt lgkmcnt(10)
    v_mfma_f32_16x16x32_bf16 v[192:195], v[224:227], v[32:35], v[192:195]
    ds_read_b64_tr_b16 v[60:61], v9 offset:13312
    v_mfma_f32_16x16x32_bf16 v[196:199], v[224:227], v[36:39], v[196:199]
    ds_read_b64_tr_b16 v[62:63], v9 offset:15872
    v_mfma_f32_16x16x32_bf16 v[200:203], v[224:227], v[40:43], v[200:203]
    ds_read_b128 v[24:27], v5 offset:2048
    v_mfma_f32_16x16x32_bf16 v[204:207], v[224:227], v[44:47], v[204:207]
    s_waitcnt lgkmcnt(11)
    v_mfma_f32_16x16x32_bf16 v[208:211], v[228:231], v[32:35], v[208:211]
    ds_read_b64_tr_b16 v[224:225], v9 offset:8224
    v_mfma_f32_16x16x32_bf16 v[212:215], v[228:231], v[36:39], v[212:215]
    ds_read_b64_tr_b16 v[226:227], v9 offset:10784
    v_mfma_f32_16x16x32_bf16 v[216:219], v[228:231], v[40:43], v[216:219]
    ds_read_b128 v[28:31], v5 offset:3072
    v_mfma_f32_16x16x32_bf16 v[220:223], v[228:231], v[44:47], v[220:223]
    s_waitcnt lgkmcnt(12)
    s_waitcnt lgkmcnt(0)
    v_mfma_f32_16x16x32_bf16 v[64:67], v[48:51], v[16:19], v[64:67]
    ds_read_b64_tr_b16 v[228:229], v9 offset:13344
    v_mfma_f32_16x16x32_bf16 v[68:71], v[48:51], v[20:23], v[68:71]
    v_mfma_f32_16x16x32_bf16 v[72:75], v[48:51], v[24:27], v[72:75]
    ds_read_b64_tr_b16 v[230:231], v9 offset:15904
    v_mfma_f32_16x16x32_bf16 v[76:79], v[48:51], v[28:31], v[76:79]
    v_mfma_f32_16x16x32_bf16 v[80:83], v[52:55], v[16:19], v[80:83]
    ds_read_b64_tr_b16 v[48:49], v9 offset:8256
    v_mfma_f32_16x16x32_bf16 v[84:87], v[52:55], v[20:23], v[84:87]
    v_mfma_f32_16x16x32_bf16 v[88:91], v[52:55], v[24:27], v[88:91]
    ds_read_b64_tr_b16 v[50:51], v9 offset:10816
    v_mfma_f32_16x16x32_bf16 v[92:95], v[52:55], v[28:31], v[92:95]
    v_mfma_f32_16x16x32_bf16 v[96:99], v[56:59], v[16:19], v[96:99]
    ds_read_b64_tr_b16 v[52:53], v9 offset:13376
    v_mfma_f32_16x16x32_bf16 v[100:103], v[56:59], v[20:23], v[100:103]
    v_mfma_f32_16x16x32_bf16 v[104:107], v[56:59], v[24:27], v[104:107]
    ds_read_b64_tr_b16 v[54:55], v9 offset:15936
    v_mfma_f32_16x16x32_bf16 v[108:111], v[56:59], v[28:31], v[108:111]
    v_mfma_f32_16x16x32_bf16 v[112:115], v[60:63], v[16:19], v[112:115]
    ds_read_b64_tr_b16 v[56:57], v9 offset:8288
    v_mfma_f32_16x16x32_bf16 v[116:119], v[60:63], v[20:23], v[116:119]
    v_mfma_f32_16x16x32_bf16 v[120:123], v[60:63], v[24:27], v[120:123]
    ds_read_b64_tr_b16 v[58:59], v9 offset:10848
    v_mfma_f32_16x16x32_bf16 v[124:127], v[60:63], v[28:31], v[124:127]
    s_barrier
    v_mfma_f32_16x16x32_bf16 v[128:131], v[224:227], v[16:19], v[128:131]
    ds_read_b64_tr_b16 v[60:61], v9 offset:13408
    v_mfma_f32_16x16x32_bf16 v[132:135], v[224:227], v[20:23], v[132:135]
    v_mfma_f32_16x16x32_bf16 v[136:139], v[224:227], v[24:27], v[136:139]
    ds_read_b64_tr_b16 v[62:63], v9 offset:15968
    v_mfma_f32_16x16x32_bf16 v[140:143], v[224:227], v[28:31], v[140:143]
    s_waitcnt lgkmcnt(8)
    v_mfma_f32_16x16x32_bf16 v[144:147], v[228:231], v[16:19], v[144:147]
    ds_read_b64_tr_b16 v[224:225], v11 offset:18432
    v_mfma_f32_16x16x32_bf16 v[148:151], v[228:231], v[20:23], v[148:151]
    v_mfma_f32_16x16x32_bf16 v[152:155], v[228:231], v[24:27], v[152:155]
    ds_read_b64_tr_b16 v[226:227], v11 offset:20992
    v_mfma_f32_16x16x32_bf16 v[156:159], v[228:231], v[28:31], v[156:159]
    s_waitcnt lgkmcnt(8)
    v_mfma_f32_16x16x32_bf16 v[160:163], v[48:51], v[16:19], v[160:163]
    ds_read_b64_tr_b16 v[228:229], v11 offset:23552
    v_mfma_f32_16x16x32_bf16 v[164:167], v[48:51], v[20:23], v[164:167]
    ds_read_b64_tr_b16 v[230:231], v11 offset:26112
    v_mfma_f32_16x16x32_bf16 v[168:171], v[48:51], v[24:27], v[168:171]
    ds_read_b128 v[32:35], v5 offset:16384
    v_mfma_f32_16x16x32_bf16 v[172:175], v[48:51], v[28:31], v[172:175]
    s_waitcnt lgkmcnt(9)
    v_mfma_f32_16x16x32_bf16 v[176:179], v[52:55], v[16:19], v[176:179]
    ds_read_b64_tr_b16 v[48:49], v9 offset:18432
    v_mfma_f32_16x16x32_bf16 v[180:183], v[52:55], v[20:23], v[180:183]
    ds_read_b64_tr_b16 v[50:51], v9 offset:20992
    v_mfma_f32_16x16x32_bf16 v[184:187], v[52:55], v[24:27], v[184:187]
    ds_read_b128 v[36:39], v5 offset:17408
    v_mfma_f32_16x16x32_bf16 v[188:191], v[52:55], v[28:31], v[188:191]
    s_waitcnt lgkmcnt(10)
    v_mfma_f32_16x16x32_bf16 v[192:195], v[56:59], v[16:19], v[192:195]
    ds_read_b64_tr_b16 v[52:53], v9 offset:23552
    v_mfma_f32_16x16x32_bf16 v[196:199], v[56:59], v[20:23], v[196:199]
    ds_read_b64_tr_b16 v[54:55], v9 offset:26112
    v_mfma_f32_16x16x32_bf16 v[200:203], v[56:59], v[24:27], v[200:203]
    ds_read_b128 v[40:43], v5 offset:18432
    v_mfma_f32_16x16x32_bf16 v[204:207], v[56:59], v[28:31], v[204:207]
    s_waitcnt lgkmcnt(11)
    v_mfma_f32_16x16x32_bf16 v[208:211], v[60:63], v[16:19], v[208:211]
    ds_read_b64_tr_b16 v[56:57], v9 offset:18464
    v_mfma_f32_16x16x32_bf16 v[212:215], v[60:63], v[20:23], v[212:215]
    ds_read_b64_tr_b16 v[58:59], v9 offset:21024
    v_mfma_f32_16x16x32_bf16 v[216:219], v[60:63], v[24:27], v[216:219]
    ds_read_b128 v[44:47], v5 offset:19456
    v_mfma_f32_16x16x32_bf16 v[220:223], v[60:63], v[28:31], v[220:223]
    s_waitcnt lgkmcnt(12)
    s_waitcnt lgkmcnt(0)
    v_mfma_f32_16x16x32_bf16 v[64:67], v[224:227], v[32:35], v[64:67]
    ds_read_b64_tr_b16 v[60:61], v9 offset:23584
    v_mfma_f32_16x16x32_bf16 v[68:71], v[224:227], v[36:39], v[68:71]
    v_mfma_f32_16x16x32_bf16 v[72:75], v[224:227], v[40:43], v[72:75]
    ds_read_b64_tr_b16 v[62:63], v9 offset:26144
    v_mfma_f32_16x16x32_bf16 v[76:79], v[224:227], v[44:47], v[76:79]
    v_mfma_f32_16x16x32_bf16 v[80:83], v[228:231], v[32:35], v[80:83]
    ds_read_b64_tr_b16 v[224:225], v9 offset:18496
    v_mfma_f32_16x16x32_bf16 v[84:87], v[228:231], v[36:39], v[84:87]
    v_mfma_f32_16x16x32_bf16 v[88:91], v[228:231], v[40:43], v[88:91]
    ds_read_b64_tr_b16 v[226:227], v9 offset:21056
    v_mfma_f32_16x16x32_bf16 v[92:95], v[228:231], v[44:47], v[92:95]
    v_mfma_f32_16x16x32_bf16 v[96:99], v[48:51], v[32:35], v[96:99]
    ds_read_b64_tr_b16 v[228:229], v9 offset:23616
    v_mfma_f32_16x16x32_bf16 v[100:103], v[48:51], v[36:39], v[100:103]
    v_mfma_f32_16x16x32_bf16 v[104:107], v[48:51], v[40:43], v[104:107]
    ds_read_b64_tr_b16 v[230:231], v9 offset:26176
    v_mfma_f32_16x16x32_bf16 v[108:111], v[48:51], v[44:47], v[108:111]
    v_mfma_f32_16x16x32_bf16 v[112:115], v[52:55], v[32:35], v[112:115]
    ds_read_b64_tr_b16 v[48:49], v9 offset:18528
    v_mfma_f32_16x16x32_bf16 v[116:119], v[52:55], v[36:39], v[116:119]
    v_mfma_f32_16x16x32_bf16 v[120:123], v[52:55], v[40:43], v[120:123]
    ds_read_b64_tr_b16 v[50:51], v9 offset:21088
    v_mfma_f32_16x16x32_bf16 v[124:127], v[52:55], v[44:47], v[124:127]
    s_barrier
    v_mfma_f32_16x16x32_bf16 v[128:131], v[56:59], v[32:35], v[128:131]
    ds_read_b64_tr_b16 v[52:53], v9 offset:23648
    v_mfma_f32_16x16x32_bf16 v[132:135], v[56:59], v[36:39], v[132:135]
    v_mfma_f32_16x16x32_bf16 v[136:139], v[56:59], v[40:43], v[136:139]
    ds_read_b64_tr_b16 v[54:55], v9 offset:26208
    v_mfma_f32_16x16x32_bf16 v[140:143], v[56:59], v[44:47], v[140:143]
    s_waitcnt lgkmcnt(8)
    v_mfma_f32_16x16x32_bf16 v[144:147], v[60:63], v[32:35], v[144:147]
    ds_read_b64_tr_b16 v[56:57], v11 offset:28672
    v_mfma_f32_16x16x32_bf16 v[148:151], v[60:63], v[36:39], v[148:151]
    v_mfma_f32_16x16x32_bf16 v[152:155], v[60:63], v[40:43], v[152:155]
    ds_read_b64_tr_b16 v[58:59], v11 offset:31232
    v_mfma_f32_16x16x32_bf16 v[156:159], v[60:63], v[44:47], v[156:159]
    s_waitcnt lgkmcnt(8)
    v_mfma_f32_16x16x32_bf16 v[160:163], v[224:227], v[32:35], v[160:163]
    ds_read_b64_tr_b16 v[60:61], v11 offset:33792
    v_mfma_f32_16x16x32_bf16 v[164:167], v[224:227], v[36:39], v[164:167]
    ds_read_b64_tr_b16 v[62:63], v11 offset:36352
    v_mfma_f32_16x16x32_bf16 v[168:171], v[224:227], v[40:43], v[168:171]
    ds_read_b128 v[16:19], v5 offset:32768
    v_mfma_f32_16x16x32_bf16 v[172:175], v[224:227], v[44:47], v[172:175]
    s_waitcnt lgkmcnt(9)
    v_mfma_f32_16x16x32_bf16 v[176:179], v[228:231], v[32:35], v[176:179]
    ds_read_b64_tr_b16 v[224:225], v9 offset:28672
    v_mfma_f32_16x16x32_bf16 v[180:183], v[228:231], v[36:39], v[180:183]
    ds_read_b64_tr_b16 v[226:227], v9 offset:31232
    v_mfma_f32_16x16x32_bf16 v[184:187], v[228:231], v[40:43], v[184:187]
    ds_read_b128 v[20:23], v5 offset:33792
    v_mfma_f32_16x16x32_bf16 v[188:191], v[228:231], v[44:47], v[188:191]
    s_waitcnt lgkmcnt(10)
    v_mfma_f32_16x16x32_bf16 v[192:195], v[48:51], v[32:35], v[192:195]
    ds_read_b64_tr_b16 v[228:229], v9 offset:33792
    v_mfma_f32_16x16x32_bf16 v[196:199], v[48:51], v[36:39], v[196:199]
    ds_read_b64_tr_b16 v[230:231], v9 offset:36352
    v_mfma_f32_16x16x32_bf16 v[200:203], v[48:51], v[40:43], v[200:203]
    ds_read_b128 v[24:27], v5 offset:34816
    v_mfma_f32_16x16x32_bf16 v[204:207], v[48:51], v[44:47], v[204:207]
    s_waitcnt lgkmcnt(11)
    v_mfma_f32_16x16x32_bf16 v[208:211], v[52:55], v[32:35], v[208:211]
    ds_read_b64_tr_b16 v[48:49], v9 offset:28704
    v_mfma_f32_16x16x32_bf16 v[212:215], v[52:55], v[36:39], v[212:215]
    ds_read_b64_tr_b16 v[50:51], v9 offset:31264
    v_mfma_f32_16x16x32_bf16 v[216:219], v[52:55], v[40:43], v[216:219]
    ds_read_b128 v[28:31], v5 offset:35840
    v_mfma_f32_16x16x32_bf16 v[220:223], v[52:55], v[44:47], v[220:223]
    s_waitcnt lgkmcnt(12)
    s_waitcnt lgkmcnt(0)
    v_mfma_f32_16x16x32_bf16 v[64:67], v[56:59], v[16:19], v[64:67]
    ds_read_b64_tr_b16 v[52:53], v9 offset:33824
    v_mfma_f32_16x16x32_bf16 v[68:71], v[56:59], v[20:23], v[68:71]
    v_mfma_f32_16x16x32_bf16 v[72:75], v[56:59], v[24:27], v[72:75]
    ds_read_b64_tr_b16 v[54:55], v9 offset:36384
    v_mfma_f32_16x16x32_bf16 v[76:79], v[56:59], v[28:31], v[76:79]
    v_mfma_f32_16x16x32_bf16 v[80:83], v[60:63], v[16:19], v[80:83]
    ds_read_b64_tr_b16 v[56:57], v9 offset:28736
    v_mfma_f32_16x16x32_bf16 v[84:87], v[60:63], v[20:23], v[84:87]
    v_mfma_f32_16x16x32_bf16 v[88:91], v[60:63], v[24:27], v[88:91]
    ds_read_b64_tr_b16 v[58:59], v9 offset:31296
    v_mfma_f32_16x16x32_bf16 v[92:95], v[60:63], v[28:31], v[92:95]
    v_mfma_f32_16x16x32_bf16 v[96:99], v[224:227], v[16:19], v[96:99]
    ds_read_b64_tr_b16 v[60:61], v9 offset:33856
    v_mfma_f32_16x16x32_bf16 v[100:103], v[224:227], v[20:23], v[100:103]
    v_mfma_f32_16x16x32_bf16 v[104:107], v[224:227], v[24:27], v[104:107]
    ds_read_b64_tr_b16 v[62:63], v9 offset:36416
    v_mfma_f32_16x16x32_bf16 v[108:111], v[224:227], v[28:31], v[108:111]
    v_mfma_f32_16x16x32_bf16 v[112:115], v[228:231], v[16:19], v[112:115]
    ds_read_b64_tr_b16 v[224:225], v9 offset:28768
    v_mfma_f32_16x16x32_bf16 v[116:119], v[228:231], v[20:23], v[116:119]
    v_mfma_f32_16x16x32_bf16 v[120:123], v[228:231], v[24:27], v[120:123]
    ds_read_b64_tr_b16 v[226:227], v9 offset:31328
    v_mfma_f32_16x16x32_bf16 v[124:127], v[228:231], v[28:31], v[124:127]
    s_barrier
    v_mfma_f32_16x16x32_bf16 v[128:131], v[48:51], v[16:19], v[128:131]
    ds_read_b64_tr_b16 v[228:229], v9 offset:33888
    v_mfma_f32_16x16x32_bf16 v[132:135], v[48:51], v[20:23], v[132:135]
    v_mfma_f32_16x16x32_bf16 v[136:139], v[48:51], v[24:27], v[136:139]
    ds_read_b64_tr_b16 v[230:231], v9 offset:36448
    v_mfma_f32_16x16x32_bf16 v[140:143], v[48:51], v[28:31], v[140:143]
    s_waitcnt lgkmcnt(8)
    v_mfma_f32_16x16x32_bf16 v[144:147], v[52:55], v[16:19], v[144:147]
    ds_read_b64_tr_b16 v[48:49], v10 offset:0
    v_mfma_f32_16x16x32_bf16 v[148:151], v[52:55], v[20:23], v[148:151]
    v_mfma_f32_16x16x32_bf16 v[152:155], v[52:55], v[24:27], v[152:155]
    ds_read_b64_tr_b16 v[50:51], v10 offset:2560
    v_mfma_f32_16x16x32_bf16 v[156:159], v[52:55], v[28:31], v[156:159]
    s_waitcnt lgkmcnt(8)
    v_mfma_f32_16x16x32_bf16 v[160:163], v[56:59], v[16:19], v[160:163]
    ds_read_b64_tr_b16 v[52:53], v10 offset:5120
    v_mfma_f32_16x16x32_bf16 v[164:167], v[56:59], v[20:23], v[164:167]
    ds_read_b64_tr_b16 v[54:55], v10 offset:7680
    v_mfma_f32_16x16x32_bf16 v[168:171], v[56:59], v[24:27], v[168:171]
    ds_read_b128 v[32:35], v4 offset:0
    v_mfma_f32_16x16x32_bf16 v[172:175], v[56:59], v[28:31], v[172:175]
    s_waitcnt lgkmcnt(9)
    v_mfma_f32_16x16x32_bf16 v[176:179], v[60:63], v[16:19], v[176:179]
    ds_read_b64_tr_b16 v[56:57], v8 offset:0
    v_mfma_f32_16x16x32_bf16 v[180:183], v[60:63], v[20:23], v[180:183]
    ds_read_b64_tr_b16 v[58:59], v8 offset:2560
    v_mfma_f32_16x16x32_bf16 v[184:187], v[60:63], v[24:27], v[184:187]
    ds_read_b128 v[36:39], v4 offset:1024
    v_mfma_f32_16x16x32_bf16 v[188:191], v[60:63], v[28:31], v[188:191]
    s_waitcnt lgkmcnt(10)
    v_mfma_f32_16x16x32_bf16 v[192:195], v[224:227], v[16:19], v[192:195]
    ds_read_b64_tr_b16 v[60:61], v8 offset:5120
    v_mfma_f32_16x16x32_bf16 v[196:199], v[224:227], v[20:23], v[196:199]
    ds_read_b64_tr_b16 v[62:63], v8 offset:7680
    v_mfma_f32_16x16x32_bf16 v[200:203], v[224:227], v[24:27], v[200:203]
    ds_read_b128 v[40:43], v4 offset:2048
    v_mfma_f32_16x16x32_bf16 v[204:207], v[224:227], v[28:31], v[204:207]
    s_waitcnt lgkmcnt(11)
    v_mfma_f32_16x16x32_bf16 v[208:211], v[228:231], v[16:19], v[208:211]
    ds_read_b64_tr_b16 v[224:225], v8 offset:32
    v_mfma_f32_16x16x32_bf16 v[212:215], v[228:231], v[20:23], v[212:215]
    ds_read_b64_tr_b16 v[226:227], v8 offset:2592
    v_mfma_f32_16x16x32_bf16 v[216:219], v[228:231], v[24:27], v[216:219]
    ds_read_b128 v[44:47], v4 offset:3072
    v_mfma_f32_16x16x32_bf16 v[220:223], v[228:231], v[28:31], v[220:223]
    s_waitcnt lgkmcnt(12)
    s_waitcnt lgkmcnt(0)
    v_mfma_f32_16x16x32_bf16 v[64:67], v[48:51], v[32:35], v[64:67]
    ds_read_b64_tr_b16 v[228:229], v8 offset:5152
    v_mfma_f32_16x16x32_bf16 v[68:71], v[48:51], v[36:39], v[68:71]
    v_mfma_f32_16x16x32_bf16 v[72:75], v[48:51], v[40:43], v[72:75]
    ds_read_b64_tr_b16 v[230:231], v8 offset:7712
    v_mfma_f32_16x16x32_bf16 v[76:79], v[48:51], v[44:47], v[76:79]
    v_mfma_f32_16x16x32_bf16 v[80:83], v[52:55], v[32:35], v[80:83]
    ds_read_b64_tr_b16 v[48:49], v8 offset:64
    v_mfma_f32_16x16x32_bf16 v[84:87], v[52:55], v[36:39], v[84:87]
    v_mfma_f32_16x16x32_bf16 v[88:91], v[52:55], v[40:43], v[88:91]
    ds_read_b64_tr_b16 v[50:51], v8 offset:2624
    v_mfma_f32_16x16x32_bf16 v[92:95], v[52:55], v[44:47], v[92:95]
    v_mfma_f32_16x16x32_bf16 v[96:99], v[56:59], v[32:35], v[96:99]
    ds_read_b64_tr_b16 v[52:53], v8 offset:5184
    v_mfma_f32_16x16x32_bf16 v[100:103], v[56:59], v[36:39], v[100:103]
    v_mfma_f32_16x16x32_bf16 v[104:107], v[56:59], v[40:43], v[104:107]
    ds_read_b64_tr_b16 v[54:55], v8 offset:7744
    v_mfma_f32_16x16x32_bf16 v[108:111], v[56:59], v[44:47], v[108:111]
    v_mfma_f32_16x16x32_bf16 v[112:115], v[60:63], v[32:35], v[112:115]
    ds_read_b64_tr_b16 v[56:57], v8 offset:96
    v_mfma_f32_16x16x32_bf16 v[116:119], v[60:63], v[36:39], v[116:119]
    v_mfma_f32_16x16x32_bf16 v[120:123], v[60:63], v[40:43], v[120:123]
    ds_read_b64_tr_b16 v[58:59], v8 offset:2656
    v_mfma_f32_16x16x32_bf16 v[124:127], v[60:63], v[44:47], v[124:127]
    s_barrier
    v_mfma_f32_16x16x32_bf16 v[128:131], v[224:227], v[32:35], v[128:131]
    ds_read_b64_tr_b16 v[60:61], v8 offset:5216
    v_mfma_f32_16x16x32_bf16 v[132:135], v[224:227], v[36:39], v[132:135]
    v_mfma_f32_16x16x32_bf16 v[136:139], v[224:227], v[40:43], v[136:139]
    ds_read_b64_tr_b16 v[62:63], v8 offset:7776
    v_mfma_f32_16x16x32_bf16 v[140:143], v[224:227], v[44:47], v[140:143]
    s_waitcnt lgkmcnt(8)
    v_mfma_f32_16x16x32_bf16 v[144:147], v[228:231], v[32:35], v[144:147]
    ds_read_b64_tr_b16 v[224:225], v10 offset:10240
    v_mfma_f32_16x16x32_bf16 v[148:151], v[228:231], v[36:39], v[148:151]
    v_mfma_f32_16x16x32_bf16 v[152:155], v[228:231], v[40:43], v[152:155]
    ds_read_b64_tr_b16 v[226:227], v10 offset:12800
    v_mfma_f32_16x16x32_bf16 v[156:159], v[228:231], v[44:47], v[156:159]
    s_waitcnt lgkmcnt(8)
    v_mfma_f32_16x16x32_bf16 v[160:163], v[48:51], v[32:35], v[160:163]
    ds_read_b64_tr_b16 v[228:229], v10 offset:15360
    v_mfma_f32_16x16x32_bf16 v[164:167], v[48:51], v[36:39], v[164:167]
    ds_read_b64_tr_b16 v[230:231], v10 offset:17920
    v_mfma_f32_16x16x32_bf16 v[168:171], v[48:51], v[40:43], v[168:171]
    ds_read_b128 v[16:19], v4 offset:16384
    v_mfma_f32_16x16x32_bf16 v[172:175], v[48:51], v[44:47], v[172:175]
    s_waitcnt lgkmcnt(9)
    v_mfma_f32_16x16x32_bf16 v[176:179], v[52:55], v[32:35], v[176:179]
    ds_read_b64_tr_b16 v[48:49], v8 offset:10240
    v_mfma_f32_16x16x32_bf16 v[180:183], v[52:55], v[36:39], v[180:183]
    ds_read_b64_tr_b16 v[50:51], v8 offset:12800
    v_mfma_f32_16x16x32_bf16 v[184:187], v[52:55], v[40:43], v[184:187]
    ds_read_b128 v[20:23], v4 offset:17408
    v_mfma_f32_16x16x32_bf16 v[188:191], v[52:55], v[44:47], v[188:191]
    s_waitcnt lgkmcnt(10)
    v_mfma_f32_16x16x32_bf16 v[192:195], v[56:59], v[32:35], v[192:195]
    ds_read_b64_tr_b16 v[52:53], v8 offset:15360
    v_mfma_f32_16x16x32_bf16 v[196:199], v[56:59], v[36:39], v[196:199]
    ds_read_b64_tr_b16 v[54:55], v8 offset:17920
    v_mfma_f32_16x16x32_bf16 v[200:203], v[56:59], v[40:43], v[200:203]
    ds_read_b128 v[24:27], v4 offset:18432
    v_mfma_f32_16x16x32_bf16 v[204:207], v[56:59], v[44:47], v[204:207]
    s_waitcnt lgkmcnt(11)
    v_mfma_f32_16x16x32_bf16 v[208:211], v[60:63], v[32:35], v[208:211]
    ds_read_b64_tr_b16 v[56:57], v8 offset:10272
    v_mfma_f32_16x16x32_bf16 v[212:215], v[60:63], v[36:39], v[212:215]
    ds_read_b64_tr_b16 v[58:59], v8 offset:12832
    v_mfma_f32_16x16x32_bf16 v[216:219], v[60:63], v[40:43], v[216:219]
    ds_read_b128 v[28:31], v4 offset:19456
    v_mfma_f32_16x16x32_bf16 v[220:223], v[60:63], v[44:47], v[220:223]
    s_waitcnt lgkmcnt(12)
    s_waitcnt lgkmcnt(0)
    v_mfma_f32_16x16x32_bf16 v[64:67], v[224:227], v[16:19], v[64:67]
    ds_read_b64_tr_b16 v[60:61], v8 offset:15392
    v_mfma_f32_16x16x32_bf16 v[68:71], v[224:227], v[20:23], v[68:71]
    v_mfma_f32_16x16x32_bf16 v[72:75], v[224:227], v[24:27], v[72:75]
    ds_read_b64_tr_b16 v[62:63], v8 offset:17952
    v_mfma_f32_16x16x32_bf16 v[76:79], v[224:227], v[28:31], v[76:79]
    v_mfma_f32_16x16x32_bf16 v[80:83], v[228:231], v[16:19], v[80:83]
    ds_read_b64_tr_b16 v[224:225], v8 offset:10304
    v_mfma_f32_16x16x32_bf16 v[84:87], v[228:231], v[20:23], v[84:87]
    v_mfma_f32_16x16x32_bf16 v[88:91], v[228:231], v[24:27], v[88:91]
    ds_read_b64_tr_b16 v[226:227], v8 offset:12864
    v_mfma_f32_16x16x32_bf16 v[92:95], v[228:231], v[28:31], v[92:95]
    v_mfma_f32_16x16x32_bf16 v[96:99], v[48:51], v[16:19], v[96:99]
    ds_read_b64_tr_b16 v[228:229], v8 offset:15424
    v_mfma_f32_16x16x32_bf16 v[100:103], v[48:51], v[20:23], v[100:103]
    v_mfma_f32_16x16x32_bf16 v[104:107], v[48:51], v[24:27], v[104:107]
    ds_read_b64_tr_b16 v[230:231], v8 offset:17984
    v_mfma_f32_16x16x32_bf16 v[108:111], v[48:51], v[28:31], v[108:111]
    v_mfma_f32_16x16x32_bf16 v[112:115], v[52:55], v[16:19], v[112:115]
    ds_read_b64_tr_b16 v[48:49], v8 offset:10336
    v_mfma_f32_16x16x32_bf16 v[116:119], v[52:55], v[20:23], v[116:119]
    v_mfma_f32_16x16x32_bf16 v[120:123], v[52:55], v[24:27], v[120:123]
    ds_read_b64_tr_b16 v[50:51], v8 offset:12896
    v_mfma_f32_16x16x32_bf16 v[124:127], v[52:55], v[28:31], v[124:127]
    s_barrier
    v_mfma_f32_16x16x32_bf16 v[128:131], v[56:59], v[16:19], v[128:131]
    ds_read_b64_tr_b16 v[52:53], v8 offset:15456
    v_mfma_f32_16x16x32_bf16 v[132:135], v[56:59], v[20:23], v[132:135]
    v_mfma_f32_16x16x32_bf16 v[136:139], v[56:59], v[24:27], v[136:139]
    ds_read_b64_tr_b16 v[54:55], v8 offset:18016
    v_mfma_f32_16x16x32_bf16 v[140:143], v[56:59], v[28:31], v[140:143]
    s_waitcnt lgkmcnt(8)
    v_mfma_f32_16x16x32_bf16 v[144:147], v[60:63], v[16:19], v[144:147]
    ds_read_b64_tr_b16 v[56:57], v10 offset:20480
    v_mfma_f32_16x16x32_bf16 v[148:151], v[60:63], v[20:23], v[148:151]
    v_mfma_f32_16x16x32_bf16 v[152:155], v[60:63], v[24:27], v[152:155]
    ds_read_b64_tr_b16 v[58:59], v10 offset:23040
    v_mfma_f32_16x16x32_bf16 v[156:159], v[60:63], v[28:31], v[156:159]
    s_waitcnt lgkmcnt(8)
    v_mfma_f32_16x16x32_bf16 v[160:163], v[224:227], v[16:19], v[160:163]
    ds_read_b64_tr_b16 v[60:61], v10 offset:25600
    v_mfma_f32_16x16x32_bf16 v[164:167], v[224:227], v[20:23], v[164:167]
    ds_read_b64_tr_b16 v[62:63], v10 offset:28160
    v_mfma_f32_16x16x32_bf16 v[168:171], v[224:227], v[24:27], v[168:171]
    ds_read_b128 v[32:35], v5 offset:0
    v_mfma_f32_16x16x32_bf16 v[172:175], v[224:227], v[28:31], v[172:175]
    s_waitcnt lgkmcnt(9)
    v_mfma_f32_16x16x32_bf16 v[176:179], v[228:231], v[16:19], v[176:179]
    ds_read_b64_tr_b16 v[224:225], v8 offset:20480
    v_mfma_f32_16x16x32_bf16 v[180:183], v[228:231], v[20:23], v[180:183]
    ds_read_b64_tr_b16 v[226:227], v8 offset:23040
    v_mfma_f32_16x16x32_bf16 v[184:187], v[228:231], v[24:27], v[184:187]
    ds_read_b128 v[36:39], v5 offset:1024
    v_mfma_f32_16x16x32_bf16 v[188:191], v[228:231], v[28:31], v[188:191]
    s_waitcnt lgkmcnt(10)
    v_mfma_f32_16x16x32_bf16 v[192:195], v[48:51], v[16:19], v[192:195]
    ds_read_b64_tr_b16 v[228:229], v8 offset:25600
    v_mfma_f32_16x16x32_bf16 v[196:199], v[48:51], v[20:23], v[196:199]
    ds_read_b64_tr_b16 v[230:231], v8 offset:28160
    v_mfma_f32_16x16x32_bf16 v[200:203], v[48:51], v[24:27], v[200:203]
    ds_read_b128 v[40:43], v5 offset:2048
    v_mfma_f32_16x16x32_bf16 v[204:207], v[48:51], v[28:31], v[204:207]
    s_waitcnt lgkmcnt(11)
    v_mfma_f32_16x16x32_bf16 v[208:211], v[52:55], v[16:19], v[208:211]
    ds_read_b64_tr_b16 v[48:49], v8 offset:20512
    v_mfma_f32_16x16x32_bf16 v[212:215], v[52:55], v[20:23], v[212:215]
    ds_read_b64_tr_b16 v[50:51], v8 offset:23072
    v_mfma_f32_16x16x32_bf16 v[216:219], v[52:55], v[24:27], v[216:219]
    ds_read_b128 v[44:47], v5 offset:3072
    v_mfma_f32_16x16x32_bf16 v[220:223], v[52:55], v[28:31], v[220:223]
    s_waitcnt lgkmcnt(12)
    s_waitcnt lgkmcnt(0)
    v_mfma_f32_16x16x32_bf16 v[64:67], v[56:59], v[32:35], v[64:67]
    ds_read_b64_tr_b16 v[52:53], v8 offset:25632
    v_mfma_f32_16x16x32_bf16 v[68:71], v[56:59], v[36:39], v[68:71]
    v_mfma_f32_16x16x32_bf16 v[72:75], v[56:59], v[40:43], v[72:75]
    ds_read_b64_tr_b16 v[54:55], v8 offset:28192
    v_mfma_f32_16x16x32_bf16 v[76:79], v[56:59], v[44:47], v[76:79]
    v_mfma_f32_16x16x32_bf16 v[80:83], v[60:63], v[32:35], v[80:83]
    ds_read_b64_tr_b16 v[56:57], v8 offset:20544
    v_mfma_f32_16x16x32_bf16 v[84:87], v[60:63], v[36:39], v[84:87]
    v_mfma_f32_16x16x32_bf16 v[88:91], v[60:63], v[40:43], v[88:91]
    ds_read_b64_tr_b16 v[58:59], v8 offset:23104
    v_mfma_f32_16x16x32_bf16 v[92:95], v[60:63], v[44:47], v[92:95]
    v_mfma_f32_16x16x32_bf16 v[96:99], v[224:227], v[32:35], v[96:99]
    ds_read_b64_tr_b16 v[60:61], v8 offset:25664
    v_mfma_f32_16x16x32_bf16 v[100:103], v[224:227], v[36:39], v[100:103]
    v_mfma_f32_16x16x32_bf16 v[104:107], v[224:227], v[40:43], v[104:107]
    ds_read_b64_tr_b16 v[62:63], v8 offset:28224
    v_mfma_f32_16x16x32_bf16 v[108:111], v[224:227], v[44:47], v[108:111]
    v_mfma_f32_16x16x32_bf16 v[112:115], v[228:231], v[32:35], v[112:115]
    ds_read_b64_tr_b16 v[224:225], v8 offset:20576
    v_mfma_f32_16x16x32_bf16 v[116:119], v[228:231], v[36:39], v[116:119]
    v_mfma_f32_16x16x32_bf16 v[120:123], v[228:231], v[40:43], v[120:123]
    ds_read_b64_tr_b16 v[226:227], v8 offset:23136
    v_mfma_f32_16x16x32_bf16 v[124:127], v[228:231], v[44:47], v[124:127]
    s_barrier
    v_mfma_f32_16x16x32_bf16 v[128:131], v[48:51], v[32:35], v[128:131]
    ds_read_b64_tr_b16 v[228:229], v8 offset:25696
    v_mfma_f32_16x16x32_bf16 v[132:135], v[48:51], v[36:39], v[132:135]
    v_mfma_f32_16x16x32_bf16 v[136:139], v[48:51], v[40:43], v[136:139]
    ds_read_b64_tr_b16 v[230:231], v8 offset:28256
    v_mfma_f32_16x16x32_bf16 v[140:143], v[48:51], v[44:47], v[140:143]
    s_waitcnt lgkmcnt(8)
    v_mfma_f32_16x16x32_bf16 v[144:147], v[52:55], v[32:35], v[144:147]
    ds_read_b64_tr_b16 v[48:49], v8 offset:30720
    v_mfma_f32_16x16x32_bf16 v[148:151], v[52:55], v[36:39], v[148:151]
    v_mfma_f32_16x16x32_bf16 v[152:155], v[52:55], v[40:43], v[152:155]
    ds_read_b64_tr_b16 v[50:51], v8 offset:33280
    v_mfma_f32_16x16x32_bf16 v[156:159], v[52:55], v[44:47], v[156:159]
    s_waitcnt lgkmcnt(8)
    v_mfma_f32_16x16x32_bf16 v[160:163], v[56:59], v[32:35], v[160:163]
    ds_read_b64_tr_b16 v[52:53], v9 offset:3072
    v_mfma_f32_16x16x32_bf16 v[164:167], v[56:59], v[36:39], v[164:167]
    ds_read_b64_tr_b16 v[54:55], v9 offset:5632
    v_mfma_f32_16x16x32_bf16 v[168:171], v[56:59], v[40:43], v[168:171]
    ds_read_b128 v[16:19], v5 offset:16384
    v_mfma_f32_16x16x32_bf16 v[172:175], v[56:59], v[44:47], v[172:175]
    s_waitcnt lgkmcnt(9)
    v_mfma_f32_16x16x32_bf16 v[176:179], v[60:63], v[32:35], v[176:179]
    ds_read_b64_tr_b16 v[56:57], v8 offset:30752
    v_mfma_f32_16x16x32_bf16 v[180:183], v[60:63], v[36:39], v[180:183]
    ds_read_b64_tr_b16 v[58:59], v8 offset:33312
    v_mfma_f32_16x16x32_bf16 v[184:187], v[60:63], v[40:43], v[184:187]
    ds_read_b128 v[20:23], v5 offset:17408
    v_mfma_f32_16x16x32_bf16 v[188:191], v[60:63], v[44:47], v[188:191]
    s_waitcnt lgkmcnt(10)
    v_mfma_f32_16x16x32_bf16 v[192:195], v[224:227], v[32:35], v[192:195]
    ds_read_b64_tr_b16 v[60:61], v9 offset:3104
    v_mfma_f32_16x16x32_bf16 v[196:199], v[224:227], v[36:39], v[196:199]
    ds_read_b64_tr_b16 v[62:63], v9 offset:5664
    v_mfma_f32_16x16x32_bf16 v[200:203], v[224:227], v[40:43], v[200:203]
    ds_read_b128 v[24:27], v5 offset:18432
    v_mfma_f32_16x16x32_bf16 v[204:207], v[224:227], v[44:47], v[204:207]
    s_waitcnt lgkmcnt(11)
    v_mfma_f32_16x16x32_bf16 v[208:211], v[228:231], v[32:35], v[208:211]
    ds_read_b64_tr_b16 v[224:225], v8 offset:30784
    v_mfma_f32_16x16x32_bf16 v[212:215], v[228:231], v[36:39], v[212:215]
    ds_read_b64_tr_b16 v[226:227], v8 offset:33344
    v_mfma_f32_16x16x32_bf16 v[216:219], v[228:231], v[40:43], v[216:219]
    ds_read_b128 v[28:31], v5 offset:19456
    v_mfma_f32_16x16x32_bf16 v[220:223], v[228:231], v[44:47], v[220:223]
    s_nop 7
    s_waitcnt vmcnt(0)
    v_max_f32 v64, 0, v64
    v_max_f32 v65, 0, v65
    v_max_f32 v66, 0, v66
    v_max_f32 v67, 0, v67
    v_mul_f32 v64, v64, v80
    v_mul_f32 v65, v65, v81
    v_mul_f32 v66, v66, v82
    v_mul_f32 v67, v67, v83
    v_cvt_pk_bf16_f32 v232, v64, v65
    v_cvt_pk_bf16_f32 v233, v66, v67
    v_max_f32 v68, 0, v68
    v_max_f32 v69, 0, v69
    v_max_f32 v70, 0, v70
    v_max_f32 v71, 0, v71
    v_mul_f32 v68, v68, v84
    v_mul_f32 v69, v69, v85
    v_mul_f32 v70, v70, v86
    v_mul_f32 v71, v71, v87
    v_cvt_pk_bf16_f32 v234, v68, v69
    v_cvt_pk_bf16_f32 v235, v70, v71
    v_max_f32 v72, 0, v72
    v_max_f32 v73, 0, v73
    v_max_f32 v74, 0, v74
    v_max_f32 v75, 0, v75
    v_mul_f32 v72, v72, v88
    v_mul_f32 v73, v73, v89
    v_mul_f32 v74, v74, v90
    v_mul_f32 v75, v75, v91
    v_cvt_pk_bf16_f32 v236, v72, v73
    v_cvt_pk_bf16_f32 v237, v74, v75
    v_max_f32 v76, 0, v76
    v_max_f32 v77, 0, v77
    v_max_f32 v78, 0, v78
    v_max_f32 v79, 0, v79
    v_mul_f32 v76, v76, v92
    v_mul_f32 v77, v77, v93
    v_mul_f32 v78, v78, v94
    v_mul_f32 v79, v79, v95
    v_cvt_pk_bf16_f32 v238, v76, v77
    v_cvt_pk_bf16_f32 v239, v78, v79
    v_max_f32 v96, 0, v96
    v_max_f32 v97, 0, v97
    v_max_f32 v98, 0, v98
    v_max_f32 v99, 0, v99
    v_mul_f32 v96, v96, v112
    v_mul_f32 v97, v97, v113
    v_mul_f32 v98, v98, v114
    v_mul_f32 v99, v99, v115
    v_cvt_pk_bf16_f32 v64, v96, v97
    v_cvt_pk_bf16_f32 v65, v98, v99
    v_max_f32 v128, 0, v128
    v_max_f32 v129, 0, v129
    v_max_f32 v130, 0, v130
    v_max_f32 v131, 0, v131
    v_mul_f32 v128, v128, v144
    v_mul_f32 v129, v129, v145
    v_mul_f32 v130, v130, v146
    v_mul_f32 v131, v131, v147
    v_cvt_pk_bf16_f32 v66, v128, v129
    v_cvt_pk_bf16_f32 v67, v130, v131
    v_max_f32 v160, 0, v160
    v_max_f32 v161, 0, v161
    v_max_f32 v162, 0, v162
    v_max_f32 v163, 0, v163
    v_mul_f32 v160, v160, v176
    v_mul_f32 v161, v161, v177
    v_mul_f32 v162, v162, v178
    v_mul_f32 v163, v163, v179
    v_cvt_pk_bf16_f32 v68, v160, v161
    v_cvt_pk_bf16_f32 v69, v162, v163
    v_max_f32 v192, 0, v192
    v_max_f32 v193, 0, v193
    v_max_f32 v194, 0, v194
    v_max_f32 v195, 0, v195
    v_mul_f32 v192, v192, v208
    v_mul_f32 v193, v193, v209
    v_mul_f32 v194, v194, v210
    v_mul_f32 v195, v195, v211
    v_cvt_pk_bf16_f32 v70, v192, v193
    v_cvt_pk_bf16_f32 v71, v194, v195
    v_max_f32 v100, 0, v100
    v_max_f32 v101, 0, v101
    v_max_f32 v102, 0, v102
    v_max_f32 v103, 0, v103
    v_mul_f32 v100, v100, v116
    v_mul_f32 v101, v101, v117
    v_mul_f32 v102, v102, v118
    v_mul_f32 v103, v103, v119
    v_cvt_pk_bf16_f32 v72, v100, v101
    v_cvt_pk_bf16_f32 v73, v102, v103
    v_max_f32 v132, 0, v132
    v_max_f32 v133, 0, v133
    v_max_f32 v134, 0, v134
    v_max_f32 v135, 0, v135
    v_mul_f32 v132, v132, v148
    v_mul_f32 v133, v133, v149
    v_mul_f32 v134, v134, v150
    v_mul_f32 v135, v135, v151
    v_cvt_pk_bf16_f32 v74, v132, v133
    v_cvt_pk_bf16_f32 v75, v134, v135
    v_max_f32 v164, 0, v164
    v_max_f32 v165, 0, v165
    v_max_f32 v166, 0, v166
    v_max_f32 v167, 0, v167
    v_mul_f32 v164, v164, v180
    v_mul_f32 v165, v165, v181
    v_mul_f32 v166, v166, v182
    v_mul_f32 v167, v167, v183
    v_cvt_pk_bf16_f32 v76, v164, v165
    v_cvt_pk_bf16_f32 v77, v166, v167
    v_max_f32 v196, 0, v196
    v_max_f32 v197, 0, v197
    v_max_f32 v198, 0, v198
    v_max_f32 v199, 0, v199
    v_mul_f32 v196, v196, v212
    v_mul_f32 v197, v197, v213
    v_mul_f32 v198, v198, v214
    v_mul_f32 v199, v199, v215
    v_cvt_pk_bf16_f32 v78, v196, v197
    v_cvt_pk_bf16_f32 v79, v198, v199
    v_max_f32 v104, 0, v104
    v_max_f32 v105, 0, v105
    v_max_f32 v106, 0, v106
    v_max_f32 v107, 0, v107
    v_mul_f32 v104, v104, v120
    v_mul_f32 v105, v105, v121
    v_mul_f32 v106, v106, v122
    v_mul_f32 v107, v107, v123
    v_cvt_pk_bf16_f32 v80, v104, v105
    v_cvt_pk_bf16_f32 v81, v106, v107
    v_max_f32 v136, 0, v136
    v_max_f32 v137, 0, v137
    v_max_f32 v138, 0, v138
    v_max_f32 v139, 0, v139
    v_mul_f32 v136, v136, v152
    v_mul_f32 v137, v137, v153
    v_mul_f32 v138, v138, v154
    v_mul_f32 v139, v139, v155
    v_cvt_pk_bf16_f32 v82, v136, v137
    v_cvt_pk_bf16_f32 v83, v138, v139
    v_max_f32 v168, 0, v168
    v_max_f32 v169, 0, v169
    v_max_f32 v170, 0, v170
    v_max_f32 v171, 0, v171
    v_mul_f32 v168, v168, v184
    v_mul_f32 v169, v169, v185
    v_mul_f32 v170, v170, v186
    v_mul_f32 v171, v171, v187
    v_cvt_pk_bf16_f32 v84, v168, v169
    v_cvt_pk_bf16_f32 v85, v170, v171
    v_max_f32 v200, 0, v200
    v_max_f32 v201, 0, v201
    v_max_f32 v202, 0, v202
    v_max_f32 v203, 0, v203
    v_mul_f32 v200, v200, v216
    v_mul_f32 v201, v201, v217
    v_mul_f32 v202, v202, v218
    v_mul_f32 v203, v203, v219
    v_cvt_pk_bf16_f32 v86, v200, v201
    v_cvt_pk_bf16_f32 v87, v202, v203
    v_max_f32 v108, 0, v108
    v_max_f32 v109, 0, v109
    v_max_f32 v110, 0, v110
    v_max_f32 v111, 0, v111
    v_mul_f32 v108, v108, v124
    v_mul_f32 v109, v109, v125
    v_mul_f32 v110, v110, v126
    v_mul_f32 v111, v111, v127
    v_cvt_pk_bf16_f32 v88, v108, v109
    v_cvt_pk_bf16_f32 v89, v110, v111
    v_max_f32 v140, 0, v140
    v_max_f32 v141, 0, v141
    v_max_f32 v142, 0, v142
    v_max_f32 v143, 0, v143
    v_mul_f32 v140, v140, v156
    v_mul_f32 v141, v141, v157
    v_mul_f32 v142, v142, v158
    v_mul_f32 v143, v143, v159
    v_cvt_pk_bf16_f32 v90, v140, v141
    v_cvt_pk_bf16_f32 v91, v142, v143
    v_max_f32 v172, 0, v172
    v_max_f32 v173, 0, v173
    v_max_f32 v174, 0, v174
    v_max_f32 v175, 0, v175
    v_mul_f32 v172, v172, v188
    v_mul_f32 v173, v173, v189
    v_mul_f32 v174, v174, v190
    v_mul_f32 v175, v175, v191
    v_cvt_pk_bf16_f32 v92, v172, v173
    v_cvt_pk_bf16_f32 v93, v174, v175
    v_max_f32 v204, 0, v204
    v_max_f32 v205, 0, v205
    v_max_f32 v206, 0, v206
    v_max_f32 v207, 0, v207
    v_mul_f32 v204, v204, v220
    v_mul_f32 v205, v205, v221
    v_mul_f32 v206, v206, v222
    v_mul_f32 v207, v207, v223
    v_cvt_pk_bf16_f32 v94, v204, v205
    v_cvt_pk_bf16_f32 v95, v206, v207
    s_waitcnt lgkmcnt(12)
    s_waitcnt lgkmcnt(0)
    v_mfma_f32_16x16x32_bf16 v[96:99], v[48:51], v[16:19], 0
    ds_read_b64_tr_b16 v[228:229], v9 offset:3136
    v_mfma_f32_16x16x32_bf16 v[100:103], v[48:51], v[20:23], 0
    v_mfma_f32_16x16x32_bf16 v[104:107], v[48:51], v[24:27], 0
    ds_read_b64_tr_b16 v[230:231], v9 offset:5696
    v_mfma_f32_16x16x32_bf16 v[108:111], v[48:51], v[28:31], 0
    s_add_u32 s43, s42, 0
    buffer_store_dwordx2 v[232:233], v3, s[32:35], s43 offen sc1
    v_mfma_f32_16x16x32_bf16 v[112:115], v[52:55], v[16:19], 0
    ds_read_b64_tr_b16 v[48:49], v8 offset:30816
    v_mfma_f32_16x16x32_bf16 v[116:119], v[52:55], v[20:23], 0
    v_mfma_f32_16x16x32_bf16 v[120:123], v[52:55], v[24:27], 0
    ds_read_b64_tr_b16 v[50:51], v8 offset:33376
    v_mfma_f32_16x16x32_bf16 v[124:127], v[52:55], v[28:31], 0
    s_barrier
    v_mfma_f32_16x16x32_bf16 v[128:131], v[56:59], v[16:19], 0
    ds_read_b64_tr_b16 v[52:53], v9 offset:3168
    v_mfma_f32_16x16x32_bf16 v[132:135], v[56:59], v[20:23], 0
    v_mfma_f32_16x16x32_bf16 v[136:139], v[56:59], v[24:27], 0
    ds_read_b64_tr_b16 v[54:55], v9 offset:5728
    v_mfma_f32_16x16x32_bf16 v[140:143], v[56:59], v[28:31], 0
    v_mfma_f32_16x16x32_bf16 v[144:147], v[60:63], v[16:19], 0
    ds_read_b64_tr_b16 v[56:57], v9 offset:8192
    v_mfma_f32_16x16x32_bf16 v[148:151], v[60:63], v[20:23], 0
    v_mfma_f32_16x16x32_bf16 v[152:155], v[60:63], v[24:27], 0
    ds_read_b64_tr_b16 v[58:59], v9 offset:10752
    v_mfma_f32_16x16x32_bf16 v[156:159], v[60:63], v[28:31], 0
    v_mfma_f32_16x16x32_bf16 v[160:163], v[224:227], v[16:19], 0
    ds_read_b64_tr_b16 v[60:61], v9 offset:13312
    v_mfma_f32_16x16x32_bf16 v[164:167], v[224:227], v[20:23], 0
    ds_read_b64_tr_b16 v[62:63], v9 offset:15872
    v_mfma_f32_16x16x32_bf16 v[168:171], v[224:227], v[24:27], 0
    ds_read_b128 v[32:35], v5 offset:32768
    v_mfma_f32_16x16x32_bf16 v[172:175], v[224:227], v[28:31], 0
    s_waitcnt lgkmcnt(9)
    v_mfma_f32_16x16x32_bf16 v[176:179], v[228:231], v[16:19], 0
    ds_read_b64_tr_b16 v[224:225], v9 offset:8224
    v_mfma_f32_16x16x32_bf16 v[180:183], v[228:231], v[20:23], 0
    ds_read_b64_tr_b16 v[226:227], v9 offset:10784
    v_mfma_f32_16x16x32_bf16 v[184:187], v[228:231], v[24:27], 0
    ds_read_b128 v[36:39], v5 offset:33792
    v_mfma_f32_16x16x32_bf16 v[188:191], v[228:231], v[28:31], 0
    s_waitcnt lgkmcnt(10)
    v_mfma_f32_16x16x32_bf16 v[192:195], v[48:51], v[16:19], 0
    ds_read_b64_tr_b16 v[228:229], v9 offset:13344
    v_mfma_f32_16x16x32_bf16 v[196:199], v[48:51], v[20:23], 0
    ds_read_b64_tr_b16 v[230:231], v9 offset:15904
    v_mfma_f32_16x16x32_bf16 v[200:203], v[48:51], v[24:27], 0
    ds_read_b128 v[40:43], v5 offset:34816
    v_mfma_f32_16x16x32_bf16 v[204:207], v[48:51], v[28:31], 0
    s_add_u32 s43, s42, 147456
    buffer_store_dwordx2 v[234:235], v3, s[32:35], s43 offen sc1
    s_waitcnt lgkmcnt(11)
    v_mfma_f32_16x16x32_bf16 v[208:211], v[52:55], v[16:19], 0
    ds_read_b64_tr_b16 v[48:49], v9 offset:8256
    v_mfma_f32_16x16x32_bf16 v[212:215], v[52:55], v[20:23], 0
    ds_read_b64_tr_b16 v[50:51], v9 offset:10816
    v_mfma_f32_16x16x32_bf16 v[216:219], v[52:55], v[24:27], 0
    ds_read_b128 v[44:47], v5 offset:35840
    v_mfma_f32_16x16x32_bf16 v[220:223], v[52:55], v[28:31], 0
    s_waitcnt lgkmcnt(12)
    s_waitcnt lgkmcnt(0)
    v_mfma_f32_16x16x32_bf16 v[96:99], v[56:59], v[32:35], v[96:99]
    ds_read_b64_tr_b16 v[52:53], v9 offset:13376
    v_mfma_f32_16x16x32_bf16 v[100:103], v[56:59], v[36:39], v[100:103]
    v_mfma_f32_16x16x32_bf16 v[104:107], v[56:59], v[40:43], v[104:107]
    ds_read_b64_tr_b16 v[54:55], v9 offset:15936
    v_mfma_f32_16x16x32_bf16 v[108:111], v[56:59], v[44:47], v[108:111]
    v_mfma_f32_16x16x32_bf16 v[112:115], v[60:63], v[32:35], v[112:115]
    ds_read_b64_tr_b16 v[56:57], v9 offset:8288
    v_mfma_f32_16x16x32_bf16 v[116:119], v[60:63], v[36:39], v[116:119]
    v_mfma_f32_16x16x32_bf16 v[120:123], v[60:63], v[40:43], v[120:123]
    ds_read_b64_tr_b16 v[58:59], v9 offset:10848
    v_mfma_f32_16x16x32_bf16 v[124:127], v[60:63], v[44:47], v[124:127]
    s_barrier
    v_mfma_f32_16x16x32_bf16 v[128:131], v[224:227], v[32:35], v[128:131]
    ds_read_b64_tr_b16 v[60:61], v9 offset:13408
    v_mfma_f32_16x16x32_bf16 v[132:135], v[224:227], v[36:39], v[132:135]
    v_mfma_f32_16x16x32_bf16 v[136:139], v[224:227], v[40:43], v[136:139]
    ds_read_b64_tr_b16 v[62:63], v9 offset:15968
    v_mfma_f32_16x16x32_bf16 v[140:143], v[224:227], v[44:47], v[140:143]
    v_mfma_f32_16x16x32_bf16 v[144:147], v[228:231], v[32:35], v[144:147]
    ds_read_b64_tr_b16 v[224:225], v9 offset:18432
    v_mfma_f32_16x16x32_bf16 v[148:151], v[228:231], v[36:39], v[148:151]
    v_mfma_f32_16x16x32_bf16 v[152:155], v[228:231], v[40:43], v[152:155]
    ds_read_b64_tr_b16 v[226:227], v9 offset:20992
    v_mfma_f32_16x16x32_bf16 v[156:159], v[228:231], v[44:47], v[156:159]
    v_mfma_f32_16x16x32_bf16 v[160:163], v[48:51], v[32:35], v[160:163]
    ds_read_b64_tr_b16 v[228:229], v9 offset:23552
    v_mfma_f32_16x16x32_bf16 v[164:167], v[48:51], v[36:39], v[164:167]
    ds_read_b64_tr_b16 v[230:231], v9 offset:26112
    v_mfma_f32_16x16x32_bf16 v[168:171], v[48:51], v[40:43], v[168:171]
    ds_read_b128 v[16:19], v4 offset:0
    v_mfma_f32_16x16x32_bf16 v[172:175], v[48:51], v[44:47], v[172:175]
    s_add_u32 s43, s42, 294912
    buffer_store_dwordx2 v[236:237], v3, s[32:35], s43 offen sc1
    s_waitcnt lgkmcnt(9)
    v_mfma_f32_16x16x32_bf16 v[176:179], v[52:55], v[32:35], v[176:179]
    ds_read_b64_tr_b16 v[48:49], v9 offset:18464
    v_mfma_f32_16x16x32_bf16 v[180:183], v[52:55], v[36:39], v[180:183]
    ds_read_b64_tr_b16 v[50:51], v9 offset:21024
    v_mfma_f32_16x16x32_bf16 v[184:187], v[52:55], v[40:43], v[184:187]
    ds_read_b128 v[20:23], v4 offset:1024
    v_mfma_f32_16x16x32_bf16 v[188:191], v[52:55], v[44:47], v[188:191]
    s_waitcnt lgkmcnt(10)
    v_mfma_f32_16x16x32_bf16 v[192:195], v[56:59], v[32:35], v[192:195]
    ds_read_b64_tr_b16 v[52:53], v9 offset:23584
    v_mfma_f32_16x16x32_bf16 v[196:199], v[56:59], v[36:39], v[196:199]
    ds_read_b64_tr_b16 v[54:55], v9 offset:26144
    v_mfma_f32_16x16x32_bf16 v[200:203], v[56:59], v[40:43], v[200:203]
    ds_read_b128 v[24:27], v4 offset:2048
    v_mfma_f32_16x16x32_bf16 v[204:207], v[56:59], v[44:47], v[204:207]
    s_waitcnt lgkmcnt(11)
    v_mfma_f32_16x16x32_bf16 v[208:211], v[60:63], v[32:35], v[208:211]
    ds_read_b64_tr_b16 v[56:57], v9 offset:18496
    v_mfma_f32_16x16x32_bf16 v[212:215], v[60:63], v[36:39], v[212:215]
    ds_read_b64_tr_b16 v[58:59], v9 offset:21056
    v_mfma_f32_16x16x32_bf16 v[216:219], v[60:63], v[40:43], v[216:219]
    ds_read_b128 v[28:31], v4 offset:3072
    v_mfma_f32_16x16x32_bf16 v[220:223], v[60:63], v[44:47], v[220:223]
    s_waitcnt lgkmcnt(12)
    s_waitcnt lgkmcnt(0)
    v_mfma_f32_16x16x32_bf16 v[96:99], v[224:227], v[16:19], v[96:99]
    ds_read_b64_tr_b16 v[60:61], v9 offset:23616
    v_mfma_f32_16x16x32_bf16 v[100:103], v[224:227], v[20:23], v[100:103]
    v_mfma_f32_16x16x32_bf16 v[104:107], v[224:227], v[24:27], v[104:107]
    ds_read_b64_tr_b16 v[62:63], v9 offset:26176
    v_mfma_f32_16x16x32_bf16 v[108:111], v[224:227], v[28:31], v[108:111]
    v_mfma_f32_16x16x32_bf16 v[112:115], v[228:231], v[16:19], v[112:115]
    ds_read_b64_tr_b16 v[224:225], v9 offset:18528
    v_mfma_f32_16x16x32_bf16 v[116:119], v[228:231], v[20:23], v[116:119]
    v_mfma_f32_16x16x32_bf16 v[120:123], v[228:231], v[24:27], v[120:123]
    ds_read_b64_tr_b16 v[226:227], v9 offset:21088
    v_mfma_f32_16x16x32_bf16 v[124:127], v[228:231], v[28:31], v[124:127]
    s_barrier
    v_mfma_f32_16x16x32_bf16 v[128:131], v[48:51], v[16:19], v[128:131]
    ds_read_b64_tr_b16 v[228:229], v9 offset:23648
    v_mfma_f32_16x16x32_bf16 v[132:135], v[48:51], v[20:23], v[132:135]
    v_mfma_f32_16x16x32_bf16 v[136:139], v[48:51], v[24:27], v[136:139]
    ds_read_b64_tr_b16 v[230:231], v9 offset:26208
    v_mfma_f32_16x16x32_bf16 v[140:143], v[48:51], v[28:31], v[140:143]
    s_add_u32 s43, s42, 442368
    buffer_store_dwordx2 v[238:239], v3, s[32:35], s43 offen sc1
    v_mfma_f32_16x16x32_bf16 v[144:147], v[52:55], v[16:19], v[144:147]
    ds_read_b64_tr_b16 v[48:49], v9 offset:28672
    v_mfma_f32_16x16x32_bf16 v[148:151], v[52:55], v[20:23], v[148:151]
    v_mfma_f32_16x16x32_bf16 v[152:155], v[52:55], v[24:27], v[152:155]
    ds_read_b64_tr_b16 v[50:51], v9 offset:31232
    v_mfma_f32_16x16x32_bf16 v[156:159], v[52:55], v[28:31], v[156:159]
    v_mfma_f32_16x16x32_bf16 v[160:163], v[56:59], v[16:19], v[160:163]
    ds_read_b64_tr_b16 v[52:53], v9 offset:33792
    v_mfma_f32_16x16x32_bf16 v[164:167], v[56:59], v[20:23], v[164:167]
    ds_read_b64_tr_b16 v[54:55], v9 offset:36352
    v_mfma_f32_16x16x32_bf16 v[168:171], v[56:59], v[24:27], v[168:171]
    ds_read_b128 v[32:35], v4 offset:16384
    v_mfma_f32_16x16x32_bf16 v[172:175], v[56:59], v[28:31], v[172:175]
    s_waitcnt lgkmcnt(9)
    v_mfma_f32_16x16x32_bf16 v[176:179], v[60:63], v[16:19], v[176:179]
    ds_read_b64_tr_b16 v[56:57], v9 offset:28704
    v_mfma_f32_16x16x32_bf16 v[180:183], v[60:63], v[20:23], v[180:183]
    ds_read_b64_tr_b16 v[58:59], v9 offset:31264
    v_mfma_f32_16x16x32_bf16 v[184:187], v[60:63], v[24:27], v[184:187]
    ds_read_b128 v[36:39], v4 offset:17408
    v_mfma_f32_16x16x32_bf16 v[188:191], v[60:63], v[28:31], v[188:191]
    s_waitcnt lgkmcnt(10)
    v_mfma_f32_16x16x32_bf16 v[192:195], v[224:227], v[16:19], v[192:195]
    ds_read_b64_tr_b16 v[60:61], v9 offset:33824
    v_mfma_f32_16x16x32_bf16 v[196:199], v[224:227], v[20:23], v[196:199]
    ds_read_b64_tr_b16 v[62:63], v9 offset:36384
    v_mfma_f32_16x16x32_bf16 v[200:203], v[224:227], v[24:27], v[200:203]
    ds_read_b128 v[40:43], v4 offset:18432
    v_mfma_f32_16x16x32_bf16 v[204:207], v[224:227], v[28:31], v[204:207]
    s_waitcnt lgkmcnt(11)
    v_mfma_f32_16x16x32_bf16 v[208:211], v[228:231], v[16:19], v[208:211]
    ds_read_b64_tr_b16 v[224:225], v9 offset:28736
    v_mfma_f32_16x16x32_bf16 v[212:215], v[228:231], v[20:23], v[212:215]
    ds_read_b64_tr_b16 v[226:227], v9 offset:31296
    v_mfma_f32_16x16x32_bf16 v[216:219], v[228:231], v[24:27], v[216:219]
    ds_read_b128 v[44:47], v4 offset:19456
    v_mfma_f32_16x16x32_bf16 v[220:223], v[228:231], v[28:31], v[220:223]
    s_waitcnt lgkmcnt(12)
    s_waitcnt lgkmcnt(0)
    v_mfma_f32_16x16x32_bf16 v[96:99], v[48:51], v[32:35], v[96:99]
    ds_read_b64_tr_b16 v[228:229], v9 offset:33856
    v_mfma_f32_16x16x32_bf16 v[100:103], v[48:51], v[36:39], v[100:103]
    v_mfma_f32_16x16x32_bf16 v[104:107], v[48:51], v[40:43], v[104:107]
    ds_read_b64_tr_b16 v[230:231], v9 offset:36416
    v_mfma_f32_16x16x32_bf16 v[108:111], v[48:51], v[44:47], v[108:111]
    s_add_u32 s43, s40, 0
    buffer_store_dwordx4 v[64:67], v3, s[32:35], s43 offen sc1
    v_mfma_f32_16x16x32_bf16 v[112:115], v[52:55], v[32:35], v[112:115]
    ds_read_b64_tr_b16 v[48:49], v9 offset:28768
    v_mfma_f32_16x16x32_bf16 v[116:119], v[52:55], v[36:39], v[116:119]
    v_mfma_f32_16x16x32_bf16 v[120:123], v[52:55], v[40:43], v[120:123]
    ds_read_b64_tr_b16 v[50:51], v9 offset:31328
    v_mfma_f32_16x16x32_bf16 v[124:127], v[52:55], v[44:47], v[124:127]
    s_barrier
    v_mfma_f32_16x16x32_bf16 v[128:131], v[56:59], v[32:35], v[128:131]
    ds_read_b64_tr_b16 v[52:53], v9 offset:33888
    v_mfma_f32_16x16x32_bf16 v[132:135], v[56:59], v[36:39], v[132:135]
    v_mfma_f32_16x16x32_bf16 v[136:139], v[56:59], v[40:43], v[136:139]
    ds_read_b64_tr_b16 v[54:55], v9 offset:36448
    v_mfma_f32_16x16x32_bf16 v[140:143], v[56:59], v[44:47], v[140:143]
    v_mfma_f32_16x16x32_bf16 v[144:147], v[60:63], v[32:35], v[144:147]
    ds_read_b64_tr_b16 v[56:57], v8 offset:0
    v_mfma_f32_16x16x32_bf16 v[148:151], v[60:63], v[36:39], v[148:151]
    v_mfma_f32_16x16x32_bf16 v[152:155], v[60:63], v[40:43], v[152:155]
    ds_read_b64_tr_b16 v[58:59], v8 offset:2560
    v_mfma_f32_16x16x32_bf16 v[156:159], v[60:63], v[44:47], v[156:159]
    v_mfma_f32_16x16x32_bf16 v[160:163], v[224:227], v[32:35], v[160:163]
    ds_read_b64_tr_b16 v[60:61], v8 offset:5120
    v_mfma_f32_16x16x32_bf16 v[164:167], v[224:227], v[36:39], v[164:167]
    ds_read_b64_tr_b16 v[62:63], v8 offset:7680
    v_mfma_f32_16x16x32_bf16 v[168:171], v[224:227], v[40:43], v[168:171]
    ds_read_b128 v[16:19], v5 offset:0
    v_mfma_f32_16x16x32_bf16 v[172:175], v[224:227], v[44:47], v[172:175]
    s_waitcnt lgkmcnt(9)
    v_mfma_f32_16x16x32_bf16 v[176:179], v[228:231], v[32:35], v[176:179]
    ds_read_b64_tr_b16 v[224:225], v8 offset:32
    v_mfma_f32_16x16x32_bf16 v[180:183], v[228:231], v[36:39], v[180:183]
    ds_read_b64_tr_b16 v[226:227], v8 offset:2592
    v_mfma_f32_16x16x32_bf16 v[184:187], v[228:231], v[40:43], v[184:187]
    ds_read_b128 v[20:23], v5 offset:1024
    v_mfma_f32_16x16x32_bf16 v[188:191], v[228:231], v[44:47], v[188:191]
    s_waitcnt lgkmcnt(10)
    v_mfma_f32_16x16x32_bf16 v[192:195], v[48:51], v[32:35], v[192:195]
    ds_read_b64_tr_b16 v[228:229], v8 offset:5152
    v_mfma_f32_16x16x32_bf16 v[196:199], v[48:51], v[36:39], v[196:199]
    ds_read_b64_tr_b16 v[230:231], v8 offset:7712
    v_mfma_f32_16x16x32_bf16 v[200:203], v[48:51], v[40:43], v[200:203]
    ds_read_b128 v[24:27], v5 offset:2048
    v_mfma_f32_16x16x32_bf16 v[204:207], v[48:51], v[44:47], v[204:207]
    s_add_u32 s43, s40, 1024
    buffer_store_dwordx4 v[68:71], v3, s[32:35], s43 offen sc1
    s_waitcnt lgkmcnt(11)
    v_mfma_f32_16x16x32_bf16 v[208:211], v[52:55], v[32:35], v[208:211]
    ds_read_b64_tr_b16 v[48:49], v8 offset:64
    v_mfma_f32_16x16x32_bf16 v[212:215], v[52:55], v[36:39], v[212:215]
    ds_read_b64_tr_b16 v[50:51], v8 offset:2624
    v_mfma_f32_16x16x32_bf16 v[216:219], v[52:55], v[40:43], v[216:219]
    ds_read_b128 v[28:31], v5 offset:3072
    v_mfma_f32_16x16x32_bf16 v[220:223], v[52:55], v[44:47], v[220:223]
    s_waitcnt lgkmcnt(12)
    s_waitcnt lgkmcnt(0)
    v_mfma_f32_16x16x32_bf16 v[96:99], v[56:59], v[16:19], v[96:99]
    ds_read_b64_tr_b16 v[52:53], v8 offset:5184
    v_mfma_f32_16x16x32_bf16 v[100:103], v[56:59], v[20:23], v[100:103]
    v_mfma_f32_16x16x32_bf16 v[104:107], v[56:59], v[24:27], v[104:107]
    ds_read_b64_tr_b16 v[54:55], v8 offset:7744
    v_mfma_f32_16x16x32_bf16 v[108:111], v[56:59], v[28:31], v[108:111]
    v_mfma_f32_16x16x32_bf16 v[112:115], v[60:63], v[16:19], v[112:115]
    ds_read_b64_tr_b16 v[56:57], v8 offset:96
    v_mfma_f32_16x16x32_bf16 v[116:119], v[60:63], v[20:23], v[116:119]
    v_mfma_f32_16x16x32_bf16 v[120:123], v[60:63], v[24:27], v[120:123]
    ds_read_b64_tr_b16 v[58:59], v8 offset:2656
    v_mfma_f32_16x16x32_bf16 v[124:127], v[60:63], v[28:31], v[124:127]
    s_barrier
    v_mfma_f32_16x16x32_bf16 v[128:131], v[224:227], v[16:19], v[128:131]
    ds_read_b64_tr_b16 v[60:61], v8 offset:5216
    v_mfma_f32_16x16x32_bf16 v[132:135], v[224:227], v[20:23], v[132:135]
    v_mfma_f32_16x16x32_bf16 v[136:139], v[224:227], v[24:27], v[136:139]
    ds_read_b64_tr_b16 v[62:63], v8 offset:7776
    v_mfma_f32_16x16x32_bf16 v[140:143], v[224:227], v[28:31], v[140:143]
    v_mfma_f32_16x16x32_bf16 v[144:147], v[228:231], v[16:19], v[144:147]
    ds_read_b64_tr_b16 v[224:225], v8 offset:10240
    v_mfma_f32_16x16x32_bf16 v[148:151], v[228:231], v[20:23], v[148:151]
    v_mfma_f32_16x16x32_bf16 v[152:155], v[228:231], v[24:27], v[152:155]
    ds_read_b64_tr_b16 v[226:227], v8 offset:12800
    v_mfma_f32_16x16x32_bf16 v[156:159], v[228:231], v[28:31], v[156:159]
    v_mfma_f32_16x16x32_bf16 v[160:163], v[48:51], v[16:19], v[160:163]
    ds_read_b64_tr_b16 v[228:229], v8 offset:15360
    v_mfma_f32_16x16x32_bf16 v[164:167], v[48:51], v[20:23], v[164:167]
    ds_read_b64_tr_b16 v[230:231], v8 offset:17920
    v_mfma_f32_16x16x32_bf16 v[168:171], v[48:51], v[24:27], v[168:171]
    ds_read_b128 v[32:35], v5 offset:16384
    v_mfma_f32_16x16x32_bf16 v[172:175], v[48:51], v[28:31], v[172:175]
    s_add_u32 s43, s40, 147456
    buffer_store_dwordx4 v[72:75], v3, s[32:35], s43 offen sc1
    s_waitcnt lgkmcnt(9)
    v_mfma_f32_16x16x32_bf16 v[176:179], v[52:55], v[16:19], v[176:179]
    ds_read_b64_tr_b16 v[48:49], v8 offset:10272
    v_mfma_f32_16x16x32_bf16 v[180:183], v[52:55], v[20:23], v[180:183]
    ds_read_b64_tr_b16 v[50:51], v8 offset:12832
    v_mfma_f32_16x16x32_bf16 v[184:187], v[52:55], v[24:27], v[184:187]
    ds_read_b128 v[36:39], v5 offset:17408
    v_mfma_f32_16x16x32_bf16 v[188:191], v[52:55], v[28:31], v[188:191]
    s_waitcnt lgkmcnt(10)
    v_mfma_f32_16x16x32_bf16 v[192:195], v[56:59], v[16:19], v[192:195]
    ds_read_b64_tr_b16 v[52:53], v8 offset:15392
    v_mfma_f32_16x16x32_bf16 v[196:199], v[56:59], v[20:23], v[196:199]
    ds_read_b64_tr_b16 v[54:55], v8 offset:17952
    v_mfma_f32_16x16x32_bf16 v[200:203], v[56:59], v[24:27], v[200:203]
    ds_read_b128 v[40:43], v5 offset:18432
    v_mfma_f32_16x16x32_bf16 v[204:207], v[56:59], v[28:31], v[204:207]
    s_waitcnt lgkmcnt(11)
    v_mfma_f32_16x16x32_bf16 v[208:211], v[60:63], v[16:19], v[208:211]
    ds_read_b64_tr_b16 v[56:57], v8 offset:10304
    v_mfma_f32_16x16x32_bf16 v[212:215], v[60:63], v[20:23], v[212:215]
    ds_read_b64_tr_b16 v[58:59], v8 offset:12864
    v_mfma_f32_16x16x32_bf16 v[216:219], v[60:63], v[24:27], v[216:219]
    ds_read_b128 v[44:47], v5 offset:19456
    v_mfma_f32_16x16x32_bf16 v[220:223], v[60:63], v[28:31], v[220:223]
    s_waitcnt lgkmcnt(12)
    s_waitcnt lgkmcnt(0)
    v_mfma_f32_16x16x32_bf16 v[96:99], v[224:227], v[32:35], v[96:99]
    ds_read_b64_tr_b16 v[60:61], v8 offset:15424
    v_mfma_f32_16x16x32_bf16 v[100:103], v[224:227], v[36:39], v[100:103]
    v_mfma_f32_16x16x32_bf16 v[104:107], v[224:227], v[40:43], v[104:107]
    ds_read_b64_tr_b16 v[62:63], v8 offset:17984
    v_mfma_f32_16x16x32_bf16 v[108:111], v[224:227], v[44:47], v[108:111]
    v_mfma_f32_16x16x32_bf16 v[112:115], v[228:231], v[32:35], v[112:115]
    ds_read_b64_tr_b16 v[224:225], v8 offset:10336
    v_mfma_f32_16x16x32_bf16 v[116:119], v[228:231], v[36:39], v[116:119]
    v_mfma_f32_16x16x32_bf16 v[120:123], v[228:231], v[40:43], v[120:123]
    ds_read_b64_tr_b16 v[226:227], v8 offset:12896
    v_mfma_f32_16x16x32_bf16 v[124:127], v[228:231], v[44:47], v[124:127]
    s_barrier
    v_mfma_f32_16x16x32_bf16 v[128:131], v[48:51], v[32:35], v[128:131]
    ds_read_b64_tr_b16 v[228:229], v8 offset:15456
    v_mfma_f32_16x16x32_bf16 v[132:135], v[48:51], v[36:39], v[132:135]
    v_mfma_f32_16x16x32_bf16 v[136:139], v[48:51], v[40:43], v[136:139]
    ds_read_b64_tr_b16 v[230:231], v8 offset:18016
    v_mfma_f32_16x16x32_bf16 v[140:143], v[48:51], v[44:47], v[140:143]
    s_add_u32 s43, s40, 148480
    buffer_store_dwordx4 v[76:79], v3, s[32:35], s43 offen sc1
    v_mfma_f32_16x16x32_bf16 v[144:147], v[52:55], v[32:35], v[144:147]
    ds_read_b64_tr_b16 v[48:49], v8 offset:20480
    v_mfma_f32_16x16x32_bf16 v[148:151], v[52:55], v[36:39], v[148:151]
    v_mfma_f32_16x16x32_bf16 v[152:155], v[52:55], v[40:43], v[152:155]
    ds_read_b64_tr_b16 v[50:51], v8 offset:23040
    v_mfma_f32_16x16x32_bf16 v[156:159], v[52:55], v[44:47], v[156:159]
    v_mfma_f32_16x16x32_bf16 v[160:163], v[56:59], v[32:35], v[160:163]
    ds_read_b64_tr_b16 v[52:53], v8 offset:25600
    v_mfma_f32_16x16x32_bf16 v[164:167], v[56:59], v[36:39], v[164:167]
    ds_read_b64_tr_b16 v[54:55], v8 offset:28160
    v_mfma_f32_16x16x32_bf16 v[168:171], v[56:59], v[40:43], v[168:171]
    ds_read_b128 v[16:19], v5 offset:32768
    v_mfma_f32_16x16x32_bf16 v[172:175], v[56:59], v[44:47], v[172:175]
    s_waitcnt lgkmcnt(9)
    v_mfma_f32_16x16x32_bf16 v[176:179], v[60:63], v[32:35], v[176:179]
    ds_read_b64_tr_b16 v[56:57], v8 offset:20512
    v_mfma_f32_16x16x32_bf16 v[180:183], v[60:63], v[36:39], v[180:183]
    ds_read_b64_tr_b16 v[58:59], v8 offset:23072
    v_mfma_f32_16x16x32_bf16 v[184:187], v[60:63], v[40:43], v[184:187]
    ds_read_b128 v[20:23], v5 offset:33792
    v_mfma_f32_16x16x32_bf16 v[188:191], v[60:63], v[44:47], v[188:191]
    s_waitcnt lgkmcnt(10)
    v_mfma_f32_16x16x32_bf16 v[192:195], v[224:227], v[32:35], v[192:195]
    ds_read_b64_tr_b16 v[60:61], v8 offset:25632
    v_mfma_f32_16x16x32_bf16 v[196:199], v[224:227], v[36:39], v[196:199]
    ds_read_b64_tr_b16 v[62:63], v8 offset:28192
    v_mfma_f32_16x16x32_bf16 v[200:203], v[224:227], v[40:43], v[200:203]
    ds_read_b128 v[24:27], v5 offset:34816
    v_mfma_f32_16x16x32_bf16 v[204:207], v[224:227], v[44:47], v[204:207]
    s_waitcnt lgkmcnt(11)
    v_mfma_f32_16x16x32_bf16 v[208:211], v[228:231], v[32:35], v[208:211]
    ds_read_b64_tr_b16 v[224:225], v8 offset:20544
    v_mfma_f32_16x16x32_bf16 v[212:215], v[228:231], v[36:39], v[212:215]
    ds_read_b64_tr_b16 v[226:227], v8 offset:23104
    v_mfma_f32_16x16x32_bf16 v[216:219], v[228:231], v[40:43], v[216:219]
    ds_read_b128 v[28:31], v5 offset:35840
    v_mfma_f32_16x16x32_bf16 v[220:223], v[228:231], v[44:47], v[220:223]
    s_waitcnt lgkmcnt(12)
    s_waitcnt lgkmcnt(0)
    v_mfma_f32_16x16x32_bf16 v[96:99], v[48:51], v[16:19], v[96:99]
    ds_read_b64_tr_b16 v[228:229], v8 offset:25664
    v_mfma_f32_16x16x32_bf16 v[100:103], v[48:51], v[20:23], v[100:103]
    v_mfma_f32_16x16x32_bf16 v[104:107], v[48:51], v[24:27], v[104:107]
    ds_read_b64_tr_b16 v[230:231], v8 offset:28224
    v_mfma_f32_16x16x32_bf16 v[108:111], v[48:51], v[28:31], v[108:111]
    s_add_u32 s43, s40, 294912
    buffer_store_dwordx4 v[80:83], v3, s[32:35], s43 offen sc1
    v_mfma_f32_16x16x32_bf16 v[112:115], v[52:55], v[16:19], v[112:115]
    ds_read_b64_tr_b16 v[48:49], v8 offset:20576
    v_mfma_f32_16x16x32_bf16 v[116:119], v[52:55], v[20:23], v[116:119]
    v_mfma_f32_16x16x32_bf16 v[120:123], v[52:55], v[24:27], v[120:123]
    ds_read_b64_tr_b16 v[50:51], v8 offset:23136
    v_mfma_f32_16x16x32_bf16 v[124:127], v[52:55], v[28:31], v[124:127]
    s_barrier
    v_mfma_f32_16x16x32_bf16 v[128:131], v[56:59], v[16:19], v[128:131]
    ds_read_b64_tr_b16 v[52:53], v8 offset:25696
    v_mfma_f32_16x16x32_bf16 v[132:135], v[56:59], v[20:23], v[132:135]
    v_mfma_f32_16x16x32_bf16 v[136:139], v[56:59], v[24:27], v[136:139]
    ds_read_b64_tr_b16 v[54:55], v8 offset:28256
    v_mfma_f32_16x16x32_bf16 v[140:143], v[56:59], v[28:31], v[140:143]
    v_mfma_f32_16x16x32_bf16 v[144:147], v[60:63], v[16:19], v[144:147]
    ds_read_b64_tr_b16 v[56:57], v8 offset:30720
    v_mfma_f32_16x16x32_bf16 v[148:151], v[60:63], v[20:23], v[148:151]
    v_mfma_f32_16x16x32_bf16 v[152:155], v[60:63], v[24:27], v[152:155]
    ds_read_b64_tr_b16 v[58:59], v8 offset:33280
    v_mfma_f32_16x16x32_bf16 v[156:159], v[60:63], v[28:31], v[156:159]
    v_mfma_f32_16x16x32_bf16 v[160:163], v[224:227], v[16:19], v[160:163]
    ds_read_b64_tr_b16 v[60:61], v9 offset:3072
    v_mfma_f32_16x16x32_bf16 v[164:167], v[224:227], v[20:23], v[164:167]
    ds_read_b64_tr_b16 v[62:63], v9 offset:5632
    v_mfma_f32_16x16x32_bf16 v[168:171], v[224:227], v[24:27], v[168:171]
    ds_read_b128 v[32:35], v4 offset:0
    v_mfma_f32_16x16x32_bf16 v[172:175], v[224:227], v[28:31], v[172:175]
    s_waitcnt lgkmcnt(9)
    v_mfma_f32_16x16x32_bf16 v[176:179], v[228:231], v[16:19], v[176:179]
    ds_read_b64_tr_b16 v[224:225], v8 offset:30752
    v_mfma_f32_16x16x32_bf16 v[180:183], v[228:231], v[20:23], v[180:183]
    ds_read_b64_tr_b16 v[226:227], v8 offset:33312
    v_mfma_f32_16x16x32_bf16 v[184:187], v[228:231], v[24:27], v[184:187]
    ds_read_b128 v[36:39], v4 offset:1024
    v_mfma_f32_16x16x32_bf16 v[188:191], v[228:231], v[28:31], v[188:191]
    s_waitcnt lgkmcnt(10)
    v_mfma_f32_16x16x32_bf16 v[192:195], v[48:51], v[16:19], v[192:195]
    ds_read_b64_tr_b16 v[228:229], v9 offset:3104
    v_mfma_f32_16x16x32_bf16 v[196:199], v[48:51], v[20:23], v[196:199]
    ds_read_b64_tr_b16 v[230:231], v9 offset:5664
    v_mfma_f32_16x16x32_bf16 v[200:203], v[48:51], v[24:27], v[200:203]
    ds_read_b128 v[40:43], v4 offset:2048
    v_mfma_f32_16x16x32_bf16 v[204:207], v[48:51], v[28:31], v[204:207]
    s_add_u32 s43, s40, 295936
    buffer_store_dwordx4 v[84:87], v3, s[32:35], s43 offen sc1
    s_waitcnt lgkmcnt(11)
    v_mfma_f32_16x16x32_bf16 v[208:211], v[52:55], v[16:19], v[208:211]
    ds_read_b64_tr_b16 v[48:49], v8 offset:30784
    v_mfma_f32_16x16x32_bf16 v[212:215], v[52:55], v[20:23], v[212:215]
    ds_read_b64_tr_b16 v[50:51], v8 offset:33344
    v_mfma_f32_16x16x32_bf16 v[216:219], v[52:55], v[24:27], v[216:219]
    ds_read_b128 v[44:47], v4 offset:3072
    v_mfma_f32_16x16x32_bf16 v[220:223], v[52:55], v[28:31], v[220:223]
    s_waitcnt lgkmcnt(12)
    s_waitcnt lgkmcnt(0)
    v_mfma_f32_16x16x32_bf16 v[96:99], v[56:59], v[32:35], v[96:99]
    ds_read_b64_tr_b16 v[52:53], v9 offset:3136
    v_mfma_f32_16x16x32_bf16 v[100:103], v[56:59], v[36:39], v[100:103]
    v_mfma_f32_16x16x32_bf16 v[104:107], v[56:59], v[40:43], v[104:107]
    ds_read_b64_tr_b16 v[54:55], v9 offset:5696
    v_mfma_f32_16x16x32_bf16 v[108:111], v[56:59], v[44:47], v[108:111]
    v_mfma_f32_16x16x32_bf16 v[112:115], v[60:63], v[32:35], v[112:115]
    ds_read_b64_tr_b16 v[56:57], v8 offset:30816
    v_mfma_f32_16x16x32_bf16 v[116:119], v[60:63], v[36:39], v[116:119]
    v_mfma_f32_16x16x32_bf16 v[120:123], v[60:63], v[40:43], v[120:123]
    ds_read_b64_tr_b16 v[58:59], v8 offset:33376
    v_mfma_f32_16x16x32_bf16 v[124:127], v[60:63], v[44:47], v[124:127]
    s_barrier
    v_mfma_f32_16x16x32_bf16 v[128:131], v[224:227], v[32:35], v[128:131]
    ds_read_b64_tr_b16 v[60:61], v9 offset:3168
    v_mfma_f32_16x16x32_bf16 v[132:135], v[224:227], v[36:39], v[132:135]
    v_mfma_f32_16x16x32_bf16 v[136:139], v[224:227], v[40:43], v[136:139]
    ds_read_b64_tr_b16 v[62:63], v9 offset:5728
    v_mfma_f32_16x16x32_bf16 v[140:143], v[224:227], v[44:47], v[140:143]
    v_mfma_f32_16x16x32_bf16 v[144:147], v[228:231], v[32:35], v[144:147]
    ds_read_b64_tr_b16 v[224:225], v9 offset:8192
    v_mfma_f32_16x16x32_bf16 v[148:151], v[228:231], v[36:39], v[148:151]
    v_mfma_f32_16x16x32_bf16 v[152:155], v[228:231], v[40:43], v[152:155]
    ds_read_b64_tr_b16 v[226:227], v9 offset:10752
    v_mfma_f32_16x16x32_bf16 v[156:159], v[228:231], v[44:47], v[156:159]
    v_mfma_f32_16x16x32_bf16 v[160:163], v[48:51], v[32:35], v[160:163]
    ds_read_b64_tr_b16 v[228:229], v9 offset:13312
    v_mfma_f32_16x16x32_bf16 v[164:167], v[48:51], v[36:39], v[164:167]
    ds_read_b64_tr_b16 v[230:231], v9 offset:15872
    v_mfma_f32_16x16x32_bf16 v[168:171], v[48:51], v[40:43], v[168:171]
    ds_read_b128 v[16:19], v4 offset:16384
    v_mfma_f32_16x16x32_bf16 v[172:175], v[48:51], v[44:47], v[172:175]
    s_add_u32 s43, s40, 442368
    buffer_store_dwordx4 v[88:91], v3, s[32:35], s43 offen sc1
    s_waitcnt lgkmcnt(9)
    v_mfma_f32_16x16x32_bf16 v[176:179], v[52:55], v[32:35], v[176:179]
    ds_read_b64_tr_b16 v[48:49], v9 offset:8224
    v_mfma_f32_16x16x32_bf16 v[180:183], v[52:55], v[36:39], v[180:183]
    ds_read_b64_tr_b16 v[50:51], v9 offset:10784
    v_mfma_f32_16x16x32_bf16 v[184:187], v[52:55], v[40:43], v[184:187]
    ds_read_b128 v[20:23], v4 offset:17408
    v_mfma_f32_16x16x32_bf16 v[188:191], v[52:55], v[44:47], v[188:191]
    s_waitcnt lgkmcnt(10)
    v_mfma_f32_16x16x32_bf16 v[192:195], v[56:59], v[32:35], v[192:195]
    ds_read_b64_tr_b16 v[52:53], v9 offset:13344
    v_mfma_f32_16x16x32_bf16 v[196:199], v[56:59], v[36:39], v[196:199]
    ds_read_b64_tr_b16 v[54:55], v9 offset:15904
    v_mfma_f32_16x16x32_bf16 v[200:203], v[56:59], v[40:43], v[200:203]
    ds_read_b128 v[24:27], v4 offset:18432
    v_mfma_f32_16x16x32_bf16 v[204:207], v[56:59], v[44:47], v[204:207]
    s_waitcnt lgkmcnt(11)
    v_mfma_f32_16x16x32_bf16 v[208:211], v[60:63], v[32:35], v[208:211]
    ds_read_b64_tr_b16 v[56:57], v9 offset:8256
    v_mfma_f32_16x16x32_bf16 v[212:215], v[60:63], v[36:39], v[212:215]
    ds_read_b64_tr_b16 v[58:59], v9 offset:10816
    v_mfma_f32_16x16x32_bf16 v[216:219], v[60:63], v[40:43], v[216:219]
    ds_read_b128 v[28:31], v4 offset:19456
    v_mfma_f32_16x16x32_bf16 v[220:223], v[60:63], v[44:47], v[220:223]
    s_waitcnt lgkmcnt(12)
    s_waitcnt lgkmcnt(0)
    v_mfma_f32_16x16x32_bf16 v[96:99], v[224:227], v[16:19], v[96:99]
    ds_read_b64_tr_b16 v[60:61], v9 offset:13376
    v_mfma_f32_16x16x32_bf16 v[100:103], v[224:227], v[20:23], v[100:103]
    v_mfma_f32_16x16x32_bf16 v[104:107], v[224:227], v[24:27], v[104:107]
    ds_read_b64_tr_b16 v[62:63], v9 offset:15936
    v_mfma_f32_16x16x32_bf16 v[108:111], v[224:227], v[28:31], v[108:111]
    v_mfma_f32_16x16x32_bf16 v[112:115], v[228:231], v[16:19], v[112:115]
    ds_read_b64_tr_b16 v[224:225], v9 offset:8288
    v_mfma_f32_16x16x32_bf16 v[116:119], v[228:231], v[20:23], v[116:119]
    v_mfma_f32_16x16x32_bf16 v[120:123], v[228:231], v[24:27], v[120:123]
    ds_read_b64_tr_b16 v[226:227], v9 offset:10848
    v_mfma_f32_16x16x32_bf16 v[124:127], v[228:231], v[28:31], v[124:127]
    s_barrier
    v_mfma_f32_16x16x32_bf16 v[128:131], v[48:51], v[16:19], v[128:131]
    ds_read_b64_tr_b16 v[228:229], v9 offset:13408
    v_mfma_f32_16x16x32_bf16 v[132:135], v[48:51], v[20:23], v[132:135]
    v_mfma_f32_16x16x32_bf16 v[136:139], v[48:51], v[24:27], v[136:139]
    ds_read_b64_tr_b16 v[230:231], v9 offset:15968
    v_mfma_f32_16x16x32_bf16 v[140:143], v[48:51], v[28:31], v[140:143]
    s_add_u32 s43, s40, 443392
    buffer_store_dwordx4 v[92:95], v3, s[32:35], s43 offen sc1
    v_mfma_f32_16x16x32_bf16 v[144:147], v[52:55], v[16:19], v[144:147]
    ds_read_b64_tr_b16 v[48:49], v9 offset:18432
    v_mfma_f32_16x16x32_bf16 v[148:151], v[52:55], v[20:23], v[148:151]
    v_mfma_f32_16x16x32_bf16 v[152:155], v[52:55], v[24:27], v[152:155]
    ds_read_b64_tr_b16 v[50:51], v9 offset:20992
    v_mfma_f32_16x16x32_bf16 v[156:159], v[52:55], v[28:31], v[156:159]
    v_mfma_f32_16x16x32_bf16 v[160:163], v[56:59], v[16:19], v[160:163]
    ds_read_b64_tr_b16 v[52:53], v9 offset:23552
    v_mfma_f32_16x16x32_bf16 v[164:167], v[56:59], v[20:23], v[164:167]
    ds_read_b64_tr_b16 v[54:55], v9 offset:26112
    v_mfma_f32_16x16x32_bf16 v[168:171], v[56:59], v[24:27], v[168:171]
    ds_read_b128 v[32:35], v5 offset:0
    v_mfma_f32_16x16x32_bf16 v[172:175], v[56:59], v[28:31], v[172:175]
    s_waitcnt lgkmcnt(9)
    v_mfma_f32_16x16x32_bf16 v[176:179], v[60:63], v[16:19], v[176:179]
    ds_read_b64_tr_b16 v[56:57], v9 offset:18464
    v_mfma_f32_16x16x32_bf16 v[180:183], v[60:63], v[20:23], v[180:183]
    ds_read_b64_tr_b16 v[58:59], v9 offset:21024
    v_mfma_f32_16x16x32_bf16 v[184:187], v[60:63], v[24:27], v[184:187]
    ds_read_b128 v[36:39], v5 offset:1024
    v_mfma_f32_16x16x32_bf16 v[188:191], v[60:63], v[28:31], v[188:191]
    s_waitcnt lgkmcnt(10)
    v_mfma_f32_16x16x32_bf16 v[192:195], v[224:227], v[16:19], v[192:195]
    ds_read_b64_tr_b16 v[60:61], v9 offset:23584
    v_mfma_f32_16x16x32_bf16 v[196:199], v[224:227], v[20:23], v[196:199]
    ds_read_b64_tr_b16 v[62:63], v9 offset:26144
    v_mfma_f32_16x16x32_bf16 v[200:203], v[224:227], v[24:27], v[200:203]
    ds_read_b128 v[40:43], v5 offset:2048
    v_mfma_f32_16x16x32_bf16 v[204:207], v[224:227], v[28:31], v[204:207]
    s_waitcnt lgkmcnt(11)
    v_mfma_f32_16x16x32_bf16 v[208:211], v[228:231], v[16:19], v[208:211]
    ds_read_b64_tr_b16 v[224:225], v9 offset:18496
    v_mfma_f32_16x16x32_bf16 v[212:215], v[228:231], v[20:23], v[212:215]
    ds_read_b64_tr_b16 v[226:227], v9 offset:21056
    v_mfma_f32_16x16x32_bf16 v[216:219], v[228:231], v[24:27], v[216:219]
    ds_read_b128 v[44:47], v5 offset:3072
    v_mfma_f32_16x16x32_bf16 v[220:223], v[228:231], v[28:31], v[220:223]
    s_waitcnt lgkmcnt(12)
    s_waitcnt lgkmcnt(0)
    v_mfma_f32_16x16x32_bf16 v[96:99], v[48:51], v[32:35], v[96:99]
    ds_read_b64_tr_b16 v[228:229], v9 offset:23616
    v_mfma_f32_16x16x32_bf16 v[100:103], v[48:51], v[36:39], v[100:103]
    v_mfma_f32_16x16x32_bf16 v[104:107], v[48:51], v[40:43], v[104:107]
    ds_read_b64_tr_b16 v[230:231], v9 offset:26176
    v_mfma_f32_16x16x32_bf16 v[108:111], v[48:51], v[44:47], v[108:111]
    v_mfma_f32_16x16x32_bf16 v[112:115], v[52:55], v[32:35], v[112:115]
    ds_read_b64_tr_b16 v[48:49], v9 offset:18528
    v_mfma_f32_16x16x32_bf16 v[116:119], v[52:55], v[36:39], v[116:119]
    v_mfma_f32_16x16x32_bf16 v[120:123], v[52:55], v[40:43], v[120:123]
    ds_read_b64_tr_b16 v[50:51], v9 offset:21088
    v_mfma_f32_16x16x32_bf16 v[124:127], v[52:55], v[44:47], v[124:127]
    s_barrier
    v_mfma_f32_16x16x32_bf16 v[128:131], v[56:59], v[32:35], v[128:131]
    ds_read_b64_tr_b16 v[52:53], v9 offset:23648
    v_mfma_f32_16x16x32_bf16 v[132:135], v[56:59], v[36:39], v[132:135]
    v_mfma_f32_16x16x32_bf16 v[136:139], v[56:59], v[40:43], v[136:139]
    ds_read_b64_tr_b16 v[54:55], v9 offset:26208
    v_mfma_f32_16x16x32_bf16 v[140:143], v[56:59], v[44:47], v[140:143]
    v_mfma_f32_16x16x32_bf16 v[144:147], v[60:63], v[32:35], v[144:147]
    ds_read_b64_tr_b16 v[56:57], v9 offset:28672
    v_mfma_f32_16x16x32_bf16 v[148:151], v[60:63], v[36:39], v[148:151]
    v_mfma_f32_16x16x32_bf16 v[152:155], v[60:63], v[40:43], v[152:155]
    ds_read_b64_tr_b16 v[58:59], v9 offset:31232
    v_mfma_f32_16x16x32_bf16 v[156:159], v[60:63], v[44:47], v[156:159]
    v_mfma_f32_16x16x32_bf16 v[160:163], v[224:227], v[32:35], v[160:163]
    ds_read_b64_tr_b16 v[60:61], v9 offset:33792
    v_mfma_f32_16x16x32_bf16 v[164:167], v[224:227], v[36:39], v[164:167]
    ds_read_b64_tr_b16 v[62:63], v9 offset:36352
    v_mfma_f32_16x16x32_bf16 v[168:171], v[224:227], v[40:43], v[168:171]
    ds_read_b128 v[16:19], v5 offset:16384
    v_mfma_f32_16x16x32_bf16 v[172:175], v[224:227], v[44:47], v[172:175]
    s_waitcnt lgkmcnt(9)
    v_mfma_f32_16x16x32_bf16 v[176:179], v[228:231], v[32:35], v[176:179]
    ds_read_b64_tr_b16 v[224:225], v9 offset:28704
    v_mfma_f32_16x16x32_bf16 v[180:183], v[228:231], v[36:39], v[180:183]
    ds_read_b64_tr_b16 v[226:227], v9 offset:31264
    v_mfma_f32_16x16x32_bf16 v[184:187], v[228:231], v[40:43], v[184:187]
    ds_read_b128 v[20:23], v5 offset:17408
    v_mfma_f32_16x16x32_bf16 v[188:191], v[228:231], v[44:47], v[188:191]
    s_waitcnt lgkmcnt(10)
    v_mfma_f32_16x16x32_bf16 v[192:195], v[48:51], v[32:35], v[192:195]
    ds_read_b64_tr_b16 v[228:229], v9 offset:33824
    v_mfma_f32_16x16x32_bf16 v[196:199], v[48:51], v[36:39], v[196:199]
    ds_read_b64_tr_b16 v[230:231], v9 offset:36384
    v_mfma_f32_16x16x32_bf16 v[200:203], v[48:51], v[40:43], v[200:203]
    ds_read_b128 v[24:27], v5 offset:18432
    v_mfma_f32_16x16x32_bf16 v[204:207], v[48:51], v[44:47], v[204:207]
    s_waitcnt lgkmcnt(11)
    v_mfma_f32_16x16x32_bf16 v[208:211], v[52:55], v[32:35], v[208:211]
    ds_read_b64_tr_b16 v[48:49], v9 offset:28736
    v_mfma_f32_16x16x32_bf16 v[212:215], v[52:55], v[36:39], v[212:215]
    ds_read_b64_tr_b16 v[50:51], v9 offset:31296
    v_mfma_f32_16x16x32_bf16 v[216:219], v[52:55], v[40:43], v[216:219]
    ds_read_b128 v[28:31], v5 offset:19456
    v_mfma_f32_16x16x32_bf16 v[220:223], v[52:55], v[44:47], v[220:223]
    s_waitcnt lgkmcnt(12)
    s_waitcnt lgkmcnt(0)
    v_mfma_f32_16x16x32_bf16 v[96:99], v[56:59], v[16:19], v[96:99]
    ds_read_b64_tr_b16 v[52:53], v9 offset:33856
    v_mfma_f32_16x16x32_bf16 v[100:103], v[56:59], v[20:23], v[100:103]
    v_mfma_f32_16x16x32_bf16 v[104:107], v[56:59], v[24:27], v[104:107]
    ds_read_b64_tr_b16 v[54:55], v9 offset:36416
    v_mfma_f32_16x16x32_bf16 v[108:111], v[56:59], v[28:31], v[108:111]
    v_mfma_f32_16x16x32_bf16 v[112:115], v[60:63], v[16:19], v[112:115]
    ds_read_b64_tr_b16 v[56:57], v9 offset:28768
    v_mfma_f32_16x16x32_bf16 v[116:119], v[60:63], v[20:23], v[116:119]
    v_mfma_f32_16x16x32_bf16 v[120:123], v[60:63], v[24:27], v[120:123]
    ds_read_b64_tr_b16 v[58:59], v9 offset:31328
    v_mfma_f32_16x16x32_bf16 v[124:127], v[60:63], v[28:31], v[124:127]
    s_barrier
    v_mfma_f32_16x16x32_bf16 v[128:131], v[224:227], v[16:19], v[128:131]
    ds_read_b64_tr_b16 v[60:61], v9 offset:33888
    v_mfma_f32_16x16x32_bf16 v[132:135], v[224:227], v[20:23], v[132:135]
    v_mfma_f32_16x16x32_bf16 v[136:139], v[224:227], v[24:27], v[136:139]
    ds_read_b64_tr_b16 v[62:63], v9 offset:36448
    v_mfma_f32_16x16x32_bf16 v[140:143], v[224:227], v[28:31], v[140:143]
    v_mfma_f32_16x16x32_bf16 v[144:147], v[228:231], v[16:19], v[144:147]
    ds_read_b64_tr_b16 v[224:225], v8 offset:0
    v_mfma_f32_16x16x32_bf16 v[148:151], v[228:231], v[20:23], v[148:151]
    v_mfma_f32_16x16x32_bf16 v[152:155], v[228:231], v[24:27], v[152:155]
    ds_read_b64_tr_b16 v[226:227], v8 offset:2560
    v_mfma_f32_16x16x32_bf16 v[156:159], v[228:231], v[28:31], v[156:159]
    v_mfma_f32_16x16x32_bf16 v[160:163], v[48:51], v[16:19], v[160:163]
    ds_read_b64_tr_b16 v[228:229], v8 offset:5120
    v_mfma_f32_16x16x32_bf16 v[164:167], v[48:51], v[20:23], v[164:167]
    ds_read_b64_tr_b16 v[230:231], v8 offset:7680
    v_mfma_f32_16x16x32_bf16 v[168:171], v[48:51], v[24:27], v[168:171]
    ds_read_b128 v[32:35], v5 offset:32768
    v_mfma_f32_16x16x32_bf16 v[172:175], v[48:51], v[28:31], v[172:175]
    s_waitcnt lgkmcnt(9)
    v_mfma_f32_16x16x32_bf16 v[176:179], v[52:55], v[16:19], v[176:179]
    ds_read_b64_tr_b16 v[48:49], v8 offset:32
    v_mfma_f32_16x16x32_bf16 v[180:183], v[52:55], v[20:23], v[180:183]
    ds_read_b64_tr_b16 v[50:51], v8 offset:2592
    v_mfma_f32_16x16x32_bf16 v[184:187], v[52:55], v[24:27], v[184:187]
    ds_read_b128 v[36:39], v5 offset:33792
    v_mfma_f32_16x16x32_bf16 v[188:191], v[52:55], v[28:31], v[188:191]
    s_waitcnt lgkmcnt(10)
    v_mfma_f32_16x16x32_bf16 v[192:195], v[56:59], v[16:19], v[192:195]
    ds_read_b64_tr_b16 v[52:53], v8 offset:5152
    v_mfma_f32_16x16x32_bf16 v[196:199], v[56:59], v[20:23], v[196:199]
    ds_read_b64_tr_b16 v[54:55], v8 offset:7712
    v_mfma_f32_16x16x32_bf16 v[200:203], v[56:59], v[24:27], v[200:203]
    ds_read_b128 v[40:43], v5 offset:34816
    v_mfma_f32_16x16x32_bf16 v[204:207], v[56:59], v[28:31], v[204:207]
    s_waitcnt lgkmcnt(11)
    v_mfma_f32_16x16x32_bf16 v[208:211], v[60:63], v[16:19], v[208:211]
    ds_read_b64_tr_b16 v[56:57], v8 offset:64
    v_mfma_f32_16x16x32_bf16 v[212:215], v[60:63], v[20:23], v[212:215]
    ds_read_b64_tr_b16 v[58:59], v8 offset:2624
    v_mfma_f32_16x16x32_bf16 v[216:219], v[60:63], v[24:27], v[216:219]
    ds_read_b128 v[44:47], v5 offset:35840
    v_mfma_f32_16x16x32_bf16 v[220:223], v[60:63], v[28:31], v[220:223]
    s_waitcnt lgkmcnt(12)
    s_waitcnt lgkmcnt(0)
    v_mfma_f32_16x16x32_bf16 v[96:99], v[224:227], v[32:35], v[96:99]
    ds_read_b64_tr_b16 v[60:61], v8 offset:5184
    v_mfma_f32_16x16x32_bf16 v[100:103], v[224:227], v[36:39], v[100:103]
    v_mfma_f32_16x16x32_bf16 v[104:107], v[224:227], v[40:43], v[104:107]
    ds_read_b64_tr_b16 v[62:63], v8 offset:7744
    v_mfma_f32_16x16x32_bf16 v[108:111], v[224:227], v[44:47], v[108:111]
    v_mfma_f32_16x16x32_bf16 v[112:115], v[228:231], v[32:35], v[112:115]
    ds_read_b64_tr_b16 v[224:225], v8 offset:96
    v_mfma_f32_16x16x32_bf16 v[116:119], v[228:231], v[36:39], v[116:119]
    v_mfma_f32_16x16x32_bf16 v[120:123], v[228:231], v[40:43], v[120:123]
    ds_read_b64_tr_b16 v[226:227], v8 offset:2656
    v_mfma_f32_16x16x32_bf16 v[124:127], v[228:231], v[44:47], v[124:127]
    s_waitcnt vmcnt(0)
    s_barrier
    v_mfma_f32_16x16x32_bf16 v[128:131], v[48:51], v[32:35], v[128:131]
    ds_read_b64_tr_b16 v[228:229], v8 offset:5216
    v_mfma_f32_16x16x32_bf16 v[132:135], v[48:51], v[36:39], v[132:135]
    v_mfma_f32_16x16x32_bf16 v[136:139], v[48:51], v[40:43], v[136:139]
    ds_read_b64_tr_b16 v[230:231], v8 offset:7776
    v_mfma_f32_16x16x32_bf16 v[140:143], v[48:51], v[44:47], v[140:143]
    v_mfma_f32_16x16x32_bf16 v[144:147], v[52:55], v[32:35], v[144:147]
    ds_read_b64_tr_b16 v[48:49], v8 offset:10240
    v_mfma_f32_16x16x32_bf16 v[148:151], v[52:55], v[36:39], v[148:151]
    v_mfma_f32_16x16x32_bf16 v[152:155], v[52:55], v[40:43], v[152:155]
    ds_read_b64_tr_b16 v[50:51], v8 offset:12800
    v_mfma_f32_16x16x32_bf16 v[156:159], v[52:55], v[44:47], v[156:159]
    v_mfma_f32_16x16x32_bf16 v[160:163], v[56:59], v[32:35], v[160:163]
    ds_read_b64_tr_b16 v[52:53], v8 offset:15360
    v_mfma_f32_16x16x32_bf16 v[164:167], v[56:59], v[36:39], v[164:167]
    ds_read_b64_tr_b16 v[54:55], v8 offset:17920
    v_mfma_f32_16x16x32_bf16 v[168:171], v[56:59], v[40:43], v[168:171]
    ds_read_b128 v[16:19], v4 offset:0
    v_mfma_f32_16x16x32_bf16 v[172:175], v[56:59], v[44:47], v[172:175]
    s_waitcnt lgkmcnt(9)
    v_mfma_f32_16x16x32_bf16 v[176:179], v[60:63], v[32:35], v[176:179]
    ds_read_b64_tr_b16 v[56:57], v8 offset:10272
    v_mfma_f32_16x16x32_bf16 v[180:183], v[60:63], v[36:39], v[180:183]
    ds_read_b64_tr_b16 v[58:59], v8 offset:12832
    v_mfma_f32_16x16x32_bf16 v[184:187], v[60:63], v[40:43], v[184:187]
    ds_read_b128 v[20:23], v4 offset:1024
    v_mfma_f32_16x16x32_bf16 v[188:191], v[60:63], v[44:47], v[188:191]
    s_waitcnt lgkmcnt(10)
    v_mfma_f32_16x16x32_bf16 v[192:195], v[224:227], v[32:35], v[192:195]
    ds_read_b64_tr_b16 v[60:61], v8 offset:15392
    v_mfma_f32_16x16x32_bf16 v[196:199], v[224:227], v[36:39], v[196:199]
    ds_read_b64_tr_b16 v[62:63], v8 offset:17952
    v_mfma_f32_16x16x32_bf16 v[200:203], v[224:227], v[40:43], v[200:203]
    ds_read_b128 v[24:27], v4 offset:2048
    v_mfma_f32_16x16x32_bf16 v[204:207], v[224:227], v[44:47], v[204:207]
    s_waitcnt lgkmcnt(11)
    v_mfma_f32_16x16x32_bf16 v[208:211], v[228:231], v[32:35], v[208:211]
    ds_read_b64_tr_b16 v[224:225], v8 offset:10304
    v_mfma_f32_16x16x32_bf16 v[212:215], v[228:231], v[36:39], v[212:215]
    ds_read_b64_tr_b16 v[226:227], v8 offset:12864
    v_mfma_f32_16x16x32_bf16 v[216:219], v[228:231], v[40:43], v[216:219]
    ds_read_b128 v[28:31], v4 offset:3072
    v_mfma_f32_16x16x32_bf16 v[220:223], v[228:231], v[44:47], v[220:223]
    s_waitcnt lgkmcnt(12)
    s_waitcnt lgkmcnt(0)
    v_mfma_f32_16x16x32_bf16 v[96:99], v[48:51], v[16:19], v[96:99]
    ds_read_b64_tr_b16 v[228:229], v8 offset:15424
    v_mfma_f32_16x16x32_bf16 v[100:103], v[48:51], v[20:23], v[100:103]
    v_mfma_f32_16x16x32_bf16 v[104:107], v[48:51], v[24:27], v[104:107]
    ds_read_b64_tr_b16 v[230:231], v8 offset:17984
    v_mfma_f32_16x16x32_bf16 v[108:111], v[48:51], v[28:31], v[108:111]
    v_mfma_f32_16x16x32_bf16 v[112:115], v[52:55], v[16:19], v[112:115]
    ds_read_b64_tr_b16 v[48:49], v8 offset:10336
    v_mfma_f32_16x16x32_bf16 v[116:119], v[52:55], v[20:23], v[116:119]
    v_mfma_f32_16x16x32_bf16 v[120:123], v[52:55], v[24:27], v[120:123]
    ds_read_b64_tr_b16 v[50:51], v8 offset:12896
    v_mfma_f32_16x16x32_bf16 v[124:127], v[52:55], v[28:31], v[124:127]
    s_barrier
    v_mfma_f32_16x16x32_bf16 v[128:131], v[56:59], v[16:19], v[128:131]
    ds_read_b64_tr_b16 v[52:53], v8 offset:15456
    v_mfma_f32_16x16x32_bf16 v[132:135], v[56:59], v[20:23], v[132:135]
    v_mfma_f32_16x16x32_bf16 v[136:139], v[56:59], v[24:27], v[136:139]
    ds_read_b64_tr_b16 v[54:55], v8 offset:18016
    v_mfma_f32_16x16x32_bf16 v[140:143], v[56:59], v[28:31], v[140:143]
    v_mfma_f32_16x16x32_bf16 v[144:147], v[60:63], v[16:19], v[144:147]
    ds_read_b64_tr_b16 v[56:57], v8 offset:20480
    v_mfma_f32_16x16x32_bf16 v[148:151], v[60:63], v[20:23], v[148:151]
    v_mfma_f32_16x16x32_bf16 v[152:155], v[60:63], v[24:27], v[152:155]
    ds_read_b64_tr_b16 v[58:59], v8 offset:23040
    v_mfma_f32_16x16x32_bf16 v[156:159], v[60:63], v[28:31], v[156:159]
    v_mfma_f32_16x16x32_bf16 v[160:163], v[224:227], v[16:19], v[160:163]
    ds_read_b64_tr_b16 v[60:61], v8 offset:25600
    v_mfma_f32_16x16x32_bf16 v[164:167], v[224:227], v[20:23], v[164:167]
    ds_read_b64_tr_b16 v[62:63], v8 offset:28160
    v_mfma_f32_16x16x32_bf16 v[168:171], v[224:227], v[24:27], v[168:171]
    ds_read_b128 v[32:35], v4 offset:16384
    v_mfma_f32_16x16x32_bf16 v[172:175], v[224:227], v[28:31], v[172:175]
    s_waitcnt lgkmcnt(9)
    v_mfma_f32_16x16x32_bf16 v[176:179], v[228:231], v[16:19], v[176:179]
    ds_read_b64_tr_b16 v[224:225], v8 offset:20512
    v_mfma_f32_16x16x32_bf16 v[180:183], v[228:231], v[20:23], v[180:183]
    ds_read_b64_tr_b16 v[226:227], v8 offset:23072
    v_mfma_f32_16x16x32_bf16 v[184:187], v[228:231], v[24:27], v[184:187]
    ds_read_b128 v[36:39], v4 offset:17408
    v_mfma_f32_16x16x32_bf16 v[188:191], v[228:231], v[28:31], v[188:191]
    s_waitcnt lgkmcnt(10)
    v_mfma_f32_16x16x32_bf16 v[192:195], v[48:51], v[16:19], v[192:195]
    ds_read_b64_tr_b16 v[228:229], v8 offset:25632
    v_mfma_f32_16x16x32_bf16 v[196:199], v[48:51], v[20:23], v[196:199]
    ds_read_b64_tr_b16 v[230:231], v8 offset:28192
    v_mfma_f32_16x16x32_bf16 v[200:203], v[48:51], v[24:27], v[200:203]
    ds_read_b128 v[40:43], v4 offset:18432
    v_mfma_f32_16x16x32_bf16 v[204:207], v[48:51], v[28:31], v[204:207]
    s_waitcnt lgkmcnt(11)
    v_mfma_f32_16x16x32_bf16 v[208:211], v[52:55], v[16:19], v[208:211]
    ds_read_b64_tr_b16 v[48:49], v8 offset:20544
    v_mfma_f32_16x16x32_bf16 v[212:215], v[52:55], v[20:23], v[212:215]
    ds_read_b64_tr_b16 v[50:51], v8 offset:23104
    v_mfma_f32_16x16x32_bf16 v[216:219], v[52:55], v[24:27], v[216:219]
    ds_read_b128 v[44:47], v4 offset:19456
    v_mfma_f32_16x16x32_bf16 v[220:223], v[52:55], v[28:31], v[220:223]
    s_waitcnt lgkmcnt(12)
    s_waitcnt lgkmcnt(0)
    v_mfma_f32_16x16x32_bf16 v[96:99], v[56:59], v[32:35], v[96:99]
    ds_read_b64_tr_b16 v[52:53], v8 offset:25664
    v_mfma_f32_16x16x32_bf16 v[100:103], v[56:59], v[36:39], v[100:103]
    v_mfma_f32_16x16x32_bf16 v[104:107], v[56:59], v[40:43], v[104:107]
    ds_read_b64_tr_b16 v[54:55], v8 offset:28224
    v_mfma_f32_16x16x32_bf16 v[108:111], v[56:59], v[44:47], v[108:111]
    v_mfma_f32_16x16x32_bf16 v[112:115], v[60:63], v[32:35], v[112:115]
    ds_read_b64_tr_b16 v[56:57], v8 offset:20576
    v_mfma_f32_16x16x32_bf16 v[116:119], v[60:63], v[36:39], v[116:119]
    v_mfma_f32_16x16x32_bf16 v[120:123], v[60:63], v[40:43], v[120:123]
    ds_read_b64_tr_b16 v[58:59], v8 offset:23136
    v_mfma_f32_16x16x32_bf16 v[124:127], v[60:63], v[44:47], v[124:127]
    s_barrier
    v_mfma_f32_16x16x32_bf16 v[128:131], v[224:227], v[32:35], v[128:131]
    ds_read_b64_tr_b16 v[60:61], v8 offset:25696
    v_mfma_f32_16x16x32_bf16 v[132:135], v[224:227], v[36:39], v[132:135]
    v_mfma_f32_16x16x32_bf16 v[136:139], v[224:227], v[40:43], v[136:139]
    ds_read_b64_tr_b16 v[62:63], v8 offset:28256
    v_mfma_f32_16x16x32_bf16 v[140:143], v[224:227], v[44:47], v[140:143]
    v_mfma_f32_16x16x32_bf16 v[144:147], v[228:231], v[32:35], v[144:147]
    ds_read_b64_tr_b16 v[224:225], v8 offset:30720
    v_mfma_f32_16x16x32_bf16 v[148:151], v[228:231], v[36:39], v[148:151]
    v_mfma_f32_16x16x32_bf16 v[152:155], v[228:231], v[40:43], v[152:155]
    ds_read_b64_tr_b16 v[226:227], v8 offset:33280
    v_mfma_f32_16x16x32_bf16 v[156:159], v[228:231], v[44:47], v[156:159]
    v_mfma_f32_16x16x32_bf16 v[160:163], v[48:51], v[32:35], v[160:163]
    ds_read_b64_tr_b16 v[228:229], v9 offset:3072
    v_mfma_f32_16x16x32_bf16 v[164:167], v[48:51], v[36:39], v[164:167]
    ds_read_b64_tr_b16 v[230:231], v9 offset:5632
    v_mfma_f32_16x16x32_bf16 v[168:171], v[48:51], v[40:43], v[168:171]
    ds_read_b128 v[16:19], v5 offset:0
    v_mfma_f32_16x16x32_bf16 v[172:175], v[48:51], v[44:47], v[172:175]
    s_waitcnt lgkmcnt(9)
    v_mfma_f32_16x16x32_bf16 v[176:179], v[52:55], v[32:35], v[176:179]
    ds_read_b64_tr_b16 v[48:49], v8 offset:30752
    v_mfma_f32_16x16x32_bf16 v[180:183], v[52:55], v[36:39], v[180:183]
    ds_read_b64_tr_b16 v[50:51], v8 offset:33312
    v_mfma_f32_16x16x32_bf16 v[184:187], v[52:55], v[40:43], v[184:187]
    ds_read_b128 v[20:23], v5 offset:1024
    v_mfma_f32_16x16x32_bf16 v[188:191], v[52:55], v[44:47], v[188:191]
    s_waitcnt lgkmcnt(10)
    v_mfma_f32_16x16x32_bf16 v[192:195], v[56:59], v[32:35], v[192:195]
    ds_read_b64_tr_b16 v[52:53], v9 offset:3104
    v_mfma_f32_16x16x32_bf16 v[196:199], v[56:59], v[36:39], v[196:199]
    ds_read_b64_tr_b16 v[54:55], v9 offset:5664
    v_mfma_f32_16x16x32_bf16 v[200:203], v[56:59], v[40:43], v[200:203]
    ds_read_b128 v[24:27], v5 offset:2048
    v_mfma_f32_16x16x32_bf16 v[204:207], v[56:59], v[44:47], v[204:207]
    s_waitcnt lgkmcnt(11)
    v_mfma_f32_16x16x32_bf16 v[208:211], v[60:63], v[32:35], v[208:211]
    ds_read_b64_tr_b16 v[56:57], v8 offset:30784
    v_mfma_f32_16x16x32_bf16 v[212:215], v[60:63], v[36:39], v[212:215]
    ds_read_b64_tr_b16 v[58:59], v8 offset:33344
    v_mfma_f32_16x16x32_bf16 v[216:219], v[60:63], v[40:43], v[216:219]
    ds_read_b128 v[28:31], v5 offset:3072
    v_mfma_f32_16x16x32_bf16 v[220:223], v[60:63], v[44:47], v[220:223]
    s_waitcnt lgkmcnt(12)
    s_waitcnt lgkmcnt(0)
    v_mfma_f32_16x16x32_bf16 v[96:99], v[224:227], v[16:19], v[96:99]
    ds_read_b64_tr_b16 v[60:61], v9 offset:3136
    v_mfma_f32_16x16x32_bf16 v[100:103], v[224:227], v[20:23], v[100:103]
    v_mfma_f32_16x16x32_bf16 v[104:107], v[224:227], v[24:27], v[104:107]
    ds_read_b64_tr_b16 v[62:63], v9 offset:5696
    v_mfma_f32_16x16x32_bf16 v[108:111], v[224:227], v[28:31], v[108:111]
    v_mfma_f32_16x16x32_bf16 v[112:115], v[228:231], v[16:19], v[112:115]
    ds_read_b64_tr_b16 v[224:225], v8 offset:30816
    v_mfma_f32_16x16x32_bf16 v[116:119], v[228:231], v[20:23], v[116:119]
    v_mfma_f32_16x16x32_bf16 v[120:123], v[228:231], v[24:27], v[120:123]
    ds_read_b64_tr_b16 v[226:227], v8 offset:33376
    v_mfma_f32_16x16x32_bf16 v[124:127], v[228:231], v[28:31], v[124:127]
    s_barrier
    v_mfma_f32_16x16x32_bf16 v[128:131], v[48:51], v[16:19], v[128:131]
    ds_read_b64_tr_b16 v[228:229], v9 offset:3168
    v_mfma_f32_16x16x32_bf16 v[132:135], v[48:51], v[20:23], v[132:135]
    v_mfma_f32_16x16x32_bf16 v[136:139], v[48:51], v[24:27], v[136:139]
    ds_read_b64_tr_b16 v[230:231], v9 offset:5728
    v_mfma_f32_16x16x32_bf16 v[140:143], v[48:51], v[28:31], v[140:143]
    v_mfma_f32_16x16x32_bf16 v[144:147], v[52:55], v[16:19], v[144:147]
    ds_read_b64_tr_b16 v[48:49], v9 offset:8192
    v_mfma_f32_16x16x32_bf16 v[148:151], v[52:55], v[20:23], v[148:151]
    v_mfma_f32_16x16x32_bf16 v[152:155], v[52:55], v[24:27], v[152:155]
    ds_read_b64_tr_b16 v[50:51], v9 offset:10752
    v_mfma_f32_16x16x32_bf16 v[156:159], v[52:55], v[28:31], v[156:159]
    v_mfma_f32_16x16x32_bf16 v[160:163], v[56:59], v[16:19], v[160:163]
    ds_read_b64_tr_b16 v[52:53], v9 offset:13312
    v_mfma_f32_16x16x32_bf16 v[164:167], v[56:59], v[20:23], v[164:167]
    ds_read_b64_tr_b16 v[54:55], v9 offset:15872
    v_mfma_f32_16x16x32_bf16 v[168:171], v[56:59], v[24:27], v[168:171]
    ds_read_b128 v[32:35], v5 offset:16384
    v_mfma_f32_16x16x32_bf16 v[172:175], v[56:59], v[28:31], v[172:175]
    s_waitcnt lgkmcnt(9)
    v_mfma_f32_16x16x32_bf16 v[176:179], v[60:63], v[16:19], v[176:179]
    ds_read_b64_tr_b16 v[56:57], v9 offset:8224
    v_mfma_f32_16x16x32_bf16 v[180:183], v[60:63], v[20:23], v[180:183]
    ds_read_b64_tr_b16 v[58:59], v9 offset:10784
    v_mfma_f32_16x16x32_bf16 v[184:187], v[60:63], v[24:27], v[184:187]
    ds_read_b128 v[36:39], v5 offset:17408
    v_mfma_f32_16x16x32_bf16 v[188:191], v[60:63], v[28:31], v[188:191]
    s_waitcnt lgkmcnt(10)
    v_mfma_f32_16x16x32_bf16 v[192:195], v[224:227], v[16:19], v[192:195]
    ds_read_b64_tr_b16 v[60:61], v9 offset:13344
    v_mfma_f32_16x16x32_bf16 v[196:199], v[224:227], v[20:23], v[196:199]
    ds_read_b64_tr_b16 v[62:63], v9 offset:15904
    v_mfma_f32_16x16x32_bf16 v[200:203], v[224:227], v[24:27], v[200:203]
    ds_read_b128 v[40:43], v5 offset:18432
    v_mfma_f32_16x16x32_bf16 v[204:207], v[224:227], v[28:31], v[204:207]
    s_waitcnt lgkmcnt(11)
    v_mfma_f32_16x16x32_bf16 v[208:211], v[228:231], v[16:19], v[208:211]
    ds_read_b64_tr_b16 v[224:225], v9 offset:8256
    v_mfma_f32_16x16x32_bf16 v[212:215], v[228:231], v[20:23], v[212:215]
    ds_read_b64_tr_b16 v[226:227], v9 offset:10816
    v_mfma_f32_16x16x32_bf16 v[216:219], v[228:231], v[24:27], v[216:219]
    ds_read_b128 v[44:47], v5 offset:19456
    v_mfma_f32_16x16x32_bf16 v[220:223], v[228:231], v[28:31], v[220:223]
    s_waitcnt lgkmcnt(12)
    s_waitcnt lgkmcnt(0)
    v_mfma_f32_16x16x32_bf16 v[96:99], v[48:51], v[32:35], v[96:99]
    ds_read_b64_tr_b16 v[228:229], v9 offset:13376
    v_mfma_f32_16x16x32_bf16 v[100:103], v[48:51], v[36:39], v[100:103]
    v_mfma_f32_16x16x32_bf16 v[104:107], v[48:51], v[40:43], v[104:107]
    ds_read_b64_tr_b16 v[230:231], v9 offset:15936
    v_mfma_f32_16x16x32_bf16 v[108:111], v[48:51], v[44:47], v[108:111]
    v_mfma_f32_16x16x32_bf16 v[112:115], v[52:55], v[32:35], v[112:115]
    ds_read_b64_tr_b16 v[48:49], v9 offset:8288
    v_mfma_f32_16x16x32_bf16 v[116:119], v[52:55], v[36:39], v[116:119]
    v_mfma_f32_16x16x32_bf16 v[120:123], v[52:55], v[40:43], v[120:123]
    ds_read_b64_tr_b16 v[50:51], v9 offset:10848
    v_mfma_f32_16x16x32_bf16 v[124:127], v[52:55], v[44:47], v[124:127]
    s_barrier
    v_mfma_f32_16x16x32_bf16 v[128:131], v[56:59], v[32:35], v[128:131]
    ds_read_b64_tr_b16 v[52:53], v9 offset:13408
    v_mfma_f32_16x16x32_bf16 v[132:135], v[56:59], v[36:39], v[132:135]
    v_mfma_f32_16x16x32_bf16 v[136:139], v[56:59], v[40:43], v[136:139]
    ds_read_b64_tr_b16 v[54:55], v9 offset:15968
    v_mfma_f32_16x16x32_bf16 v[140:143], v[56:59], v[44:47], v[140:143]
    v_mfma_f32_16x16x32_bf16 v[144:147], v[60:63], v[32:35], v[144:147]
    ds_read_b64_tr_b16 v[56:57], v9 offset:18432
    v_mfma_f32_16x16x32_bf16 v[148:151], v[60:63], v[36:39], v[148:151]
    v_mfma_f32_16x16x32_bf16 v[152:155], v[60:63], v[40:43], v[152:155]
    ds_read_b64_tr_b16 v[58:59], v9 offset:20992
    v_mfma_f32_16x16x32_bf16 v[156:159], v[60:63], v[44:47], v[156:159]
    v_mfma_f32_16x16x32_bf16 v[160:163], v[224:227], v[32:35], v[160:163]
    ds_read_b64_tr_b16 v[60:61], v9 offset:23552
    v_mfma_f32_16x16x32_bf16 v[164:167], v[224:227], v[36:39], v[164:167]
    ds_read_b64_tr_b16 v[62:63], v9 offset:26112
    v_mfma_f32_16x16x32_bf16 v[168:171], v[224:227], v[40:43], v[168:171]
    ds_read_b128 v[16:19], v5 offset:32768
    v_mfma_f32_16x16x32_bf16 v[172:175], v[224:227], v[44:47], v[172:175]
    s_waitcnt lgkmcnt(9)
    v_mfma_f32_16x16x32_bf16 v[176:179], v[228:231], v[32:35], v[176:179]
    ds_read_b64_tr_b16 v[224:225], v9 offset:18464
    v_mfma_f32_16x16x32_bf16 v[180:183], v[228:231], v[36:39], v[180:183]
    ds_read_b64_tr_b16 v[226:227], v9 offset:21024
    v_mfma_f32_16x16x32_bf16 v[184:187], v[228:231], v[40:43], v[184:187]
    ds_read_b128 v[20:23], v5 offset:33792
    v_mfma_f32_16x16x32_bf16 v[188:191], v[228:231], v[44:47], v[188:191]
    s_waitcnt lgkmcnt(10)
    v_mfma_f32_16x16x32_bf16 v[192:195], v[48:51], v[32:35], v[192:195]
    ds_read_b64_tr_b16 v[228:229], v9 offset:23584
    v_mfma_f32_16x16x32_bf16 v[196:199], v[48:51], v[36:39], v[196:199]
    ds_read_b64_tr_b16 v[230:231], v9 offset:26144
    v_mfma_f32_16x16x32_bf16 v[200:203], v[48:51], v[40:43], v[200:203]
    ds_read_b128 v[24:27], v5 offset:34816
    v_mfma_f32_16x16x32_bf16 v[204:207], v[48:51], v[44:47], v[204:207]
    s_waitcnt lgkmcnt(11)
    v_mfma_f32_16x16x32_bf16 v[208:211], v[52:55], v[32:35], v[208:211]
    ds_read_b64_tr_b16 v[48:49], v9 offset:18496
    v_mfma_f32_16x16x32_bf16 v[212:215], v[52:55], v[36:39], v[212:215]
    ds_read_b64_tr_b16 v[50:51], v9 offset:21056
    v_mfma_f32_16x16x32_bf16 v[216:219], v[52:55], v[40:43], v[216:219]
    ds_read_b128 v[28:31], v5 offset:35840
    v_mfma_f32_16x16x32_bf16 v[220:223], v[52:55], v[44:47], v[220:223]
    s_waitcnt lgkmcnt(12)
    s_waitcnt lgkmcnt(0)
    v_mfma_f32_16x16x32_bf16 v[96:99], v[56:59], v[16:19], v[96:99]
    ds_read_b64_tr_b16 v[52:53], v9 offset:23616
    v_mfma_f32_16x16x32_bf16 v[100:103], v[56:59], v[20:23], v[100:103]
    v_mfma_f32_16x16x32_bf16 v[104:107], v[56:59], v[24:27], v[104:107]
    ds_read_b64_tr_b16 v[54:55], v9 offset:26176
    v_mfma_f32_16x16x32_bf16 v[108:111], v[56:59], v[28:31], v[108:111]
    v_mfma_f32_16x16x32_bf16 v[112:115], v[60:63], v[16:19], v[112:115]
    ds_read_b64_tr_b16 v[56:57], v9 offset:18528
    v_mfma_f32_16x16x32_bf16 v[116:119], v[60:63], v[20:23], v[116:119]
    v_mfma_f32_16x16x32_bf16 v[120:123], v[60:63], v[24:27], v[120:123]
    ds_read_b64_tr_b16 v[58:59], v9 offset:21088
    v_mfma_f32_16x16x32_bf16 v[124:127], v[60:63], v[28:31], v[124:127]
    s_barrier
    v_mfma_f32_16x16x32_bf16 v[128:131], v[224:227], v[16:19], v[128:131]
    ds_read_b64_tr_b16 v[60:61], v9 offset:23648
    v_mfma_f32_16x16x32_bf16 v[132:135], v[224:227], v[20:23], v[132:135]
    v_mfma_f32_16x16x32_bf16 v[136:139], v[224:227], v[24:27], v[136:139]
    ds_read_b64_tr_b16 v[62:63], v9 offset:26208
    v_mfma_f32_16x16x32_bf16 v[140:143], v[224:227], v[28:31], v[140:143]
    v_mfma_f32_16x16x32_bf16 v[144:147], v[228:231], v[16:19], v[144:147]
    ds_read_b64_tr_b16 v[224:225], v9 offset:28672
    v_mfma_f32_16x16x32_bf16 v[148:151], v[228:231], v[20:23], v[148:151]
    v_mfma_f32_16x16x32_bf16 v[152:155], v[228:231], v[24:27], v[152:155]
    ds_read_b64_tr_b16 v[226:227], v9 offset:31232
    v_mfma_f32_16x16x32_bf16 v[156:159], v[228:231], v[28:31], v[156:159]
    v_mfma_f32_16x16x32_bf16 v[160:163], v[48:51], v[16:19], v[160:163]
    ds_read_b64_tr_b16 v[228:229], v9 offset:33792
    v_mfma_f32_16x16x32_bf16 v[164:167], v[48:51], v[20:23], v[164:167]
    ds_read_b64_tr_b16 v[230:231], v9 offset:36352
    v_mfma_f32_16x16x32_bf16 v[168:171], v[48:51], v[24:27], v[168:171]
    ds_read_b128 v[32:35], v4 offset:0
    v_mfma_f32_16x16x32_bf16 v[172:175], v[48:51], v[28:31], v[172:175]
    s_waitcnt lgkmcnt(9)
    v_mfma_f32_16x16x32_bf16 v[176:179], v[52:55], v[16:19], v[176:179]
    ds_read_b64_tr_b16 v[48:49], v9 offset:28704
    v_mfma_f32_16x16x32_bf16 v[180:183], v[52:55], v[20:23], v[180:183]
    ds_read_b64_tr_b16 v[50:51], v9 offset:31264
    v_mfma_f32_16x16x32_bf16 v[184:187], v[52:55], v[24:27], v[184:187]
    ds_read_b128 v[36:39], v4 offset:1024
    v_mfma_f32_16x16x32_bf16 v[188:191], v[52:55], v[28:31], v[188:191]
    s_waitcnt lgkmcnt(10)
    v_mfma_f32_16x16x32_bf16 v[192:195], v[56:59], v[16:19], v[192:195]
    ds_read_b64_tr_b16 v[52:53], v9 offset:33824
    v_mfma_f32_16x16x32_bf16 v[196:199], v[56:59], v[20:23], v[196:199]
    ds_read_b64_tr_b16 v[54:55], v9 offset:36384
    v_mfma_f32_16x16x32_bf16 v[200:203], v[56:59], v[24:27], v[200:203]
    ds_read_b128 v[40:43], v4 offset:2048
    v_mfma_f32_16x16x32_bf16 v[204:207], v[56:59], v[28:31], v[204:207]
    s_waitcnt lgkmcnt(11)
    v_mfma_f32_16x16x32_bf16 v[208:211], v[60:63], v[16:19], v[208:211]
    ds_read_b64_tr_b16 v[56:57], v9 offset:28736
    v_mfma_f32_16x16x32_bf16 v[212:215], v[60:63], v[20:23], v[212:215]
    ds_read_b64_tr_b16 v[58:59], v9 offset:31296
    v_mfma_f32_16x16x32_bf16 v[216:219], v[60:63], v[24:27], v[216:219]
    ds_read_b128 v[44:47], v4 offset:3072
    v_mfma_f32_16x16x32_bf16 v[220:223], v[60:63], v[28:31], v[220:223]
    s_waitcnt lgkmcnt(12)
    s_waitcnt lgkmcnt(0)
    v_mfma_f32_16x16x32_bf16 v[96:99], v[224:227], v[32:35], v[96:99]
    ds_read_b64_tr_b16 v[60:61], v9 offset:33856
    v_mfma_f32_16x16x32_bf16 v[100:103], v[224:227], v[36:39], v[100:103]
    v_mfma_f32_16x16x32_bf16 v[104:107], v[224:227], v[40:43], v[104:107]
    ds_read_b64_tr_b16 v[62:63], v9 offset:36416
    v_mfma_f32_16x16x32_bf16 v[108:111], v[224:227], v[44:47], v[108:111]
    v_mfma_f32_16x16x32_bf16 v[112:115], v[228:231], v[32:35], v[112:115]
    ds_read_b64_tr_b16 v[224:225], v9 offset:28768
    v_mfma_f32_16x16x32_bf16 v[116:119], v[228:231], v[36:39], v[116:119]
    v_mfma_f32_16x16x32_bf16 v[120:123], v[228:231], v[40:43], v[120:123]
    ds_read_b64_tr_b16 v[226:227], v9 offset:31328
    v_mfma_f32_16x16x32_bf16 v[124:127], v[228:231], v[44:47], v[124:127]
    s_barrier
    v_mfma_f32_16x16x32_bf16 v[128:131], v[48:51], v[32:35], v[128:131]
    ds_read_b64_tr_b16 v[228:229], v9 offset:33888
    v_mfma_f32_16x16x32_bf16 v[132:135], v[48:51], v[36:39], v[132:135]
    v_mfma_f32_16x16x32_bf16 v[136:139], v[48:51], v[40:43], v[136:139]
    ds_read_b64_tr_b16 v[230:231], v9 offset:36448
    v_mfma_f32_16x16x32_bf16 v[140:143], v[48:51], v[44:47], v[140:143]
    v_mfma_f32_16x16x32_bf16 v[144:147], v[52:55], v[32:35], v[144:147]
    v_mfma_f32_16x16x32_bf16 v[148:151], v[52:55], v[36:39], v[148:151]
    v_mfma_f32_16x16x32_bf16 v[152:155], v[52:55], v[40:43], v[152:155]
    v_mfma_f32_16x16x32_bf16 v[156:159], v[52:55], v[44:47], v[156:159]
    v_mfma_f32_16x16x32_bf16 v[160:163], v[56:59], v[32:35], v[160:163]
    ds_read_b128 v[16:19], v6 offset:16384
    v_mfma_f32_16x16x32_bf16 v[164:167], v[56:59], v[36:39], v[164:167]
    v_mfma_f32_16x16x32_bf16 v[168:171], v[56:59], v[40:43], v[168:171]
    v_mfma_f32_16x16x32_bf16 v[172:175], v[56:59], v[44:47], v[172:175]
    s_waitcnt lgkmcnt(5)
    v_mfma_f32_16x16x32_bf16 v[176:179], v[60:63], v[32:35], v[176:179]
    ds_read_b128 v[20:23], v6 offset:17408
    v_mfma_f32_16x16x32_bf16 v[180:183], v[60:63], v[36:39], v[180:183]
    v_mfma_f32_16x16x32_bf16 v[184:187], v[60:63], v[40:43], v[184:187]
    v_mfma_f32_16x16x32_bf16 v[188:191], v[60:63], v[44:47], v[188:191]
    s_waitcnt lgkmcnt(4)
    v_mfma_f32_16x16x32_bf16 v[192:195], v[224:227], v[32:35], v[192:195]
    ds_read_b128 v[24:27], v6 offset:24576
    v_mfma_f32_16x16x32_bf16 v[196:199], v[224:227], v[36:39], v[196:199]
    v_mfma_f32_16x16x32_bf16 v[200:203], v[224:227], v[40:43], v[200:203]
    v_mfma_f32_16x16x32_bf16 v[204:207], v[224:227], v[44:47], v[204:207]
    s_waitcnt lgkmcnt(3)
    v_mfma_f32_16x16x32_bf16 v[208:211], v[228:231], v[32:35], v[208:211]
    ds_read_b128 v[28:31], v6 offset:25600
    v_mfma_f32_16x16x32_bf16 v[212:215], v[228:231], v[36:39], v[212:215]
    v_mfma_f32_16x16x32_bf16 v[216:219], v[228:231], v[40:43], v[216:219]
    v_mfma_f32_16x16x32_bf16 v[220:223], v[228:231], v[44:47], v[220:223]
    s_nop 7
    v_max_f32 v160, 0, v160
    v_max_f32 v161, 0, v161
    v_max_f32 v162, 0, v162
    v_max_f32 v163, 0, v163
    v_mul_f32 v160, v160, v176
    v_mul_f32 v161, v161, v177
    v_mul_f32 v162, v162, v178
    v_mul_f32 v163, v163, v179
    v_cvt_pk_bf16_f32 v224, v160, v161
    v_cvt_pk_bf16_f32 v225, v162, v163
    v_max_f32 v192, 0, v192
    v_max_f32 v193, 0, v193
    v_max_f32 v194, 0, v194
    v_max_f32 v195, 0, v195
    v_mul_f32 v192, v192, v208
    v_mul_f32 v193, v193, v209
    v_mul_f32 v194, v194, v210
    v_mul_f32 v195, v195, v211
    v_cvt_pk_bf16_f32 v226, v192, v193
    v_cvt_pk_bf16_f32 v227, v194, v195
    v_max_f32 v164, 0, v164
    v_max_f32 v165, 0, v165
    v_max_f32 v166, 0, v166
    v_max_f32 v167, 0, v167
    v_mul_f32 v164, v164, v180
    v_mul_f32 v165, v165, v181
    v_mul_f32 v166, v166, v182
    v_mul_f32 v167, v167, v183
    v_cvt_pk_bf16_f32 v228, v164, v165
    v_cvt_pk_bf16_f32 v229, v166, v167
    v_max_f32 v196, 0, v196
    v_max_f32 v197, 0, v197
    v_max_f32 v198, 0, v198
    v_max_f32 v199, 0, v199
    v_mul_f32 v196, v196, v212
    v_mul_f32 v197, v197, v213
    v_mul_f32 v198, v198, v214
    v_mul_f32 v199, v199, v215
    v_cvt_pk_bf16_f32 v230, v196, v197
    v_cvt_pk_bf16_f32 v231, v198, v199
    v_max_f32 v168, 0, v168
    v_max_f32 v169, 0, v169
    v_max_f32 v170, 0, v170
    v_max_f32 v171, 0, v171
    v_mul_f32 v168, v168, v184
    v_mul_f32 v169, v169, v185
    v_mul_f32 v170, v170, v186
    v_mul_f32 v171, v171, v187
    v_cvt_pk_bf16_f32 v232, v168, v169
    v_cvt_pk_bf16_f32 v233, v170, v171
    v_max_f32 v200, 0, v200
    v_max_f32 v201, 0, v201
    v_max_f32 v202, 0, v202
    v_max_f32 v203, 0, v203
    v_mul_f32 v200, v200, v216
    v_mul_f32 v201, v201, v217
    v_mul_f32 v202, v202, v218
    v_mul_f32 v203, v203, v219
    v_cvt_pk_bf16_f32 v234, v200, v201
    v_cvt_pk_bf16_f32 v235, v202, v203
    v_max_f32 v172, 0, v172
    v_max_f32 v173, 0, v173
    v_max_f32 v174, 0, v174
    v_max_f32 v175, 0, v175
    v_mul_f32 v172, v172, v188
    v_mul_f32 v173, v173, v189
    v_mul_f32 v174, v174, v190
    v_mul_f32 v175, v175, v191
    v_cvt_pk_bf16_f32 v236, v172, v173
    v_cvt_pk_bf16_f32 v237, v174, v175
    v_max_f32 v204, 0, v204
    v_max_f32 v205, 0, v205
    v_max_f32 v206, 0, v206
    v_max_f32 v207, 0, v207
    v_mul_f32 v204, v204, v220
    v_mul_f32 v205, v205, v221
    v_mul_f32 v206, v206, v222
    v_mul_f32 v207, v207, v223
    v_cvt_pk_bf16_f32 v238, v204, v205
    v_cvt_pk_bf16_f32 v239, v206, v207
    v_max_f32 v96, 0, v96
    v_max_f32 v97, 0, v97
    v_max_f32 v98, 0, v98
    v_max_f32 v99, 0, v99
    v_mul_f32 v96, v96, v112
    v_mul_f32 v97, v97, v113
    v_mul_f32 v98, v98, v114
    v_mul_f32 v99, v99, v115
    v_cvt_pk_bf16_f32 v208, v96, v97
    v_cvt_pk_bf16_f32 v209, v98, v99
    v_max_f32 v128, 0, v128
    v_max_f32 v129, 0, v129
    v_max_f32 v130, 0, v130
    v_max_f32 v131, 0, v131
    v_mul_f32 v128, v128, v144
    v_mul_f32 v129, v129, v145
    v_mul_f32 v130, v130, v146
    v_mul_f32 v131, v131, v147
    v_cvt_pk_bf16_f32 v210, v128, v129
    v_cvt_pk_bf16_f32 v211, v130, v131
    v_max_f32 v100, 0, v100
    v_max_f32 v101, 0, v101
    v_max_f32 v102, 0, v102
    v_max_f32 v103, 0, v103
    v_mul_f32 v100, v100, v116
    v_mul_f32 v101, v101, v117
    v_mul_f32 v102, v102, v118
    v_mul_f32 v103, v103, v119
    v_cvt_pk_bf16_f32 v212, v100, v101
    v_cvt_pk_bf16_f32 v213, v102, v103
    v_max_f32 v132, 0, v132
    v_max_f32 v133, 0, v133
    v_max_f32 v134, 0, v134
    v_max_f32 v135, 0, v135
    v_mul_f32 v132, v132, v148
    v_mul_f32 v133, v133, v149
    v_mul_f32 v134, v134, v150
    v_mul_f32 v135, v135, v151
    v_cvt_pk_bf16_f32 v214, v132, v133
    v_cvt_pk_bf16_f32 v215, v134, v135
    v_max_f32 v104, 0, v104
    v_max_f32 v105, 0, v105
    v_max_f32 v106, 0, v106
    v_max_f32 v107, 0, v107
    v_mul_f32 v104, v104, v120
    v_mul_f32 v105, v105, v121
    v_mul_f32 v106, v106, v122
    v_mul_f32 v107, v107, v123
    v_cvt_pk_bf16_f32 v216, v104, v105
    v_cvt_pk_bf16_f32 v217, v106, v107
    v_max_f32 v136, 0, v136
    v_max_f32 v137, 0, v137
    v_max_f32 v138, 0, v138
    v_max_f32 v139, 0, v139
    v_mul_f32 v136, v136, v152
    v_mul_f32 v137, v137, v153
    v_mul_f32 v138, v138, v154
    v_mul_f32 v139, v139, v155
    v_cvt_pk_bf16_f32 v218, v136, v137
    v_cvt_pk_bf16_f32 v219, v138, v139
    v_max_f32 v108, 0, v108
    v_max_f32 v109, 0, v109
    v_max_f32 v110, 0, v110
    v_max_f32 v111, 0, v111
    v_mul_f32 v108, v108, v124
    v_mul_f32 v109, v109, v125
    v_mul_f32 v110, v110, v126
    v_mul_f32 v111, v111, v127
    v_cvt_pk_bf16_f32 v220, v108, v109
    v_cvt_pk_bf16_f32 v221, v110, v111
    v_max_f32 v140, 0, v140
    v_max_f32 v141, 0, v141
    v_max_f32 v142, 0, v142
    v_max_f32 v143, 0, v143
    v_mul_f32 v140, v140, v156
    v_mul_f32 v141, v141, v157
    v_mul_f32 v142, v142, v158
    v_mul_f32 v143, v143, v159
    v_cvt_pk_bf16_f32 v222, v140, v141
    v_cvt_pk_bf16_f32 v223, v142, v143
    ds_read_b64_tr_b16 v[160:161], v12 offset:0
    ds_read_b64_tr_b16 v[162:163], v12 offset:4608
    ds_read_b64_tr_b16 v[164:165], v12 offset:32
    ds_read_b64_tr_b16 v[166:167], v12 offset:4640
    ds_read_b64_tr_b16 v[168:169], v12 offset:64
    ds_read_b64_tr_b16 v[170:171], v12 offset:4672
    ds_read_b64_tr_b16 v[172:173], v12 offset:96
    ds_read_b64_tr_b16 v[174:175], v12 offset:4704
    s_waitcnt lgkmcnt(6)
    v_mfma_f32_16x16x32_bf16 v[64:67], v[160:163], v[16:19], 0
    ds_read_b64_tr_b16 v[144:145], v12 offset:128
    ds_read_b64_tr_b16 v[146:147], v12 offset:4736
    v_mfma_f32_16x16x32_bf16 v[68:71], v[160:163], v[20:23], 0
    ds_read_b64_tr_b16 v[148:149], v12 offset:160
    ds_read_b64_tr_b16 v[150:151], v12 offset:4768
    s_add_u32 s43, s41, 1024
    buffer_store_dwordx4 v[224:227], v3, s[32:35], s43 offen sc1
    s_waitcnt lgkmcnt(8)
    v_mfma_f32_16x16x32_bf16 v[72:75], v[164:167], v[16:19], 0
    ds_read_b64_tr_b16 v[152:153], v12 offset:192
    ds_read_b64_tr_b16 v[154:155], v12 offset:4800
    v_mfma_f32_16x16x32_bf16 v[76:79], v[164:167], v[20:23], 0
    ds_read_b64_tr_b16 v[156:157], v12 offset:224
    ds_read_b64_tr_b16 v[158:159], v12 offset:4832
    s_waitcnt lgkmcnt(10)
    v_mfma_f32_16x16x32_bf16 v[80:83], v[168:171], v[16:19], 0
    ds_read_b64_tr_b16 v[160:161], v12 offset:256
    v_mfma_f32_16x16x32_bf16 v[84:87], v[168:171], v[20:23], 0
    ds_read_b64_tr_b16 v[162:163], v12 offset:4864
    s_waitcnt lgkmcnt(10)
    v_mfma_f32_16x16x32_bf16 v[88:91], v[172:175], v[16:19], 0
    ds_read_b64_tr_b16 v[164:165], v12 offset:9216
    v_mfma_f32_16x16x32_bf16 v[92:95], v[172:175], v[20:23], 0
    ds_read_b64_tr_b16 v[166:167], v12 offset:13824
    s_waitcnt lgkmcnt(10)
    v_mfma_f32_16x16x32_bf16 v[96:99], v[144:147], v[16:19], 0
    ds_read_b64_tr_b16 v[168:169], v12 offset:9248
    v_mfma_f32_16x16x32_bf16 v[100:103], v[144:147], v[20:23], 0
    ds_read_b64_tr_b16 v[170:171], v12 offset:13856
    s_waitcnt lgkmcnt(10)
    v_mfma_f32_16x16x32_bf16 v[104:107], v[148:151], v[16:19], 0
    ds_read_b64_tr_b16 v[172:173], v12 offset:9280
    v_mfma_f32_16x16x32_bf16 v[108:111], v[148:151], v[20:23], 0
    ds_read_b64_tr_b16 v[174:175], v12 offset:13888
    s_barrier
    s_waitcnt lgkmcnt(10)
    v_mfma_f32_16x16x32_bf16 v[112:115], v[152:155], v[16:19], 0
    ds_read_b64_tr_b16 v[144:145], v12 offset:9312
    v_mfma_f32_16x16x32_bf16 v[116:119], v[152:155], v[20:23], 0
    ds_read_b64_tr_b16 v[146:147], v12 offset:13920
    s_waitcnt lgkmcnt(10)
    v_mfma_f32_16x16x32_bf16 v[120:123], v[156:159], v[16:19], 0
    ds_read_b64_tr_b16 v[148:149], v12 offset:9344
    v_mfma_f32_16x16x32_bf16 v[124:127], v[156:159], v[20:23], 0
    ds_read_b64_tr_b16 v[150:151], v12 offset:13952
    s_waitcnt lgkmcnt(10)
    v_mfma_f32_16x16x32_bf16 v[128:131], v[160:163], v[16:19], 0
    ds_read_b64_tr_b16 v[152:153], v12 offset:9376
    v_mfma_f32_16x16x32_bf16 v[132:135], v[160:163], v[20:23], 0
    ds_read_b64_tr_b16 v[154:155], v12 offset:13984
    s_add_u32 s43, s41, 148480
    buffer_store_dwordx4 v[228:231], v3, s[32:35], s43 offen sc1
    s_waitcnt lgkmcnt(10)
    v_mfma_f32_16x16x32_bf16 v[64:67], v[164:167], v[24:27], v[64:67]
    ds_read_b64_tr_b16 v[156:157], v12 offset:9408
    v_mfma_f32_16x16x32_bf16 v[68:71], v[164:167], v[28:31], v[68:71]
    ds_read_b64_tr_b16 v[158:159], v12 offset:14016
    s_waitcnt lgkmcnt(10)
    v_mfma_f32_16x16x32_bf16 v[72:75], v[168:171], v[24:27], v[72:75]
    ds_read_b64_tr_b16 v[160:161], v12 offset:9440
    ds_read_b64_tr_b16 v[162:163], v12 offset:14048
    v_mfma_f32_16x16x32_bf16 v[76:79], v[168:171], v[28:31], v[76:79]
    ds_read_b128 v[32:35], v7 offset:0
    s_waitcnt lgkmcnt(11)
    v_mfma_f32_16x16x32_bf16 v[80:83], v[172:175], v[24:27], v[80:83]
    ds_read_b64_tr_b16 v[164:165], v12 offset:9472
    v_mfma_f32_16x16x32_bf16 v[84:87], v[172:175], v[28:31], v[84:87]
    ds_read_b64_tr_b16 v[166:167], v12 offset:14080
    s_waitcnt lgkmcnt(11)
    v_mfma_f32_16x16x32_bf16 v[88:91], v[144:147], v[24:27], v[88:91]
    ds_read_b64_tr_b16 v[168:169], v12 offset:18432
    ds_read_b64_tr_b16 v[170:171], v12 offset:23040
    v_mfma_f32_16x16x32_bf16 v[92:95], v[144:147], v[28:31], v[92:95]
    ds_read_b128 v[36:39], v7 offset:1024
    s_waitcnt lgkmcnt(12)
    v_mfma_f32_16x16x32_bf16 v[96:99], v[148:151], v[24:27], v[96:99]
    ds_read_b64_tr_b16 v[172:173], v12 offset:18464
    v_mfma_f32_16x16x32_bf16 v[100:103], v[148:151], v[28:31], v[100:103]
    ds_read_b64_tr_b16 v[174:175], v12 offset:23072
    s_waitcnt lgkmcnt(12)
    v_mfma_f32_16x16x32_bf16 v[104:107], v[152:155], v[24:27], v[104:107]
    ds_read_b64_tr_b16 v[144:145], v12 offset:18496
    ds_read_b64_tr_b16 v[146:147], v12 offset:23104
    v_mfma_f32_16x16x32_bf16 v[108:111], v[152:155], v[28:31], v[108:111]
    ds_read_b128 v[40:43], v7 offset:8192
    s_waitcnt lgkmcnt(13)
    v_mfma_f32_16x16x32_bf16 v[112:115], v[156:159], v[24:27], v[112:115]
    ds_read_b64_tr_b16 v[148:149], v12 offset:18528
    v_mfma_f32_16x16x32_bf16 v[116:119], v[156:159], v[28:31], v[116:119]
    ds_read_b64_tr_b16 v[150:151], v12 offset:23136
    s_waitcnt lgkmcnt(13)
    v_mfma_f32_16x16x32_bf16 v[120:123], v[160:163], v[24:27], v[120:123]
    ds_read_b64_tr_b16 v[152:153], v12 offset:18560
    ds_read_b64_tr_b16 v[154:155], v12 offset:23168
    v_mfma_f32_16x16x32_bf16 v[124:127], v[160:163], v[28:31], v[124:127]
    ds_read_b128 v[44:47], v7 offset:9216
    s_add_u32 s43, s41, 295936
    buffer_store_dwordx4 v[232:235], v3, s[32:35], s43 offen sc1
    s_waitcnt lgkmcnt(13)
    v_mfma_f32_16x16x32_bf16 v[128:131], v[164:167], v[24:27], v[128:131]
    ds_read_b64_tr_b16 v[156:157], v12 offset:18592
    v_mfma_f32_16x16x32_bf16 v[132:135], v[164:167], v[28:31], v[132:135]
    ds_read_b64_tr_b16 v[158:159], v12 offset:23200
    s_waitcnt lgkmcnt(13)
    s_waitcnt lgkmcnt(12)
    v_mfma_f32_16x16x32_bf16 v[64:67], v[168:171], v[32:35], v[64:67]
    ds_read_b64_tr_b16 v[160:161], v12 offset:18624
    v_mfma_f32_16x16x32_bf16 v[68:71], v[168:171], v[36:39], v[68:71]
    ds_read_b64_tr_b16 v[162:163], v12 offset:23232
    s_waitcnt lgkmcnt(12)
    v_mfma_f32_16x16x32_bf16 v[72:75], v[172:175], v[32:35], v[72:75]
    ds_read_b64_tr_b16 v[164:165], v12 offset:18656
    v_mfma_f32_16x16x32_bf16 v[76:79], v[172:175], v[36:39], v[76:79]
    ds_read_b64_tr_b16 v[166:167], v12 offset:23264
    s_waitcnt lgkmcnt(12)
    v_mfma_f32_16x16x32_bf16 v[80:83], v[144:147], v[32:35], v[80:83]
    ds_read_b64_tr_b16 v[168:169], v12 offset:18688
    v_mfma_f32_16x16x32_bf16 v[84:87], v[144:147], v[36:39], v[84:87]
    ds_read_b64_tr_b16 v[170:171], v12 offset:23296
    s_waitcnt lgkmcnt(11)
    v_mfma_f32_16x16x32_bf16 v[88:91], v[148:151], v[32:35], v[88:91]
    ds_read_b64_tr_b16 v[172:173], v12 offset:27648
    v_mfma_f32_16x16x32_bf16 v[92:95], v[148:151], v[36:39], v[92:95]
    ds_read_b64_tr_b16 v[174:175], v12 offset:32256
    s_waitcnt lgkmcnt(11)
    v_mfma_f32_16x16x32_bf16 v[96:99], v[152:155], v[32:35], v[96:99]
    ds_read_b64_tr_b16 v[144:145], v12 offset:27680
    v_mfma_f32_16x16x32_bf16 v[100:103], v[152:155], v[36:39], v[100:103]
    ds_read_b64_tr_b16 v[146:147], v12 offset:32288
    s_waitcnt lgkmcnt(10)
    v_mfma_f32_16x16x32_bf16 v[104:107], v[156:159], v[32:35], v[104:107]
    ds_read_b64_tr_b16 v[148:149], v12 offset:27712
    v_mfma_f32_16x16x32_bf16 v[108:111], v[156:159], v[36:39], v[108:111]
    ds_read_b64_tr_b16 v[150:151], v12 offset:32320
    s_barrier
    s_waitcnt lgkmcnt(10)
    v_mfma_f32_16x16x32_bf16 v[112:115], v[160:163], v[32:35], v[112:115]
    ds_read_b64_tr_b16 v[152:153], v12 offset:27744
    v_mfma_f32_16x16x32_bf16 v[116:119], v[160:163], v[36:39], v[116:119]
    ds_read_b64_tr_b16 v[154:155], v12 offset:32352
    s_add_u32 s43, s41, 443392
    buffer_store_dwordx4 v[236:239], v3, s[32:35], s43 offen sc1
    s_waitcnt lgkmcnt(10)
    v_mfma_f32_16x16x32_bf16 v[120:123], v[164:167], v[32:35], v[120:123]
    ds_read_b64_tr_b16 v[156:157], v12 offset:27776
    v_mfma_f32_16x16x32_bf16 v[124:127], v[164:167], v[36:39], v[124:127]
    ds_read_b64_tr_b16 v[158:159], v12 offset:32384
    s_waitcnt lgkmcnt(10)
    v_mfma_f32_16x16x32_bf16 v[128:131], v[168:171], v[32:35], v[128:131]
    ds_read_b64_tr_b16 v[160:161], v12 offset:27808
    v_mfma_f32_16x16x32_bf16 v[132:135], v[168:171], v[36:39], v[132:135]
    ds_read_b64_tr_b16 v[162:163], v12 offset:32416
    s_waitcnt lgkmcnt(10)
    v_mfma_f32_16x16x32_bf16 v[64:67], v[172:175], v[40:43], v[64:67]
    ds_read_b64_tr_b16 v[164:165], v12 offset:27840
    v_mfma_f32_16x16x32_bf16 v[68:71], v[172:175], v[44:47], v[68:71]
    ds_read_b64_tr_b16 v[166:167], v12 offset:32448
    s_waitcnt lgkmcnt(10)
    v_mfma_f32_16x16x32_bf16 v[72:75], v[144:147], v[40:43], v[72:75]
    ds_read_b64_tr_b16 v[168:169], v12 offset:27872
    ds_read_b64_tr_b16 v[170:171], v12 offset:32480
    v_mfma_f32_16x16x32_bf16 v[76:79], v[144:147], v[44:47], v[76:79]
    ds_read_b128 v[16:19], v7 offset:16384
    s_waitcnt lgkmcnt(11)
    v_mfma_f32_16x16x32_bf16 v[80:83], v[148:151], v[40:43], v[80:83]
    ds_read_b64_tr_b16 v[172:173], v12 offset:27904
    v_mfma_f32_16x16x32_bf16 v[84:87], v[148:151], v[44:47], v[84:87]
    ds_read_b64_tr_b16 v[174:175], v12 offset:32512
    s_waitcnt lgkmcnt(11)
    v_mfma_f32_16x16x32_bf16 v[88:91], v[152:155], v[40:43], v[88:91]
    ds_read_b64_tr_b16 v[144:145], v13 offset:4096
    ds_read_b64_tr_b16 v[146:147], v13 offset:8704
    v_mfma_f32_16x16x32_bf16 v[92:95], v[152:155], v[44:47], v[92:95]
    ds_read_b128 v[20:23], v7 offset:17408
    s_waitcnt lgkmcnt(12)
    v_mfma_f32_16x16x32_bf16 v[96:99], v[156:159], v[40:43], v[96:99]
    ds_read_b64_tr_b16 v[148:149], v13 offset:4128
    v_mfma_f32_16x16x32_bf16 v[100:103], v[156:159], v[44:47], v[100:103]
    ds_read_b64_tr_b16 v[150:151], v13 offset:8736
    s_waitcnt lgkmcnt(12)
    v_mfma_f32_16x16x32_bf16 v[104:107], v[160:163], v[40:43], v[104:107]
    ds_read_b64_tr_b16 v[152:153], v13 offset:4160
    ds_read_b64_tr_b16 v[154:155], v13 offset:8768
    v_mfma_f32_16x16x32_bf16 v[108:111], v[160:163], v[44:47], v[108:111]
    ds_read_b128 v[24:27], v7 offset:24576
    s_add_u32 s43, s41, 0
    buffer_store_dwordx4 v[208:211], v3, s[32:35], s43 offen sc1
    s_waitcnt lgkmcnt(13)
    v_mfma_f32_16x16x32_bf16 v[112:115], v[164:167], v[40:43], v[112:115]
    ds_read_b64_tr_b16 v[156:157], v13 offset:4192
    v_mfma_f32_16x16x32_bf16 v[116:119], v[164:167], v[44:47], v[116:119]
    ds_read_b64_tr_b16 v[158:159], v13 offset:8800
    s_waitcnt lgkmcnt(13)
    v_mfma_f32_16x16x32_bf16 v[120:123], v[168:171], v[40:43], v[120:123]
    ds_read_b64_tr_b16 v[160:161], v13 offset:4224
    ds_read_b64_tr_b16 v[162:163], v13 offset:8832
    v_mfma_f32_16x16x32_bf16 v[124:127], v[168:171], v[44:47], v[124:127]
    ds_read_b128 v[28:31], v7 offset:25600
    s_waitcnt lgkmcnt(13)
    v_mfma_f32_16x16x32_bf16 v[128:131], v[172:175], v[40:43], v[128:131]
    ds_read_b64_tr_b16 v[164:165], v13 offset:4256
    v_mfma_f32_16x16x32_bf16 v[132:135], v[172:175], v[44:47], v[132:135]
    ds_read_b64_tr_b16 v[166:167], v13 offset:8864
    s_waitcnt lgkmcnt(13)
    s_waitcnt lgkmcnt(12)
    v_mfma_f32_16x16x32_bf16 v[64:67], v[144:147], v[16:19], v[64:67]
    ds_read_b64_tr_b16 v[168:169], v13 offset:4288
    v_mfma_f32_16x16x32_bf16 v[68:71], v[144:147], v[20:23], v[68:71]
    ds_read_b64_tr_b16 v[170:171], v13 offset:8896
    s_waitcnt lgkmcnt(12)
    v_mfma_f32_16x16x32_bf16 v[72:75], v[148:151], v[16:19], v[72:75]
    ds_read_b64_tr_b16 v[172:173], v13 offset:4320
    v_mfma_f32_16x16x32_bf16 v[76:79], v[148:151], v[20:23], v[76:79]
    ds_read_b64_tr_b16 v[174:175], v13 offset:8928
    s_waitcnt lgkmcnt(12)
    v_mfma_f32_16x16x32_bf16 v[80:83], v[152:155], v[16:19], v[80:83]
    ds_read_b64_tr_b16 v[144:145], v13 offset:4352
    v_mfma_f32_16x16x32_bf16 v[84:87], v[152:155], v[20:23], v[84:87]
    ds_read_b64_tr_b16 v[146:147], v13 offset:8960
    s_waitcnt lgkmcnt(11)
    v_mfma_f32_16x16x32_bf16 v[88:91], v[156:159], v[16:19], v[88:91]
    ds_read_b64_tr_b16 v[148:149], v13 offset:13312
    v_mfma_f32_16x16x32_bf16 v[92:95], v[156:159], v[20:23], v[92:95]
    ds_read_b64_tr_b16 v[150:151], v13 offset:17920
    s_waitcnt lgkmcnt(11)
    v_mfma_f32_16x16x32_bf16 v[96:99], v[160:163], v[16:19], v[96:99]
    ds_read_b64_tr_b16 v[152:153], v13 offset:13344
    v_mfma_f32_16x16x32_bf16 v[100:103], v[160:163], v[20:23], v[100:103]
    ds_read_b64_tr_b16 v[154:155], v13 offset:17952
    s_add_u32 s43, s41, 147456
    buffer_store_dwordx4 v[212:215], v3, s[32:35], s43 offen sc1
    s_waitcnt lgkmcnt(10)
    v_mfma_f32_16x16x32_bf16 v[104:107], v[164:167], v[16:19], v[104:107]
    ds_read_b64_tr_b16 v[156:157], v13 offset:13376
    v_mfma_f32_16x16x32_bf16 v[108:111], v[164:167], v[20:23], v[108:111]
    ds_read_b64_tr_b16 v[158:159], v13 offset:17984
    s_barrier
    s_waitcnt lgkmcnt(10)
    v_mfma_f32_16x16x32_bf16 v[112:115], v[168:171], v[16:19], v[112:115]
    ds_read_b64_tr_b16 v[160:161], v13 offset:13408
    v_mfma_f32_16x16x32_bf16 v[116:119], v[168:171], v[20:23], v[116:119]
    ds_read_b64_tr_b16 v[162:163], v13 offset:18016
    s_waitcnt lgkmcnt(10)
    v_mfma_f32_16x16x32_bf16 v[120:123], v[172:175], v[16:19], v[120:123]
    ds_read_b64_tr_b16 v[164:165], v13 offset:13440
    v_mfma_f32_16x16x32_bf16 v[124:127], v[172:175], v[20:23], v[124:127]
    ds_read_b64_tr_b16 v[166:167], v13 offset:18048
    s_waitcnt lgkmcnt(10)
    v_mfma_f32_16x16x32_bf16 v[128:131], v[144:147], v[16:19], v[128:131]
    ds_read_b64_tr_b16 v[168:169], v13 offset:13472
    v_mfma_f32_16x16x32_bf16 v[132:135], v[144:147], v[20:23], v[132:135]
    ds_read_b64_tr_b16 v[170:171], v13 offset:18080
    s_waitcnt lgkmcnt(10)
    v_mfma_f32_16x16x32_bf16 v[64:67], v[148:151], v[24:27], v[64:67]
    ds_read_b64_tr_b16 v[172:173], v13 offset:13504
    v_mfma_f32_16x16x32_bf16 v[68:71], v[148:151], v[28:31], v[68:71]
    ds_read_b64_tr_b16 v[174:175], v13 offset:18112
    s_waitcnt lgkmcnt(10)
    v_mfma_f32_16x16x32_bf16 v[72:75], v[152:155], v[24:27], v[72:75]
    ds_read_b64_tr_b16 v[144:145], v13 offset:13536
    ds_read_b64_tr_b16 v[146:147], v13 offset:18144
    v_mfma_f32_16x16x32_bf16 v[76:79], v[152:155], v[28:31], v[76:79]
    ds_read_b128 v[32:35], v7 offset:32768
    s_waitcnt lgkmcnt(11)
    v_mfma_f32_16x16x32_bf16 v[80:83], v[156:159], v[24:27], v[80:83]
    ds_read_b64_tr_b16 v[148:149], v13 offset:13568
    v_mfma_f32_16x16x32_bf16 v[84:87], v[156:159], v[28:31], v[84:87]
    ds_read_b64_tr_b16 v[150:151], v13 offset:18176
    s_waitcnt lgkmcnt(11)
    v_mfma_f32_16x16x32_bf16 v[88:91], v[160:163], v[24:27], v[88:91]
    ds_read_b64_tr_b16 v[152:153], v13 offset:22528
    ds_read_b64_tr_b16 v[154:155], v13 offset:27136
    v_mfma_f32_16x16x32_bf16 v[92:95], v[160:163], v[28:31], v[92:95]
    ds_read_b128 v[36:39], v7 offset:33792
    s_add_u32 s43, s41, 294912
    buffer_store_dwordx4 v[216:219], v3, s[32:35], s43 offen sc1
    s_waitcnt lgkmcnt(12)
    v_mfma_f32_16x16x32_bf16 v[96:99], v[164:167], v[24:27], v[96:99]
    ds_read_b64_tr_b16 v[156:157], v13 offset:22560
    v_mfma_f32_16x16x32_bf16 v[100:103], v[164:167], v[28:31], v[100:103]
    ds_read_b64_tr_b16 v[158:159], v13 offset:27168
    s_waitcnt lgkmcnt(12)
    v_mfma_f32_16x16x32_bf16 v[104:107], v[168:171], v[24:27], v[104:107]
    ds_read_b64_tr_b16 v[160:161], v13 offset:22592
    ds_read_b64_tr_b16 v[162:163], v13 offset:27200
    v_mfma_f32_16x16x32_bf16 v[108:111], v[168:171], v[28:31], v[108:111]
    ds_read_b128 v[40:43], v7 offset:40960
    s_waitcnt lgkmcnt(13)
    v_mfma_f32_16x16x32_bf16 v[112:115], v[172:175], v[24:27], v[112:115]
    ds_read_b64_tr_b16 v[164:165], v13 offset:22624
    v_mfma_f32_16x16x32_bf16 v[116:119], v[172:175], v[28:31], v[116:119]
    ds_read_b64_tr_b16 v[166:167], v13 offset:27232
    s_waitcnt lgkmcnt(13)
    v_mfma_f32_16x16x32_bf16 v[120:123], v[144:147], v[24:27], v[120:123]
    ds_read_b64_tr_b16 v[168:169], v13 offset:22656
    ds_read_b64_tr_b16 v[170:171], v13 offset:27264
    v_mfma_f32_16x16x32_bf16 v[124:127], v[144:147], v[28:31], v[124:127]
    ds_read_b128 v[44:47], v7 offset:41984
    s_waitcnt lgkmcnt(13)
    v_mfma_f32_16x16x32_bf16 v[128:131], v[148:151], v[24:27], v[128:131]
    ds_read_b64_tr_b16 v[172:173], v13 offset:22688
    v_mfma_f32_16x16x32_bf16 v[132:135], v[148:151], v[28:31], v[132:135]
    ds_read_b64_tr_b16 v[174:175], v13 offset:27296
    s_waitcnt lgkmcnt(13)
    s_waitcnt lgkmcnt(12)
    v_mfma_f32_16x16x32_bf16 v[64:67], v[152:155], v[32:35], v[64:67]
    ds_read_b64_tr_b16 v[144:145], v13 offset:22720
    v_mfma_f32_16x16x32_bf16 v[68:71], v[152:155], v[36:39], v[68:71]
    ds_read_b64_tr_b16 v[146:147], v13 offset:27328
    s_waitcnt lgkmcnt(12)
    v_mfma_f32_16x16x32_bf16 v[72:75], v[156:159], v[32:35], v[72:75]
    ds_read_b64_tr_b16 v[148:149], v13 offset:22752
    v_mfma_f32_16x16x32_bf16 v[76:79], v[156:159], v[36:39], v[76:79]
    ds_read_b64_tr_b16 v[150:151], v13 offset:27360
    s_waitcnt lgkmcnt(12)
    v_mfma_f32_16x16x32_bf16 v[80:83], v[160:163], v[32:35], v[80:83]
    ds_read_b64_tr_b16 v[152:153], v13 offset:22784
    v_mfma_f32_16x16x32_bf16 v[84:87], v[160:163], v[36:39], v[84:87]
    ds_read_b64_tr_b16 v[154:155], v13 offset:27392
    s_add_u32 s43, s41, 442368
    buffer_store_dwordx4 v[220:223], v3, s[32:35], s43 offen sc1
    s_waitcnt lgkmcnt(11)
    v_mfma_f32_16x16x32_bf16 v[88:91], v[164:167], v[32:35], v[88:91]
    ds_read_b64_tr_b16 v[156:157], v13 offset:31744
    v_mfma_f32_16x16x32_bf16 v[92:95], v[164:167], v[36:39], v[92:95]
    ds_read_b64_tr_b16 v[158:159], v13 offset:36352
    s_waitcnt lgkmcnt(11)
    v_mfma_f32_16x16x32_bf16 v[96:99], v[168:171], v[32:35], v[96:99]
    ds_read_b64_tr_b16 v[160:161], v13 offset:31776
    v_mfma_f32_16x16x32_bf16 v[100:103], v[168:171], v[36:39], v[100:103]
    ds_read_b64_tr_b16 v[162:163], v13 offset:36384
    s_waitcnt lgkmcnt(10)
    v_mfma_f32_16x16x32_bf16 v[104:107], v[172:175], v[32:35], v[104:107]
    ds_read_b64_tr_b16 v[164:165], v13 offset:31808
    v_mfma_f32_16x16x32_bf16 v[108:111], v[172:175], v[36:39], v[108:111]
    ds_read_b64_tr_b16 v[166:167], v13 offset:36416
    s_barrier
    s_waitcnt lgkmcnt(10)
    v_mfma_f32_16x16x32_bf16 v[112:115], v[144:147], v[32:35], v[112:115]
    ds_read_b64_tr_b16 v[168:169], v13 offset:31840
    v_mfma_f32_16x16x32_bf16 v[116:119], v[144:147], v[36:39], v[116:119]
    ds_read_b64_tr_b16 v[170:171], v13 offset:36448
    s_waitcnt lgkmcnt(10)
    v_mfma_f32_16x16x32_bf16 v[120:123], v[148:151], v[32:35], v[120:123]
    ds_read_b64_tr_b16 v[172:173], v13 offset:31872
    v_mfma_f32_16x16x32_bf16 v[124:127], v[148:151], v[36:39], v[124:127]
    ds_read_b64_tr_b16 v[174:175], v13 offset:36480
    s_waitcnt lgkmcnt(10)
    v_mfma_f32_16x16x32_bf16 v[128:131], v[152:155], v[32:35], v[128:131]
    ds_read_b64_tr_b16 v[144:145], v13 offset:31904
    v_mfma_f32_16x16x32_bf16 v[132:135], v[152:155], v[36:39], v[132:135]
    ds_read_b64_tr_b16 v[146:147], v13 offset:36512
    s_waitcnt lgkmcnt(10)
    v_mfma_f32_16x16x32_bf16 v[64:67], v[156:159], v[40:43], v[64:67]
    ds_read_b64_tr_b16 v[148:149], v13 offset:31936
    v_mfma_f32_16x16x32_bf16 v[68:71], v[156:159], v[44:47], v[68:71]
    ds_read_b64_tr_b16 v[150:151], v13 offset:36544
    s_waitcnt lgkmcnt(10)
    v_mfma_f32_16x16x32_bf16 v[72:75], v[160:163], v[40:43], v[72:75]
    ds_read_b64_tr_b16 v[152:153], v13 offset:31968
    ds_read_b64_tr_b16 v[154:155], v13 offset:36576
    v_mfma_f32_16x16x32_bf16 v[76:79], v[160:163], v[44:47], v[76:79]
    ds_read_b128 v[16:19], v6 offset:0
    s_waitcnt lgkmcnt(11)
    v_mfma_f32_16x16x32_bf16 v[80:83], v[164:167], v[40:43], v[80:83]
    ds_read_b64_tr_b16 v[156:157], v13 offset:32000
    v_mfma_f32_16x16x32_bf16 v[84:87], v[164:167], v[44:47], v[84:87]
    ds_read_b64_tr_b16 v[158:159], v13 offset:36608
    s_waitcnt lgkmcnt(11)
    v_mfma_f32_16x16x32_bf16 v[88:91], v[168:171], v[40:43], v[88:91]
    ds_read_b64_tr_b16 v[160:161], v12 offset:0
    ds_read_b64_tr_b16 v[162:163], v12 offset:4608
    v_mfma_f32_16x16x32_bf16 v[92:95], v[168:171], v[44:47], v[92:95]
    ds_read_b128 v[20:23], v6 offset:1024
    s_waitcnt lgkmcnt(12)
    v_mfma_f32_16x16x32_bf16 v[96:99], v[172:175], v[40:43], v[96:99]
    ds_read_b64_tr_b16 v[164:165], v12 offset:32
    v_mfma_f32_16x16x32_bf16 v[100:103], v[172:175], v[44:47], v[100:103]
    ds_read_b64_tr_b16 v[166:167], v12 offset:4640
    s_waitcnt lgkmcnt(12)
    v_mfma_f32_16x16x32_bf16 v[104:107], v[144:147], v[40:43], v[104:107]
    ds_read_b64_tr_b16 v[168:169], v12 offset:64
    ds_read_b64_tr_b16 v[170:171], v12 offset:4672
    v_mfma_f32_16x16x32_bf16 v[108:111], v[144:147], v[44:47], v[108:111]
    ds_read_b128 v[24:27], v6 offset:8192
    s_waitcnt lgkmcnt(13)
    v_mfma_f32_16x16x32_bf16 v[112:115], v[148:151], v[40:43], v[112:115]
    ds_read_b64_tr_b16 v[172:173], v12 offset:96
    v_mfma_f32_16x16x32_bf16 v[116:119], v[148:151], v[44:47], v[116:119]
    ds_read_b64_tr_b16 v[174:175], v12 offset:4704
    s_waitcnt lgkmcnt(13)
    v_mfma_f32_16x16x32_bf16 v[120:123], v[152:155], v[40:43], v[120:123]
    ds_read_b64_tr_b16 v[144:145], v12 offset:128
    ds_read_b64_tr_b16 v[146:147], v12 offset:4736
    v_mfma_f32_16x16x32_bf16 v[124:127], v[152:155], v[44:47], v[124:127]
    ds_read_b128 v[28:31], v6 offset:9216
    s_waitcnt lgkmcnt(13)
    v_mfma_f32_16x16x32_bf16 v[128:131], v[156:159], v[40:43], v[128:131]
    ds_read_b64_tr_b16 v[148:149], v12 offset:160
    v_mfma_f32_16x16x32_bf16 v[132:135], v[156:159], v[44:47], v[132:135]
    ds_read_b64_tr_b16 v[150:151], v12 offset:4768
    s_waitcnt lgkmcnt(13)
    s_waitcnt lgkmcnt(12)
    v_mfma_f32_16x16x32_bf16 v[64:67], v[160:163], v[16:19], v[64:67]
    ds_read_b64_tr_b16 v[152:153], v12 offset:192
    v_mfma_f32_16x16x32_bf16 v[68:71], v[160:163], v[20:23], v[68:71]
    ds_read_b64_tr_b16 v[154:155], v12 offset:4800
    s_waitcnt lgkmcnt(12)
    v_mfma_f32_16x16x32_bf16 v[72:75], v[164:167], v[16:19], v[72:75]
    ds_read_b64_tr_b16 v[156:157], v12 offset:224
    v_mfma_f32_16x16x32_bf16 v[76:79], v[164:167], v[20:23], v[76:79]
    ds_read_b64_tr_b16 v[158:159], v12 offset:4832
    s_waitcnt lgkmcnt(12)
    v_mfma_f32_16x16x32_bf16 v[80:83], v[168:171], v[16:19], v[80:83]
    ds_read_b64_tr_b16 v[160:161], v12 offset:256
    v_mfma_f32_16x16x32_bf16 v[84:87], v[168:171], v[20:23], v[84:87]
    ds_read_b64_tr_b16 v[162:163], v12 offset:4864
    s_waitcnt lgkmcnt(11)
    v_mfma_f32_16x16x32_bf16 v[88:91], v[172:175], v[16:19], v[88:91]
    ds_read_b64_tr_b16 v[164:165], v12 offset:9216
    v_mfma_f32_16x16x32_bf16 v[92:95], v[172:175], v[20:23], v[92:95]
    ds_read_b64_tr_b16 v[166:167], v12 offset:13824
    s_waitcnt lgkmcnt(11)
    v_mfma_f32_16x16x32_bf16 v[96:99], v[144:147], v[16:19], v[96:99]
    ds_read_b64_tr_b16 v[168:169], v12 offset:9248
    v_mfma_f32_16x16x32_bf16 v[100:103], v[144:147], v[20:23], v[100:103]
    ds_read_b64_tr_b16 v[170:171], v12 offset:13856
    s_waitcnt lgkmcnt(10)
    v_mfma_f32_16x16x32_bf16 v[104:107], v[148:151], v[16:19], v[104:107]
    ds_read_b64_tr_b16 v[172:173], v12 offset:9280
    v_mfma_f32_16x16x32_bf16 v[108:111], v[148:151], v[20:23], v[108:111]
    ds_read_b64_tr_b16 v[174:175], v12 offset:13888
    s_barrier
    s_waitcnt lgkmcnt(10)
    v_mfma_f32_16x16x32_bf16 v[112:115], v[152:155], v[16:19], v[112:115]
    ds_read_b64_tr_b16 v[144:145], v12 offset:9312
    v_mfma_f32_16x16x32_bf16 v[116:119], v[152:155], v[20:23], v[116:119]
    ds_read_b64_tr_b16 v[146:147], v12 offset:13920
    s_waitcnt lgkmcnt(10)
    v_mfma_f32_16x16x32_bf16 v[120:123], v[156:159], v[16:19], v[120:123]
    ds_read_b64_tr_b16 v[148:149], v12 offset:9344
    v_mfma_f32_16x16x32_bf16 v[124:127], v[156:159], v[20:23], v[124:127]
    ds_read_b64_tr_b16 v[150:151], v12 offset:13952
    s_waitcnt lgkmcnt(10)
    v_mfma_f32_16x16x32_bf16 v[128:131], v[160:163], v[16:19], v[128:131]
    ds_read_b64_tr_b16 v[152:153], v12 offset:9376
    v_mfma_f32_16x16x32_bf16 v[132:135], v[160:163], v[20:23], v[132:135]
    ds_read_b64_tr_b16 v[154:155], v12 offset:13984
    s_waitcnt lgkmcnt(10)
    v_mfma_f32_16x16x32_bf16 v[64:67], v[164:167], v[24:27], v[64:67]
    ds_read_b64_tr_b16 v[156:157], v12 offset:9408
    v_mfma_f32_16x16x32_bf16 v[68:71], v[164:167], v[28:31], v[68:71]
    ds_read_b64_tr_b16 v[158:159], v12 offset:14016
    s_waitcnt lgkmcnt(10)
    v_mfma_f32_16x16x32_bf16 v[72:75], v[168:171], v[24:27], v[72:75]
    ds_read_b64_tr_b16 v[160:161], v12 offset:9440
    ds_read_b64_tr_b16 v[162:163], v12 offset:14048
    v_mfma_f32_16x16x32_bf16 v[76:79], v[168:171], v[28:31], v[76:79]
    ds_read_b128 v[32:35], v6 offset:16384
    s_waitcnt lgkmcnt(11)
    v_mfma_f32_16x16x32_bf16 v[80:83], v[172:175], v[24:27], v[80:83]
    ds_read_b64_tr_b16 v[164:165], v12 offset:9472
    v_mfma_f32_16x16x32_bf16 v[84:87], v[172:175], v[28:31], v[84:87]
    ds_read_b64_tr_b16 v[166:167], v12 offset:14080
    s_waitcnt lgkmcnt(11)
    v_mfma_f32_16x16x32_bf16 v[88:91], v[144:147], v[24:27], v[88:91]
    ds_read_b64_tr_b16 v[168:169], v12 offset:18432
    ds_read_b64_tr_b16 v[170:171], v12 offset:23040
    v_mfma_f32_16x16x32_bf16 v[92:95], v[144:147], v[28:31], v[92:95]
    ds_read_b128 v[36:39], v6 offset:17408
    s_waitcnt lgkmcnt(12)
    v_mfma_f32_16x16x32_bf16 v[96:99], v[148:151], v[24:27], v[96:99]
    ds_read_b64_tr_b16 v[172:173], v12 offset:18464
    v_mfma_f32_16x16x32_bf16 v[100:103], v[148:151], v[28:31], v[100:103]
    ds_read_b64_tr_b16 v[174:175], v12 offset:23072
    s_waitcnt lgkmcnt(12)
    v_mfma_f32_16x16x32_bf16 v[104:107], v[152:155], v[24:27], v[104:107]
    ds_read_b64_tr_b16 v[144:145], v12 offset:18496
    ds_read_b64_tr_b16 v[146:147], v12 offset:23104
    v_mfma_f32_16x16x32_bf16 v[108:111], v[152:155], v[28:31], v[108:111]
    ds_read_b128 v[40:43], v6 offset:24576
    s_waitcnt lgkmcnt(13)
    v_mfma_f32_16x16x32_bf16 v[112:115], v[156:159], v[24:27], v[112:115]
    ds_read_b64_tr_b16 v[148:149], v12 offset:18528
    v_mfma_f32_16x16x32_bf16 v[116:119], v[156:159], v[28:31], v[116:119]
    ds_read_b64_tr_b16 v[150:151], v12 offset:23136
    s_waitcnt lgkmcnt(13)
    v_mfma_f32_16x16x32_bf16 v[120:123], v[160:163], v[24:27], v[120:123]
    ds_read_b64_tr_b16 v[152:153], v12 offset:18560
    ds_read_b64_tr_b16 v[154:155], v12 offset:23168
    v_mfma_f32_16x16x32_bf16 v[124:127], v[160:163], v[28:31], v[124:127]
    ds_read_b128 v[44:47], v6 offset:25600
    s_waitcnt lgkmcnt(13)
    v_mfma_f32_16x16x32_bf16 v[128:131], v[164:167], v[24:27], v[128:131]
    ds_read_b64_tr_b16 v[156:157], v12 offset:18592
    v_mfma_f32_16x16x32_bf16 v[132:135], v[164:167], v[28:31], v[132:135]
    ds_read_b64_tr_b16 v[158:159], v12 offset:23200
    s_waitcnt lgkmcnt(13)
    s_waitcnt lgkmcnt(12)
    v_mfma_f32_16x16x32_bf16 v[64:67], v[168:171], v[32:35], v[64:67]
    ds_read_b64_tr_b16 v[160:161], v12 offset:18624
    v_mfma_f32_16x16x32_bf16 v[68:71], v[168:171], v[36:39], v[68:71]
    ds_read_b64_tr_b16 v[162:163], v12 offset:23232
    s_waitcnt lgkmcnt(12)
    v_mfma_f32_16x16x32_bf16 v[72:75], v[172:175], v[32:35], v[72:75]
    ds_read_b64_tr_b16 v[164:165], v12 offset:18656
    v_mfma_f32_16x16x32_bf16 v[76:79], v[172:175], v[36:39], v[76:79]
    ds_read_b64_tr_b16 v[166:167], v12 offset:23264
    s_waitcnt lgkmcnt(12)
    v_mfma_f32_16x16x32_bf16 v[80:83], v[144:147], v[32:35], v[80:83]
    ds_read_b64_tr_b16 v[168:169], v12 offset:18688
    v_mfma_f32_16x16x32_bf16 v[84:87], v[144:147], v[36:39], v[84:87]
    ds_read_b64_tr_b16 v[170:171], v12 offset:23296
    s_waitcnt lgkmcnt(11)
    v_mfma_f32_16x16x32_bf16 v[88:91], v[148:151], v[32:35], v[88:91]
    ds_read_b64_tr_b16 v[172:173], v12 offset:27648
    v_mfma_f32_16x16x32_bf16 v[92:95], v[148:151], v[36:39], v[92:95]
    ds_read_b64_tr_b16 v[174:175], v12 offset:32256
    s_waitcnt lgkmcnt(11)
    v_mfma_f32_16x16x32_bf16 v[96:99], v[152:155], v[32:35], v[96:99]
    ds_read_b64_tr_b16 v[144:145], v12 offset:27680
    v_mfma_f32_16x16x32_bf16 v[100:103], v[152:155], v[36:39], v[100:103]
    ds_read_b64_tr_b16 v[146:147], v12 offset:32288
    s_waitcnt lgkmcnt(10)
    v_mfma_f32_16x16x32_bf16 v[104:107], v[156:159], v[32:35], v[104:107]
    ds_read_b64_tr_b16 v[148:149], v12 offset:27712
    v_mfma_f32_16x16x32_bf16 v[108:111], v[156:159], v[36:39], v[108:111]
    ds_read_b64_tr_b16 v[150:151], v12 offset:32320
    s_waitcnt vmcnt(0)
    s_barrier
    s_waitcnt lgkmcnt(10)
    v_mfma_f32_16x16x32_bf16 v[112:115], v[160:163], v[32:35], v[112:115]
    ds_read_b64_tr_b16 v[152:153], v12 offset:27744
    v_mfma_f32_16x16x32_bf16 v[116:119], v[160:163], v[36:39], v[116:119]
    ds_read_b64_tr_b16 v[154:155], v12 offset:32352
    s_waitcnt lgkmcnt(10)
    v_mfma_f32_16x16x32_bf16 v[120:123], v[164:167], v[32:35], v[120:123]
    ds_read_b64_tr_b16 v[156:157], v12 offset:27776
    v_mfma_f32_16x16x32_bf16 v[124:127], v[164:167], v[36:39], v[124:127]
    ds_read_b64_tr_b16 v[158:159], v12 offset:32384
    s_waitcnt lgkmcnt(10)
    v_mfma_f32_16x16x32_bf16 v[128:131], v[168:171], v[32:35], v[128:131]
    ds_read_b64_tr_b16 v[160:161], v12 offset:27808
    v_mfma_f32_16x16x32_bf16 v[132:135], v[168:171], v[36:39], v[132:135]
    ds_read_b64_tr_b16 v[162:163], v12 offset:32416
    s_waitcnt lgkmcnt(10)
    v_mfma_f32_16x16x32_bf16 v[64:67], v[172:175], v[40:43], v[64:67]
    ds_read_b64_tr_b16 v[164:165], v12 offset:27840
    v_mfma_f32_16x16x32_bf16 v[68:71], v[172:175], v[44:47], v[68:71]
    ds_read_b64_tr_b16 v[166:167], v12 offset:32448
    s_waitcnt lgkmcnt(10)
    v_mfma_f32_16x16x32_bf16 v[72:75], v[144:147], v[40:43], v[72:75]
    ds_read_b64_tr_b16 v[168:169], v12 offset:27872
    ds_read_b64_tr_b16 v[170:171], v12 offset:32480
    v_mfma_f32_16x16x32_bf16 v[76:79], v[144:147], v[44:47], v[76:79]
    ds_read_b128 v[16:19], v7 offset:0
    s_waitcnt lgkmcnt(11)
    v_mfma_f32_16x16x32_bf16 v[80:83], v[148:151], v[40:43], v[80:83]
    ds_read_b64_tr_b16 v[172:173], v12 offset:27904
    v_mfma_f32_16x16x32_bf16 v[84:87], v[148:151], v[44:47], v[84:87]
    ds_read_b64_tr_b16 v[174:175], v12 offset:32512
    s_waitcnt lgkmcnt(11)
    v_mfma_f32_16x16x32_bf16 v[88:91], v[152:155], v[40:43], v[88:91]
    ds_read_b64_tr_b16 v[144:145], v13 offset:4096
    ds_read_b64_tr_b16 v[146:147], v13 offset:8704
    v_mfma_f32_16x16x32_bf16 v[92:95], v[152:155], v[44:47], v[92:95]
    ds_read_b128 v[20:23], v7 offset:1024
    s_waitcnt lgkmcnt(12)
    v_mfma_f32_16x16x32_bf16 v[96:99], v[156:159], v[40:43], v[96:99]
    ds_read_b64_tr_b16 v[148:149], v13 offset:4128
    v_mfma_f32_16x16x32_bf16 v[100:103], v[156:159], v[44:47], v[100:103]
    ds_read_b64_tr_b16 v[150:151], v13 offset:8736
    s_waitcnt lgkmcnt(12)
    v_mfma_f32_16x16x32_bf16 v[104:107], v[160:163], v[40:43], v[104:107]
    ds_read_b64_tr_b16 v[152:153], v13 offset:4160
    ds_read_b64_tr_b16 v[154:155], v13 offset:8768
    v_mfma_f32_16x16x32_bf16 v[108:111], v[160:163], v[44:47], v[108:111]
    ds_read_b128 v[24:27], v7 offset:8192
    s_waitcnt lgkmcnt(13)
    v_mfma_f32_16x16x32_bf16 v[112:115], v[164:167], v[40:43], v[112:115]
    ds_read_b64_tr_b16 v[156:157], v13 offset:4192
    v_mfma_f32_16x16x32_bf16 v[116:119], v[164:167], v[44:47], v[116:119]
    ds_read_b64_tr_b16 v[158:159], v13 offset:8800
    s_waitcnt lgkmcnt(13)
    v_mfma_f32_16x16x32_bf16 v[120:123], v[168:171], v[40:43], v[120:123]
    ds_read_b64_tr_b16 v[160:161], v13 offset:4224
    ds_read_b64_tr_b16 v[162:163], v13 offset:8832
    v_mfma_f32_16x16x32_bf16 v[124:127], v[168:171], v[44:47], v[124:127]
    ds_read_b128 v[28:31], v7 offset:9216
    s_waitcnt lgkmcnt(13)
    v_mfma_f32_16x16x32_bf16 v[128:131], v[172:175], v[40:43], v[128:131]
    ds_read_b64_tr_b16 v[164:165], v13 offset:4256
    v_mfma_f32_16x16x32_bf16 v[132:135], v[172:175], v[44:47], v[132:135]
    ds_read_b64_tr_b16 v[166:167], v13 offset:8864
    s_waitcnt lgkmcnt(13)
    s_waitcnt lgkmcnt(12)
    v_mfma_f32_16x16x32_bf16 v[64:67], v[144:147], v[16:19], v[64:67]
    ds_read_b64_tr_b16 v[168:169], v13 offset:4288
    v_mfma_f32_16x16x32_bf16 v[68:71], v[144:147], v[20:23], v[68:71]
    ds_read_b64_tr_b16 v[170:171], v13 offset:8896
    s_waitcnt lgkmcnt(12)
    v_mfma_f32_16x16x32_bf16 v[72:75], v[148:151], v[16:19], v[72:75]
    ds_read_b64_tr_b16 v[172:173], v13 offset:4320
    v_mfma_f32_16x16x32_bf16 v[76:79], v[148:151], v[20:23], v[76:79]
    ds_read_b64_tr_b16 v[174:175], v13 offset:8928
    s_waitcnt lgkmcnt(12)
    v_mfma_f32_16x16x32_bf16 v[80:83], v[152:155], v[16:19], v[80:83]
    ds_read_b64_tr_b16 v[144:145], v13 offset:4352
    v_mfma_f32_16x16x32_bf16 v[84:87], v[152:155], v[20:23], v[84:87]
    ds_read_b64_tr_b16 v[146:147], v13 offset:8960
    s_waitcnt lgkmcnt(11)
    v_mfma_f32_16x16x32_bf16 v[88:91], v[156:159], v[16:19], v[88:91]
    ds_read_b64_tr_b16 v[148:149], v13 offset:13312
    v_mfma_f32_16x16x32_bf16 v[92:95], v[156:159], v[20:23], v[92:95]
    ds_read_b64_tr_b16 v[150:151], v13 offset:17920
    s_waitcnt lgkmcnt(11)
    v_mfma_f32_16x16x32_bf16 v[96:99], v[160:163], v[16:19], v[96:99]
    ds_read_b64_tr_b16 v[152:153], v13 offset:13344
    v_mfma_f32_16x16x32_bf16 v[100:103], v[160:163], v[20:23], v[100:103]
    ds_read_b64_tr_b16 v[154:155], v13 offset:17952
    s_waitcnt lgkmcnt(10)
    v_mfma_f32_16x16x32_bf16 v[104:107], v[164:167], v[16:19], v[104:107]
    ds_read_b64_tr_b16 v[156:157], v13 offset:13376
    v_mfma_f32_16x16x32_bf16 v[108:111], v[164:167], v[20:23], v[108:111]
    ds_read_b64_tr_b16 v[158:159], v13 offset:17984
    s_barrier
    s_waitcnt lgkmcnt(10)
    v_mfma_f32_16x16x32_bf16 v[112:115], v[168:171], v[16:19], v[112:115]
    ds_read_b64_tr_b16 v[160:161], v13 offset:13408
    v_mfma_f32_16x16x32_bf16 v[116:119], v[168:171], v[20:23], v[116:119]
    ds_read_b64_tr_b16 v[162:163], v13 offset:18016
    s_waitcnt lgkmcnt(10)
    v_mfma_f32_16x16x32_bf16 v[120:123], v[172:175], v[16:19], v[120:123]
    ds_read_b64_tr_b16 v[164:165], v13 offset:13440
    v_mfma_f32_16x16x32_bf16 v[124:127], v[172:175], v[20:23], v[124:127]
    ds_read_b64_tr_b16 v[166:167], v13 offset:18048
    s_waitcnt lgkmcnt(10)
    v_mfma_f32_16x16x32_bf16 v[128:131], v[144:147], v[16:19], v[128:131]
    ds_read_b64_tr_b16 v[168:169], v13 offset:13472
    v_mfma_f32_16x16x32_bf16 v[132:135], v[144:147], v[20:23], v[132:135]
    ds_read_b64_tr_b16 v[170:171], v13 offset:18080
    s_waitcnt lgkmcnt(10)
    v_mfma_f32_16x16x32_bf16 v[64:67], v[148:151], v[24:27], v[64:67]
    ds_read_b64_tr_b16 v[172:173], v13 offset:13504
    v_mfma_f32_16x16x32_bf16 v[68:71], v[148:151], v[28:31], v[68:71]
    ds_read_b64_tr_b16 v[174:175], v13 offset:18112
    s_waitcnt lgkmcnt(10)
    v_mfma_f32_16x16x32_bf16 v[72:75], v[152:155], v[24:27], v[72:75]
    ds_read_b64_tr_b16 v[144:145], v13 offset:13536
    ds_read_b64_tr_b16 v[146:147], v13 offset:18144
    v_mfma_f32_16x16x32_bf16 v[76:79], v[152:155], v[28:31], v[76:79]
    ds_read_b128 v[32:35], v7 offset:16384
    s_waitcnt lgkmcnt(11)
    v_mfma_f32_16x16x32_bf16 v[80:83], v[156:159], v[24:27], v[80:83]
    ds_read_b64_tr_b16 v[148:149], v13 offset:13568
    v_mfma_f32_16x16x32_bf16 v[84:87], v[156:159], v[28:31], v[84:87]
    ds_read_b64_tr_b16 v[150:151], v13 offset:18176
    s_waitcnt lgkmcnt(11)
    v_mfma_f32_16x16x32_bf16 v[88:91], v[160:163], v[24:27], v[88:91]
    ds_read_b64_tr_b16 v[152:153], v13 offset:22528
    ds_read_b64_tr_b16 v[154:155], v13 offset:27136
    v_mfma_f32_16x16x32_bf16 v[92:95], v[160:163], v[28:31], v[92:95]
    ds_read_b128 v[36:39], v7 offset:17408
    s_waitcnt lgkmcnt(12)
    v_mfma_f32_16x16x32_bf16 v[96:99], v[164:167], v[24:27], v[96:99]
    ds_read_b64_tr_b16 v[156:157], v13 offset:22560
    v_mfma_f32_16x16x32_bf16 v[100:103], v[164:167], v[28:31], v[100:103]
    ds_read_b64_tr_b16 v[158:159], v13 offset:27168
    s_waitcnt lgkmcnt(12)
    v_mfma_f32_16x16x32_bf16 v[104:107], v[168:171], v[24:27], v[104:107]
    ds_read_b64_tr_b16 v[160:161], v13 offset:22592
    ds_read_b64_tr_b16 v[162:163], v13 offset:27200
    v_mfma_f32_16x16x32_bf16 v[108:111], v[168:171], v[28:31], v[108:111]
    ds_read_b128 v[40:43], v7 offset:24576
    s_waitcnt lgkmcnt(13)
    v_mfma_f32_16x16x32_bf16 v[112:115], v[172:175], v[24:27], v[112:115]
    ds_read_b64_tr_b16 v[164:165], v13 offset:22624
    v_mfma_f32_16x16x32_bf16 v[116:119], v[172:175], v[28:31], v[116:119]
    ds_read_b64_tr_b16 v[166:167], v13 offset:27232
    s_waitcnt lgkmcnt(13)
    v_mfma_f32_16x16x32_bf16 v[120:123], v[144:147], v[24:27], v[120:123]
    ds_read_b64_tr_b16 v[168:169], v13 offset:22656
    ds_read_b64_tr_b16 v[170:171], v13 offset:27264
    v_mfma_f32_16x16x32_bf16 v[124:127], v[144:147], v[28:31], v[124:127]
    ds_read_b128 v[44:47], v7 offset:25600
    s_waitcnt lgkmcnt(13)
    v_mfma_f32_16x16x32_bf16 v[128:131], v[148:151], v[24:27], v[128:131]
    ds_read_b64_tr_b16 v[172:173], v13 offset:22688
    v_mfma_f32_16x16x32_bf16 v[132:135], v[148:151], v[28:31], v[132:135]
    ds_read_b64_tr_b16 v[174:175], v13 offset:27296
    s_waitcnt lgkmcnt(13)
    s_waitcnt lgkmcnt(12)
    v_mfma_f32_16x16x32_bf16 v[64:67], v[152:155], v[32:35], v[64:67]
    ds_read_b64_tr_b16 v[144:145], v13 offset:22720
    v_mfma_f32_16x16x32_bf16 v[68:71], v[152:155], v[36:39], v[68:71]
    ds_read_b64_tr_b16 v[146:147], v13 offset:27328
    s_waitcnt lgkmcnt(12)
    v_mfma_f32_16x16x32_bf16 v[72:75], v[156:159], v[32:35], v[72:75]
    ds_read_b64_tr_b16 v[148:149], v13 offset:22752
    v_mfma_f32_16x16x32_bf16 v[76:79], v[156:159], v[36:39], v[76:79]
    ds_read_b64_tr_b16 v[150:151], v13 offset:27360
    s_waitcnt lgkmcnt(12)
    v_mfma_f32_16x16x32_bf16 v[80:83], v[160:163], v[32:35], v[80:83]
    ds_read_b64_tr_b16 v[152:153], v13 offset:22784
    v_mfma_f32_16x16x32_bf16 v[84:87], v[160:163], v[36:39], v[84:87]
    ds_read_b64_tr_b16 v[154:155], v13 offset:27392
    s_waitcnt lgkmcnt(11)
    v_mfma_f32_16x16x32_bf16 v[88:91], v[164:167], v[32:35], v[88:91]
    ds_read_b64_tr_b16 v[156:157], v13 offset:31744
    v_mfma_f32_16x16x32_bf16 v[92:95], v[164:167], v[36:39], v[92:95]
    ds_read_b64_tr_b16 v[158:159], v13 offset:36352
    s_waitcnt lgkmcnt(11)
    v_mfma_f32_16x16x32_bf16 v[96:99], v[168:171], v[32:35], v[96:99]
    ds_read_b64_tr_b16 v[160:161], v13 offset:31776
    v_mfma_f32_16x16x32_bf16 v[100:103], v[168:171], v[36:39], v[100:103]
    ds_read_b64_tr_b16 v[162:163], v13 offset:36384
    s_waitcnt lgkmcnt(10)
    v_mfma_f32_16x16x32_bf16 v[104:107], v[172:175], v[32:35], v[104:107]
    ds_read_b64_tr_b16 v[164:165], v13 offset:31808
    v_mfma_f32_16x16x32_bf16 v[108:111], v[172:175], v[36:39], v[108:111]
    ds_read_b64_tr_b16 v[166:167], v13 offset:36416
    s_barrier
    s_waitcnt lgkmcnt(10)
    v_mfma_f32_16x16x32_bf16 v[112:115], v[144:147], v[32:35], v[112:115]
    ds_read_b64_tr_b16 v[168:169], v13 offset:31840
    v_mfma_f32_16x16x32_bf16 v[116:119], v[144:147], v[36:39], v[116:119]
    ds_read_b64_tr_b16 v[170:171], v13 offset:36448
    s_waitcnt lgkmcnt(10)
    v_mfma_f32_16x16x32_bf16 v[120:123], v[148:151], v[32:35], v[120:123]
    ds_read_b64_tr_b16 v[172:173], v13 offset:31872
    v_mfma_f32_16x16x32_bf16 v[124:127], v[148:151], v[36:39], v[124:127]
    ds_read_b64_tr_b16 v[174:175], v13 offset:36480
    s_waitcnt lgkmcnt(10)
    v_mfma_f32_16x16x32_bf16 v[128:131], v[152:155], v[32:35], v[128:131]
    ds_read_b64_tr_b16 v[144:145], v13 offset:31904
    v_mfma_f32_16x16x32_bf16 v[132:135], v[152:155], v[36:39], v[132:135]
    ds_read_b64_tr_b16 v[146:147], v13 offset:36512
    s_waitcnt lgkmcnt(10)
    v_mfma_f32_16x16x32_bf16 v[64:67], v[156:159], v[40:43], v[64:67]
    ds_read_b64_tr_b16 v[148:149], v13 offset:31936
    v_mfma_f32_16x16x32_bf16 v[68:71], v[156:159], v[44:47], v[68:71]
    ds_read_b64_tr_b16 v[150:151], v13 offset:36544
    s_waitcnt lgkmcnt(10)
    v_mfma_f32_16x16x32_bf16 v[72:75], v[160:163], v[40:43], v[72:75]
    ds_read_b64_tr_b16 v[152:153], v13 offset:31968
    ds_read_b64_tr_b16 v[154:155], v13 offset:36576
    v_mfma_f32_16x16x32_bf16 v[76:79], v[160:163], v[44:47], v[76:79]
    ds_read_b128 v[16:19], v7 offset:32768
    s_waitcnt lgkmcnt(11)
    v_mfma_f32_16x16x32_bf16 v[80:83], v[164:167], v[40:43], v[80:83]
    ds_read_b64_tr_b16 v[156:157], v13 offset:32000
    v_mfma_f32_16x16x32_bf16 v[84:87], v[164:167], v[44:47], v[84:87]
    ds_read_b64_tr_b16 v[158:159], v13 offset:36608
    s_waitcnt lgkmcnt(11)
    v_mfma_f32_16x16x32_bf16 v[88:91], v[168:171], v[40:43], v[88:91]
    ds_read_b64_tr_b16 v[160:161], v12 offset:0
    ds_read_b64_tr_b16 v[162:163], v12 offset:4608
    v_mfma_f32_16x16x32_bf16 v[92:95], v[168:171], v[44:47], v[92:95]
    ds_read_b128 v[20:23], v7 offset:33792
    s_waitcnt lgkmcnt(12)
    v_mfma_f32_16x16x32_bf16 v[96:99], v[172:175], v[40:43], v[96:99]
    ds_read_b64_tr_b16 v[164:165], v12 offset:32
    v_mfma_f32_16x16x32_bf16 v[100:103], v[172:175], v[44:47], v[100:103]
    ds_read_b64_tr_b16 v[166:167], v12 offset:4640
    s_waitcnt lgkmcnt(12)
    v_mfma_f32_16x16x32_bf16 v[104:107], v[144:147], v[40:43], v[104:107]
    ds_read_b64_tr_b16 v[168:169], v12 offset:64
    ds_read_b64_tr_b16 v[170:171], v12 offset:4672
    v_mfma_f32_16x16x32_bf16 v[108:111], v[144:147], v[44:47], v[108:111]
    ds_read_b128 v[24:27], v7 offset:40960
    s_waitcnt lgkmcnt(13)
    v_mfma_f32_16x16x32_bf16 v[112:115], v[148:151], v[40:43], v[112:115]
    ds_read_b64_tr_b16 v[172:173], v12 offset:96
    v_mfma_f32_16x16x32_bf16 v[116:119], v[148:151], v[44:47], v[116:119]
    ds_read_b64_tr_b16 v[174:175], v12 offset:4704
    s_waitcnt lgkmcnt(13)
    v_mfma_f32_16x16x32_bf16 v[120:123], v[152:155], v[40:43], v[120:123]
    ds_read_b64_tr_b16 v[144:145], v12 offset:128
    ds_read_b64_tr_b16 v[146:147], v12 offset:4736
    v_mfma_f32_16x16x32_bf16 v[124:127], v[152:155], v[44:47], v[124:127]
    ds_read_b128 v[28:31], v7 offset:41984
    s_waitcnt lgkmcnt(13)
    v_mfma_f32_16x16x32_bf16 v[128:131], v[156:159], v[40:43], v[128:131]
    ds_read_b64_tr_b16 v[148:149], v12 offset:160
    v_mfma_f32_16x16x32_bf16 v[132:135], v[156:159], v[44:47], v[132:135]
    ds_read_b64_tr_b16 v[150:151], v12 offset:4768
    s_waitcnt lgkmcnt(13)
    s_waitcnt lgkmcnt(12)
    v_mfma_f32_16x16x32_bf16 v[64:67], v[160:163], v[16:19], v[64:67]
    ds_read_b64_tr_b16 v[152:153], v12 offset:192
    v_mfma_f32_16x16x32_bf16 v[68:71], v[160:163], v[20:23], v[68:71]
    ds_read_b64_tr_b16 v[154:155], v12 offset:4800
    s_waitcnt lgkmcnt(12)
    v_mfma_f32_16x16x32_bf16 v[72:75], v[164:167], v[16:19], v[72:75]
    ds_read_b64_tr_b16 v[156:157], v12 offset:224
    v_mfma_f32_16x16x32_bf16 v[76:79], v[164:167], v[20:23], v[76:79]
    ds_read_b64_tr_b16 v[158:159], v12 offset:4832
    s_waitcnt lgkmcnt(12)
    v_mfma_f32_16x16x32_bf16 v[80:83], v[168:171], v[16:19], v[80:83]
    ds_read_b64_tr_b16 v[160:161], v12 offset:256
    v_mfma_f32_16x16x32_bf16 v[84:87], v[168:171], v[20:23], v[84:87]
    ds_read_b64_tr_b16 v[162:163], v12 offset:4864
    s_waitcnt lgkmcnt(11)
    v_mfma_f32_16x16x32_bf16 v[88:91], v[172:175], v[16:19], v[88:91]
    ds_read_b64_tr_b16 v[164:165], v12 offset:9216
    v_mfma_f32_16x16x32_bf16 v[92:95], v[172:175], v[20:23], v[92:95]
    ds_read_b64_tr_b16 v[166:167], v12 offset:13824
    s_waitcnt lgkmcnt(11)
    v_mfma_f32_16x16x32_bf16 v[96:99], v[144:147], v[16:19], v[96:99]
    ds_read_b64_tr_b16 v[168:169], v12 offset:9248
    v_mfma_f32_16x16x32_bf16 v[100:103], v[144:147], v[20:23], v[100:103]
    ds_read_b64_tr_b16 v[170:171], v12 offset:13856
    s_waitcnt lgkmcnt(10)
    v_mfma_f32_16x16x32_bf16 v[104:107], v[148:151], v[16:19], v[104:107]
    ds_read_b64_tr_b16 v[172:173], v12 offset:9280
    v_mfma_f32_16x16x32_bf16 v[108:111], v[148:151], v[20:23], v[108:111]
    ds_read_b64_tr_b16 v[174:175], v12 offset:13888
    s_barrier
    s_waitcnt lgkmcnt(10)
    v_mfma_f32_16x16x32_bf16 v[112:115], v[152:155], v[16:19], v[112:115]
    ds_read_b64_tr_b16 v[144:145], v12 offset:9312
    v_mfma_f32_16x16x32_bf16 v[116:119], v[152:155], v[20:23], v[116:119]
    ds_read_b64_tr_b16 v[146:147], v12 offset:13920
    s_waitcnt lgkmcnt(10)
    v_mfma_f32_16x16x32_bf16 v[120:123], v[156:159], v[16:19], v[120:123]
    ds_read_b64_tr_b16 v[148:149], v12 offset:9344
    v_mfma_f32_16x16x32_bf16 v[124:127], v[156:159], v[20:23], v[124:127]
    ds_read_b64_tr_b16 v[150:151], v12 offset:13952
    s_waitcnt lgkmcnt(10)
    v_mfma_f32_16x16x32_bf16 v[128:131], v[160:163], v[16:19], v[128:131]
    ds_read_b64_tr_b16 v[152:153], v12 offset:9376
    v_mfma_f32_16x16x32_bf16 v[132:135], v[160:163], v[20:23], v[132:135]
    ds_read_b64_tr_b16 v[154:155], v12 offset:13984
    s_waitcnt lgkmcnt(10)
    v_mfma_f32_16x16x32_bf16 v[64:67], v[164:167], v[24:27], v[64:67]
    ds_read_b64_tr_b16 v[156:157], v12 offset:9408
    v_mfma_f32_16x16x32_bf16 v[68:71], v[164:167], v[28:31], v[68:71]
    ds_read_b64_tr_b16 v[158:159], v12 offset:14016
    s_waitcnt lgkmcnt(10)
    v_mfma_f32_16x16x32_bf16 v[72:75], v[168:171], v[24:27], v[72:75]
    ds_read_b64_tr_b16 v[160:161], v12 offset:9440
    ds_read_b64_tr_b16 v[162:163], v12 offset:14048
    v_mfma_f32_16x16x32_bf16 v[76:79], v[168:171], v[28:31], v[76:79]
    ds_read_b128 v[32:35], v6 offset:0
    s_waitcnt lgkmcnt(11)
    v_mfma_f32_16x16x32_bf16 v[80:83], v[172:175], v[24:27], v[80:83]
    ds_read_b64_tr_b16 v[164:165], v12 offset:9472
    v_mfma_f32_16x16x32_bf16 v[84:87], v[172:175], v[28:31], v[84:87]
    ds_read_b64_tr_b16 v[166:167], v12 offset:14080
    s_waitcnt lgkmcnt(11)
    v_mfma_f32_16x16x32_bf16 v[88:91], v[144:147], v[24:27], v[88:91]
    ds_read_b64_tr_b16 v[168:169], v12 offset:18432
    ds_read_b64_tr_b16 v[170:171], v12 offset:23040
    v_mfma_f32_16x16x32_bf16 v[92:95], v[144:147], v[28:31], v[92:95]
    ds_read_b128 v[36:39], v6 offset:1024
    s_waitcnt lgkmcnt(12)
    v_mfma_f32_16x16x32_bf16 v[96:99], v[148:151], v[24:27], v[96:99]
    ds_read_b64_tr_b16 v[172:173], v12 offset:18464
    v_mfma_f32_16x16x32_bf16 v[100:103], v[148:151], v[28:31], v[100:103]
    ds_read_b64_tr_b16 v[174:175], v12 offset:23072
    s_waitcnt lgkmcnt(12)
    v_mfma_f32_16x16x32_bf16 v[104:107], v[152:155], v[24:27], v[104:107]
    ds_read_b64_tr_b16 v[144:145], v12 offset:18496
    ds_read_b64_tr_b16 v[146:147], v12 offset:23104
    v_mfma_f32_16x16x32_bf16 v[108:111], v[152:155], v[28:31], v[108:111]
    ds_read_b128 v[40:43], v6 offset:8192
    s_waitcnt lgkmcnt(13)
    v_mfma_f32_16x16x32_bf16 v[112:115], v[156:159], v[24:27], v[112:115]
    ds_read_b64_tr_b16 v[148:149], v12 offset:18528
    v_mfma_f32_16x16x32_bf16 v[116:119], v[156:159], v[28:31], v[116:119]
    ds_read_b64_tr_b16 v[150:151], v12 offset:23136
    s_waitcnt lgkmcnt(13)
    v_mfma_f32_16x16x32_bf16 v[120:123], v[160:163], v[24:27], v[120:123]
    ds_read_b64_tr_b16 v[152:153], v12 offset:18560
    ds_read_b64_tr_b16 v[154:155], v12 offset:23168
    v_mfma_f32_16x16x32_bf16 v[124:127], v[160:163], v[28:31], v[124:127]
    ds_read_b128 v[44:47], v6 offset:9216
    s_waitcnt lgkmcnt(13)
    v_mfma_f32_16x16x32_bf16 v[128:131], v[164:167], v[24:27], v[128:131]
    ds_read_b64_tr_b16 v[156:157], v12 offset:18592
    v_mfma_f32_16x16x32_bf16 v[132:135], v[164:167], v[28:31], v[132:135]
    ds_read_b64_tr_b16 v[158:159], v12 offset:23200
    s_waitcnt lgkmcnt(13)
    s_waitcnt lgkmcnt(12)
    v_mfma_f32_16x16x32_bf16 v[64:67], v[168:171], v[32:35], v[64:67]
    ds_read_b64_tr_b16 v[160:161], v12 offset:18624
    v_mfma_f32_16x16x32_bf16 v[68:71], v[168:171], v[36:39], v[68:71]
    ds_read_b64_tr_b16 v[162:163], v12 offset:23232
    s_waitcnt lgkmcnt(12)
    v_mfma_f32_16x16x32_bf16 v[72:75], v[172:175], v[32:35], v[72:75]
    ds_read_b64_tr_b16 v[164:165], v12 offset:18656
    v_mfma_f32_16x16x32_bf16 v[76:79], v[172:175], v[36:39], v[76:79]
    ds_read_b64_tr_b16 v[166:167], v12 offset:23264
    s_waitcnt lgkmcnt(12)
    v_mfma_f32_16x16x32_bf16 v[80:83], v[144:147], v[32:35], v[80:83]
    ds_read_b64_tr_b16 v[168:169], v12 offset:18688
    v_mfma_f32_16x16x32_bf16 v[84:87], v[144:147], v[36:39], v[84:87]
    ds_read_b64_tr_b16 v[170:171], v12 offset:23296
    s_waitcnt lgkmcnt(11)
    v_mfma_f32_16x16x32_bf16 v[88:91], v[148:151], v[32:35], v[88:91]
    ds_read_b64_tr_b16 v[172:173], v12 offset:27648
    v_mfma_f32_16x16x32_bf16 v[92:95], v[148:151], v[36:39], v[92:95]
    ds_read_b64_tr_b16 v[174:175], v12 offset:32256
    s_waitcnt lgkmcnt(11)
    v_mfma_f32_16x16x32_bf16 v[96:99], v[152:155], v[32:35], v[96:99]
    ds_read_b64_tr_b16 v[144:145], v12 offset:27680
    v_mfma_f32_16x16x32_bf16 v[100:103], v[152:155], v[36:39], v[100:103]
    ds_read_b64_tr_b16 v[146:147], v12 offset:32288
    s_waitcnt lgkmcnt(10)
    v_mfma_f32_16x16x32_bf16 v[104:107], v[156:159], v[32:35], v[104:107]
    ds_read_b64_tr_b16 v[148:149], v12 offset:27712
    v_mfma_f32_16x16x32_bf16 v[108:111], v[156:159], v[36:39], v[108:111]
    ds_read_b64_tr_b16 v[150:151], v12 offset:32320
    s_barrier
    s_waitcnt lgkmcnt(10)
    v_mfma_f32_16x16x32_bf16 v[112:115], v[160:163], v[32:35], v[112:115]
    ds_read_b64_tr_b16 v[152:153], v12 offset:27744
    v_mfma_f32_16x16x32_bf16 v[116:119], v[160:163], v[36:39], v[116:119]
    ds_read_b64_tr_b16 v[154:155], v12 offset:32352
    s_waitcnt lgkmcnt(10)
    v_mfma_f32_16x16x32_bf16 v[120:123], v[164:167], v[32:35], v[120:123]
    ds_read_b64_tr_b16 v[156:157], v12 offset:27776
    v_mfma_f32_16x16x32_bf16 v[124:127], v[164:167], v[36:39], v[124:127]
    ds_read_b64_tr_b16 v[158:159], v12 offset:32384
    s_waitcnt lgkmcnt(10)
    v_mfma_f32_16x16x32_bf16 v[128:131], v[168:171], v[32:35], v[128:131]
    ds_read_b64_tr_b16 v[160:161], v12 offset:27808
    v_mfma_f32_16x16x32_bf16 v[132:135], v[168:171], v[36:39], v[132:135]
    ds_read_b64_tr_b16 v[162:163], v12 offset:32416
    s_waitcnt lgkmcnt(10)
    v_mfma_f32_16x16x32_bf16 v[64:67], v[172:175], v[40:43], v[64:67]
    ds_read_b64_tr_b16 v[164:165], v12 offset:27840
    v_mfma_f32_16x16x32_bf16 v[68:71], v[172:175], v[44:47], v[68:71]
    ds_read_b64_tr_b16 v[166:167], v12 offset:32448
    s_waitcnt lgkmcnt(10)
    v_mfma_f32_16x16x32_bf16 v[72:75], v[144:147], v[40:43], v[72:75]
    ds_read_b64_tr_b16 v[168:169], v12 offset:27872
    ds_read_b64_tr_b16 v[170:171], v12 offset:32480
    v_mfma_f32_16x16x32_bf16 v[76:79], v[144:147], v[44:47], v[76:79]
    ds_read_b128 v[16:19], v6 offset:16384
    s_waitcnt lgkmcnt(11)
    v_mfma_f32_16x16x32_bf16 v[80:83], v[148:151], v[40:43], v[80:83]
    ds_read_b64_tr_b16 v[172:173], v12 offset:27904
    v_mfma_f32_16x16x32_bf16 v[84:87], v[148:151], v[44:47], v[84:87]
    ds_read_b64_tr_b16 v[174:175], v12 offset:32512
    s_waitcnt lgkmcnt(11)
    v_mfma_f32_16x16x32_bf16 v[88:91], v[152:155], v[40:43], v[88:91]
    ds_read_b64_tr_b16 v[144:145], v13 offset:4096
    ds_read_b64_tr_b16 v[146:147], v13 offset:8704
    v_mfma_f32_16x16x32_bf16 v[92:95], v[152:155], v[44:47], v[92:95]
    ds_read_b128 v[20:23], v6 offset:17408
    s_waitcnt lgkmcnt(12)
    v_mfma_f32_16x16x32_bf16 v[96:99], v[156:159], v[40:43], v[96:99]
    ds_read_b64_tr_b16 v[148:149], v13 offset:4128
    v_mfma_f32_16x16x32_bf16 v[100:103], v[156:159], v[44:47], v[100:103]
    ds_read_b64_tr_b16 v[150:151], v13 offset:8736
    s_waitcnt lgkmcnt(12)
    v_mfma_f32_16x16x32_bf16 v[104:107], v[160:163], v[40:43], v[104:107]
    ds_read_b64_tr_b16 v[152:153], v13 offset:4160
    ds_read_b64_tr_b16 v[154:155], v13 offset:8768
    v_mfma_f32_16x16x32_bf16 v[108:111], v[160:163], v[44:47], v[108:111]
    ds_read_b128 v[24:27], v6 offset:24576
    s_waitcnt lgkmcnt(13)
    v_mfma_f32_16x16x32_bf16 v[112:115], v[164:167], v[40:43], v[112:115]
    ds_read_b64_tr_b16 v[156:157], v13 offset:4192
    v_mfma_f32_16x16x32_bf16 v[116:119], v[164:167], v[44:47], v[116:119]
    ds_read_b64_tr_b16 v[158:159], v13 offset:8800
    s_waitcnt lgkmcnt(13)
    v_mfma_f32_16x16x32_bf16 v[120:123], v[168:171], v[40:43], v[120:123]
    ds_read_b64_tr_b16 v[160:161], v13 offset:4224
    ds_read_b64_tr_b16 v[162:163], v13 offset:8832
    v_mfma_f32_16x16x32_bf16 v[124:127], v[168:171], v[44:47], v[124:127]
    ds_read_b128 v[28:31], v6 offset:25600
    s_waitcnt lgkmcnt(13)
    v_mfma_f32_16x16x32_bf16 v[128:131], v[172:175], v[40:43], v[128:131]
    ds_read_b64_tr_b16 v[164:165], v13 offset:4256
    v_mfma_f32_16x16x32_bf16 v[132:135], v[172:175], v[44:47], v[132:135]
    ds_read_b64_tr_b16 v[166:167], v13 offset:8864
    s_waitcnt lgkmcnt(13)
    s_waitcnt lgkmcnt(12)
    v_mfma_f32_16x16x32_bf16 v[64:67], v[144:147], v[16:19], v[64:67]
    ds_read_b64_tr_b16 v[168:169], v13 offset:4288
    v_mfma_f32_16x16x32_bf16 v[68:71], v[144:147], v[20:23], v[68:71]
    ds_read_b64_tr_b16 v[170:171], v13 offset:8896
    s_waitcnt lgkmcnt(12)
    v_mfma_f32_16x16x32_bf16 v[72:75], v[148:151], v[16:19], v[72:75]
    ds_read_b64_tr_b16 v[172:173], v13 offset:4320
    v_mfma_f32_16x16x32_bf16 v[76:79], v[148:151], v[20:23], v[76:79]
    ds_read_b64_tr_b16 v[174:175], v13 offset:8928
    s_waitcnt lgkmcnt(12)
    v_mfma_f32_16x16x32_bf16 v[80:83], v[152:155], v[16:19], v[80:83]
    ds_read_b64_tr_b16 v[144:145], v13 offset:4352
    v_mfma_f32_16x16x32_bf16 v[84:87], v[152:155], v[20:23], v[84:87]
    ds_read_b64_tr_b16 v[146:147], v13 offset:8960
    s_waitcnt lgkmcnt(11)
    v_mfma_f32_16x16x32_bf16 v[88:91], v[156:159], v[16:19], v[88:91]
    ds_read_b64_tr_b16 v[148:149], v13 offset:13312
    v_mfma_f32_16x16x32_bf16 v[92:95], v[156:159], v[20:23], v[92:95]
    ds_read_b64_tr_b16 v[150:151], v13 offset:17920
    s_waitcnt lgkmcnt(11)
    v_mfma_f32_16x16x32_bf16 v[96:99], v[160:163], v[16:19], v[96:99]
    ds_read_b64_tr_b16 v[152:153], v13 offset:13344
    v_mfma_f32_16x16x32_bf16 v[100:103], v[160:163], v[20:23], v[100:103]
    ds_read_b64_tr_b16 v[154:155], v13 offset:17952
    s_waitcnt lgkmcnt(10)
    v_mfma_f32_16x16x32_bf16 v[104:107], v[164:167], v[16:19], v[104:107]
    ds_read_b64_tr_b16 v[156:157], v13 offset:13376
    v_mfma_f32_16x16x32_bf16 v[108:111], v[164:167], v[20:23], v[108:111]
    ds_read_b64_tr_b16 v[158:159], v13 offset:17984
    s_barrier
    s_waitcnt lgkmcnt(10)
    v_mfma_f32_16x16x32_bf16 v[112:115], v[168:171], v[16:19], v[112:115]
    ds_read_b64_tr_b16 v[160:161], v13 offset:13408
    v_mfma_f32_16x16x32_bf16 v[116:119], v[168:171], v[20:23], v[116:119]
    ds_read_b64_tr_b16 v[162:163], v13 offset:18016
    s_waitcnt lgkmcnt(10)
    v_mfma_f32_16x16x32_bf16 v[120:123], v[172:175], v[16:19], v[120:123]
    ds_read_b64_tr_b16 v[164:165], v13 offset:13440
    v_mfma_f32_16x16x32_bf16 v[124:127], v[172:175], v[20:23], v[124:127]
    ds_read_b64_tr_b16 v[166:167], v13 offset:18048
    s_waitcnt lgkmcnt(10)
    v_mfma_f32_16x16x32_bf16 v[128:131], v[144:147], v[16:19], v[128:131]
    ds_read_b64_tr_b16 v[168:169], v13 offset:13472
    v_mfma_f32_16x16x32_bf16 v[132:135], v[144:147], v[20:23], v[132:135]
    ds_read_b64_tr_b16 v[170:171], v13 offset:18080
    s_waitcnt lgkmcnt(10)
    v_mfma_f32_16x16x32_bf16 v[64:67], v[148:151], v[24:27], v[64:67]
    ds_read_b64_tr_b16 v[172:173], v13 offset:13504
    v_mfma_f32_16x16x32_bf16 v[68:71], v[148:151], v[28:31], v[68:71]
    ds_read_b64_tr_b16 v[174:175], v13 offset:18112
    s_waitcnt lgkmcnt(10)
    v_mfma_f32_16x16x32_bf16 v[72:75], v[152:155], v[24:27], v[72:75]
    ds_read_b64_tr_b16 v[144:145], v13 offset:13536
    ds_read_b64_tr_b16 v[146:147], v13 offset:18144
    v_mfma_f32_16x16x32_bf16 v[76:79], v[152:155], v[28:31], v[76:79]
    ds_read_b128 v[32:35], v7 offset:0
    s_waitcnt lgkmcnt(11)
    v_mfma_f32_16x16x32_bf16 v[80:83], v[156:159], v[24:27], v[80:83]
    ds_read_b64_tr_b16 v[148:149], v13 offset:13568
    v_mfma_f32_16x16x32_bf16 v[84:87], v[156:159], v[28:31], v[84:87]
    ds_read_b64_tr_b16 v[150:151], v13 offset:18176
    s_waitcnt lgkmcnt(11)
    v_mfma_f32_16x16x32_bf16 v[88:91], v[160:163], v[24:27], v[88:91]
    ds_read_b64_tr_b16 v[152:153], v13 offset:22528
    ds_read_b64_tr_b16 v[154:155], v13 offset:27136
    v_mfma_f32_16x16x32_bf16 v[92:95], v[160:163], v[28:31], v[92:95]
    ds_read_b128 v[36:39], v7 offset:1024
    s_waitcnt lgkmcnt(12)
    v_mfma_f32_16x16x32_bf16 v[96:99], v[164:167], v[24:27], v[96:99]
    ds_read_b64_tr_b16 v[156:157], v13 offset:22560
    v_mfma_f32_16x16x32_bf16 v[100:103], v[164:167], v[28:31], v[100:103]
    ds_read_b64_tr_b16 v[158:159], v13 offset:27168
    s_waitcnt lgkmcnt(12)
    v_mfma_f32_16x16x32_bf16 v[104:107], v[168:171], v[24:27], v[104:107]
    ds_read_b64_tr_b16 v[160:161], v13 offset:22592
    ds_read_b64_tr_b16 v[162:163], v13 offset:27200
    v_mfma_f32_16x16x32_bf16 v[108:111], v[168:171], v[28:31], v[108:111]
    ds_read_b128 v[40:43], v7 offset:8192
    s_waitcnt lgkmcnt(13)
    v_mfma_f32_16x16x32_bf16 v[112:115], v[172:175], v[24:27], v[112:115]
    ds_read_b64_tr_b16 v[164:165], v13 offset:22624
    v_mfma_f32_16x16x32_bf16 v[116:119], v[172:175], v[28:31], v[116:119]
    ds_read_b64_tr_b16 v[166:167], v13 offset:27232
    s_waitcnt lgkmcnt(13)
    v_mfma_f32_16x16x32_bf16 v[120:123], v[144:147], v[24:27], v[120:123]
    ds_read_b64_tr_b16 v[168:169], v13 offset:22656
    ds_read_b64_tr_b16 v[170:171], v13 offset:27264
    v_mfma_f32_16x16x32_bf16 v[124:127], v[144:147], v[28:31], v[124:127]
    ds_read_b128 v[44:47], v7 offset:9216
    s_waitcnt lgkmcnt(13)
    v_mfma_f32_16x16x32_bf16 v[128:131], v[148:151], v[24:27], v[128:131]
    ds_read_b64_tr_b16 v[172:173], v13 offset:22688
    v_mfma_f32_16x16x32_bf16 v[132:135], v[148:151], v[28:31], v[132:135]
    ds_read_b64_tr_b16 v[174:175], v13 offset:27296
    s_waitcnt lgkmcnt(13)
    s_waitcnt lgkmcnt(12)
    v_mfma_f32_16x16x32_bf16 v[64:67], v[152:155], v[32:35], v[64:67]
    ds_read_b64_tr_b16 v[144:145], v13 offset:22720
    v_mfma_f32_16x16x32_bf16 v[68:71], v[152:155], v[36:39], v[68:71]
    ds_read_b64_tr_b16 v[146:147], v13 offset:27328
    s_waitcnt lgkmcnt(12)
    v_mfma_f32_16x16x32_bf16 v[72:75], v[156:159], v[32:35], v[72:75]
    ds_read_b64_tr_b16 v[148:149], v13 offset:22752
    v_mfma_f32_16x16x32_bf16 v[76:79], v[156:159], v[36:39], v[76:79]
    ds_read_b64_tr_b16 v[150:151], v13 offset:27360
    s_waitcnt lgkmcnt(12)
    v_mfma_f32_16x16x32_bf16 v[80:83], v[160:163], v[32:35], v[80:83]
    ds_read_b64_tr_b16 v[152:153], v13 offset:22784
    v_mfma_f32_16x16x32_bf16 v[84:87], v[160:163], v[36:39], v[84:87]
    ds_read_b64_tr_b16 v[154:155], v13 offset:27392
    s_waitcnt lgkmcnt(11)
    v_mfma_f32_16x16x32_bf16 v[88:91], v[164:167], v[32:35], v[88:91]
    ds_read_b64_tr_b16 v[156:157], v13 offset:31744
    v_mfma_f32_16x16x32_bf16 v[92:95], v[164:167], v[36:39], v[92:95]
    ds_read_b64_tr_b16 v[158:159], v13 offset:36352
    s_waitcnt lgkmcnt(11)
    v_mfma_f32_16x16x32_bf16 v[96:99], v[168:171], v[32:35], v[96:99]
    ds_read_b64_tr_b16 v[160:161], v13 offset:31776
    v_mfma_f32_16x16x32_bf16 v[100:103], v[168:171], v[36:39], v[100:103]
    ds_read_b64_tr_b16 v[162:163], v13 offset:36384
    s_waitcnt lgkmcnt(10)
    v_mfma_f32_16x16x32_bf16 v[104:107], v[172:175], v[32:35], v[104:107]
    ds_read_b64_tr_b16 v[164:165], v13 offset:31808
    v_mfma_f32_16x16x32_bf16 v[108:111], v[172:175], v[36:39], v[108:111]
    ds_read_b64_tr_b16 v[166:167], v13 offset:36416
    s_barrier
    s_waitcnt lgkmcnt(10)
    v_mfma_f32_16x16x32_bf16 v[112:115], v[144:147], v[32:35], v[112:115]
    ds_read_b64_tr_b16 v[168:169], v13 offset:31840
    v_mfma_f32_16x16x32_bf16 v[116:119], v[144:147], v[36:39], v[116:119]
    ds_read_b64_tr_b16 v[170:171], v13 offset:36448
    s_waitcnt lgkmcnt(10)
    v_mfma_f32_16x16x32_bf16 v[120:123], v[148:151], v[32:35], v[120:123]
    ds_read_b64_tr_b16 v[172:173], v13 offset:31872
    v_mfma_f32_16x16x32_bf16 v[124:127], v[148:151], v[36:39], v[124:127]
    ds_read_b64_tr_b16 v[174:175], v13 offset:36480
    s_waitcnt lgkmcnt(10)
    v_mfma_f32_16x16x32_bf16 v[128:131], v[152:155], v[32:35], v[128:131]
    ds_read_b64_tr_b16 v[144:145], v13 offset:31904
    v_mfma_f32_16x16x32_bf16 v[132:135], v[152:155], v[36:39], v[132:135]
    ds_read_b64_tr_b16 v[146:147], v13 offset:36512
    s_waitcnt lgkmcnt(10)
    v_mfma_f32_16x16x32_bf16 v[64:67], v[156:159], v[40:43], v[64:67]
    ds_read_b64_tr_b16 v[148:149], v13 offset:31936
    v_mfma_f32_16x16x32_bf16 v[68:71], v[156:159], v[44:47], v[68:71]
    ds_read_b64_tr_b16 v[150:151], v13 offset:36544
    s_waitcnt lgkmcnt(10)
    v_mfma_f32_16x16x32_bf16 v[72:75], v[160:163], v[40:43], v[72:75]
    ds_read_b64_tr_b16 v[152:153], v13 offset:31968
    ds_read_b64_tr_b16 v[154:155], v13 offset:36576
    v_mfma_f32_16x16x32_bf16 v[76:79], v[160:163], v[44:47], v[76:79]
    ds_read_b128 v[16:19], v7 offset:16384
    s_waitcnt lgkmcnt(11)
    v_mfma_f32_16x16x32_bf16 v[80:83], v[164:167], v[40:43], v[80:83]
    ds_read_b64_tr_b16 v[156:157], v13 offset:32000
    v_mfma_f32_16x16x32_bf16 v[84:87], v[164:167], v[44:47], v[84:87]
    ds_read_b64_tr_b16 v[158:159], v13 offset:36608
    s_waitcnt lgkmcnt(11)
    v_mfma_f32_16x16x32_bf16 v[88:91], v[168:171], v[40:43], v[88:91]
    ds_read_b64_tr_b16 v[160:161], v12 offset:0
    ds_read_b64_tr_b16 v[162:163], v12 offset:4608
    v_mfma_f32_16x16x32_bf16 v[92:95], v[168:171], v[44:47], v[92:95]
    ds_read_b128 v[20:23], v7 offset:17408
    s_waitcnt lgkmcnt(12)
    v_mfma_f32_16x16x32_bf16 v[96:99], v[172:175], v[40:43], v[96:99]
    ds_read_b64_tr_b16 v[164:165], v12 offset:32
    v_mfma_f32_16x16x32_bf16 v[100:103], v[172:175], v[44:47], v[100:103]
    ds_read_b64_tr_b16 v[166:167], v12 offset:4640
    s_waitcnt lgkmcnt(12)
    v_mfma_f32_16x16x32_bf16 v[104:107], v[144:147], v[40:43], v[104:107]
    ds_read_b64_tr_b16 v[168:169], v12 offset:64
    ds_read_b64_tr_b16 v[170:171], v12 offset:4672
    v_mfma_f32_16x16x32_bf16 v[108:111], v[144:147], v[44:47], v[108:111]
    ds_read_b128 v[24:27], v7 offset:24576
    s_waitcnt lgkmcnt(13)
    v_mfma_f32_16x16x32_bf16 v[112:115], v[148:151], v[40:43], v[112:115]
    ds_read_b64_tr_b16 v[172:173], v12 offset:96
    v_mfma_f32_16x16x32_bf16 v[116:119], v[148:151], v[44:47], v[116:119]
    ds_read_b64_tr_b16 v[174:175], v12 offset:4704
    s_waitcnt lgkmcnt(13)
    v_mfma_f32_16x16x32_bf16 v[120:123], v[152:155], v[40:43], v[120:123]
    ds_read_b64_tr_b16 v[144:145], v12 offset:128
    ds_read_b64_tr_b16 v[146:147], v12 offset:4736
    v_mfma_f32_16x16x32_bf16 v[124:127], v[152:155], v[44:47], v[124:127]
    ds_read_b128 v[28:31], v7 offset:25600
    s_waitcnt lgkmcnt(13)
    v_mfma_f32_16x16x32_bf16 v[128:131], v[156:159], v[40:43], v[128:131]
    ds_read_b64_tr_b16 v[148:149], v12 offset:160
    v_mfma_f32_16x16x32_bf16 v[132:135], v[156:159], v[44:47], v[132:135]
    ds_read_b64_tr_b16 v[150:151], v12 offset:4768
    s_waitcnt lgkmcnt(13)
    s_waitcnt lgkmcnt(12)
    v_mfma_f32_16x16x32_bf16 v[64:67], v[160:163], v[16:19], v[64:67]
    ds_read_b64_tr_b16 v[152:153], v12 offset:192
    v_mfma_f32_16x16x32_bf16 v[68:71], v[160:163], v[20:23], v[68:71]
    ds_read_b64_tr_b16 v[154:155], v12 offset:4800
    s_waitcnt lgkmcnt(12)
    v_mfma_f32_16x16x32_bf16 v[72:75], v[164:167], v[16:19], v[72:75]
    ds_read_b64_tr_b16 v[156:157], v12 offset:224
    v_mfma_f32_16x16x32_bf16 v[76:79], v[164:167], v[20:23], v[76:79]
    ds_read_b64_tr_b16 v[158:159], v12 offset:4832
    s_waitcnt lgkmcnt(12)
    v_mfma_f32_16x16x32_bf16 v[80:83], v[168:171], v[16:19], v[80:83]
    ds_read_b64_tr_b16 v[160:161], v12 offset:256
    v_mfma_f32_16x16x32_bf16 v[84:87], v[168:171], v[20:23], v[84:87]
    ds_read_b64_tr_b16 v[162:163], v12 offset:4864
    s_waitcnt lgkmcnt(11)
    v_mfma_f32_16x16x32_bf16 v[88:91], v[172:175], v[16:19], v[88:91]
    ds_read_b64_tr_b16 v[164:165], v12 offset:9216
    v_mfma_f32_16x16x32_bf16 v[92:95], v[172:175], v[20:23], v[92:95]
    ds_read_b64_tr_b16 v[166:167], v12 offset:13824
    s_waitcnt lgkmcnt(11)
    v_mfma_f32_16x16x32_bf16 v[96:99], v[144:147], v[16:19], v[96:99]
    ds_read_b64_tr_b16 v[168:169], v12 offset:9248
    v_mfma_f32_16x16x32_bf16 v[100:103], v[144:147], v[20:23], v[100:103]
    ds_read_b64_tr_b16 v[170:171], v12 offset:13856
    s_waitcnt lgkmcnt(10)
    v_mfma_f32_16x16x32_bf16 v[104:107], v[148:151], v[16:19], v[104:107]
    ds_read_b64_tr_b16 v[172:173], v12 offset:9280
    v_mfma_f32_16x16x32_bf16 v[108:111], v[148:151], v[20:23], v[108:111]
    ds_read_b64_tr_b16 v[174:175], v12 offset:13888
    s_barrier
    s_waitcnt lgkmcnt(10)
    v_mfma_f32_16x16x32_bf16 v[112:115], v[152:155], v[16:19], v[112:115]
    ds_read_b64_tr_b16 v[144:145], v12 offset:9312
    v_mfma_f32_16x16x32_bf16 v[116:119], v[152:155], v[20:23], v[116:119]
    ds_read_b64_tr_b16 v[146:147], v12 offset:13920
    s_waitcnt lgkmcnt(10)
    v_mfma_f32_16x16x32_bf16 v[120:123], v[156:159], v[16:19], v[120:123]
    ds_read_b64_tr_b16 v[148:149], v12 offset:9344
    v_mfma_f32_16x16x32_bf16 v[124:127], v[156:159], v[20:23], v[124:127]
    ds_read_b64_tr_b16 v[150:151], v12 offset:13952
    s_waitcnt lgkmcnt(10)
    v_mfma_f32_16x16x32_bf16 v[128:131], v[160:163], v[16:19], v[128:131]
    ds_read_b64_tr_b16 v[152:153], v12 offset:9376
    v_mfma_f32_16x16x32_bf16 v[132:135], v[160:163], v[20:23], v[132:135]
    ds_read_b64_tr_b16 v[154:155], v12 offset:13984
    s_waitcnt lgkmcnt(10)
    v_mfma_f32_16x16x32_bf16 v[64:67], v[164:167], v[24:27], v[64:67]
    ds_read_b64_tr_b16 v[156:157], v12 offset:9408
    v_mfma_f32_16x16x32_bf16 v[68:71], v[164:167], v[28:31], v[68:71]
    ds_read_b64_tr_b16 v[158:159], v12 offset:14016
    s_waitcnt lgkmcnt(10)
    v_mfma_f32_16x16x32_bf16 v[72:75], v[168:171], v[24:27], v[72:75]
    ds_read_b64_tr_b16 v[160:161], v12 offset:9440
    ds_read_b64_tr_b16 v[162:163], v12 offset:14048
    v_mfma_f32_16x16x32_bf16 v[76:79], v[168:171], v[28:31], v[76:79]
    ds_read_b128 v[32:35], v7 offset:32768
    s_waitcnt lgkmcnt(11)
    v_mfma_f32_16x16x32_bf16 v[80:83], v[172:175], v[24:27], v[80:83]
    ds_read_b64_tr_b16 v[164:165], v12 offset:9472
    v_mfma_f32_16x16x32_bf16 v[84:87], v[172:175], v[28:31], v[84:87]
    ds_read_b64_tr_b16 v[166:167], v12 offset:14080
    s_waitcnt lgkmcnt(11)
    v_mfma_f32_16x16x32_bf16 v[88:91], v[144:147], v[24:27], v[88:91]
    ds_read_b64_tr_b16 v[168:169], v12 offset:18432
    ds_read_b64_tr_b16 v[170:171], v12 offset:23040
    v_mfma_f32_16x16x32_bf16 v[92:95], v[144:147], v[28:31], v[92:95]
    ds_read_b128 v[36:39], v7 offset:33792
    s_waitcnt lgkmcnt(12)
    v_mfma_f32_16x16x32_bf16 v[96:99], v[148:151], v[24:27], v[96:99]
    ds_read_b64_tr_b16 v[172:173], v12 offset:18464
    v_mfma_f32_16x16x32_bf16 v[100:103], v[148:151], v[28:31], v[100:103]
    ds_read_b64_tr_b16 v[174:175], v12 offset:23072
    s_waitcnt lgkmcnt(12)
    v_mfma_f32_16x16x32_bf16 v[104:107], v[152:155], v[24:27], v[104:107]
    ds_read_b64_tr_b16 v[144:145], v12 offset:18496
    ds_read_b64_tr_b16 v[146:147], v12 offset:23104
    v_mfma_f32_16x16x32_bf16 v[108:111], v[152:155], v[28:31], v[108:111]
    ds_read_b128 v[40:43], v7 offset:40960
    s_waitcnt lgkmcnt(13)
    v_mfma_f32_16x16x32_bf16 v[112:115], v[156:159], v[24:27], v[112:115]
    ds_read_b64_tr_b16 v[148:149], v12 offset:18528
    v_mfma_f32_16x16x32_bf16 v[116:119], v[156:159], v[28:31], v[116:119]
    ds_read_b64_tr_b16 v[150:151], v12 offset:23136
    s_waitcnt lgkmcnt(13)
    v_mfma_f32_16x16x32_bf16 v[120:123], v[160:163], v[24:27], v[120:123]
    ds_read_b64_tr_b16 v[152:153], v12 offset:18560
    ds_read_b64_tr_b16 v[154:155], v12 offset:23168
    v_mfma_f32_16x16x32_bf16 v[124:127], v[160:163], v[28:31], v[124:127]
    ds_read_b128 v[44:47], v7 offset:41984
    s_waitcnt lgkmcnt(13)
    v_mfma_f32_16x16x32_bf16 v[128:131], v[164:167], v[24:27], v[128:131]
    ds_read_b64_tr_b16 v[156:157], v12 offset:18592
    v_mfma_f32_16x16x32_bf16 v[132:135], v[164:167], v[28:31], v[132:135]
    ds_read_b64_tr_b16 v[158:159], v12 offset:23200
    s_waitcnt lgkmcnt(13)
    s_waitcnt lgkmcnt(12)
    v_mfma_f32_16x16x32_bf16 v[64:67], v[168:171], v[32:35], v[64:67]
    ds_read_b64_tr_b16 v[160:161], v12 offset:18624
    v_mfma_f32_16x16x32_bf16 v[68:71], v[168:171], v[36:39], v[68:71]
    ds_read_b64_tr_b16 v[162:163], v12 offset:23232
    s_waitcnt lgkmcnt(12)
    v_mfma_f32_16x16x32_bf16 v[72:75], v[172:175], v[32:35], v[72:75]
    ds_read_b64_tr_b16 v[164:165], v12 offset:18656
    v_mfma_f32_16x16x32_bf16 v[76:79], v[172:175], v[36:39], v[76:79]
    ds_read_b64_tr_b16 v[166:167], v12 offset:23264
    s_waitcnt lgkmcnt(12)
    v_mfma_f32_16x16x32_bf16 v[80:83], v[144:147], v[32:35], v[80:83]
    ds_read_b64_tr_b16 v[168:169], v12 offset:18688
    v_mfma_f32_16x16x32_bf16 v[84:87], v[144:147], v[36:39], v[84:87]
    ds_read_b64_tr_b16 v[170:171], v12 offset:23296
    s_waitcnt lgkmcnt(11)
    v_mfma_f32_16x16x32_bf16 v[88:91], v[148:151], v[32:35], v[88:91]
    ds_read_b64_tr_b16 v[172:173], v12 offset:27648
    v_mfma_f32_16x16x32_bf16 v[92:95], v[148:151], v[36:39], v[92:95]
    ds_read_b64_tr_b16 v[174:175], v12 offset:32256
    s_waitcnt lgkmcnt(11)
    v_mfma_f32_16x16x32_bf16 v[96:99], v[152:155], v[32:35], v[96:99]
    ds_read_b64_tr_b16 v[144:145], v12 offset:27680
    v_mfma_f32_16x16x32_bf16 v[100:103], v[152:155], v[36:39], v[100:103]
    ds_read_b64_tr_b16 v[146:147], v12 offset:32288
    s_waitcnt lgkmcnt(10)
    v_mfma_f32_16x16x32_bf16 v[104:107], v[156:159], v[32:35], v[104:107]
    ds_read_b64_tr_b16 v[148:149], v12 offset:27712
    v_mfma_f32_16x16x32_bf16 v[108:111], v[156:159], v[36:39], v[108:111]
    ds_read_b64_tr_b16 v[150:151], v12 offset:32320
    s_barrier
    s_waitcnt lgkmcnt(10)
    v_mfma_f32_16x16x32_bf16 v[112:115], v[160:163], v[32:35], v[112:115]
    ds_read_b64_tr_b16 v[152:153], v12 offset:27744
    v_mfma_f32_16x16x32_bf16 v[116:119], v[160:163], v[36:39], v[116:119]
    ds_read_b64_tr_b16 v[154:155], v12 offset:32352
    s_waitcnt lgkmcnt(10)
    v_mfma_f32_16x16x32_bf16 v[120:123], v[164:167], v[32:35], v[120:123]
    ds_read_b64_tr_b16 v[156:157], v12 offset:27776
    v_mfma_f32_16x16x32_bf16 v[124:127], v[164:167], v[36:39], v[124:127]
    ds_read_b64_tr_b16 v[158:159], v12 offset:32384
    s_waitcnt lgkmcnt(10)
    v_mfma_f32_16x16x32_bf16 v[128:131], v[168:171], v[32:35], v[128:131]
    ds_read_b64_tr_b16 v[160:161], v12 offset:27808
    v_mfma_f32_16x16x32_bf16 v[132:135], v[168:171], v[36:39], v[132:135]
    ds_read_b64_tr_b16 v[162:163], v12 offset:32416
    s_waitcnt lgkmcnt(10)
    v_mfma_f32_16x16x32_bf16 v[64:67], v[172:175], v[40:43], v[64:67]
    ds_read_b64_tr_b16 v[164:165], v12 offset:27840
    v_mfma_f32_16x16x32_bf16 v[68:71], v[172:175], v[44:47], v[68:71]
    ds_read_b64_tr_b16 v[166:167], v12 offset:32448
    s_waitcnt lgkmcnt(10)
    v_mfma_f32_16x16x32_bf16 v[72:75], v[144:147], v[40:43], v[72:75]
    ds_read_b64_tr_b16 v[168:169], v12 offset:27872
    ds_read_b64_tr_b16 v[170:171], v12 offset:32480
    v_mfma_f32_16x16x32_bf16 v[76:79], v[144:147], v[44:47], v[76:79]
    ds_read_b128 v[16:19], v6 offset:0
    s_waitcnt lgkmcnt(11)
    v_mfma_f32_16x16x32_bf16 v[80:83], v[148:151], v[40:43], v[80:83]
    ds_read_b64_tr_b16 v[172:173], v12 offset:27904
    v_mfma_f32_16x16x32_bf16 v[84:87], v[148:151], v[44:47], v[84:87]
    ds_read_b64_tr_b16 v[174:175], v12 offset:32512
    s_waitcnt lgkmcnt(11)
    v_mfma_f32_16x16x32_bf16 v[88:91], v[152:155], v[40:43], v[88:91]
    ds_read_b64_tr_b16 v[144:145], v13 offset:4096
    ds_read_b64_tr_b16 v[146:147], v13 offset:8704
    v_mfma_f32_16x16x32_bf16 v[92:95], v[152:155], v[44:47], v[92:95]
    ds_read_b128 v[20:23], v6 offset:1024
    s_waitcnt lgkmcnt(12)
    v_mfma_f32_16x16x32_bf16 v[96:99], v[156:159], v[40:43], v[96:99]
    ds_read_b64_tr_b16 v[148:149], v13 offset:4128
    v_mfma_f32_16x16x32_bf16 v[100:103], v[156:159], v[44:47], v[100:103]
    ds_read_b64_tr_b16 v[150:151], v13 offset:8736
    s_waitcnt lgkmcnt(12)
    v_mfma_f32_16x16x32_bf16 v[104:107], v[160:163], v[40:43], v[104:107]
    ds_read_b64_tr_b16 v[152:153], v13 offset:4160
    ds_read_b64_tr_b16 v[154:155], v13 offset:8768
    v_mfma_f32_16x16x32_bf16 v[108:111], v[160:163], v[44:47], v[108:111]
    ds_read_b128 v[24:27], v6 offset:8192
    s_waitcnt lgkmcnt(13)
    v_mfma_f32_16x16x32_bf16 v[112:115], v[164:167], v[40:43], v[112:115]
    ds_read_b64_tr_b16 v[156:157], v13 offset:4192
    v_mfma_f32_16x16x32_bf16 v[116:119], v[164:167], v[44:47], v[116:119]
    ds_read_b64_tr_b16 v[158:159], v13 offset:8800
    s_waitcnt lgkmcnt(13)
    v_mfma_f32_16x16x32_bf16 v[120:123], v[168:171], v[40:43], v[120:123]
    ds_read_b64_tr_b16 v[160:161], v13 offset:4224
    ds_read_b64_tr_b16 v[162:163], v13 offset:8832
    v_mfma_f32_16x16x32_bf16 v[124:127], v[168:171], v[44:47], v[124:127]
    ds_read_b128 v[28:31], v6 offset:9216
    s_waitcnt lgkmcnt(13)
    v_mfma_f32_16x16x32_bf16 v[128:131], v[172:175], v[40:43], v[128:131]
    ds_read_b64_tr_b16 v[164:165], v13 offset:4256
    v_mfma_f32_16x16x32_bf16 v[132:135], v[172:175], v[44:47], v[132:135]
    ds_read_b64_tr_b16 v[166:167], v13 offset:8864
    s_waitcnt lgkmcnt(13)
    s_waitcnt lgkmcnt(12)
    v_mfma_f32_16x16x32_bf16 v[64:67], v[144:147], v[16:19], v[64:67]
    ds_read_b64_tr_b16 v[168:169], v13 offset:4288
    v_mfma_f32_16x16x32_bf16 v[68:71], v[144:147], v[20:23], v[68:71]
    ds_read_b64_tr_b16 v[170:171], v13 offset:8896
    s_waitcnt lgkmcnt(12)
    v_mfma_f32_16x16x32_bf16 v[72:75], v[148:151], v[16:19], v[72:75]
    ds_read_b64_tr_b16 v[172:173], v13 offset:4320
    v_mfma_f32_16x16x32_bf16 v[76:79], v[148:151], v[20:23], v[76:79]
    ds_read_b64_tr_b16 v[174:175], v13 offset:8928
    s_waitcnt lgkmcnt(12)
    v_mfma_f32_16x16x32_bf16 v[80:83], v[152:155], v[16:19], v[80:83]
    ds_read_b64_tr_b16 v[144:145], v13 offset:4352
    v_mfma_f32_16x16x32_bf16 v[84:87], v[152:155], v[20:23], v[84:87]
    ds_read_b64_tr_b16 v[146:147], v13 offset:8960
    s_waitcnt lgkmcnt(11)
    v_mfma_f32_16x16x32_bf16 v[88:91], v[156:159], v[16:19], v[88:91]
    ds_read_b64_tr_b16 v[148:149], v13 offset:13312
    v_mfma_f32_16x16x32_bf16 v[92:95], v[156:159], v[20:23], v[92:95]
    ds_read_b64_tr_b16 v[150:151], v13 offset:17920
    s_waitcnt lgkmcnt(11)
    v_mfma_f32_16x16x32_bf16 v[96:99], v[160:163], v[16:19], v[96:99]
    ds_read_b64_tr_b16 v[152:153], v13 offset:13344
    v_mfma_f32_16x16x32_bf16 v[100:103], v[160:163], v[20:23], v[100:103]
    ds_read_b64_tr_b16 v[154:155], v13 offset:17952
    s_waitcnt lgkmcnt(10)
    v_mfma_f32_16x16x32_bf16 v[104:107], v[164:167], v[16:19], v[104:107]
    ds_read_b64_tr_b16 v[156:157], v13 offset:13376
    v_mfma_f32_16x16x32_bf16 v[108:111], v[164:167], v[20:23], v[108:111]
    ds_read_b64_tr_b16 v[158:159], v13 offset:17984
    s_barrier
    s_waitcnt lgkmcnt(10)
    v_mfma_f32_16x16x32_bf16 v[112:115], v[168:171], v[16:19], v[112:115]
    ds_read_b64_tr_b16 v[160:161], v13 offset:13408
    v_mfma_f32_16x16x32_bf16 v[116:119], v[168:171], v[20:23], v[116:119]
    ds_read_b64_tr_b16 v[162:163], v13 offset:18016
    s_waitcnt lgkmcnt(10)
    v_mfma_f32_16x16x32_bf16 v[120:123], v[172:175], v[16:19], v[120:123]
    ds_read_b64_tr_b16 v[164:165], v13 offset:13440
    v_mfma_f32_16x16x32_bf16 v[124:127], v[172:175], v[20:23], v[124:127]
    ds_read_b64_tr_b16 v[166:167], v13 offset:18048
    s_waitcnt lgkmcnt(10)
    v_mfma_f32_16x16x32_bf16 v[128:131], v[144:147], v[16:19], v[128:131]
    ds_read_b64_tr_b16 v[168:169], v13 offset:13472
    v_mfma_f32_16x16x32_bf16 v[132:135], v[144:147], v[20:23], v[132:135]
    ds_read_b64_tr_b16 v[170:171], v13 offset:18080
    s_waitcnt lgkmcnt(10)
    v_mfma_f32_16x16x32_bf16 v[64:67], v[148:151], v[24:27], v[64:67]
    ds_read_b64_tr_b16 v[172:173], v13 offset:13504
    v_mfma_f32_16x16x32_bf16 v[68:71], v[148:151], v[28:31], v[68:71]
    ds_read_b64_tr_b16 v[174:175], v13 offset:18112
    s_waitcnt lgkmcnt(10)
    v_mfma_f32_16x16x32_bf16 v[72:75], v[152:155], v[24:27], v[72:75]
    ds_read_b64_tr_b16 v[144:145], v13 offset:13536
    ds_read_b64_tr_b16 v[146:147], v13 offset:18144
    v_mfma_f32_16x16x32_bf16 v[76:79], v[152:155], v[28:31], v[76:79]
    ds_read_b128 v[32:35], v6 offset:16384
    s_waitcnt lgkmcnt(11)
    v_mfma_f32_16x16x32_bf16 v[80:83], v[156:159], v[24:27], v[80:83]
    ds_read_b64_tr_b16 v[148:149], v13 offset:13568
    v_mfma_f32_16x16x32_bf16 v[84:87], v[156:159], v[28:31], v[84:87]
    ds_read_b64_tr_b16 v[150:151], v13 offset:18176
    s_waitcnt lgkmcnt(11)
    v_mfma_f32_16x16x32_bf16 v[88:91], v[160:163], v[24:27], v[88:91]
    ds_read_b64_tr_b16 v[152:153], v13 offset:22528
    ds_read_b64_tr_b16 v[154:155], v13 offset:27136
    v_mfma_f32_16x16x32_bf16 v[92:95], v[160:163], v[28:31], v[92:95]
    ds_read_b128 v[36:39], v6 offset:17408
    s_waitcnt lgkmcnt(12)
    v_mfma_f32_16x16x32_bf16 v[96:99], v[164:167], v[24:27], v[96:99]
    ds_read_b64_tr_b16 v[156:157], v13 offset:22560
    v_mfma_f32_16x16x32_bf16 v[100:103], v[164:167], v[28:31], v[100:103]
    ds_read_b64_tr_b16 v[158:159], v13 offset:27168
    s_waitcnt lgkmcnt(12)
    v_mfma_f32_16x16x32_bf16 v[104:107], v[168:171], v[24:27], v[104:107]
    ds_read_b64_tr_b16 v[160:161], v13 offset:22592
    ds_read_b64_tr_b16 v[162:163], v13 offset:27200
    v_mfma_f32_16x16x32_bf16 v[108:111], v[168:171], v[28:31], v[108:111]
    ds_read_b128 v[40:43], v6 offset:24576
    s_waitcnt lgkmcnt(13)
    v_mfma_f32_16x16x32_bf16 v[112:115], v[172:175], v[24:27], v[112:115]
    ds_read_b64_tr_b16 v[164:165], v13 offset:22624
    v_mfma_f32_16x16x32_bf16 v[116:119], v[172:175], v[28:31], v[116:119]
    ds_read_b64_tr_b16 v[166:167], v13 offset:27232
    s_waitcnt lgkmcnt(13)
    v_mfma_f32_16x16x32_bf16 v[120:123], v[144:147], v[24:27], v[120:123]
    ds_read_b64_tr_b16 v[168:169], v13 offset:22656
    ds_read_b64_tr_b16 v[170:171], v13 offset:27264
    v_mfma_f32_16x16x32_bf16 v[124:127], v[144:147], v[28:31], v[124:127]
    ds_read_b128 v[44:47], v6 offset:25600
    s_waitcnt lgkmcnt(13)
    v_mfma_f32_16x16x32_bf16 v[128:131], v[148:151], v[24:27], v[128:131]
    ds_read_b64_tr_b16 v[172:173], v13 offset:22688
    v_mfma_f32_16x16x32_bf16 v[132:135], v[148:151], v[28:31], v[132:135]
    ds_read_b64_tr_b16 v[174:175], v13 offset:27296
    s_waitcnt lgkmcnt(13)
    s_waitcnt lgkmcnt(12)
    v_mfma_f32_16x16x32_bf16 v[64:67], v[152:155], v[32:35], v[64:67]
    ds_read_b64_tr_b16 v[144:145], v13 offset:22720
    v_mfma_f32_16x16x32_bf16 v[68:71], v[152:155], v[36:39], v[68:71]
    ds_read_b64_tr_b16 v[146:147], v13 offset:27328
    s_waitcnt lgkmcnt(12)
    v_mfma_f32_16x16x32_bf16 v[72:75], v[156:159], v[32:35], v[72:75]
    ds_read_b64_tr_b16 v[148:149], v13 offset:22752
    v_mfma_f32_16x16x32_bf16 v[76:79], v[156:159], v[36:39], v[76:79]
    ds_read_b64_tr_b16 v[150:151], v13 offset:27360
    s_waitcnt lgkmcnt(12)
    v_mfma_f32_16x16x32_bf16 v[80:83], v[160:163], v[32:35], v[80:83]
    ds_read_b64_tr_b16 v[152:153], v13 offset:22784
    v_mfma_f32_16x16x32_bf16 v[84:87], v[160:163], v[36:39], v[84:87]
    ds_read_b64_tr_b16 v[154:155], v13 offset:27392
    s_waitcnt lgkmcnt(11)
    v_mfma_f32_16x16x32_bf16 v[88:91], v[164:167], v[32:35], v[88:91]
    ds_read_b64_tr_b16 v[156:157], v13 offset:31744
    v_mfma_f32_16x16x32_bf16 v[92:95], v[164:167], v[36:39], v[92:95]
    ds_read_b64_tr_b16 v[158:159], v13 offset:36352
    s_waitcnt lgkmcnt(11)
    v_mfma_f32_16x16x32_bf16 v[96:99], v[168:171], v[32:35], v[96:99]
    ds_read_b64_tr_b16 v[160:161], v13 offset:31776
    v_mfma_f32_16x16x32_bf16 v[100:103], v[168:171], v[36:39], v[100:103]
    ds_read_b64_tr_b16 v[162:163], v13 offset:36384
    s_waitcnt lgkmcnt(10)
    v_mfma_f32_16x16x32_bf16 v[104:107], v[172:175], v[32:35], v[104:107]
    ds_read_b64_tr_b16 v[164:165], v13 offset:31808
    v_mfma_f32_16x16x32_bf16 v[108:111], v[172:175], v[36:39], v[108:111]
    ds_read_b64_tr_b16 v[166:167], v13 offset:36416
    s_barrier
    s_waitcnt lgkmcnt(10)
    v_mfma_f32_16x16x32_bf16 v[112:115], v[144:147], v[32:35], v[112:115]
    ds_read_b64_tr_b16 v[168:169], v13 offset:31840
    v_mfma_f32_16x16x32_bf16 v[116:119], v[144:147], v[36:39], v[116:119]
    ds_read_b64_tr_b16 v[170:171], v13 offset:36448
    s_waitcnt lgkmcnt(10)
    v_mfma_f32_16x16x32_bf16 v[120:123], v[148:151], v[32:35], v[120:123]
    ds_read_b64_tr_b16 v[172:173], v13 offset:31872
    v_mfma_f32_16x16x32_bf16 v[124:127], v[148:151], v[36:39], v[124:127]
    ds_read_b64_tr_b16 v[174:175], v13 offset:36480
    s_waitcnt lgkmcnt(10)
    v_mfma_f32_16x16x32_bf16 v[128:131], v[152:155], v[32:35], v[128:131]
    ds_read_b64_tr_b16 v[144:145], v13 offset:31904
    v_mfma_f32_16x16x32_bf16 v[132:135], v[152:155], v[36:39], v[132:135]
    ds_read_b64_tr_b16 v[146:147], v13 offset:36512
    s_waitcnt lgkmcnt(10)
    v_mfma_f32_16x16x32_bf16 v[64:67], v[156:159], v[40:43], v[64:67]
    ds_read_b64_tr_b16 v[148:149], v13 offset:31936
    v_mfma_f32_16x16x32_bf16 v[68:71], v[156:159], v[44:47], v[68:71]
    ds_read_b64_tr_b16 v[150:151], v13 offset:36544
    s_waitcnt lgkmcnt(10)
    v_mfma_f32_16x16x32_bf16 v[72:75], v[160:163], v[40:43], v[72:75]
    ds_read_b64_tr_b16 v[152:153], v13 offset:31968
    ds_read_b64_tr_b16 v[154:155], v13 offset:36576
    v_mfma_f32_16x16x32_bf16 v[76:79], v[160:163], v[44:47], v[76:79]
    ds_read_b128 v[16:19], v7 offset:0
    s_waitcnt lgkmcnt(11)
    v_mfma_f32_16x16x32_bf16 v[80:83], v[164:167], v[40:43], v[80:83]
    ds_read_b64_tr_b16 v[156:157], v13 offset:32000
    v_mfma_f32_16x16x32_bf16 v[84:87], v[164:167], v[44:47], v[84:87]
    ds_read_b64_tr_b16 v[158:159], v13 offset:36608
    s_waitcnt lgkmcnt(11)
    v_mfma_f32_16x16x32_bf16 v[88:91], v[168:171], v[40:43], v[88:91]
    ds_read_b64_tr_b16 v[160:161], v12 offset:0
    ds_read_b64_tr_b16 v[162:163], v12 offset:4608
    v_mfma_f32_16x16x32_bf16 v[92:95], v[168:171], v[44:47], v[92:95]
    ds_read_b128 v[20:23], v7 offset:1024
    s_waitcnt lgkmcnt(12)
    v_mfma_f32_16x16x32_bf16 v[96:99], v[172:175], v[40:43], v[96:99]
    ds_read_b64_tr_b16 v[164:165], v12 offset:32
    v_mfma_f32_16x16x32_bf16 v[100:103], v[172:175], v[44:47], v[100:103]
    ds_read_b64_tr_b16 v[166:167], v12 offset:4640
    s_waitcnt lgkmcnt(12)
    v_mfma_f32_16x16x32_bf16 v[104:107], v[144:147], v[40:43], v[104:107]
    ds_read_b64_tr_b16 v[168:169], v12 offset:64
    ds_read_b64_tr_b16 v[170:171], v12 offset:4672
    v_mfma_f32_16x16x32_bf16 v[108:111], v[144:147], v[44:47], v[108:111]
    ds_read_b128 v[24:27], v7 offset:8192
    s_waitcnt lgkmcnt(13)
    v_mfma_f32_16x16x32_bf16 v[112:115], v[148:151], v[40:43], v[112:115]
    ds_read_b64_tr_b16 v[172:173], v12 offset:96
    v_mfma_f32_16x16x32_bf16 v[116:119], v[148:151], v[44:47], v[116:119]
    ds_read_b64_tr_b16 v[174:175], v12 offset:4704
    s_waitcnt lgkmcnt(13)
    v_mfma_f32_16x16x32_bf16 v[120:123], v[152:155], v[40:43], v[120:123]
    ds_read_b64_tr_b16 v[144:145], v12 offset:128
    ds_read_b64_tr_b16 v[146:147], v12 offset:4736
    v_mfma_f32_16x16x32_bf16 v[124:127], v[152:155], v[44:47], v[124:127]
    ds_read_b128 v[28:31], v7 offset:9216
    s_waitcnt lgkmcnt(13)
    v_mfma_f32_16x16x32_bf16 v[128:131], v[156:159], v[40:43], v[128:131]
    ds_read_b64_tr_b16 v[148:149], v12 offset:160
    v_mfma_f32_16x16x32_bf16 v[132:135], v[156:159], v[44:47], v[132:135]
    ds_read_b64_tr_b16 v[150:151], v12 offset:4768
    s_waitcnt lgkmcnt(13)
    s_waitcnt lgkmcnt(12)
    v_mfma_f32_16x16x32_bf16 v[64:67], v[160:163], v[16:19], v[64:67]
    ds_read_b64_tr_b16 v[152:153], v12 offset:192
    v_mfma_f32_16x16x32_bf16 v[68:71], v[160:163], v[20:23], v[68:71]
    ds_read_b64_tr_b16 v[154:155], v12 offset:4800
    s_waitcnt lgkmcnt(12)
    v_mfma_f32_16x16x32_bf16 v[72:75], v[164:167], v[16:19], v[72:75]
    ds_read_b64_tr_b16 v[156:157], v12 offset:224
    v_mfma_f32_16x16x32_bf16 v[76:79], v[164:167], v[20:23], v[76:79]
    ds_read_b64_tr_b16 v[158:159], v12 offset:4832
    s_waitcnt lgkmcnt(12)
    v_mfma_f32_16x16x32_bf16 v[80:83], v[168:171], v[16:19], v[80:83]
    ds_read_b64_tr_b16 v[160:161], v12 offset:256
    v_mfma_f32_16x16x32_bf16 v[84:87], v[168:171], v[20:23], v[84:87]
    ds_read_b64_tr_b16 v[162:163], v12 offset:4864
    s_waitcnt lgkmcnt(11)
    v_mfma_f32_16x16x32_bf16 v[88:91], v[172:175], v[16:19], v[88:91]
    ds_read_b64_tr_b16 v[164:165], v12 offset:9216
    v_mfma_f32_16x16x32_bf16 v[92:95], v[172:175], v[20:23], v[92:95]
    ds_read_b64_tr_b16 v[166:167], v12 offset:13824
    s_waitcnt lgkmcnt(11)
    v_mfma_f32_16x16x32_bf16 v[96:99], v[144:147], v[16:19], v[96:99]
    ds_read_b64_tr_b16 v[168:169], v12 offset:9248
    v_mfma_f32_16x16x32_bf16 v[100:103], v[144:147], v[20:23], v[100:103]
    ds_read_b64_tr_b16 v[170:171], v12 offset:13856
    s_waitcnt lgkmcnt(10)
    v_mfma_f32_16x16x32_bf16 v[104:107], v[148:151], v[16:19], v[104:107]
    ds_read_b64_tr_b16 v[172:173], v12 offset:9280
    v_mfma_f32_16x16x32_bf16 v[108:111], v[148:151], v[20:23], v[108:111]
    ds_read_b64_tr_b16 v[174:175], v12 offset:13888
    s_barrier
    s_waitcnt lgkmcnt(10)
    v_mfma_f32_16x16x32_bf16 v[112:115], v[152:155], v[16:19], v[112:115]
    ds_read_b64_tr_b16 v[144:145], v12 offset:9312
    v_mfma_f32_16x16x32_bf16 v[116:119], v[152:155], v[20:23], v[116:119]
    ds_read_b64_tr_b16 v[146:147], v12 offset:13920
    s_waitcnt lgkmcnt(10)
    v_mfma_f32_16x16x32_bf16 v[120:123], v[156:159], v[16:19], v[120:123]
    ds_read_b64_tr_b16 v[148:149], v12 offset:9344
    v_mfma_f32_16x16x32_bf16 v[124:127], v[156:159], v[20:23], v[124:127]
    ds_read_b64_tr_b16 v[150:151], v12 offset:13952
    s_waitcnt lgkmcnt(10)
    v_mfma_f32_16x16x32_bf16 v[128:131], v[160:163], v[16:19], v[128:131]
    ds_read_b64_tr_b16 v[152:153], v12 offset:9376
    v_mfma_f32_16x16x32_bf16 v[132:135], v[160:163], v[20:23], v[132:135]
    ds_read_b64_tr_b16 v[154:155], v12 offset:13984
    s_waitcnt lgkmcnt(10)
    v_mfma_f32_16x16x32_bf16 v[64:67], v[164:167], v[24:27], v[64:67]
    ds_read_b64_tr_b16 v[156:157], v12 offset:9408
    v_mfma_f32_16x16x32_bf16 v[68:71], v[164:167], v[28:31], v[68:71]
    ds_read_b64_tr_b16 v[158:159], v12 offset:14016
    s_waitcnt lgkmcnt(10)
    v_mfma_f32_16x16x32_bf16 v[72:75], v[168:171], v[24:27], v[72:75]
    ds_read_b64_tr_b16 v[160:161], v12 offset:9440
    ds_read_b64_tr_b16 v[162:163], v12 offset:14048
    v_mfma_f32_16x16x32_bf16 v[76:79], v[168:171], v[28:31], v[76:79]
    ds_read_b128 v[32:35], v7 offset:16384
    s_waitcnt lgkmcnt(11)
    v_mfma_f32_16x16x32_bf16 v[80:83], v[172:175], v[24:27], v[80:83]
    ds_read_b64_tr_b16 v[164:165], v12 offset:9472
    v_mfma_f32_16x16x32_bf16 v[84:87], v[172:175], v[28:31], v[84:87]
    ds_read_b64_tr_b16 v[166:167], v12 offset:14080
    s_waitcnt lgkmcnt(11)
    v_mfma_f32_16x16x32_bf16 v[88:91], v[144:147], v[24:27], v[88:91]
    ds_read_b64_tr_b16 v[168:169], v12 offset:18432
    ds_read_b64_tr_b16 v[170:171], v12 offset:23040
    v_mfma_f32_16x16x32_bf16 v[92:95], v[144:147], v[28:31], v[92:95]
    ds_read_b128 v[36:39], v7 offset:17408
    s_waitcnt lgkmcnt(12)
    v_mfma_f32_16x16x32_bf16 v[96:99], v[148:151], v[24:27], v[96:99]
    ds_read_b64_tr_b16 v[172:173], v12 offset:18464
    v_mfma_f32_16x16x32_bf16 v[100:103], v[148:151], v[28:31], v[100:103]
    ds_read_b64_tr_b16 v[174:175], v12 offset:23072
    s_waitcnt lgkmcnt(12)
    v_mfma_f32_16x16x32_bf16 v[104:107], v[152:155], v[24:27], v[104:107]
    ds_read_b64_tr_b16 v[144:145], v12 offset:18496
    ds_read_b64_tr_b16 v[146:147], v12 offset:23104
    v_mfma_f32_16x16x32_bf16 v[108:111], v[152:155], v[28:31], v[108:111]
    ds_read_b128 v[40:43], v7 offset:24576
    s_waitcnt lgkmcnt(13)
    v_mfma_f32_16x16x32_bf16 v[112:115], v[156:159], v[24:27], v[112:115]
    ds_read_b64_tr_b16 v[148:149], v12 offset:18528
    v_mfma_f32_16x16x32_bf16 v[116:119], v[156:159], v[28:31], v[116:119]
    ds_read_b64_tr_b16 v[150:151], v12 offset:23136
    s_waitcnt lgkmcnt(13)
    v_mfma_f32_16x16x32_bf16 v[120:123], v[160:163], v[24:27], v[120:123]
    ds_read_b64_tr_b16 v[152:153], v12 offset:18560
    ds_read_b64_tr_b16 v[154:155], v12 offset:23168
    v_mfma_f32_16x16x32_bf16 v[124:127], v[160:163], v[28:31], v[124:127]
    ds_read_b128 v[44:47], v7 offset:25600
    s_waitcnt lgkmcnt(13)
    v_mfma_f32_16x16x32_bf16 v[128:131], v[164:167], v[24:27], v[128:131]
    ds_read_b64_tr_b16 v[156:157], v12 offset:18592
    v_mfma_f32_16x16x32_bf16 v[132:135], v[164:167], v[28:31], v[132:135]
    ds_read_b64_tr_b16 v[158:159], v12 offset:23200
    s_waitcnt lgkmcnt(13)
    s_waitcnt lgkmcnt(12)
    v_mfma_f32_16x16x32_bf16 v[64:67], v[168:171], v[32:35], v[64:67]
    ds_read_b64_tr_b16 v[160:161], v12 offset:18624
    v_mfma_f32_16x16x32_bf16 v[68:71], v[168:171], v[36:39], v[68:71]
    ds_read_b64_tr_b16 v[162:163], v12 offset:23232
    s_waitcnt lgkmcnt(12)
    v_mfma_f32_16x16x32_bf16 v[72:75], v[172:175], v[32:35], v[72:75]
    ds_read_b64_tr_b16 v[164:165], v12 offset:18656
    v_mfma_f32_16x16x32_bf16 v[76:79], v[172:175], v[36:39], v[76:79]
    ds_read_b64_tr_b16 v[166:167], v12 offset:23264
    s_waitcnt lgkmcnt(12)
    v_mfma_f32_16x16x32_bf16 v[80:83], v[144:147], v[32:35], v[80:83]
    ds_read_b64_tr_b16 v[168:169], v12 offset:18688
    v_mfma_f32_16x16x32_bf16 v[84:87], v[144:147], v[36:39], v[84:87]
    ds_read_b64_tr_b16 v[170:171], v12 offset:23296
    s_waitcnt lgkmcnt(11)
    v_mfma_f32_16x16x32_bf16 v[88:91], v[148:151], v[32:35], v[88:91]
    ds_read_b64_tr_b16 v[172:173], v12 offset:27648
    v_mfma_f32_16x16x32_bf16 v[92:95], v[148:151], v[36:39], v[92:95]
    ds_read_b64_tr_b16 v[174:175], v12 offset:32256
    s_waitcnt lgkmcnt(11)
    v_mfma_f32_16x16x32_bf16 v[96:99], v[152:155], v[32:35], v[96:99]
    ds_read_b64_tr_b16 v[144:145], v12 offset:27680
    v_mfma_f32_16x16x32_bf16 v[100:103], v[152:155], v[36:39], v[100:103]
    ds_read_b64_tr_b16 v[146:147], v12 offset:32288
    s_waitcnt lgkmcnt(10)
    v_mfma_f32_16x16x32_bf16 v[104:107], v[156:159], v[32:35], v[104:107]
    ds_read_b64_tr_b16 v[148:149], v12 offset:27712
    v_mfma_f32_16x16x32_bf16 v[108:111], v[156:159], v[36:39], v[108:111]
    ds_read_b64_tr_b16 v[150:151], v12 offset:32320
    s_barrier
    s_waitcnt lgkmcnt(10)
    v_mfma_f32_16x16x32_bf16 v[112:115], v[160:163], v[32:35], v[112:115]
    ds_read_b64_tr_b16 v[152:153], v12 offset:27744
    v_mfma_f32_16x16x32_bf16 v[116:119], v[160:163], v[36:39], v[116:119]
    ds_read_b64_tr_b16 v[154:155], v12 offset:32352
    s_waitcnt lgkmcnt(10)
    v_mfma_f32_16x16x32_bf16 v[120:123], v[164:167], v[32:35], v[120:123]
    ds_read_b64_tr_b16 v[156:157], v12 offset:27776
    v_mfma_f32_16x16x32_bf16 v[124:127], v[164:167], v[36:39], v[124:127]
    ds_read_b64_tr_b16 v[158:159], v12 offset:32384
    s_waitcnt lgkmcnt(10)
    v_mfma_f32_16x16x32_bf16 v[128:131], v[168:171], v[32:35], v[128:131]
    ds_read_b64_tr_b16 v[160:161], v12 offset:27808
    v_mfma_f32_16x16x32_bf16 v[132:135], v[168:171], v[36:39], v[132:135]
    ds_read_b64_tr_b16 v[162:163], v12 offset:32416
    s_waitcnt lgkmcnt(10)
    v_mfma_f32_16x16x32_bf16 v[64:67], v[172:175], v[40:43], v[64:67]
    ds_read_b64_tr_b16 v[164:165], v12 offset:27840
    v_mfma_f32_16x16x32_bf16 v[68:71], v[172:175], v[44:47], v[68:71]
    ds_read_b64_tr_b16 v[166:167], v12 offset:32448
    s_waitcnt lgkmcnt(10)
    v_mfma_f32_16x16x32_bf16 v[72:75], v[144:147], v[40:43], v[72:75]
    ds_read_b64_tr_b16 v[168:169], v12 offset:27872
    v_mfma_f32_16x16x32_bf16 v[76:79], v[144:147], v[44:47], v[76:79]
    ds_read_b64_tr_b16 v[170:171], v12 offset:32480
    s_waitcnt lgkmcnt(10)
    v_mfma_f32_16x16x32_bf16 v[80:83], v[148:151], v[40:43], v[80:83]
    ds_read_b64_tr_b16 v[172:173], v12 offset:27904
    v_mfma_f32_16x16x32_bf16 v[84:87], v[148:151], v[44:47], v[84:87]
    ds_read_b64_tr_b16 v[174:175], v12 offset:32512
    s_waitcnt lgkmcnt(10)
    v_mfma_f32_16x16x32_bf16 v[88:91], v[152:155], v[40:43], v[88:91]
    v_mfma_f32_16x16x32_bf16 v[92:95], v[152:155], v[44:47], v[92:95]
    s_waitcnt lgkmcnt(8)
    v_mfma_f32_16x16x32_bf16 v[96:99], v[156:159], v[40:43], v[96:99]
    v_mfma_f32_16x16x32_bf16 v[100:103], v[156:159], v[44:47], v[100:103]
    s_waitcnt lgkmcnt(6)
    v_mfma_f32_16x16x32_bf16 v[104:107], v[160:163], v[40:43], v[104:107]
    v_mfma_f32_16x16x32_bf16 v[108:111], v[160:163], v[44:47], v[108:111]
    s_waitcnt lgkmcnt(4)
    v_mfma_f32_16x16x32_bf16 v[112:115], v[164:167], v[40:43], v[112:115]
    v_mfma_f32_16x16x32_bf16 v[116:119], v[164:167], v[44:47], v[116:119]
    s_waitcnt lgkmcnt(2)
    v_mfma_f32_16x16x32_bf16 v[120:123], v[168:171], v[40:43], v[120:123]
    v_mfma_f32_16x16x32_bf16 v[124:127], v[168:171], v[44:47], v[124:127]
    s_waitcnt lgkmcnt(0)
    v_mfma_f32_16x16x32_bf16 v[128:131], v[172:175], v[40:43], v[128:131]
    v_mfma_f32_16x16x32_bf16 v[132:135], v[172:175], v[44:47], v[132:135]
    s_nop 7
    s_barrier
    s_lshl_b32 s40, s52, 2
    s_add_u32 s40, s40, s14
    s_lshl_b32 s40, s40, 2
    s_add_u32 s40, s40, s15
    s_lshl_b32 s40, s40, 2
    s_add_u32 s40, s40, s10
    s_mul_i32 s40, s40, 9216
    s_cmp_eq_u32 s15, s10
    s_cbranch_scc1 K34_KEEP
    v_cvt_pk_bf16_f32 v208, v64, v65
    v_cvt_pk_bf16_f32 v209, v66, v67
    v_cvt_pk_bf16_f32 v210, v68, v69
    v_cvt_pk_bf16_f32 v211, v70, v71
    buffer_store_dwordx4 v[208:211], v3, s[36:39], s40 offen offset:0 sc1
    v_cvt_pk_bf16_f32 v212, v72, v73
    v_cvt_pk_bf16_f32 v213, v74, v75
    v_cvt_pk_bf16_f32 v214, v76, v77
    v_cvt_pk_bf16_f32 v215, v78, v79
    buffer_store_dwordx4 v[212:215], v3, s[36:39], s40 offen offset:1024 sc1
    v_cvt_pk_bf16_f32 v216, v80, v81
    v_cvt_pk_bf16_f32 v217, v82, v83
    v_cvt_pk_bf16_f32 v218, v84, v85
    v_cvt_pk_bf16_f32 v219, v86, v87
    buffer_store_dwordx4 v[216:219], v3, s[36:39], s40 offen offset:2048 sc1
    v_cvt_pk_bf16_f32 v220, v88, v89
    v_cvt_pk_bf16_f32 v221, v90, v91
    v_cvt_pk_bf16_f32 v222, v92, v93
    v_cvt_pk_bf16_f32 v223, v94, v95
    buffer_store_dwordx4 v[220:223], v3, s[36:39], s40 offen offset:3072 sc1
    s_add_u32 s40, s40, 4096
    v_cvt_pk_bf16_f32 v224, v96, v97
    v_cvt_pk_bf16_f32 v225, v98, v99
    v_cvt_pk_bf16_f32 v226, v100, v101
    v_cvt_pk_bf16_f32 v227, v102, v103
    buffer_store_dwordx4 v[224:227], v3, s[36:39], s40 offen offset:0 sc1
    v_cvt_pk_bf16_f32 v228, v104, v105
    v_cvt_pk_bf16_f32 v229, v106, v107
    v_cvt_pk_bf16_f32 v230, v108, v109
    v_cvt_pk_bf16_f32 v231, v110, v111
    buffer_store_dwordx4 v[228:231], v3, s[36:39], s40 offen offset:1024 sc1
    v_cvt_pk_bf16_f32 v232, v112, v113
    v_cvt_pk_bf16_f32 v233, v114, v115
    v_cvt_pk_bf16_f32 v234, v116, v117
    v_cvt_pk_bf16_f32 v235, v118, v119
    buffer_store_dwordx4 v[232:235], v3, s[36:39], s40 offen offset:2048 sc1
    v_cvt_pk_bf16_f32 v236, v120, v121
    v_cvt_pk_bf16_f32 v237, v122, v123
    v_cvt_pk_bf16_f32 v238, v124, v125
    v_cvt_pk_bf16_f32 v239, v126, v127
    buffer_store_dwordx4 v[236:239], v3, s[36:39], s40 offen offset:3072 sc1
    s_add_u32 s40, s40, 4096
    v_cvt_pk_bf16_f32 v208, v128, v129
    v_cvt_pk_bf16_f32 v209, v130, v131
    v_cvt_pk_bf16_f32 v210, v132, v133
    v_cvt_pk_bf16_f32 v211, v134, v135
    buffer_store_dwordx4 v[208:211], v3, s[36:39], s40 offen offset:0 sc1
    s_branch K34_F1
K34_KEEP:
    ds_write_b128 v3, v[64:67] offset:0
    ds_write_b128 v3, v[68:71] offset:1024
    ds_write_b128 v3, v[72:75] offset:2048
    ds_write_b128 v3, v[76:79] offset:3072
    ds_write_b128 v3, v[80:83] offset:4096
    ds_write_b128 v3, v[84:87] offset:5120
    ds_write_b128 v3, v[88:91] offset:6144
    ds_write_b128 v3, v[92:95] offset:7168
    ds_write_b128 v3, v[96:99] offset:8192
    ds_write_b128 v3, v[100:103] offset:9216
    ds_write_b128 v3, v[104:107] offset:10240
    ds_write_b128 v3, v[108:111] offset:11264
    ds_write_b128 v3, v[112:115] offset:12288
    ds_write_b128 v3, v[116:119] offset:13312
    ds_write_b128 v3, v[120:123] offset:14336
    ds_write_b128 v3, v[124:127] offset:15360
    ds_write_b128 v3, v[128:131] offset:16384
    ds_write_b128 v3, v[132:135] offset:17408
K34_F1:
    s_waitcnt vmcnt(0) lgkmcnt(0)
    s_barrier
    s_branch K34_FINAL
K34_LOADER:
    s_mov_b32 s20, s4
    s_mov_b32 s21, s5
    s_mov_b32 s22, 5308416
    s_mov_b32 s23, 0x00020000
    s_mov_b32 s24, s6
    s_mov_b32 s25, s7
    s_mov_b32 s26, 5308416
    s_mov_b32 s27, 0x00020000
    s_add_u32 s28, s50, 2424832
    s_addc_u32 s29, s51, 0
    s_mov_b32 s30, 2359296
    s_mov_b32 s31, 0x00020000
    s_add_u32 s32, s50, 7340032
    s_addc_u32 s33, s51, 0
    s_mov_b32 s34, 18874368
    s_mov_b32 s35, 0x00020000
    s_mov_b32 s56, s8
    s_mov_b32 s57, s9
    s_mov_b32 s58, 5308416
    s_mov_b32 s59, 0x00020000
    s_cmp_lt_u32 s15, 2
    s_cselect_b32 s36, s4, s6
    s_cselect_b32 s37, s5, s7
    s_mov_b32 s38, 5308416
    s_mov_b32 s39, 0x00020000
    s_lshr_b32 s53, s15, 1
    s_lshl_b32 s18, s15, 6
    v_add_u32 v8, s18, v2
    s_and_b32 s18, s15, 1
    s_lshl_b32 s18, s18, 5
    s_add_u32 s19, s18, 256
    v_add_u32 v9, s19, v2
    v_mul_u32_u24 v12, 6554, v8
    v_lshrrev_b32 v12, 16, v12
    v_mul_u32_u24 v13, 10, v12
    v_sub_u32 v13, v8, v13
    v_lshrrev_b32 v14, 4, v12
    v_bfe_u32 v15, v12, 2, 2
    v_and_b32 v12, 3, v12
    v_lshl_add_u32 v12, v15, 3, v12
    v_lshl_add_u32 v12, v14, 2, v12
    v_mul_u32_u24 v12, 9216, v12
    v_lshl_add_u32 v8, v13, 4, v12
    v_mul_u32_u24 v12, 6554, v9
    v_lshrrev_b32 v12, 16, v12
    v_mul_u32_u24 v13, 10, v12
    v_sub_u32 v13, v9, v13
    v_lshrrev_b32 v14, 4, v12
    v_bfe_u32 v15, v12, 2, 2
    v_and_b32 v12, 3, v12
    v_lshl_add_u32 v12, v15, 3, v12
    v_lshl_add_u32 v12, v14, 2, v12
    v_mul_u32_u24 v12, 9216, v12
    v_lshl_add_u32 v9, v13, 4, v12
    s_mul_i32 s45, s13, 288
    s_lshl_b32 s19, s16, 7
    s_add_u32 s46, s45, s19
    s_xor_b32 s19, s19, 128
    s_add_u32 s45, s45, s19
    s_lshl_b32 s47, s15, 10
    s_mul_i32 s54, s53, 5120
    s_and_b32 s18, s15, 1
    s_lshl_b32 s18, s18, 9
    s_add_u32 s54, s54, s18
    s_lshl_b32 s44, s15, 12
    s_add_u32 s55, s45, 0
    s_add_u32 m0, s47, 143360
    s_nop 0
    buffer_load_dwordx4 v8, s[20:23], s55 offen lds
    s_add_u32 m0, s47, 148480
    s_nop 0
    buffer_load_dwordx4 v8, s[24:27], s55 offen lds
    s_add_u32 m0, s54, 147456
    s_mov_b64 exec, 0xffffffff
    buffer_load_dwordx4 v9, s[36:39], s55 offen lds
    s_mov_b64 exec, -1
    s_add_u32 s55, s45, 294912
    s_add_u32 m0, s47, 81920
    s_nop 0
    buffer_load_dwordx4 v8, s[20:23], s55 offen lds
    s_add_u32 m0, s47, 87040
    s_nop 0
    buffer_load_dwordx4 v8, s[24:27], s55 offen lds
    s_add_u32 m0, s54, 86016
    s_mov_b64 exec, 0xffffffff
    buffer_load_dwordx4 v9, s[36:39], s55 offen lds
    s_mov_b64 exec, -1
    s_add_u32 s55, s45, 589824
    s_add_u32 m0, s47, 92160
    s_nop 0
    buffer_load_dwordx4 v8, s[20:23], s55 offen lds
    s_add_u32 m0, s47, 97280
    s_nop 0
    buffer_load_dwordx4 v8, s[24:27], s55 offen lds
    s_add_u32 m0, s54, 96256
    s_mov_b64 exec, 0xffffffff
    buffer_load_dwordx4 v9, s[36:39], s55 offen lds
    s_mov_b64 exec, -1
    s_lshl_b32 s18, s12, 4
    s_lshl_b32 s19, s15, 2
    s_add_u32 s18, s18, s19
    s_add_u32 s18, s18, 0
    s_mul_i32 s40, s18, 18432
    s_lshl_b32 s18, s12, 4
    s_lshl_b32 s19, s15, 2
    s_add_u32 s18, s18, s19
    s_add_u32 s18, s18, 1
    s_mul_i32 s41, s18, 18432
    s_lshl_b32 s18, s12, 4
    s_lshl_b32 s19, s15, 2
    s_add_u32 s18, s18, s19
    s_add_u32 s18, s18, 2
    s_mul_i32 s42, s18, 18432
    s_lshl_b32 s18, s12, 4
    s_lshl_b32 s19, s15, 2
    s_add_u32 s18, s18, s19
    s_add_u32 s18, s18, 3
    s_mul_i32 s43, s18, 18432
    s_mov_b32 s71, 0
    s_cmp_lg_u32 s17, 4
    s_cbranch_scc1 K34_POLLLN_W
K34_POLLLN:
    buffer_load_dword v23, v19, s[60:63], 0 offen offset:0 sc1
    s_waitcnt vmcnt(0)
    v_readfirstlane_b32 s72, v23
    s_add_u32 s71, s71, 1
    s_lshr_b32 s72, s72, 0
    s_and_b32 s72, s72, 0xff
    s_cmp_ge_u32 s72, 32
    s_cbranch_scc1 K34_POLLLN_OK
    s_sleep 2
    s_cmp_lt_u32 s71, 0x100000
    s_cbranch_scc1 K34_POLLLN
K34_POLLLN_OK:
    v_mov_b32 v23, 1
    ds_write_b32 v7, v23
    s_branch K34_POLLLN_GO
K34_POLLLN_W:
    ds_read_b32 v23, v7
    s_waitcnt lgkmcnt(0)
    v_readfirstlane_b32 s72, v23
    s_add_u32 s71, s71, 1
    s_cmp_eq_u32 s72, 1
    s_cbranch_scc1 K34_POLLLN_GO
    s_sleep 1
    s_cmp_lt_u32 s71, 0x400000
    s_cbranch_scc1 K34_POLLLN_W
K34_POLLLN_GO:
    v_add_u32 v10, 0, v3
    s_add_u32 m0, s44, 0
    s_nop 0
    buffer_load_dwordx4 v10, s[28:31], s40 offen lds
    s_add_u32 m0, s44, 1024
    s_nop 0
    buffer_load_dwordx4 v10, s[28:31], s41 offen lds
    s_add_u32 m0, s44, 2048
    s_nop 0
    buffer_load_dwordx4 v10, s[28:31], s42 offen lds
    s_add_u32 m0, s44, 3072
    s_nop 0
    buffer_load_dwordx4 v10, s[28:31], s43 offen lds
    v_add_u32 v10, 1024, v3
    s_add_u32 m0, s44, 16384
    s_nop 0
    buffer_load_dwordx4 v10, s[28:31], s40 offen lds
    s_add_u32 m0, s44, 17408
    s_nop 0
    buffer_load_dwordx4 v10, s[28:31], s41 offen lds
    s_add_u32 m0, s44, 18432
    s_nop 0
    buffer_load_dwordx4 v10, s[28:31], s42 offen lds
    s_add_u32 m0, s44, 19456
    s_nop 0
    buffer_load_dwordx4 v10, s[28:31], s43 offen lds
    v_add_u32 v10, 2048, v3
    s_add_u32 m0, s44, 32768
    s_nop 0
    buffer_load_dwordx4 v10, s[28:31], s40 offen lds
    s_add_u32 m0, s44, 33792
    s_nop 0
    buffer_load_dwordx4 v10, s[28:31], s41 offen lds
    s_add_u32 m0, s44, 34816
    s_nop 0
    buffer_load_dwordx4 v10, s[28:31], s42 offen lds
    s_add_u32 m0, s44, 35840
    s_nop 0
    buffer_load_dwordx4 v10, s[28:31], s43 offen lds
    s_add_u32 s55, s45, 884736
    s_add_u32 m0, s47, 102400
    s_nop 0
    buffer_load_dwordx4 v8, s[20:23], s55 offen lds
    s_add_u32 m0, s47, 107520
    s_nop 0
    buffer_load_dwordx4 v8, s[24:27], s55 offen lds
    s_add_u32 m0, s54, 106496
    s_mov_b64 exec, 0xffffffff
    buffer_load_dwordx4 v9, s[36:39], s55 offen lds
    s_mov_b64 exec, -1
    s_add_u32 s55, s45, 1179648
    s_add_u32 m0, s47, 112640
    s_nop 0
    buffer_load_dwordx4 v8, s[20:23], s55 offen lds
    s_add_u32 m0, s47, 117760
    s_nop 0
    buffer_load_dwordx4 v8, s[24:27], s55 offen lds
    s_add_u32 m0, s54, 116736
    s_mov_b64 exec, 0xffffffff
    buffer_load_dwordx4 v9, s[36:39], s55 offen lds
    s_mov_b64 exec, -1
    s_and_b32 s18, s15, 1
    s_lshl_b32 s18, s18, 2
    s_lshl_b32 s19, s52, 3
    s_add_u32 s18, s18, s19
    s_add_u32 s18, s18, 0
    s_mul_i32 s18, s18, 144
    s_mul_i32 s19, s10, 36
    s_add_u32 s18, s18, s19
    s_lshl_b32 s64, s18, 10
    s_and_b32 s18, s15, 1
    s_lshl_b32 s18, s18, 2
    s_lshl_b32 s19, s52, 3
    s_add_u32 s18, s18, s19
    s_add_u32 s18, s18, 1
    s_mul_i32 s18, s18, 144
    s_mul_i32 s19, s10, 36
    s_add_u32 s18, s18, s19
    s_lshl_b32 s65, s18, 10
    s_and_b32 s18, s15, 1
    s_lshl_b32 s18, s18, 2
    s_lshl_b32 s19, s52, 3
    s_add_u32 s18, s18, s19
    s_add_u32 s18, s18, 2
    s_mul_i32 s18, s18, 144
    s_mul_i32 s19, s10, 36
    s_add_u32 s18, s18, s19
    s_lshl_b32 s66, s18, 10
    s_and_b32 s18, s15, 1
    s_lshl_b32 s18, s18, 2
    s_lshl_b32 s19, s52, 3
    s_add_u32 s18, s18, s19
    s_add_u32 s18, s18, 3
    s_mul_i32 s18, s18, 144
    s_mul_i32 s19, s10, 36
    s_add_u32 s18, s18, s19
    s_lshl_b32 s67, s18, 10
    s_lshl_b32 s18, s15, 7
    v_add_u32 v16, s18, v2
    v_add_u32 v17, 64, v16
    s_and_b32 s18, s15, 1
    s_lshl_b32 s18, s18, 5
    s_add_u32 s18, s18, 512
    v_add_u32 v18, s18, v2
    v_mul_u32_u24 v12, 3641, v16
    v_lshrrev_b32 v12, 16, v12
    v_mul_u32_u24 v13, 18, v12
    v_sub_u32 v13, v16, v13
    v_mul_u32_u24 v12, 1152, v12
    v_lshl_add_u32 v16, v13, 4, v12
    v_mul_u32_u24 v12, 3641, v17
    v_lshrrev_b32 v12, 16, v12
    v_mul_u32_u24 v13, 18, v12
    v_sub_u32 v13, v17, v13
    v_mul_u32_u24 v12, 1152, v12
    v_lshl_add_u32 v17, v13, 4, v12
    v_mul_u32_u24 v12, 3641, v18
    v_lshrrev_b32 v12, 16, v12
    v_mul_u32_u24 v13, 18, v12
    v_sub_u32 v13, v18, v13
    v_mul_u32_u24 v12, 1152, v12
    v_lshl_add_u32 v18, v13, 4, v12
    s_mul_i32 s68, s10, 1327104
    s_mul_i32 s18, s14, 288
    s_add_u32 s68, s68, s18
    s_lshl_b32 s69, s15, 11
    s_mul_i32 s70, s53, 9216
    s_and_b32 s18, s15, 1
    s_lshl_b32 s18, s18, 9
    s_add_u32 s70, s70, s18
    s_lshl_b32 s18, s12, 2
    s_add_u32 s18, s18, s10
    s_lshl_b32 s18, s18, 8
    v_mov_b32 v20, s18
    s_lshr_b32 s18, s52, 1
    s_lshl_b32 s18, s18, 2
    s_add_u32 s18, s18, s10
    s_lshl_b32 s18, s18, 8
    v_mov_b32 v21, s18
    v_mov_b32 v11, 0x100
    v_add_u32 v5, s44, v3
    s_waitcnt vmcnt(14)
    s_barrier
    s_waitcnt vmcnt(10)
    s_waitcnt lgkmcnt(0)
    s_barrier
    s_add_u32 s55, s45, 1474560
    s_add_u32 m0, s47, 122880
    s_nop 0
    buffer_load_dwordx4 v8, s[20:23], s55 offen lds
    s_add_u32 m0, s47, 128000
    s_nop 0
    buffer_load_dwordx4 v8, s[24:27], s55 offen lds
    s_add_u32 m0, s54, 126976
    s_mov_b64 exec, 0xffffffff
    buffer_load_dwordx4 v9, s[36:39], s55 offen lds
    s_mov_b64 exec, -1
    v_add_u32 v10, 3072, v3
    s_add_u32 m0, s44, 49152
    s_nop 0
    buffer_load_dwordx4 v10, s[28:31], s40 offen lds
    s_add_u32 m0, s44, 50176
    s_nop 0
    buffer_load_dwordx4 v10, s[28:31], s41 offen lds
    s_add_u32 m0, s44, 51200
    s_nop 0
    buffer_load_dwordx4 v10, s[28:31], s42 offen lds
    s_add_u32 m0, s44, 52224
    s_nop 0
    buffer_load_dwordx4 v10, s[28:31], s43 offen lds
    v_add_u32 v10, 4096, v3
    s_add_u32 m0, s44, 65536
    s_nop 0
    buffer_load_dwordx4 v10, s[28:31], s40 offen lds
    s_add_u32 m0, s44, 66560
    s_nop 0
    buffer_load_dwordx4 v10, s[28:31], s41 offen lds
    s_add_u32 m0, s44, 67584
    s_nop 0
    buffer_load_dwordx4 v10, s[28:31], s42 offen lds
    s_add_u32 m0, s44, 68608
    s_nop 0
    buffer_load_dwordx4 v10, s[28:31], s43 offen lds
    s_waitcnt vmcnt(17)
    s_waitcnt lgkmcnt(0)
    s_barrier
    s_add_u32 s55, s45, 1769472
    s_add_u32 m0, s47, 133120
    s_nop 0
    buffer_load_dwordx4 v8, s[20:23], s55 offen lds
    s_add_u32 m0, s47, 138240
    s_nop 0
    buffer_load_dwordx4 v8, s[24:27], s55 offen lds
    s_add_u32 m0, s54, 137216
    s_mov_b64 exec, 0xffffffff
    buffer_load_dwordx4 v9, s[36:39], s55 offen lds
    s_mov_b64 exec, -1
    v_add_u32 v10, 5120, v3
    s_add_u32 m0, s44, 0
    s_nop 0
    buffer_load_dwordx4 v10, s[28:31], s40 offen lds
    s_add_u32 m0, s44, 1024
    s_nop 0
    buffer_load_dwordx4 v10, s[28:31], s41 offen lds
    s_add_u32 m0, s44, 2048
    s_nop 0
    buffer_load_dwordx4 v10, s[28:31], s42 offen lds
    s_add_u32 m0, s44, 3072
    s_nop 0
    buffer_load_dwordx4 v10, s[28:31], s43 offen lds
    s_waitcnt vmcnt(11)
    s_waitcnt lgkmcnt(0)
    s_barrier
    s_add_u32 s55, s45, 2064384
    s_add_u32 m0, s47, 143360
    s_nop 0
    buffer_load_dwordx4 v8, s[20:23], s55 offen lds
    s_add_u32 m0, s47, 148480
    s_nop 0
    buffer_load_dwordx4 v8, s[24:27], s55 offen lds
    s_add_u32 m0, s54, 147456
    s_mov_b64 exec, 0xffffffff
    buffer_load_dwordx4 v9, s[36:39], s55 offen lds
    s_mov_b64 exec, -1
    v_add_u32 v10, 6144, v3
    s_add_u32 m0, s44, 16384
    s_nop 0
    buffer_load_dwordx4 v10, s[28:31], s40 offen lds
    s_add_u32 m0, s44, 17408
    s_nop 0
    buffer_load_dwordx4 v10, s[28:31], s41 offen lds
    s_add_u32 m0, s44, 18432
    s_nop 0
    buffer_load_dwordx4 v10, s[28:31], s42 offen lds
    s_add_u32 m0, s44, 19456
    s_nop 0
    buffer_load_dwordx4 v10, s[28:31], s43 offen lds
    s_waitcnt vmcnt(14)
    s_waitcnt lgkmcnt(0)
    s_barrier
    s_add_u32 s55, s45, 2359296
    s_add_u32 m0, s47, 81920
    s_nop 0
    buffer_load_dwordx4 v8, s[20:23], s55 offen lds
    s_add_u32 m0, s47, 87040
    s_nop 0
    buffer_load_dwordx4 v8, s[24:27], s55 offen lds
    s_add_u32 m0, s54, 86016
    s_mov_b64 exec, 0xffffffff
    buffer_load_dwordx4 v9, s[36:39], s55 offen lds
    s_mov_b64 exec, -1
    v_add_u32 v10, 7168, v3
    s_add_u32 m0, s44, 32768
    s_nop 0
    buffer_load_dwordx4 v10, s[28:31], s40 offen lds
    s_add_u32 m0, s44, 33792
    s_nop 0
    buffer_load_dwordx4 v10, s[28:31], s41 offen lds
    s_add_u32 m0, s44, 34816
    s_nop 0
    buffer_load_dwordx4 v10, s[28:31], s42 offen lds
    s_add_u32 m0, s44, 35840
    s_nop 0
    buffer_load_dwordx4 v10, s[28:31], s43 offen lds
    s_waitcnt vmcnt(14)
    s_waitcnt lgkmcnt(0)
    s_barrier
    s_add_u32 s55, s45, 2654208
    s_add_u32 m0, s47, 92160
    s_nop 0
    buffer_load_dwordx4 v8, s[20:23], s55 offen lds
    s_add_u32 m0, s47, 97280
    s_nop 0
    buffer_load_dwordx4 v8, s[24:27], s55 offen lds
    s_add_u32 m0, s54, 96256
    s_mov_b64 exec, 0xffffffff
    buffer_load_dwordx4 v9, s[36:39], s55 offen lds
    s_mov_b64 exec, -1
    v_add_u32 v10, 8192, v3
    s_add_u32 m0, s44, 49152
    s_nop 0
    buffer_load_dwordx4 v10, s[28:31], s40 offen lds
    s_add_u32 m0, s44, 50176
    s_nop 0
    buffer_load_dwordx4 v10, s[28:31], s41 offen lds
    s_add_u32 m0, s44, 51200
    s_nop 0
    buffer_load_dwordx4 v10, s[28:31], s42 offen lds
    s_add_u32 m0, s44, 52224
    s_nop 0
    buffer_load_dwordx4 v10, s[28:31], s43 offen lds
    s_waitcnt vmcnt(14)
    s_waitcnt lgkmcnt(0)
    s_barrier
    s_add_u32 s55, s45, 2949120
    s_add_u32 m0, s47, 102400
    s_nop 0
    buffer_load_dwordx4 v8, s[20:23], s55 offen lds
    s_add_u32 m0, s47, 107520
    s_nop 0
    buffer_load_dwordx4 v8, s[24:27], s55 offen lds
    s_add_u32 m0, s54, 106496
    s_mov_b64 exec, 0xffffffff
    buffer_load_dwordx4 v9, s[36:39], s55 offen lds
    s_mov_b64 exec, -1
    v_add_u32 v10, 9216, v3
    s_add_u32 m0, s44, 65536
    s_nop 0
    buffer_load_dwordx4 v10, s[28:31], s40 offen lds
    s_add_u32 m0, s44, 66560
    s_nop 0
    buffer_load_dwordx4 v10, s[28:31], s41 offen lds
    s_add_u32 m0, s44, 67584
    s_nop 0
    buffer_load_dwordx4 v10, s[28:31], s42 offen lds
    s_add_u32 m0, s44, 68608
    s_nop 0
    buffer_load_dwordx4 v10, s[28:31], s43 offen lds
    s_waitcnt vmcnt(14)
    s_waitcnt lgkmcnt(0)
    s_barrier
    s_add_u32 s55, s45, 3244032
    s_add_u32 m0, s47, 112640
    s_nop 0
    buffer_load_dwordx4 v8, s[20:23], s55 offen lds
    s_add_u32 m0, s47, 117760
    s_nop 0
    buffer_load_dwordx4 v8, s[24:27], s55 offen lds
    s_add_u32 m0, s54, 116736
    s_mov_b64 exec, 0xffffffff
    buffer_load_dwordx4 v9, s[36:39], s55 offen lds
    s_mov_b64 exec, -1
    v_add_u32 v10, 10240, v3
    s_add_u32 m0, s44, 0
    s_nop 0
    buffer_load_dwordx4 v10, s[28:31], s40 offen lds
    s_add_u32 m0, s44, 1024
    s_nop 0
    buffer_load_dwordx4 v10, s[28:31], s41 offen lds
    s_add_u32 m0, s44, 2048
    s_nop 0
    buffer_load_dwordx4 v10, s[28:31], s42 offen lds
    s_add_u32 m0, s44, 3072
    s_nop 0
    buffer_load_dwordx4 v10, s[28:31], s43 offen lds
    s_waitcnt vmcnt(14)
    s_waitcnt lgkmcnt(0)
    s_barrier
    s_add_u32 s55, s45, 3538944
    s_add_u32 m0, s47, 122880
    s_nop 0
    buffer_load_dwordx4 v8, s[20:23], s55 offen lds
    s_add_u32 m0, s47, 128000
    s_nop 0
    buffer_load_dwordx4 v8, s[24:27], s55 offen lds
    s_add_u32 m0, s54, 126976
    s_mov_b64 exec, 0xffffffff
    buffer_load_dwordx4 v9, s[36:39], s55 offen lds
    s_mov_b64 exec, -1
    v_add_u32 v10, 11264, v3
    s_add_u32 m0, s44, 16384
    s_nop 0
    buffer_load_dwordx4 v10, s[28:31], s40 offen lds
    s_add_u32 m0, s44, 17408
    s_nop 0
    buffer_load_dwordx4 v10, s[28:31], s41 offen lds
    s_add_u32 m0, s44, 18432
    s_nop 0
    buffer_load_dwordx4 v10, s[28:31], s42 offen lds
    s_add_u32 m0, s44, 19456
    s_nop 0
    buffer_load_dwordx4 v10, s[28:31], s43 offen lds
    s_waitcnt vmcnt(14)
    s_waitcnt lgkmcnt(0)
    s_barrier
    s_add_u32 s55, s45, 3833856
    s_add_u32 m0, s47, 133120
    s_nop 0
    buffer_load_dwordx4 v8, s[20:23], s55 offen lds
    s_add_u32 m0, s47, 138240
    s_nop 0
    buffer_load_dwordx4 v8, s[24:27], s55 offen lds
    s_add_u32 m0, s54, 137216
    s_mov_b64 exec, 0xffffffff
    buffer_load_dwordx4 v9, s[36:39], s55 offen lds
    s_mov_b64 exec, -1
    v_add_u32 v10, 12288, v3
    s_add_u32 m0, s44, 32768
    s_nop 0
    buffer_load_dwordx4 v10, s[28:31], s40 offen lds
    s_add_u32 m0, s44, 33792
    s_nop 0
    buffer_load_dwordx4 v10, s[28:31], s41 offen lds
    s_add_u32 m0, s44, 34816
    s_nop 0
    buffer_load_dwordx4 v10, s[28:31], s42 offen lds
    s_add_u32 m0, s44, 35840
    s_nop 0
    buffer_load_dwordx4 v10, s[28:31], s43 offen lds
    s_waitcnt vmcnt(14)
    s_waitcnt lgkmcnt(0)
    s_barrier
    s_add_u32 s55, s45, 4128768
    s_add_u32 m0, s47, 143360
    s_nop 0
    buffer_load_dwordx4 v8, s[20:23], s55 offen lds
    s_add_u32 m0, s47, 148480
    s_nop 0
    buffer_load_dwordx4 v8, s[24:27], s55 offen lds
    s_add_u32 m0, s54, 147456
    s_mov_b64 exec, 0xffffffff
    buffer_load_dwordx4 v9, s[36:39], s55 offen lds
    s_mov_b64 exec, -1
    v_add_u32 v10, 13312, v3
    s_add_u32 m0, s44, 49152
    s_nop 0
    buffer_load_dwordx4 v10, s[28:31], s40 offen lds
    s_add_u32 m0, s44, 50176
    s_nop 0
    buffer_load_dwordx4 v10, s[28:31], s41 offen lds
    s_add_u32 m0, s44, 51200
    s_nop 0
    buffer_load_dwordx4 v10, s[28:31], s42 offen lds
    s_add_u32 m0, s44, 52224
    s_nop 0
    buffer_load_dwordx4 v10, s[28:31], s43 offen lds
    s_waitcnt vmcnt(14)
    s_waitcnt lgkmcnt(0)
    s_barrier
    s_add_u32 s55, s45, 4423680
    s_add_u32 m0, s47, 81920
    s_nop 0
    buffer_load_dwordx4 v8, s[20:23], s55 offen lds
    s_add_u32 m0, s47, 87040
    s_nop 0
    buffer_load_dwordx4 v8, s[24:27], s55 offen lds
    s_add_u32 m0, s54, 86016
    s_mov_b64 exec, 0xffffffff
    buffer_load_dwordx4 v9, s[36:39], s55 offen lds
    s_mov_b64 exec, -1
    v_add_u32 v10, 14336, v3
    s_add_u32 m0, s44, 65536
    s_nop 0
    buffer_load_dwordx4 v10, s[28:31], s40 offen lds
    s_add_u32 m0, s44, 66560
    s_nop 0
    buffer_load_dwordx4 v10, s[28:31], s41 offen lds
    s_add_u32 m0, s44, 67584
    s_nop 0
    buffer_load_dwordx4 v10, s[28:31], s42 offen lds
    s_add_u32 m0, s44, 68608
    s_nop 0
    buffer_load_dwordx4 v10, s[28:31], s43 offen lds
    s_waitcnt vmcnt(14)
    s_waitcnt lgkmcnt(0)
    s_barrier
    s_add_u32 s55, s45, 4718592
    s_add_u32 m0, s47, 92160
    s_nop 0
    buffer_load_dwordx4 v8, s[20:23], s55 offen lds
    s_add_u32 m0, s47, 97280
    s_nop 0
    buffer_load_dwordx4 v8, s[24:27], s55 offen lds
    s_add_u32 m0, s54, 96256
    s_mov_b64 exec, 0xffffffff
    buffer_load_dwordx4 v9, s[36:39], s55 offen lds
    s_mov_b64 exec, -1
    v_add_u32 v10, 15360, v3
    s_add_u32 m0, s44, 0
    s_nop 0
    buffer_load_dwordx4 v10, s[28:31], s40 offen lds
    s_add_u32 m0, s44, 1024
    s_nop 0
    buffer_load_dwordx4 v10, s[28:31], s41 offen lds
    s_add_u32 m0, s44, 2048
    s_nop 0
    buffer_load_dwordx4 v10, s[28:31], s42 offen lds
    s_add_u32 m0, s44, 3072
    s_nop 0
    buffer_load_dwordx4 v10, s[28:31], s43 offen lds
    s_waitcnt vmcnt(14)
    s_waitcnt lgkmcnt(0)
    s_barrier
    s_add_u32 s55, s45, 5013504
    s_add_u32 m0, s47, 102400
    s_nop 0
    buffer_load_dwordx4 v8, s[20:23], s55 offen lds
    s_add_u32 m0, s47, 107520
    s_nop 0
    buffer_load_dwordx4 v8, s[24:27], s55 offen lds
    s_add_u32 m0, s54, 106496
    s_mov_b64 exec, 0xffffffff
    buffer_load_dwordx4 v9, s[36:39], s55 offen lds
    s_mov_b64 exec, -1
    v_add_u32 v10, 16384, v3
    s_add_u32 m0, s44, 16384
    s_nop 0
    buffer_load_dwordx4 v10, s[28:31], s40 offen lds
    s_add_u32 m0, s44, 17408
    s_nop 0
    buffer_load_dwordx4 v10, s[28:31], s41 offen lds
    s_add_u32 m0, s44, 18432
    s_nop 0
    buffer_load_dwordx4 v10, s[28:31], s42 offen lds
    s_add_u32 m0, s44, 19456
    s_nop 0
    buffer_load_dwordx4 v10, s[28:31], s43 offen lds
    s_waitcnt vmcnt(14)
    s_waitcnt lgkmcnt(0)
    s_barrier
    s_add_u32 s55, s46, 0
    s_add_u32 m0, s47, 112640
    s_nop 0
    buffer_load_dwordx4 v8, s[20:23], s55 offen lds
    s_add_u32 m0, s47, 117760
    s_nop 0
    buffer_load_dwordx4 v8, s[24:27], s55 offen lds
    s_add_u32 m0, s54, 116736
    s_mov_b64 exec, 0xffffffff
    buffer_load_dwordx4 v9, s[36:39], s55 offen lds
    s_mov_b64 exec, -1
    v_add_u32 v10, 17408, v3
    s_add_u32 m0, s44, 32768
    s_nop 0
    buffer_load_dwordx4 v10, s[28:31], s40 offen lds
    s_add_u32 m0, s44, 33792
    s_nop 0
    buffer_load_dwordx4 v10, s[28:31], s41 offen lds
    s_add_u32 m0, s44, 34816
    s_nop 0
    buffer_load_dwordx4 v10, s[28:31], s42 offen lds
    s_add_u32 m0, s44, 35840
    s_nop 0
    buffer_load_dwordx4 v10, s[28:31], s43 offen lds
    s_waitcnt vmcnt(14)
    s_waitcnt lgkmcnt(0)
    s_barrier
    s_add_u32 s55, s46, 294912
    s_add_u32 m0, s47, 122880
    s_nop 0
    buffer_load_dwordx4 v8, s[20:23], s55 offen lds
    s_add_u32 m0, s47, 128000
    s_nop 0
    buffer_load_dwordx4 v8, s[24:27], s55 offen lds
    s_add_u32 m0, s54, 126976
    s_mov_b64 exec, 0xffffffff
    buffer_load_dwordx4 v9, s[36:39], s55 offen lds
    s_mov_b64 exec, -1
    v_add_u32 v10, 0, v3
    s_add_u32 m0, s44, 49152
    s_nop 0
    buffer_load_dwordx4 v10, s[28:31], s40 offen lds
    s_add_u32 m0, s44, 50176
    s_nop 0
    buffer_load_dwordx4 v10, s[28:31], s41 offen lds
    s_add_u32 m0, s44, 51200
    s_nop 0
    buffer_load_dwordx4 v10, s[28:31], s42 offen lds
    s_add_u32 m0, s44, 52224
    s_nop 0
    buffer_load_dwordx4 v10, s[28:31], s43 offen lds
    s_waitcnt vmcnt(14)
    s_waitcnt lgkmcnt(0)
    s_barrier
    s_add_u32 s55, s46, 589824
    s_add_u32 m0, s47, 133120
    s_nop 0
    buffer_load_dwordx4 v8, s[20:23], s55 offen lds
    s_add_u32 m0, s47, 138240
    s_nop 0
    buffer_load_dwordx4 v8, s[24:27], s55 offen lds
    s_add_u32 m0, s54, 137216
    s_mov_b64 exec, 0xffffffff
    buffer_load_dwordx4 v9, s[36:39], s55 offen lds
    s_mov_b64 exec, -1
    v_add_u32 v10, 1024, v3
    s_add_u32 m0, s44, 65536
    s_nop 0
    buffer_load_dwordx4 v10, s[28:31], s40 offen lds
    s_add_u32 m0, s44, 66560
    s_nop 0
    buffer_load_dwordx4 v10, s[28:31], s41 offen lds
    s_add_u32 m0, s44, 67584
    s_nop 0
    buffer_load_dwordx4 v10, s[28:31], s42 offen lds
    s_add_u32 m0, s44, 68608
    s_nop 0
    buffer_load_dwordx4 v10, s[28:31], s43 offen lds
    s_waitcnt vmcnt(14)
    s_waitcnt lgkmcnt(0)
    s_barrier
    s_add_u32 s55, s46, 884736
    s_add_u32 m0, s47, 143360
    s_nop 0
    buffer_load_dwordx4 v8, s[20:23], s55 offen lds
    s_add_u32 m0, s47, 148480
    s_nop 0
    buffer_load_dwordx4 v8, s[24:27], s55 offen lds
    s_add_u32 m0, s54, 147456
    s_mov_b64 exec, 0xffffffff
    buffer_load_dwordx4 v9, s[36:39], s55 offen lds
    s_mov_b64 exec, -1
    v_add_u32 v10, 2048, v3
    s_add_u32 m0, s44, 0
    s_nop 0
    buffer_load_dwordx4 v10, s[28:31], s40 offen lds
    s_add_u32 m0, s44, 1024
    s_nop 0
    buffer_load_dwordx4 v10, s[28:31], s41 offen lds
    s_add_u32 m0, s44, 2048
    s_nop 0
    buffer_load_dwordx4 v10, s[28:31], s42 offen lds
    s_add_u32 m0, s44, 3072
    s_nop 0
    buffer_load_dwordx4 v10, s[28:31], s43 offen lds
    s_waitcnt vmcnt(14)
    s_waitcnt lgkmcnt(0)
    s_barrier
    s_add_u32 s55, s46, 1179648
    s_add_u32 m0, s47, 81920
    s_nop 0
    buffer_load_dwordx4 v8, s[20:23], s55 offen lds
    s_add_u32 m0, s47, 87040
    s_nop 0
    buffer_load_dwordx4 v8, s[24:27], s55 offen lds
    s_add_u32 m0, s54, 86016
    s_mov_b64 exec, 0xffffffff
    buffer_load_dwordx4 v9, s[36:39], s55 offen lds
    s_mov_b64 exec, -1
    v_add_u32 v10, 3072, v3
    s_add_u32 m0, s44, 16384
    s_nop 0
    buffer_load_dwordx4 v10, s[28:31], s40 offen lds
    s_add_u32 m0, s44, 17408
    s_nop 0
    buffer_load_dwordx4 v10, s[28:31], s41 offen lds
    s_add_u32 m0, s44, 18432
    s_nop 0
    buffer_load_dwordx4 v10, s[28:31], s42 offen lds
    s_add_u32 m0, s44, 19456
    s_nop 0
    buffer_load_dwordx4 v10, s[28:31], s43 offen lds
    s_waitcnt vmcnt(14)
    s_waitcnt lgkmcnt(0)
    s_barrier
    s_add_u32 s55, s46, 1474560
    s_add_u32 m0, s47, 92160
    s_nop 0
    buffer_load_dwordx4 v8, s[20:23], s55 offen lds
    s_add_u32 m0, s47, 97280
    s_nop 0
    buffer_load_dwordx4 v8, s[24:27], s55 offen lds
    s_add_u32 m0, s54, 96256
    s_mov_b64 exec, 0xffffffff
    buffer_load_dwordx4 v9, s[36:39], s55 offen lds
    s_mov_b64 exec, -1
    v_add_u32 v10, 4096, v3
    s_add_u32 m0, s44, 32768
    s_nop 0
    buffer_load_dwordx4 v10, s[28:31], s40 offen lds
    s_add_u32 m0, s44, 33792
    s_nop 0
    buffer_load_dwordx4 v10, s[28:31], s41 offen lds
    s_add_u32 m0, s44, 34816
    s_nop 0
    buffer_load_dwordx4 v10, s[28:31], s42 offen lds
    s_add_u32 m0, s44, 35840
    s_nop 0
    buffer_load_dwordx4 v10, s[28:31], s43 offen lds
    s_waitcnt vmcnt(14)
    s_waitcnt lgkmcnt(0)
    s_barrier
    s_add_u32 s55, s46, 1769472
    s_add_u32 m0, s47, 102400
    s_nop 0
    buffer_load_dwordx4 v8, s[20:23], s55 offen lds
    s_add_u32 m0, s47, 107520
    s_nop 0
    buffer_load_dwordx4 v8, s[24:27], s55 offen lds
    s_add_u32 m0, s54, 106496
    s_mov_b64 exec, 0xffffffff
    buffer_load_dwordx4 v9, s[36:39], s55 offen lds
    s_mov_b64 exec, -1
    v_add_u32 v10, 5120, v3
    s_add_u32 m0, s44, 49152
    s_nop 0
    buffer_load_dwordx4 v10, s[28:31], s40 offen lds
    s_add_u32 m0, s44, 50176
    s_nop 0
    buffer_load_dwordx4 v10, s[28:31], s41 offen lds
    s_add_u32 m0, s44, 51200
    s_nop 0
    buffer_load_dwordx4 v10, s[28:31], s42 offen lds
    s_add_u32 m0, s44, 52224
    s_nop 0
    buffer_load_dwordx4 v10, s[28:31], s43 offen lds
    s_waitcnt vmcnt(14)
    s_waitcnt lgkmcnt(0)
    s_barrier
    s_add_u32 s55, s46, 2064384
    s_add_u32 m0, s47, 112640
    s_nop 0
    buffer_load_dwordx4 v8, s[20:23], s55 offen lds
    s_add_u32 m0, s47, 117760
    s_nop 0
    buffer_load_dwordx4 v8, s[24:27], s55 offen lds
    s_add_u32 m0, s54, 116736
    s_mov_b64 exec, 0xffffffff
    buffer_load_dwordx4 v9, s[36:39], s55 offen lds
    s_mov_b64 exec, -1
    v_add_u32 v10, 6144, v3
    s_add_u32 m0, s44, 65536
    s_nop 0
    buffer_load_dwordx4 v10, s[28:31], s40 offen lds
    s_add_u32 m0, s44, 66560
    s_nop 0
    buffer_load_dwordx4 v10, s[28:31], s41 offen lds
    s_add_u32 m0, s44, 67584
    s_nop 0
    buffer_load_dwordx4 v10, s[28:31], s42 offen lds
    s_add_u32 m0, s44, 68608
    s_nop 0
    buffer_load_dwordx4 v10, s[28:31], s43 offen lds
    s_waitcnt vmcnt(14)
    s_waitcnt lgkmcnt(0)
    s_barrier
    s_add_u32 s55, s46, 2359296
    s_add_u32 m0, s47, 122880
    s_nop 0
    buffer_load_dwordx4 v8, s[20:23], s55 offen lds
    s_add_u32 m0, s47, 128000
    s_nop 0
    buffer_load_dwordx4 v8, s[24:27], s55 offen lds
    s_add_u32 m0, s54, 126976
    s_mov_b64 exec, 0xffffffff
    buffer_load_dwordx4 v9, s[36:39], s55 offen lds
    s_mov_b64 exec, -1
    v_add_u32 v10, 7168, v3
    s_add_u32 m0, s44, 0
    s_nop 0
    buffer_load_dwordx4 v10, s[28:31], s40 offen lds
    s_add_u32 m0, s44, 1024
    s_nop 0
    buffer_load_dwordx4 v10, s[28:31], s41 offen lds
    s_add_u32 m0, s44, 2048
    s_nop 0
    buffer_load_dwordx4 v10, s[28:31], s42 offen lds
    s_add_u32 m0, s44, 3072
    s_nop 0
    buffer_load_dwordx4 v10, s[28:31], s43 offen lds
    s_waitcnt vmcnt(14)
    s_waitcnt lgkmcnt(0)
    s_barrier
    s_add_u32 s55, s46, 2654208
    s_add_u32 m0, s47, 133120
    s_nop 0
    buffer_load_dwordx4 v8, s[20:23], s55 offen lds
    s_add_u32 m0, s47, 138240
    s_nop 0
    buffer_load_dwordx4 v8, s[24:27], s55 offen lds
    s_add_u32 m0, s54, 137216
    s_mov_b64 exec, 0xffffffff
    buffer_load_dwordx4 v9, s[36:39], s55 offen lds
    s_mov_b64 exec, -1
    v_add_u32 v10, 8192, v3
    s_add_u32 m0, s44, 16384
    s_nop 0
    buffer_load_dwordx4 v10, s[28:31], s40 offen lds
    s_add_u32 m0, s44, 17408
    s_nop 0
    buffer_load_dwordx4 v10, s[28:31], s41 offen lds
    s_add_u32 m0, s44, 18432
    s_nop 0
    buffer_load_dwordx4 v10, s[28:31], s42 offen lds
    s_add_u32 m0, s44, 19456
    s_nop 0
    buffer_load_dwordx4 v10, s[28:31], s43 offen lds
    s_waitcnt vmcnt(14)
    s_waitcnt lgkmcnt(0)
    s_barrier
    s_add_u32 s55, s46, 2949120
    s_add_u32 m0, s47, 143360
    s_nop 0
    buffer_load_dwordx4 v8, s[20:23], s55 offen lds
    s_add_u32 m0, s47, 148480
    s_nop 0
    buffer_load_dwordx4 v8, s[24:27], s55 offen lds
    s_add_u32 m0, s54, 147456
    s_mov_b64 exec, 0xffffffff
    buffer_load_dwordx4 v9, s[36:39], s55 offen lds
    s_mov_b64 exec, -1
    v_add_u32 v10, 9216, v3
    s_add_u32 m0, s44, 32768
    s_nop 0
    buffer_load_dwordx4 v10, s[28:31], s40 offen lds
    s_add_u32 m0, s44, 33792
    s_nop 0
    buffer_load_dwordx4 v10, s[28:31], s41 offen lds
    s_add_u32 m0, s44, 34816
    s_nop 0
    buffer_load_dwordx4 v10, s[28:31], s42 offen lds
    s_add_u32 m0, s44, 35840
    s_nop 0
    buffer_load_dwordx4 v10, s[28:31], s43 offen lds
    s_waitcnt vmcnt(14)
    s_waitcnt lgkmcnt(0)
    s_barrier
    s_add_u32 s55, s46, 3244032
    s_add_u32 m0, s47, 81920
    s_nop 0
    buffer_load_dwordx4 v8, s[20:23], s55 offen lds
    s_add_u32 m0, s47, 87040
    s_nop 0
    buffer_load_dwordx4 v8, s[24:27], s55 offen lds
    s_add_u32 m0, s54, 86016
    s_mov_b64 exec, 0xffffffff
    buffer_load_dwordx4 v9, s[36:39], s55 offen lds
    s_mov_b64 exec, -1
    v_add_u32 v10, 10240, v3
    s_add_u32 m0, s44, 49152
    s_nop 0
    buffer_load_dwordx4 v10, s[28:31], s40 offen lds
    s_add_u32 m0, s44, 50176
    s_nop 0
    buffer_load_dwordx4 v10, s[28:31], s41 offen lds
    s_add_u32 m0, s44, 51200
    s_nop 0
    buffer_load_dwordx4 v10, s[28:31], s42 offen lds
    s_add_u32 m0, s44, 52224
    s_nop 0
    buffer_load_dwordx4 v10, s[28:31], s43 offen lds
    s_waitcnt vmcnt(14)
    s_waitcnt lgkmcnt(0)
    s_barrier
    s_add_u32 s55, s46, 3538944
    s_add_u32 m0, s47, 92160
    s_nop 0
    buffer_load_dwordx4 v8, s[20:23], s55 offen lds
    s_add_u32 m0, s47, 97280
    s_nop 0
    buffer_load_dwordx4 v8, s[24:27], s55 offen lds
    s_add_u32 m0, s54, 96256
    s_mov_b64 exec, 0xffffffff
    buffer_load_dwordx4 v9, s[36:39], s55 offen lds
    s_mov_b64 exec, -1
    v_add_u32 v10, 11264, v3
    s_add_u32 m0, s44, 65536
    s_nop 0
    buffer_load_dwordx4 v10, s[28:31], s40 offen lds
    s_add_u32 m0, s44, 66560
    s_nop 0
    buffer_load_dwordx4 v10, s[28:31], s41 offen lds
    s_add_u32 m0, s44, 67584
    s_nop 0
    buffer_load_dwordx4 v10, s[28:31], s42 offen lds
    s_add_u32 m0, s44, 68608
    s_nop 0
    buffer_load_dwordx4 v10, s[28:31], s43 offen lds
    s_waitcnt vmcnt(14)
    s_waitcnt lgkmcnt(0)
    s_barrier
    s_add_u32 s55, s46, 3833856
    s_add_u32 m0, s47, 102400
    s_nop 0
    buffer_load_dwordx4 v8, s[20:23], s55 offen lds
    s_add_u32 m0, s47, 107520
    s_nop 0
    buffer_load_dwordx4 v8, s[24:27], s55 offen lds
    s_add_u32 m0, s54, 106496
    s_mov_b64 exec, 0xffffffff
    buffer_load_dwordx4 v9, s[36:39], s55 offen lds
    s_mov_b64 exec, -1
    v_add_u32 v10, 12288, v3
    s_add_u32 m0, s44, 0
    s_nop 0
    buffer_load_dwordx4 v10, s[28:31], s40 offen lds
    s_add_u32 m0, s44, 1024
    s_nop 0
    buffer_load_dwordx4 v10, s[28:31], s41 offen lds
    s_add_u32 m0, s44, 2048
    s_nop 0
    buffer_load_dwordx4 v10, s[28:31], s42 offen lds
    s_add_u32 m0, s44, 3072
    s_nop 0
    buffer_load_dwordx4 v10, s[28:31], s43 offen lds
    s_waitcnt vmcnt(14)
    s_waitcnt lgkmcnt(0)
    s_barrier
    s_add_u32 s55, s46, 4128768
    s_add_u32 m0, s47, 112640
    s_nop 0
    buffer_load_dwordx4 v8, s[20:23], s55 offen lds
    s_add_u32 m0, s47, 117760
    s_nop 0
    buffer_load_dwordx4 v8, s[24:27], s55 offen lds
    s_add_u32 m0, s54, 116736
    s_mov_b64 exec, 0xffffffff
    buffer_load_dwordx4 v9, s[36:39], s55 offen lds
    s_mov_b64 exec, -1
    v_add_u32 v10, 13312, v3
    s_add_u32 m0, s44, 16384
    s_nop 0
    buffer_load_dwordx4 v10, s[28:31], s40 offen lds
    s_add_u32 m0, s44, 17408
    s_nop 0
    buffer_load_dwordx4 v10, s[28:31], s41 offen lds
    s_add_u32 m0, s44, 18432
    s_nop 0
    buffer_load_dwordx4 v10, s[28:31], s42 offen lds
    s_add_u32 m0, s44, 19456
    s_nop 0
    buffer_load_dwordx4 v10, s[28:31], s43 offen lds
    s_waitcnt vmcnt(14)
    s_waitcnt lgkmcnt(0)
    s_barrier
    s_add_u32 s55, s46, 4423680
    s_add_u32 m0, s47, 122880
    s_nop 0
    buffer_load_dwordx4 v8, s[20:23], s55 offen lds
    s_add_u32 m0, s47, 128000
    s_nop 0
    buffer_load_dwordx4 v8, s[24:27], s55 offen lds
    s_add_u32 m0, s54, 126976
    s_mov_b64 exec, 0xffffffff
    buffer_load_dwordx4 v9, s[36:39], s55 offen lds
    s_mov_b64 exec, -1
    v_add_u32 v10, 14336, v3
    s_add_u32 m0, s44, 32768
    s_nop 0
    buffer_load_dwordx4 v10, s[28:31], s40 offen lds
    s_add_u32 m0, s44, 33792
    s_nop 0
    buffer_load_dwordx4 v10, s[28:31], s41 offen lds
    s_add_u32 m0, s44, 34816
    s_nop 0
    buffer_load_dwordx4 v10, s[28:31], s42 offen lds
    s_add_u32 m0, s44, 35840
    s_nop 0
    buffer_load_dwordx4 v10, s[28:31], s43 offen lds
    s_waitcnt vmcnt(14)
    s_waitcnt lgkmcnt(0)
    s_barrier
    s_cmp_lg_u32 s17, 4
    s_cbranch_scc1 K34_SIGA
    s_mov_b64 exec, 1
    buffer_atomic_add v22, v20, s[60:63], 0 offen offset:0 sc1
    s_mov_b64 exec, -1
K34_SIGA:
    s_add_u32 s55, s46, 4718592
    s_add_u32 m0, s47, 133120
    s_nop 0
    buffer_load_dwordx4 v8, s[20:23], s55 offen lds
    s_add_u32 m0, s47, 138240
    s_nop 0
    buffer_load_dwordx4 v8, s[24:27], s55 offen lds
    s_add_u32 m0, s54, 137216
    s_mov_b64 exec, 0xffffffff
    buffer_load_dwordx4 v9, s[36:39], s55 offen lds
    s_mov_b64 exec, -1
    v_add_u32 v10, 15360, v3
    s_add_u32 m0, s44, 49152
    s_nop 0
    buffer_load_dwordx4 v10, s[28:31], s40 offen lds
    s_add_u32 m0, s44, 50176
    s_nop 0
    buffer_load_dwordx4 v10, s[28:31], s41 offen lds
    s_add_u32 m0, s44, 51200
    s_nop 0
    buffer_load_dwordx4 v10, s[28:31], s42 offen lds
    s_add_u32 m0, s44, 52224
    s_nop 0
    buffer_load_dwordx4 v10, s[28:31], s43 offen lds
    s_waitcnt vmcnt(14)
    s_waitcnt lgkmcnt(0)
    s_barrier
    s_add_u32 s55, s46, 5013504
    s_add_u32 m0, s47, 143360
    s_nop 0
    buffer_load_dwordx4 v8, s[20:23], s55 offen lds
    s_add_u32 m0, s47, 148480
    s_nop 0
    buffer_load_dwordx4 v8, s[24:27], s55 offen lds
    s_add_u32 m0, s54, 147456
    s_mov_b64 exec, 0xffffffff
    buffer_load_dwordx4 v9, s[36:39], s55 offen lds
    s_mov_b64 exec, -1
    v_add_u32 v10, 16384, v3
    s_add_u32 m0, s44, 65536
    s_nop 0
    buffer_load_dwordx4 v10, s[28:31], s40 offen lds
    s_add_u32 m0, s44, 66560
    s_nop 0
    buffer_load_dwordx4 v10, s[28:31], s41 offen lds
    s_add_u32 m0, s44, 67584
    s_nop 0
    buffer_load_dwordx4 v10, s[28:31], s42 offen lds
    s_add_u32 m0, s44, 68608
    s_nop 0
    buffer_load_dwordx4 v10, s[28:31], s43 offen lds
    s_waitcnt vmcnt(14)
    s_waitcnt lgkmcnt(0)
    s_barrier
    s_add_u32 s72, s68, 73728
    s_add_u32 s73, s68, 110592
    s_cmp_eq_u32 s53, 0
    s_cselect_b32 s74, s72, s73
    s_add_u32 m0, s69, 81920
    s_nop 0
    buffer_load_dwordx4 v16, s[56:59], s72 offen lds
    s_add_u32 m0, s69, 82944
    s_nop 0
    buffer_load_dwordx4 v17, s[56:59], s72 offen lds
    s_add_u32 m0, s69, 91136
    s_nop 0
    buffer_load_dwordx4 v16, s[56:59], s73 offen lds
    s_add_u32 m0, s69, 92160
    s_nop 0
    buffer_load_dwordx4 v17, s[56:59], s73 offen lds
    s_add_u32 m0, s70, 90112
    s_mov_b64 exec, 0xffffffff
    buffer_load_dwordx4 v18, s[56:59], s74 offen lds
    s_mov_b64 exec, -1
    v_add_u32 v10, 17408, v3
    s_add_u32 m0, s44, 0
    s_nop 0
    buffer_load_dwordx4 v10, s[28:31], s40 offen lds
    s_add_u32 m0, s44, 1024
    s_nop 0
    buffer_load_dwordx4 v10, s[28:31], s41 offen lds
    s_add_u32 m0, s44, 2048
    s_nop 0
    buffer_load_dwordx4 v10, s[28:31], s42 offen lds
    s_add_u32 m0, s44, 3072
    s_nop 0
    buffer_load_dwordx4 v10, s[28:31], s43 offen lds
    s_waitcnt vmcnt(16)
    s_waitcnt lgkmcnt(0)
    s_barrier
    s_waitcnt vmcnt(9)
    s_waitcnt lgkmcnt(0)
    s_barrier
    s_add_u32 s72, s68, 147456
    s_add_u32 s73, s68, 184320
    s_cmp_eq_u32 s53, 0
    s_cselect_b32 s74, s72, s73
    s_add_u32 m0, s69, 100352
    s_nop 0
    buffer_load_dwordx4 v16, s[56:59], s72 offen lds
    s_add_u32 m0, s69, 101376
    s_nop 0
    buffer_load_dwordx4 v17, s[56:59], s72 offen lds
    s_add_u32 m0, s69, 109568
    s_nop 0
    buffer_load_dwordx4 v16, s[56:59], s73 offen lds
    s_add_u32 m0, s69, 110592
    s_nop 0
    buffer_load_dwordx4 v17, s[56:59], s73 offen lds
    s_add_u32 m0, s70, 108544
    s_mov_b64 exec, 0xffffffff
    buffer_load_dwordx4 v18, s[56:59], s74 offen lds
    s_mov_b64 exec, -1
    s_waitcnt vmcnt(5)
    s_waitcnt lgkmcnt(0)
    s_barrier
    s_mov_b32 s71, 0
    s_cmp_lg_u32 s17, 4
    s_cbranch_scc1 K34_POLL36_W
K34_POLL36:
    buffer_load_dword v23, v21, s[60:63], 0 offen offset:0 sc1
    s_waitcnt vmcnt(0)
    v_readfirstlane_b32 s72, v23
    s_add_u32 s71, s71, 1
    s_lshr_b32 s72, s72, 0
    s_and_b32 s72, s72, 0xff
    s_cmp_ge_u32 s72, 8
    s_cbranch_scc1 K34_POLL36_OK
    s_sleep 2
    s_cmp_lt_u32 s71, 0x100000
    s_cbranch_scc1 K34_POLL36
K34_POLL36_OK:
    v_mov_b32 v23, 2
    ds_write_b32 v7, v23
    s_branch K34_POLL36_GO
K34_POLL36_W:
    ds_read_b32 v23, v7
    s_waitcnt lgkmcnt(0)
    v_readfirstlane_b32 s72, v23
    s_add_u32 s71, s71, 1
    s_cmp_eq_u32 s72, 2
    s_cbranch_scc1 K34_POLL36_GO
    s_sleep 1
    s_cmp_lt_u32 s71, 0x400000
    s_cbranch_scc1 K34_POLL36_W
K34_POLL36_GO:
    s_cmp_eq_u32 s53, 0
    s_mov_b32 s75, 2048
    s_mov_b32 s76, 3072
    s_cselect_b32 s75, s75, s76
    v_add_u32 v10, s75, v3
    s_add_u32 m0, s44, 16384
    s_nop 0
    buffer_load_dwordx4 v10, s[32:35], s64 offen lds
    s_add_u32 m0, s44, 17408
    s_nop 0
    buffer_load_dwordx4 v10, s[32:35], s65 offen lds
    s_add_u32 m0, s44, 18432
    s_nop 0
    buffer_load_dwordx4 v10, s[32:35], s66 offen lds
    s_add_u32 m0, s44, 19456
    s_nop 0
    buffer_load_dwordx4 v10, s[32:35], s67 offen lds
    s_cmp_eq_u32 s53, 0
    s_mov_b32 s75, 4096
    s_mov_b32 s76, 5120
    s_cselect_b32 s75, s75, s76
    v_add_u32 v10, s75, v3
    s_add_u32 m0, s44, 32768
    s_nop 0
    buffer_load_dwordx4 v10, s[32:35], s64 offen lds
    s_add_u32 m0, s44, 33792
    s_nop 0
    buffer_load_dwordx4 v10, s[32:35], s65 offen lds
    s_add_u32 m0, s44, 34816
    s_nop 0
    buffer_load_dwordx4 v10, s[32:35], s66 offen lds
    s_add_u32 m0, s44, 35840
    s_nop 0
    buffer_load_dwordx4 v10, s[32:35], s67 offen lds
    s_cmp_eq_u32 s53, 0
    s_mov_b32 s75, 6144
    s_mov_b32 s76, 11264
    s_cselect_b32 s75, s75, s76
    v_add_u32 v10, s75, v3
    s_add_u32 m0, s44, 49152
    s_nop 0
    buffer_load_dwordx4 v10, s[32:35], s64 offen lds
    s_add_u32 m0, s44, 50176
    s_nop 0
    buffer_load_dwordx4 v10, s[32:35], s65 offen lds
    s_add_u32 m0, s44, 51200
    s_nop 0
    buffer_load_dwordx4 v10, s[32:35], s66 offen lds
    s_add_u32 m0, s44, 52224
    s_nop 0
    buffer_load_dwordx4 v10, s[32:35], s67 offen lds
    s_waitcnt vmcnt(8)
    s_waitcnt lgkmcnt(0)
    s_barrier
    s_add_u32 s72, s68, 221184
    s_add_u32 s73, s68, 405504
    s_cmp_eq_u32 s53, 0
    s_cselect_b32 s74, s72, s73
    s_add_u32 m0, s69, 118784
    s_nop 0
    buffer_load_dwordx4 v16, s[56:59], s72 offen lds
    s_add_u32 m0, s69, 119808
    s_nop 0
    buffer_load_dwordx4 v17, s[56:59], s72 offen lds
    s_add_u32 m0, s69, 128000
    s_nop 0
    buffer_load_dwordx4 v16, s[56:59], s73 offen lds
    s_add_u32 m0, s69, 129024
    s_nop 0
    buffer_load_dwordx4 v17, s[56:59], s73 offen lds
    s_add_u32 m0, s70, 126976
    s_mov_b64 exec, 0xffffffff
    buffer_load_dwordx4 v18, s[56:59], s74 offen lds
    s_mov_b64 exec, -1
    s_cmp_eq_u32 s53, 0
    s_mov_b32 s75, 12288
    s_mov_b32 s76, 13312
    s_cselect_b32 s75, s75, s76
    v_add_u32 v10, s75, v3
    s_add_u32 m0, s44, 65536
    s_nop 0
    buffer_load_dwordx4 v10, s[32:35], s64 offen lds
    s_add_u32 m0, s44, 66560
    s_nop 0
    buffer_load_dwordx4 v10, s[32:35], s65 offen lds
    s_add_u32 m0, s44, 67584
    s_nop 0
    buffer_load_dwordx4 v10, s[32:35], s66 offen lds
    s_add_u32 m0, s44, 68608
    s_nop 0
    buffer_load_dwordx4 v10, s[32:35], s67 offen lds
    s_waitcnt vmcnt(13)
    s_barrier
    s_add_u32 s72, s68, 442368
    s_add_u32 s73, s68, 479232
    s_cmp_eq_u32 s53, 0
    s_cselect_b32 s74, s72, s73
    s_add_u32 m0, s69, 137216
    s_nop 0
    buffer_load_dwordx4 v16, s[56:59], s72 offen lds
    s_add_u32 m0, s69, 138240
    s_nop 0
    buffer_load_dwordx4 v17, s[56:59], s72 offen lds
    s_add_u32 m0, s69, 146432
    s_nop 0
    buffer_load_dwordx4 v16, s[56:59], s73 offen lds
    s_add_u32 m0, s69, 147456
    s_nop 0
    buffer_load_dwordx4 v17, s[56:59], s73 offen lds
    s_add_u32 m0, s70, 145408
    s_mov_b64 exec, 0xffffffff
    buffer_load_dwordx4 v18, s[56:59], s74 offen lds
    s_mov_b64 exec, -1
    s_cmp_eq_u32 s53, 0
    s_mov_b32 s75, 14336
    s_mov_b32 s76, 15360
    s_cselect_b32 s75, s75, s76
    v_add_u32 v10, s75, v3
    s_add_u32 m0, s44, 0
    s_nop 0
    buffer_load_dwordx4 v10, s[32:35], s64 offen lds
    s_add_u32 m0, s44, 1024
    s_nop 0
    buffer_load_dwordx4 v10, s[32:35], s65 offen lds
    s_add_u32 m0, s44, 2048
    s_nop 0
    buffer_load_dwordx4 v10, s[32:35], s66 offen lds
    s_add_u32 m0, s44, 3072
    s_nop 0
    buffer_load_dwordx4 v10, s[32:35], s67 offen lds
    s_waitcnt vmcnt(13)
    s_barrier
    s_add_u32 s72, s68, 516096
    s_add_u32 s73, s68, 552960
    s_cmp_eq_u32 s53, 0
    s_cselect_b32 s74, s72, s73
    s_add_u32 m0, s69, 81920
    s_nop 0
    buffer_load_dwordx4 v16, s[56:59], s72 offen lds
    s_add_u32 m0, s69, 82944
    s_nop 0
    buffer_load_dwordx4 v17, s[56:59], s72 offen lds
    s_add_u32 m0, s69, 91136
    s_nop 0
    buffer_load_dwordx4 v16, s[56:59], s73 offen lds
    s_add_u32 m0, s69, 92160
    s_nop 0
    buffer_load_dwordx4 v17, s[56:59], s73 offen lds
    s_add_u32 m0, s70, 90112
    s_mov_b64 exec, 0xffffffff
    buffer_load_dwordx4 v18, s[56:59], s74 offen lds
    s_mov_b64 exec, -1
    s_cmp_eq_u32 s53, 0
    s_mov_b32 s75, 20480
    s_mov_b32 s76, 21504
    s_cselect_b32 s75, s75, s76
    v_add_u32 v10, s75, v3
    s_add_u32 m0, s44, 16384
    s_nop 0
    buffer_load_dwordx4 v10, s[32:35], s64 offen lds
    s_add_u32 m0, s44, 17408
    s_nop 0
    buffer_load_dwordx4 v10, s[32:35], s65 offen lds
    s_add_u32 m0, s44, 18432
    s_nop 0
    buffer_load_dwordx4 v10, s[32:35], s66 offen lds
    s_add_u32 m0, s44, 19456
    s_nop 0
    buffer_load_dwordx4 v10, s[32:35], s67 offen lds
    s_waitcnt vmcnt(13)
    s_barrier
    s_add_u32 s72, s68, 737280
    s_add_u32 s73, s68, 774144
    s_cmp_eq_u32 s53, 0
    s_cselect_b32 s74, s72, s73
    s_add_u32 m0, s69, 100352
    s_nop 0
    buffer_load_dwordx4 v16, s[56:59], s72 offen lds
    s_add_u32 m0, s69, 101376
    s_nop 0
    buffer_load_dwordx4 v17, s[56:59], s72 offen lds
    s_add_u32 m0, s69, 109568
    s_nop 0
    buffer_load_dwordx4 v16, s[56:59], s73 offen lds
    s_add_u32 m0, s69, 110592
    s_nop 0
    buffer_load_dwordx4 v17, s[56:59], s73 offen lds
    s_add_u32 m0, s70, 108544
    s_mov_b64 exec, 0xffffffff
    buffer_load_dwordx4 v18, s[56:59], s74 offen lds
    s_mov_b64 exec, -1
    s_cmp_eq_u32 s53, 0
    s_mov_b32 s75, 22528
    s_mov_b32 s76, 23552
    s_cselect_b32 s75, s75, s76
    v_add_u32 v10, s75, v3
    s_add_u32 m0, s44, 32768
    s_nop 0
    buffer_load_dwordx4 v10, s[32:35], s64 offen lds
    s_add_u32 m0, s44, 33792
    s_nop 0
    buffer_load_dwordx4 v10, s[32:35], s65 offen lds
    s_add_u32 m0, s44, 34816
    s_nop 0
    buffer_load_dwordx4 v10, s[32:35], s66 offen lds
    s_add_u32 m0, s44, 35840
    s_nop 0
    buffer_load_dwordx4 v10, s[32:35], s67 offen lds
    s_waitcnt vmcnt(13)
    s_barrier
    s_add_u32 s72, s68, 811008
    s_add_u32 s73, s68, 847872
    s_cmp_eq_u32 s53, 0
    s_cselect_b32 s74, s72, s73
    s_add_u32 m0, s69, 118784
    s_nop 0
    buffer_load_dwordx4 v16, s[56:59], s72 offen lds
    s_add_u32 m0, s69, 119808
    s_nop 0
    buffer_load_dwordx4 v17, s[56:59], s72 offen lds
    s_add_u32 m0, s69, 128000
    s_nop 0
    buffer_load_dwordx4 v16, s[56:59], s73 offen lds
    s_add_u32 m0, s69, 129024
    s_nop 0
    buffer_load_dwordx4 v17, s[56:59], s73 offen lds
    s_add_u32 m0, s70, 126976
    s_mov_b64 exec, 0xffffffff
    buffer_load_dwordx4 v18, s[56:59], s74 offen lds
    s_mov_b64 exec, -1
    s_cmp_eq_u32 s53, 0
    s_mov_b32 s75, 24576
    s_mov_b32 s76, 29696
    s_cselect_b32 s75, s75, s76
    v_add_u32 v10, s75, v3
    s_add_u32 m0, s44, 49152
    s_nop 0
    buffer_load_dwordx4 v10, s[32:35], s64 offen lds
    s_add_u32 m0, s44, 50176
    s_nop 0
    buffer_load_dwordx4 v10, s[32:35], s65 offen lds
    s_add_u32 m0, s44, 51200
    s_nop 0
    buffer_load_dwordx4 v10, s[32:35], s66 offen lds
    s_add_u32 m0, s44, 52224
    s_nop 0
    buffer_load_dwordx4 v10, s[32:35], s67 offen lds
    s_waitcnt vmcnt(13)
    s_barrier
    s_add_u32 s72, s68, 884736
    s_add_u32 s73, s68, 1069056
    s_cmp_eq_u32 s53, 0
    s_cselect_b32 s74, s72, s73
    s_add_u32 m0, s69, 137216
    s_nop 0
    buffer_load_dwordx4 v16, s[56:59], s72 offen lds
    s_add_u32 m0, s69, 138240
    s_nop 0
    buffer_load_dwordx4 v17, s[56:59], s72 offen lds
    s_add_u32 m0, s69, 146432
    s_nop 0
    buffer_load_dwordx4 v16, s[56:59], s73 offen lds
    s_add_u32 m0, s69, 147456
    s_nop 0
    buffer_load_dwordx4 v17, s[56:59], s73 offen lds
    s_add_u32 m0, s70, 145408
    s_mov_b64 exec, 0xffffffff
    buffer_load_dwordx4 v18, s[56:59], s74 offen lds
    s_mov_b64 exec, -1
    s_cmp_eq_u32 s53, 0
    s_mov_b32 s75, 30720
    s_mov_b32 s76, 31744
    s_cselect_b32 s75, s75, s76
    v_add_u32 v10, s75, v3
    s_add_u32 m0, s44, 65536
    s_nop 0
    buffer_load_dwordx4 v10, s[32:35], s64 offen lds
    s_add_u32 m0, s44, 66560
    s_nop 0
    buffer_load_dwordx4 v10, s[32:35], s65 offen lds
    s_add_u32 m0, s44, 67584
    s_nop 0
    buffer_load_dwordx4 v10, s[32:35], s66 offen lds
    s_add_u32 m0, s44, 68608
    s_nop 0
    buffer_load_dwordx4 v10, s[32:35], s67 offen lds
    s_waitcnt vmcnt(13)
    s_barrier
    s_cmp_lg_u32 s17, 4
    s_cbranch_scc1 K34_SIGB
    s_mov_b64 exec, 1
    buffer_atomic_add v11, v20, s[60:63], 0 offen offset:0 sc1
    s_mov_b64 exec, -1
K34_SIGB:
    s_add_u32 s72, s68, 1105920
    s_add_u32 s73, s68, 1142784
    s_cmp_eq_u32 s53, 0
    s_cselect_b32 s74, s72, s73
    s_add_u32 m0, s69, 81920
    s_nop 0
    buffer_load_dwordx4 v16, s[56:59], s72 offen lds
    s_add_u32 m0, s69, 82944
    s_nop 0
    buffer_load_dwordx4 v17, s[56:59], s72 offen lds
    s_add_u32 m0, s69, 91136
    s_nop 0
    buffer_load_dwordx4 v16, s[56:59], s73 offen lds
    s_add_u32 m0, s69, 92160
    s_nop 0
    buffer_load_dwordx4 v17, s[56:59], s73 offen lds
    s_add_u32 m0, s70, 90112
    s_mov_b64 exec, 0xffffffff
    buffer_load_dwordx4 v18, s[56:59], s74 offen lds
    s_mov_b64 exec, -1
    s_cmp_eq_u32 s53, 0
    s_mov_b32 s75, 32768
    s_mov_b32 s76, 33792
    s_cselect_b32 s75, s75, s76
    v_add_u32 v10, s75, v3
    s_add_u32 m0, s44, 0
    s_nop 0
    buffer_load_dwordx4 v10, s[32:35], s64 offen lds
    s_add_u32 m0, s44, 1024
    s_nop 0
    buffer_load_dwordx4 v10, s[32:35], s65 offen lds
    s_add_u32 m0, s44, 2048
    s_nop 0
    buffer_load_dwordx4 v10, s[32:35], s66 offen lds
    s_add_u32 m0, s44, 3072
    s_nop 0
    buffer_load_dwordx4 v10, s[32:35], s67 offen lds
    s_waitcnt vmcnt(13)
    s_barrier
    s_add_u32 s72, s68, 1179648
    s_add_u32 s73, s68, 1216512
    s_cmp_eq_u32 s53, 0
    s_cselect_b32 s74, s72, s73
    s_add_u32 m0, s69, 100352
    s_nop 0
    buffer_load_dwordx4 v16, s[56:59], s72 offen lds
    s_add_u32 m0, s69, 101376
    s_nop 0
    buffer_load_dwordx4 v17, s[56:59], s72 offen lds
    s_add_u32 m0, s69, 109568
    s_nop 0
    buffer_load_dwordx4 v16, s[56:59], s73 offen lds
    s_add_u32 m0, s69, 110592
    s_nop 0
    buffer_load_dwordx4 v17, s[56:59], s73 offen lds
    s_add_u32 m0, s70, 108544
    s_mov_b64 exec, 0xffffffff
    buffer_load_dwordx4 v18, s[56:59], s74 offen lds
    s_mov_b64 exec, -1
    s_waitcnt vmcnt(9)
    s_barrier
    s_add_u32 s72, s68, 0
    s_add_u32 s73, s68, 36864
    s_cmp_eq_u32 s53, 0
    s_cselect_b32 s74, s72, s73
    s_add_u32 m0, s69, 118784
    s_nop 0
    buffer_load_dwordx4 v16, s[56:59], s72 offen lds
    s_add_u32 m0, s69, 119808
    s_nop 0
    buffer_load_dwordx4 v17, s[56:59], s72 offen lds
    s_add_u32 m0, s69, 128000
    s_nop 0
    buffer_load_dwordx4 v16, s[56:59], s73 offen lds
    s_add_u32 m0, s69, 129024
    s_nop 0
    buffer_load_dwordx4 v17, s[56:59], s73 offen lds
    s_add_u32 m0, s70, 126976
    s_mov_b64 exec, 0xffffffff
    buffer_load_dwordx4 v18, s[56:59], s74 offen lds
    s_mov_b64 exec, -1
    s_waitcnt vmcnt(5)
    s_barrier
    s_add_u32 s72, s68, 258048
    s_add_u32 s73, s68, 294912
    s_cmp_eq_u32 s53, 0
    s_cselect_b32 s74, s72, s73
    s_add_u32 m0, s69, 137216
    s_nop 0
    buffer_load_dwordx4 v16, s[56:59], s72 offen lds
    s_add_u32 m0, s69, 138240
    s_nop 0
    buffer_load_dwordx4 v17, s[56:59], s72 offen lds
    s_add_u32 m0, s69, 146432
    s_nop 0
    buffer_load_dwordx4 v16, s[56:59], s73 offen lds
    s_add_u32 m0, s69, 147456
    s_nop 0
    buffer_load_dwordx4 v17, s[56:59], s73 offen lds
    s_add_u32 m0, s70, 145408
    s_mov_b64 exec, 0xffffffff
    buffer_load_dwordx4 v18, s[56:59], s74 offen lds
    s_mov_b64 exec, -1
    s_mov_b32 s71, 0
    s_cmp_lg_u32 s17, 4
    s_cbranch_scc1 K34_POLL46_W
K34_POLL46:
    buffer_load_dword v23, v21, s[60:63], 0 offen offset:0 sc1
    s_waitcnt vmcnt(0)
    v_readfirstlane_b32 s72, v23
    s_add_u32 s71, s71, 1
    s_lshr_b32 s72, s72, 8
    s_and_b32 s72, s72, 0xff
    s_cmp_ge_u32 s72, 8
    s_cbranch_scc1 K34_POLL46_OK
    s_sleep 2
    s_cmp_lt_u32 s71, 0x100000
    s_cbranch_scc1 K34_POLL46
K34_POLL46_OK:
    v_mov_b32 v23, 3
    ds_write_b32 v7, v23
    s_branch K34_POLL46_GO
K34_POLL46_W:
    ds_read_b32 v23, v7
    s_waitcnt lgkmcnt(0)
    v_readfirstlane_b32 s72, v23
    s_add_u32 s71, s71, 1
    s_cmp_eq_u32 s72, 3
    s_cbranch_scc1 K34_POLL46_GO
    s_sleep 1
    s_cmp_lt_u32 s71, 0x400000
    s_cbranch_scc1 K34_POLL46_W
K34_POLL46_GO:
    s_cmp_eq_u32 s53, 0
    s_mov_b32 s75, 0
    s_mov_b32 s76, 1024
    s_cselect_b32 s75, s75, s76
    v_add_u32 v10, s75, v3
    s_add_u32 m0, s44, 16384
    s_nop 0
    buffer_load_dwordx4 v10, s[32:35], s64 offen lds
    s_add_u32 m0, s44, 17408
    s_nop 0
    buffer_load_dwordx4 v10, s[32:35], s65 offen lds
    s_add_u32 m0, s44, 18432
    s_nop 0
    buffer_load_dwordx4 v10, s[32:35], s66 offen lds
    s_add_u32 m0, s44, 19456
    s_nop 0
    buffer_load_dwordx4 v10, s[32:35], s67 offen lds
    s_cmp_eq_u32 s53, 0
    s_mov_b32 s75, 7168
    s_mov_b32 s76, 8192
    s_cselect_b32 s75, s75, s76
    v_add_u32 v10, s75, v3
    s_add_u32 m0, s44, 32768
    s_nop 0
    buffer_load_dwordx4 v10, s[32:35], s64 offen lds
    s_add_u32 m0, s44, 33792
    s_nop 0
    buffer_load_dwordx4 v10, s[32:35], s65 offen lds
    s_add_u32 m0, s44, 34816
    s_nop 0
    buffer_load_dwordx4 v10, s[32:35], s66 offen lds
    s_add_u32 m0, s44, 35840
    s_nop 0
    buffer_load_dwordx4 v10, s[32:35], s67 offen lds
    s_cmp_eq_u32 s53, 0
    s_mov_b32 s75, 9216
    s_mov_b32 s76, 10240
    s_cselect_b32 s75, s75, s76
    v_add_u32 v10, s75, v3
    s_add_u32 m0, s44, 49152
    s_nop 0
    buffer_load_dwordx4 v10, s[32:35], s64 offen lds
    s_add_u32 m0, s44, 50176
    s_nop 0
    buffer_load_dwordx4 v10, s[32:35], s65 offen lds
    s_add_u32 m0, s44, 51200
    s_nop 0
    buffer_load_dwordx4 v10, s[32:35], s66 offen lds
    s_add_u32 m0, s44, 52224
    s_nop 0
    buffer_load_dwordx4 v10, s[32:35], s67 offen lds
    s_waitcnt vmcnt(8)
    s_barrier
    s_add_u32 s72, s68, 331776
    s_add_u32 s73, s68, 368640
    s_cmp_eq_u32 s53, 0
    s_cselect_b32 s74, s72, s73
    s_add_u32 m0, s69, 81920
    s_nop 0
    buffer_load_dwordx4 v16, s[56:59], s72 offen lds
    s_add_u32 m0, s69, 82944
    s_nop 0
    buffer_load_dwordx4 v17, s[56:59], s72 offen lds
    s_add_u32 m0, s69, 91136
    s_nop 0
    buffer_load_dwordx4 v16, s[56:59], s73 offen lds
    s_add_u32 m0, s69, 92160
    s_nop 0
    buffer_load_dwordx4 v17, s[56:59], s73 offen lds
    s_add_u32 m0, s70, 90112
    s_mov_b64 exec, 0xffffffff
    buffer_load_dwordx4 v18, s[56:59], s74 offen lds
    s_mov_b64 exec, -1
    s_cmp_eq_u32 s53, 0
    s_mov_b32 s75, 16384
    s_mov_b32 s76, 17408
    s_cselect_b32 s75, s75, s76
    v_add_u32 v10, s75, v3
    s_add_u32 m0, s44, 65536
    s_nop 0
    buffer_load_dwordx4 v10, s[32:35], s64 offen lds
    s_add_u32 m0, s44, 66560
    s_nop 0
    buffer_load_dwordx4 v10, s[32:35], s65 offen lds
    s_add_u32 m0, s44, 67584
    s_nop 0
    buffer_load_dwordx4 v10, s[32:35], s66 offen lds
    s_add_u32 m0, s44, 68608
    s_nop 0
    buffer_load_dwordx4 v10, s[32:35], s67 offen lds
    s_waitcnt vmcnt(13)
    s_barrier
    s_add_u32 s72, s68, 589824
    s_add_u32 s73, s68, 626688
    s_cmp_eq_u32 s53, 0
    s_cselect_b32 s74, s72, s73
    s_add_u32 m0, s69, 100352
    s_nop 0
    buffer_load_dwordx4 v16, s[56:59], s72 offen lds
    s_add_u32 m0, s69, 101376
    s_nop 0
    buffer_load_dwordx4 v17, s[56:59], s72 offen lds
    s_add_u32 m0, s69, 109568
    s_nop 0
    buffer_load_dwordx4 v16, s[56:59], s73 offen lds
    s_add_u32 m0, s69, 110592
    s_nop 0
    buffer_load_dwordx4 v17, s[56:59], s73 offen lds
    s_add_u32 m0, s70, 108544
    s_mov_b64 exec, 0xffffffff
    buffer_load_dwordx4 v18, s[56:59], s74 offen lds
    s_mov_b64 exec, -1
    s_cmp_eq_u32 s53, 0
    s_mov_b32 s75, 18432
    s_mov_b32 s76, 19456
    s_cselect_b32 s75, s75, s76
    v_add_u32 v10, s75, v3
    s_add_u32 m0, s44, 0
    s_nop 0
    buffer_load_dwordx4 v10, s[32:35], s64 offen lds
    s_add_u32 m0, s44, 1024
    s_nop 0
    buffer_load_dwordx4 v10, s[32:35], s65 offen lds
    s_add_u32 m0, s44, 2048
    s_nop 0
    buffer_load_dwordx4 v10, s[32:35], s66 offen lds
    s_add_u32 m0, s44, 3072
    s_nop 0
    buffer_load_dwordx4 v10, s[32:35], s67 offen lds
    s_waitcnt vmcnt(13)
    s_barrier
    s_add_u32 s72, s68, 663552
    s_add_u32 s73, s68, 700416
    s_cmp_eq_u32 s53, 0
    s_cselect_b32 s74, s72, s73
    s_add_u32 m0, s69, 118784
    s_nop 0
    buffer_load_dwordx4 v16, s[56:59], s72 offen lds
    s_add_u32 m0, s69, 119808
    s_nop 0
    buffer_load_dwordx4 v17, s[56:59], s72 offen lds
    s_add_u32 m0, s69, 128000
    s_nop 0
    buffer_load_dwordx4 v16, s[56:59], s73 offen lds
    s_add_u32 m0, s69, 129024
    s_nop 0
    buffer_load_dwordx4 v17, s[56:59], s73 offen lds
    s_add_u32 m0, s70, 126976
    s_mov_b64 exec, 0xffffffff
    buffer_load_dwordx4 v18, s[56:59], s74 offen lds
    s_mov_b64 exec, -1
    s_cmp_eq_u32 s53, 0
    s_mov_b32 s75, 25600
    s_mov_b32 s76, 26624
    s_cselect_b32 s75, s75, s76
    v_add_u32 v10, s75, v3
    s_add_u32 m0, s44, 16384
    s_nop 0
    buffer_load_dwordx4 v10, s[32:35], s64 offen lds
    s_add_u32 m0, s44, 17408
    s_nop 0
    buffer_load_dwordx4 v10, s[32:35], s65 offen lds
    s_add_u32 m0, s44, 18432
    s_nop 0
    buffer_load_dwordx4 v10, s[32:35], s66 offen lds
    s_add_u32 m0, s44, 19456
    s_nop 0
    buffer_load_dwordx4 v10, s[32:35], s67 offen lds
    s_waitcnt vmcnt(13)
    s_barrier
    s_add_u32 s72, s68, 921600
    s_add_u32 s73, s68, 958464
    s_cmp_eq_u32 s53, 0
    s_cselect_b32 s74, s72, s73
    s_add_u32 m0, s69, 137216
    s_nop 0
    buffer_load_dwordx4 v16, s[56:59], s72 offen lds
    s_add_u32 m0, s69, 138240
    s_nop 0
    buffer_load_dwordx4 v17, s[56:59], s72 offen lds
    s_add_u32 m0, s69, 146432
    s_nop 0
    buffer_load_dwordx4 v16, s[56:59], s73 offen lds
    s_add_u32 m0, s69, 147456
    s_nop 0
    buffer_load_dwordx4 v17, s[56:59], s73 offen lds
    s_add_u32 m0, s70, 145408
    s_mov_b64 exec, 0xffffffff
    buffer_load_dwordx4 v18, s[56:59], s74 offen lds
    s_mov_b64 exec, -1
    s_cmp_eq_u32 s53, 0
    s_mov_b32 s75, 27648
    s_mov_b32 s76, 28672
    s_cselect_b32 s75, s75, s76
    v_add_u32 v10, s75, v3
    s_add_u32 m0, s44, 32768
    s_nop 0
    buffer_load_dwordx4 v10, s[32:35], s64 offen lds
    s_add_u32 m0, s44, 33792
    s_nop 0
    buffer_load_dwordx4 v10, s[32:35], s65 offen lds
    s_add_u32 m0, s44, 34816
    s_nop 0
    buffer_load_dwordx4 v10, s[32:35], s66 offen lds
    s_add_u32 m0, s44, 35840
    s_nop 0
    buffer_load_dwordx4 v10, s[32:35], s67 offen lds
    s_waitcnt vmcnt(13)
    s_barrier
    s_add_u32 s72, s68, 995328
    s_add_u32 s73, s68, 1032192
    s_cmp_eq_u32 s53, 0
    s_cselect_b32 s74, s72, s73
    s_add_u32 m0, s69, 81920
    s_nop 0
    buffer_load_dwordx4 v16, s[56:59], s72 offen lds
    s_add_u32 m0, s69, 82944
    s_nop 0
    buffer_load_dwordx4 v17, s[56:59], s72 offen lds
    s_add_u32 m0, s69, 91136
    s_nop 0
    buffer_load_dwordx4 v16, s[56:59], s73 offen lds
    s_add_u32 m0, s69, 92160
    s_nop 0
    buffer_load_dwordx4 v17, s[56:59], s73 offen lds
    s_add_u32 m0, s70, 90112
    s_mov_b64 exec, 0xffffffff
    buffer_load_dwordx4 v18, s[56:59], s74 offen lds
    s_mov_b64 exec, -1
    s_cmp_eq_u32 s53, 0
    s_mov_b32 s75, 34816
    s_mov_b32 s76, 35840
    s_cselect_b32 s75, s75, s76
    v_add_u32 v10, s75, v3
    s_add_u32 m0, s44, 49152
    s_nop 0
    buffer_load_dwordx4 v10, s[32:35], s64 offen lds
    s_add_u32 m0, s44, 50176
    s_nop 0
    buffer_load_dwordx4 v10, s[32:35], s65 offen lds
    s_add_u32 m0, s44, 51200
    s_nop 0
    buffer_load_dwordx4 v10, s[32:35], s66 offen lds
    s_add_u32 m0, s44, 52224
    s_nop 0
    buffer_load_dwordx4 v10, s[32:35], s67 offen lds
    s_waitcnt vmcnt(13)
    s_barrier
    s_add_u32 s72, s68, 1253376
    s_add_u32 s73, s68, 1290240
    s_cmp_eq_u32 s53, 0
    s_cselect_b32 s74, s72, s73
    s_add_u32 m0, s69, 100352
    s_nop 0
    buffer_load_dwordx4 v16, s[56:59], s72 offen lds
    s_add_u32 m0, s69, 101376
    s_nop 0
    buffer_load_dwordx4 v17, s[56:59], s72 offen lds
    s_add_u32 m0, s69, 109568
    s_nop 0
    buffer_load_dwordx4 v16, s[56:59], s73 offen lds
    s_add_u32 m0, s69, 110592
    s_nop 0
    buffer_load_dwordx4 v17, s[56:59], s73 offen lds
    s_add_u32 m0, s70, 108544
    s_mov_b64 exec, 0xffffffff
    buffer_load_dwordx4 v18, s[56:59], s74 offen lds
    s_mov_b64 exec, -1
    s_waitcnt vmcnt(9)
    s_barrier
    s_waitcnt vmcnt(0)
    s_barrier
    s_barrier
    s_barrier
    s_barrier
    s_lshl_b32 s18, s52, 2
    s_add_u32 s18, s18, s14
    s_add_u32 s18, s18, 40
    s_lshl_b32 s18, s18, 8
    v_mov_b32 v19, s18
    s_cmp_lg_u32 s17, 4
    s_cbranch_scc1 K34_SIGF
    s_mov_b64 exec, 1
    buffer_atomic_add v22, v19, s[60:63], 0 offen offset:0 sc1
    s_mov_b64 exec, -1
K34_SIGF:
    s_mov_b32 s71, 0
    s_cmp_lg_u32 s17, 4
    s_cbranch_scc1 K34_POLLF_W
K34_POLLF:
    buffer_load_dword v23, v19, s[60:63], 0 offen offset:0 sc1
    s_waitcnt vmcnt(0)
    v_readfirstlane_b32 s72, v23
    s_add_u32 s71, s71, 1
    s_lshr_b32 s72, s72, 0
    s_and_b32 s72, s72, 0xff
    s_cmp_ge_u32 s72, 4
    s_cbranch_scc1 K34_POLLF_OK
    s_sleep 2
    s_cmp_lt_u32 s71, 0x100000
    s_cbranch_scc1 K34_POLLF
K34_POLLF_OK:
K34_POLLF_W:
K34_FINAL:
    s_mov_b32 s92, s80
    s_mov_b32 s93, s81
    s_mov_b32 s94, 2359296
    s_mov_b32 s95, 0x00020000
    s_add_u32 s96, s50, 26214400
    s_addc_u32 s97, s51, 0
    s_mov_b32 s98, 9437184
    s_mov_b32 s99, 0x00020000
    v_and_b32 v24, 15, v2
    v_lshrrev_b32 v25, 4, v2
    s_lshl_b32 s18, s52, 7
    s_lshl_b32 s19, s10, 5
    s_add_u32 s18, s18, s19
    v_add_u32 v24, s18, v24
    s_movk_i32 s18, 1152
    v_mul_lo_u32 v24, v24, s18
    v_lshlrev_b32 v25, 3, v25
    s_mul_i32 s18, s14, 288
    s_lshl_b32 s19, s17, 5
    s_add_u32 s18, s18, s19
    v_add_u32 v25, s18, v25
    v_add_u32 v24, v24, v25
    s_movk_i32 s76, 18432
    s_movk_i32 s77, 11520
    v_lshlrev_b32 v25, 1, v25
    buffer_load_dwordx2 v[32:33], v24, s[84:87], 0 offen offset:0
    buffer_load_dwordx2 v[34:35], v24, s[84:87], s76 offen offset:0
    buffer_load_dwordx4 v[36:39], v25, s[88:91], s77 offen offset:0
    s_cmp_lg_u32 s17, 0
    s_cbranch_scc1 FN_A_S
    buffer_load_dwordx2 v[40:41], v24, s[84:87], 0 offen offset:256
    buffer_load_dwordx2 v[42:43], v24, s[84:87], s76 offen offset:256
    buffer_load_dwordx4 v[44:47], v25, s[88:91], s77 offen offset:512
FN_A_S:
    s_lshl_b32 s18, s52, 2
    s_add_u32 s18, s18, s14
    s_lshl_b32 s18, s18, 2
    s_add_u32 s18, s18, s10
    s_mul_i32 s18, s18, 36864
    s_lshl_b32 s19, s17, 10
    s_add_u32 s82, s18, s19
    s_lshl_b32 s19, s17, 11
    v_add_u32 v26, s19, v3
    s_barrier
    s_add_u32 s18, s10, 1
    s_and_b32 s18, s18, 3
    s_mul_i32 s18, s18, 9216
    s_add_u32 s18, s18, s82
    buffer_load_dwordx4 v[52:55], v3, s[96:99], s18 offen
    s_add_u32 s18, s10, 2
    s_and_b32 s18, s18, 3
    s_mul_i32 s18, s18, 9216
    s_add_u32 s18, s18, s82
    buffer_load_dwordx4 v[56:59], v3, s[96:99], s18 offen
    s_add_u32 s18, s10, 3
    s_and_b32 s18, s18, 3
    s_mul_i32 s18, s18, 9216
    s_add_u32 s18, s18, s82
    buffer_load_dwordx4 v[60:63], v3, s[96:99], s18 offen
    ds_read_b128 v[64:67], v26 offset:0
    ds_read_b128 v[68:71], v26 offset:1024
    s_waitcnt vmcnt(0) lgkmcnt(0)
    v_lshlrev_b32 v72, 16, v52
    v_and_b32 v73, 0xffff0000, v52
    v_add_f32 v64, v64, v72
    v_add_f32 v65, v65, v73
    v_lshlrev_b32 v72, 16, v53
    v_and_b32 v73, 0xffff0000, v53
    v_add_f32 v66, v66, v72
    v_add_f32 v67, v67, v73
    v_lshlrev_b32 v72, 16, v54
    v_and_b32 v73, 0xffff0000, v54
    v_add_f32 v68, v68, v72
    v_add_f32 v69, v69, v73
    v_lshlrev_b32 v72, 16, v55
    v_and_b32 v73, 0xffff0000, v55
    v_add_f32 v70, v70, v72
    v_add_f32 v71, v71, v73
    v_lshlrev_b32 v72, 16, v56
    v_and_b32 v73, 0xffff0000, v56
    v_add_f32 v64, v64, v72
    v_add_f32 v65, v65, v73
    v_lshlrev_b32 v72, 16, v57
    v_and_b32 v73, 0xffff0000, v57
    v_add_f32 v66, v66, v72
    v_add_f32 v67, v67, v73
    v_lshlrev_b32 v72, 16, v58
    v_and_b32 v73, 0xffff0000, v58
    v_add_f32 v68, v68, v72
    v_add_f32 v69, v69, v73
    v_lshlrev_b32 v72, 16, v59
    v_and_b32 v73, 0xffff0000, v59
    v_add_f32 v70, v70, v72
    v_add_f32 v71, v71, v73
    v_lshlrev_b32 v72, 16, v60
    v_and_b32 v73, 0xffff0000, v60
    v_add_f32 v64, v64, v72
    v_add_f32 v65, v65, v73
    v_lshlrev_b32 v72, 16, v61
    v_and_b32 v73, 0xffff0000, v61
    v_add_f32 v66, v66, v72
    v_add_f32 v67, v67, v73
    v_lshlrev_b32 v72, 16, v62
    v_and_b32 v73, 0xffff0000, v62
    v_add_f32 v68, v68, v72
    v_add_f32 v69, v69, v73
    v_lshlrev_b32 v72, 16, v63
    v_and_b32 v73, 0xffff0000, v63
    v_add_f32 v70, v70, v72
    v_add_f32 v71, v71, v73
    v_cvt_pk_bf16_f32 v74, v64, v65
    v_cvt_pk_bf16_f32 v75, v66, v67
    v_lshlrev_b32 v84, 16, v74
    v_lshlrev_b32 v85, 16, v32
    v_mul_f32 v84, v84, v36
    v_cvt_pk_bf16_f32 v84, v84, v84
    v_lshlrev_b32 v84, 16, v84
    v_add_f32 v64, v84, v85
    v_and_b32 v84, 0xffff0000, v74
    v_and_b32 v85, 0xffff0000, v32
    v_mul_f32 v84, v84, v37
    v_cvt_pk_bf16_f32 v84, v84, v84
    v_lshlrev_b32 v84, 16, v84
    v_add_f32 v65, v84, v85
    v_lshlrev_b32 v84, 16, v75
    v_lshlrev_b32 v85, 16, v33
    v_mul_f32 v84, v84, v38
    v_cvt_pk_bf16_f32 v84, v84, v84
    v_lshlrev_b32 v84, 16, v84
    v_add_f32 v66, v84, v85
    v_and_b32 v84, 0xffff0000, v75
    v_and_b32 v85, 0xffff0000, v33
    v_mul_f32 v84, v84, v39
    v_cvt_pk_bf16_f32 v84, v84, v84
    v_lshlrev_b32 v84, 16, v84
    v_add_f32 v67, v84, v85
    v_cvt_pk_bf16_f32 v88, v64, v65
    v_cvt_pk_bf16_f32 v89, v66, v67
    buffer_store_dwordx2 v[88:89], v24, s[92:95], 0 offen offset:0
    v_cvt_pk_bf16_f32 v74, v68, v69
    v_cvt_pk_bf16_f32 v75, v70, v71
    v_lshlrev_b32 v84, 16, v74
    v_lshlrev_b32 v85, 16, v34
    v_mul_f32 v84, v84, v36
    v_cvt_pk_bf16_f32 v84, v84, v84
    v_lshlrev_b32 v84, 16, v84
    v_add_f32 v68, v84, v85
    v_and_b32 v84, 0xffff0000, v74
    v_and_b32 v85, 0xffff0000, v34
    v_mul_f32 v84, v84, v37
    v_cvt_pk_bf16_f32 v84, v84, v84
    v_lshlrev_b32 v84, 16, v84
    v_add_f32 v69, v84, v85
    v_lshlrev_b32 v84, 16, v75
    v_lshlrev_b32 v85, 16, v35
    v_mul_f32 v84, v84, v38
    v_cvt_pk_bf16_f32 v84, v84, v84
    v_lshlrev_b32 v84, 16, v84
    v_add_f32 v70, v84, v85
    v_and_b32 v84, 0xffff0000, v75
    v_and_b32 v85, 0xffff0000, v35
    v_mul_f32 v84, v84, v39
    v_cvt_pk_bf16_f32 v84, v84, v84
    v_lshlrev_b32 v84, 16, v84
    v_add_f32 v71, v84, v85
    v_cvt_pk_bf16_f32 v90, v68, v69
    v_cvt_pk_bf16_f32 v91, v70, v71
    buffer_store_dwordx2 v[90:91], v24, s[92:95], s76 offen offset:0
    s_cmp_lg_u32 s17, 0
    s_cbranch_scc1 FN_B_S
    s_add_u32 s18, s10, 1
    s_and_b32 s18, s18, 3
    s_mul_i32 s18, s18, 9216
    s_add_u32 s18, s18, s82
    s_add_u32 s18, s18, 8192
    buffer_load_dwordx4 v[52:55], v3, s[96:99], s18 offen
    s_add_u32 s18, s10, 2
    s_and_b32 s18, s18, 3
    s_mul_i32 s18, s18, 9216
    s_add_u32 s18, s18, s82
    s_add_u32 s18, s18, 8192
    buffer_load_dwordx4 v[56:59], v3, s[96:99], s18 offen
    s_add_u32 s18, s10, 3
    s_and_b32 s18, s18, 3
    s_mul_i32 s18, s18, 9216
    s_add_u32 s18, s18, s82
    s_add_u32 s18, s18, 8192
    buffer_load_dwordx4 v[60:63], v3, s[96:99], s18 offen
    ds_read_b128 v[64:67], v26 offset:16384
    ds_read_b128 v[68:71], v26 offset:17408
    s_waitcnt vmcnt(0) lgkmcnt(0)
    v_lshlrev_b32 v72, 16, v52
    v_and_b32 v73, 0xffff0000, v52
    v_add_f32 v64, v64, v72
    v_add_f32 v65, v65, v73
    v_lshlrev_b32 v72, 16, v53
    v_and_b32 v73, 0xffff0000, v53
    v_add_f32 v66, v66, v72
    v_add_f32 v67, v67, v73
    v_lshlrev_b32 v72, 16, v54
    v_and_b32 v73, 0xffff0000, v54
    v_add_f32 v68, v68, v72
    v_add_f32 v69, v69, v73
    v_lshlrev_b32 v72, 16, v55
    v_and_b32 v73, 0xffff0000, v55
    v_add_f32 v70, v70, v72
    v_add_f32 v71, v71, v73
    v_lshlrev_b32 v72, 16, v56
    v_and_b32 v73, 0xffff0000, v56
    v_add_f32 v64, v64, v72
    v_add_f32 v65, v65, v73
    v_lshlrev_b32 v72, 16, v57
    v_and_b32 v73, 0xffff0000, v57
    v_add_f32 v66, v66, v72
    v_add_f32 v67, v67, v73
    v_lshlrev_b32 v72, 16, v58
    v_and_b32 v73, 0xffff0000, v58
    v_add_f32 v68, v68, v72
    v_add_f32 v69, v69, v73
    v_lshlrev_b32 v72, 16, v59
    v_and_b32 v73, 0xffff0000, v59
    v_add_f32 v70, v70, v72
    v_add_f32 v71, v71, v73
    v_lshlrev_b32 v72, 16, v60
    v_and_b32 v73, 0xffff0000, v60
    v_add_f32 v64, v64, v72
    v_add_f32 v65, v65, v73
    v_lshlrev_b32 v72, 16, v61
    v_and_b32 v73, 0xffff0000, v61
    v_add_f32 v66, v66, v72
    v_add_f32 v67, v67, v73
    v_lshlrev_b32 v72, 16, v62
    v_and_b32 v73, 0xffff0000, v62
    v_add_f32 v68, v68, v72
    v_add_f32 v69, v69, v73
    v_lshlrev_b32 v72, 16, v63
    v_and_b32 v73, 0xffff0000, v63
    v_add_f32 v70, v70, v72
    v_add_f32 v71, v71, v73
    v_cvt_pk_bf16_f32 v74, v64, v65
    v_cvt_pk_bf16_f32 v75, v66, v67
    v_lshlrev_b32 v84, 16, v74
    v_lshlrev_b32 v85, 16, v40
    v_mul_f32 v84, v84, v44
    v_cvt_pk_bf16_f32 v84, v84, v84
    v_lshlrev_b32 v84, 16, v84
    v_add_f32 v64, v84, v85
    v_and_b32 v84, 0xffff0000, v74
    v_and_b32 v85, 0xffff0000, v40
    v_mul_f32 v84, v84, v45
    v_cvt_pk_bf16_f32 v84, v84, v84
    v_lshlrev_b32 v84, 16, v84
    v_add_f32 v65, v84, v85
    v_lshlrev_b32 v84, 16, v75
    v_lshlrev_b32 v85, 16, v41
    v_mul_f32 v84, v84, v46
    v_cvt_pk_bf16_f32 v84, v84, v84
    v_lshlrev_b32 v84, 16, v84
    v_add_f32 v66, v84, v85
    v_and_b32 v84, 0xffff0000, v75
    v_and_b32 v85, 0xffff0000, v41
    v_mul_f32 v84, v84, v47
    v_cvt_pk_bf16_f32 v84, v84, v84
    v_lshlrev_b32 v84, 16, v84
    v_add_f32 v67, v84, v85
    v_cvt_pk_bf16_f32 v92, v64, v65
    v_cvt_pk_bf16_f32 v93, v66, v67
    buffer_store_dwordx2 v[92:93], v24, s[92:95], 0 offen offset:256
    v_cvt_pk_bf16_f32 v74, v68, v69
    v_cvt_pk_bf16_f32 v75, v70, v71
    v_lshlrev_b32 v84, 16, v74
    v_lshlrev_b32 v85, 16, v42
    v_mul_f32 v84, v84, v44
    v_cvt_pk_bf16_f32 v84, v84, v84
    v_lshlrev_b32 v84, 16, v84
    v_add_f32 v68, v84, v85
    v_and_b32 v84, 0xffff0000, v74
    v_and_b32 v85, 0xffff0000, v42
    v_mul_f32 v84, v84, v45
    v_cvt_pk_bf16_f32 v84, v84, v84
    v_lshlrev_b32 v84, 16, v84
    v_add_f32 v69, v84, v85
    v_lshlrev_b32 v84, 16, v75
    v_lshlrev_b32 v85, 16, v43
    v_mul_f32 v84, v84, v46
    v_cvt_pk_bf16_f32 v84, v84, v84
    v_lshlrev_b32 v84, 16, v84
    v_add_f32 v70, v84, v85
    v_and_b32 v84, 0xffff0000, v75
    v_and_b32 v85, 0xffff0000, v43
    v_mul_f32 v84, v84, v47
    v_cvt_pk_bf16_f32 v84, v84, v84
    v_lshlrev_b32 v84, 16, v84
    v_add_f32 v71, v84, v85
    v_cvt_pk_bf16_f32 v94, v68, v69
    v_cvt_pk_bf16_f32 v95, v70, v71
    buffer_store_dwordx2 v[94:95], v24, s[92:95], s76 offen offset:256
FN_B_S:
K34_END:
    s_endpgm
CODE_END:
    s_endpgm
.section .rodata,"a"
.p2align 6
.amdhsa_kernel k1_kernel
  .amdhsa_next_free_vgpr 128
  .amdhsa_next_free_sgpr 102
  .amdhsa_accum_offset 128
  .amdhsa_group_segment_fixed_size 0
  .amdhsa_kernarg_size 120
  .amdhsa_user_sgpr_count 2
  .amdhsa_user_sgpr_kernarg_segment_ptr 1
  .amdhsa_system_sgpr_workgroup_id_x 1
.end_amdhsa_kernel
.p2align 6
.amdhsa_kernel k34_kernel
  .amdhsa_next_free_vgpr 240
  .amdhsa_next_free_sgpr 102
  .amdhsa_accum_offset 240
  .amdhsa_group_segment_fixed_size 0
  .amdhsa_kernarg_size 120
  .amdhsa_user_sgpr_count 2
  .amdhsa_user_sgpr_kernarg_segment_ptr 1
  .amdhsa_system_sgpr_workgroup_id_x 1
.end_amdhsa_kernel
```
